```python
import torch

def _softmax(x, axis=-1):
    return torch.softmax(x, dim=axis)
def _gelu(x):
    return torch.nn.functional.gelu(x, approximate="tanh")
def _silu(x):
    return torch.nn.functional.silu(x)
def _sigmoid(x):
    return torch.sigmoid(x)
def _layernorm(x, axis=-1, eps=1e-5):
    m = x.mean(dim=axis, keepdim=True)
    v = x.var(dim=axis, keepdim=True, unbiased=False)
    return (x - m) / torch.sqrt(v + eps)
def _scatter_add(tgt, idx, src, axis=0):
    return tgt.clone().index_add_(axis, idx, src)
def _segment_sum(src, seg, n):
    out = torch.zeros((n,) + src.shape[1:], dtype=src.dtype)
    return out.index_add_(0, seg, src)
def _pad(x, pw):
    flat = tuple(v for pair in reversed(pw) for v in pair)
    return torch.nn.functional.pad(x, flat)

kernel_name = 'interleave_layers__mha_block__glu_gated_bilinear__prompt'

def setup_inputs():

    _w = (lambda a: (lambda t: t.to(torch.bfloat16) if t.is_floating_point() else t)(torch.as_tensor(a)))
    def _A_setup():
        B, S, D, H = 1, 2048, 512, 32
        return {
            "x": _w((lambda *s: torch.randn(*s, dtype=torch.bfloat16) * 0.05)(B, S, D)),
            "wqkv": _w((lambda *s: torch.randn(*s, dtype=torch.bfloat16) * 0.05)(D, 3 * D)),
            "wo": _w((lambda *s: torch.randn(*s, dtype=torch.bfloat16) * 0.05)(D, D)),
        }
    _A_in = _A_setup()

    def _B_setup():
        B, S, D, F = 1, 2048, 512, 1376
        return {
            "x": _w((lambda *s: torch.randn(*s, dtype=torch.bfloat16) * 0.05)(B, S, D)),
            "w_gate": _w((lambda *s: torch.randn(*s, dtype=torch.bfloat16) * 0.4)(D, F) * (D ** -0.5)),
            "w_up": _w((lambda *s: torch.randn(*s, dtype=torch.bfloat16) * 0.4)(D, F) * (D ** -0.5)),
            "w_down": _w((lambda *s: torch.randn(*s, dtype=torch.bfloat16) * 0.4)(F, D) * (F ** -0.5)),
        }
    _B_in = _B_setup()

    return {
        "A_x": _A_in["x"],
        "A_wqkv": _A_in["wqkv"],
        "A_wo": _A_in["wo"],
        "B_x": _B_in["x"],
        "B_w_gate": _B_in["w_gate"],
        "B_w_up": _B_in["w_up"],
        "B_w_down": _B_in["w_down"],
    }

def reference(A_x, A_wqkv, A_wo, B_x, B_w_gate, B_w_up, B_w_down):
    def _A_ref(x, wqkv, wo):
        B, S, D = x.shape
        H = 32
        Dh = D // H
        qkv = (lambda x, *d: x.permute(*d))((x @ wqkv).reshape(B, S, 3, H, Dh), 2, 0, 3, 1, 4)
        q, k, v = qkv[0], qkv[1], qkv[2]
        scores = torch.einsum("bhqd,bhkd->bhqk", q, k) * (Dh ** -0.5)
        p = _softmax(scores, axis=-1)
        o = torch.einsum("bhqk,bhkd->bhqd", p, v)
        return (lambda x, *d: x.permute(*d))(o, 0, 2, 1, 3).reshape(B, S, D) @ wo

    def _B_ref(x, w_gate, w_up, w_down):
        g = torch.einsum("bsd,df->bsf", x, w_gate)
        u = torch.einsum("bsd,df->bsf", x, w_up)
        h = g * u
        return torch.einsum("bsf,fd->bsd", h, w_down)

    x = A_x
    x = x + _A_ref(_layernorm(x, axis=-1), A_wqkv, A_wo)
    x = x + _B_ref(_layernorm(x, axis=-1), B_w_gate, B_w_up, B_w_down)
    x = x + _A_ref(_layernorm(x, axis=-1), A_wqkv, A_wo)
    x = x + _B_ref(_layernorm(x, axis=-1), B_w_gate, B_w_up, B_w_down)
    return x
```

```asm
; @launch grid=(256,1,1) block=(256,1,1) lds=163840
.amdgcn_target "amdgcn-amd-amdhsa--gfx950"
.text
.globl interleave_layers__mha_block__glu_gated_bilinear__prompt_kernel
.p2align 8
.type interleave_layers__mha_block__glu_gated_bilinear__prompt_kernel,@function
interleave_layers__mha_block__glu_gated_bilinear__prompt_kernel:
  s_cmp_ge_u32 s2, 256
  s_cbranch_scc1 L_end
  s_load_dwordx16 s[16:31], s[0:1], 0
  s_getpc_b64 s[12:13]
  v_lshlrev_b32 v4, 6, v0
  global_load_dword a64, v4, s[12:13]
  s_load_dwordx4 s[32:35], s[0:1], 64
  v_lshrrev_b32 v3, 6, v0
  v_and_b32 v1, 63, v0
  v_lshlrev_b32 v2, 4, v1
  v_readfirstlane_b32 s3, v3
  v_lshlrev_b32 v247, 2, v1
  v_lshlrev_b32 v234, 7, v1
  v_mov_b32 v233, 0
  v_mov_b32 v232, 0
  v_mov_b32 v231, 0
  s_getreg_b32 s11, hwreg(HW_REG_XCC_ID, 0, 3)
  s_and_b32 s9, s2, 7
  s_lshr_b32 s10, s2, 3
  s_mov_b32 s68, 0
  s_mov_b32 s69, 0
  s_waitcnt lgkmcnt(0)
  s_mov_b32 s60, s16
  s_and_b32 s61, s17, 0xffff
  s_mov_b32 s62, 0x200000
  s_mov_b32 s63, 0x20000
  s_and_b32 s70, s9, 3
  s_lshl_b32 s70, s70, 2
  s_and_b32 s73, s10, 3
  s_add_u32 s70, s70, s73
  s_lshr_b32 s71, s9, 2
  s_lshl_b32 s71, s71, 3
  s_lshr_b32 s73, s10, 2
  s_add_u32 s71, s71, s73
  s_lshl_b32 s72, s70, 2
  s_add_u32 s72, s72, s3
  v_lshrrev_b32 v244, 2, v1
  v_mul_u32_u24 v244, 3072, v244
  v_and_b32 v4, 3, v1
  v_lshl_add_u32 v244, v4, 4, v244
  v_lshrrev_b32 v4, 4, v1
  v_and_b32 v7, 15, v1
  v_xor_b32 v7, v7, v4
  v_lshlrev_b32 v7, 4, v7
  v_lshl_add_u32 v7, v4, 10, v7
  s_lshl_b32 s79, s3, 15
  s_add_u32 s79, s79, 32768
  v_lshrrev_b32 v4, 5, v1
  v_and_b32 v8, 15, v1
  v_xor_b32 v8, v8, v4
  v_lshlrev_b32 v8, 4, v8
  v_and_b32 v4, 31, v1
  v_lshl_add_u32 v8, v4, 8, v8
  v_add_u32 v8, s79, v8
  s_lshl_b32 s73, s72, 15
  s_add_u32 s73, s73, 0
  s_add_u32 m0, s79, 0
  v_xor_b32 v10, 0, v7
  buffer_load_dwordx4 v10, s[60:63], s73 offen lds
  s_add_u32 s73, s73, 4096
  s_add_u32 m0, s79, 1024
  v_xor_b32 v11, 64, v7
  buffer_load_dwordx4 v11, s[60:63], s73 offen lds
  s_add_u32 s73, s73, 4096
  s_add_u32 m0, s79, 2048
  v_xor_b32 v10, 128, v7
  buffer_load_dwordx4 v10, s[60:63], s73 offen lds
  s_add_u32 s73, s73, 4096
  s_add_u32 m0, s79, 3072
  v_xor_b32 v11, 192, v7
  buffer_load_dwordx4 v11, s[60:63], s73 offen lds
  s_add_u32 s73, s73, 4096
  s_add_u32 m0, s79, 4096
  v_xor_b32 v10, 0, v7
  buffer_load_dwordx4 v10, s[60:63], s73 offen lds
  s_add_u32 s73, s73, 4096
  s_add_u32 m0, s79, 5120
  v_xor_b32 v11, 64, v7
  buffer_load_dwordx4 v11, s[60:63], s73 offen lds
  s_add_u32 s73, s73, 4096
  s_add_u32 m0, s79, 6144
  v_xor_b32 v10, 128, v7
  buffer_load_dwordx4 v10, s[60:63], s73 offen lds
  s_add_u32 s73, s73, 4096
  s_add_u32 m0, s79, 7168
  v_xor_b32 v11, 192, v7
  buffer_load_dwordx4 v11, s[60:63], s73 offen lds
  s_add_u32 s73, s73, 4096
  s_mov_b32 s40, s18
  s_and_b32 s41, s19, 0xffff
  s_mov_b32 s42, 0x180000
  s_mov_b32 s43, 0x20000
  s_mov_b32 s36, s34
  s_and_b32 s37, s35, 0xffff
  s_mov_b32 s38, 0x1b00000
  s_mov_b32 s39, 0x20000
  s_mov_b32 s4, s32
  s_and_b32 s5, s33, 0xffff
  s_mov_b32 s6, 0x100
  s_mov_b32 s7, 0x20000
  s_mov_b32 s44, s20
  s_and_b32 s45, s21, 0xffff
  s_mov_b32 s46, 0x80000
  s_mov_b32 s47, 0x20000
  s_mov_b32 s48, s24
  s_and_b32 s49, s25, 0xffff
  s_mov_b32 s50, 0x158000
  s_mov_b32 s51, 0x20000
  s_mov_b32 s52, s26
  s_and_b32 s53, s27, 0xffff
  s_mov_b32 s54, 0x158000
  s_mov_b32 s55, 0x20000
  s_mov_b32 s56, s28
  s_and_b32 s57, s29, 0xffff
  s_mov_b32 s58, 0x158000
  s_mov_b32 s59, 0x20000
  s_mov_b32 s64, s30
  s_and_b32 s65, s31, 0xffff
  s_mov_b32 s66, 0x200000
  s_mov_b32 s67, 0x20000
  s_lshl_b32 s73, s72, 15
  s_add_u32 s73, s73, 256
  s_add_u32 m0, s79, 8192
  v_xor_b32 v10, 0, v7
  buffer_load_dwordx4 v10, s[60:63], s73 offen lds
  s_add_u32 s73, s73, 4096
  s_add_u32 m0, s79, 9216
  v_xor_b32 v11, 64, v7
  buffer_load_dwordx4 v11, s[60:63], s73 offen lds
  s_add_u32 s73, s73, 4096
  s_add_u32 m0, s79, 10240
  v_xor_b32 v10, 128, v7
  buffer_load_dwordx4 v10, s[60:63], s73 offen lds
  s_add_u32 s73, s73, 4096
  s_add_u32 m0, s79, 11264
  v_xor_b32 v11, 192, v7
  buffer_load_dwordx4 v11, s[60:63], s73 offen lds
  s_add_u32 s73, s73, 4096
  s_add_u32 m0, s79, 12288
  v_xor_b32 v10, 0, v7
  buffer_load_dwordx4 v10, s[60:63], s73 offen lds
  s_add_u32 s73, s73, 4096
  s_add_u32 m0, s79, 13312
  v_xor_b32 v11, 64, v7
  buffer_load_dwordx4 v11, s[60:63], s73 offen lds
  s_add_u32 s73, s73, 4096
  s_add_u32 m0, s79, 14336
  v_xor_b32 v10, 128, v7
  buffer_load_dwordx4 v10, s[60:63], s73 offen lds
  s_add_u32 s73, s73, 4096
  s_add_u32 m0, s79, 15360
  v_xor_b32 v11, 192, v7
  buffer_load_dwordx4 v11, s[60:63], s73 offen lds
  s_add_u32 s73, s73, 4096
  s_getpc_b64 s[12:13]
  s_lshl_b32 s73, s10, 2
  s_add_u32 s73, s73, s3
  s_and_b32 s73, s73, 31
  s_lshl_b32 s73, s73, 11
  v_add_u32 v4, s73, v234
  s_mov_b64 exec, 0xffff
  global_load_dword a65, v4, s[12:13]
  s_mov_b64 exec, -1
  s_cmp_lg_u32 s3, 0
  s_cbranch_scc1 q0_nz
  v_lshlrev_b32 v4, 12, v1
  v_mov_b32 v24, 0
  v_mov_b32 v25, 0
  v_mov_b32 v26, 0
  v_mov_b32 v27, 0
  s_lshl_b32 s84, s2, 4
  s_add_u32 s84, s84, 0x4f0000
  s_mov_b64 exec, 0xffff
  buffer_store_dwordx4 v[24:27], v4, s[36:39], s84 offen sc0 sc1
  s_mov_b64 exec, -1
q0_nz:
  v_lshrrev_b32 v246, 5, v1
  v_lshlrev_b32 v246, 8, v246
  v_bfe_u32 v4, v1, 2, 2
  v_lshl_add_u32 v246, v4, 6, v246
  v_bfe_u32 v4, v1, 4, 1
  v_lshl_add_u32 v246, v4, 5, v246
  v_and_b32 v4, 3, v1
  v_lshl_add_u32 v246, v4, 3, v246
  v_lshrrev_b32 v245, 5, v1
  v_lshlrev_b32 v245, 9, v245
  v_bfe_u32 v4, v1, 2, 2
  v_lshl_add_u32 v245, v4, 7, v245
  v_bfe_u32 v4, v1, 3, 1
  v_lshl_add_u32 v245, v4, 6, v245
  v_bfe_u32 v4, v1, 4, 1
  v_lshl_add_u32 v245, v4, 5, v245
  v_and_b32 v4, 3, v1
  v_lshl_add_u32 v245, v4, 3, v245
  v_lshrrev_b32 v243, 3, v1
  v_lshlrev_b32 v243, 10, v243
  v_bfe_u32 v4, v1, 4, 1
  v_lshlrev_b32 v4, 2, v4
  v_and_b32 v5, 7, v1
  v_xor_b32 v4, v4, v5
  v_lshl_add_u32 v243, v4, 4, v243
  v_lshrrev_b32 v242, 2, v1
  v_mul_u32_u24 v242, 2752, v242
  v_and_b32 v4, 3, v1
  v_xor_b32 v5, 2, v4
  v_lshl_add_u32 v241, v5, 4, v242
  v_lshl_add_u32 v242, v4, 4, v242
  v_and_b32 v240, 0x33, v1
  v_bfe_u32 v4, v1, 2, 1
  v_lshl_or_b32 v240, v4, 3, v240
  v_bfe_u32 v4, v1, 3, 1
  v_lshl_or_b32 v240, v4, 2, v240
  v_lshlrev_b32 v240, 4, v240
  v_and_b32 v239, 15, v1
  v_lshlrev_b32 v239, 4, v239
  v_bfe_u32 v4, v1, 4, 1
  v_lshl_or_b32 v239, v4, 17, v239
  v_bfe_u32 v4, v1, 5, 1
  v_lshl_or_b32 v239, v4, 8, v239
  v_or_b32 v239, 1024, v239
  v_mov_b32 v229, 1
  v_and_b32 v228, 0x1ff, v2
  v_min_u32 v227, 224, v2
  v_lshlrev_b32 v225, 3, v1
  v_and_b32 v225, 0x78, v225
  v_and_b32 v226, 28, v247
  v_and_b32 v237, 31, v1
  v_lshlrev_b32 v237, 10, v237
  v_lshrrev_b32 v4, 5, v1
  v_lshl_add_u32 v237, v4, 3, v237
  s_cmp_lt_u32 s2, 172
  s_cselect_b32 s84, 2, 0
  s_cmp_lt_u32 s3, s84
  s_cbranch_scc1 rfgu_1
  s_lshl_b32 s87, s2, 1
  s_add_u32 s87, s87, s3
  s_sub_u32 s87, s87, 2
  s_lshl_b32 s85, s2, 2
  s_add_u32 s85, s85, s3
  s_sub_u32 s85, s85, 344
  s_mul_i32 s34, s3, 6144
  s_add_u32 s86, s34, 4096
  s_cmp_lt_u32 s2, 172
  s_cselect_b32 s87, s87, s85
  s_cselect_b32 s34, s86, s34
  s_mov_b32 s33, 0
  s_mov_b32 s35, 0
  s_lshl_b32 s84, s87, 1
  s_mul_i32 s16, s84, 683
  s_lshr_b32 s16, s16, 16
  s_mul_i32 s85, s16, 96
  s_sub_u32 s85, s84, s85
  s_mul_i32 s86, s85, 171
  s_lshr_b32 s86, s86, 9
  s_mul_i32 s88, s86, 3
  s_sub_u32 s85, s85, s88
  s_lshl_b32 s16, s16, 6
  s_lshl_b32 s85, s85, 10
  s_add_u32 s16, s16, s85
  s_mul_i32 s86, s86, 49152
  s_add_u32 s16, s16, s86
  s_add_u32 s84, s84, 1
  s_mul_i32 s17, s84, 683
  s_lshr_b32 s17, s17, 16
  s_mul_i32 s85, s17, 96
  s_sub_u32 s85, s84, s85
  s_mul_i32 s86, s85, 171
  s_lshr_b32 s86, s86, 9
  s_mul_i32 s88, s86, 3
  s_sub_u32 s85, s85, s88
  s_lshl_b32 s17, s17, 6
  s_lshl_b32 s85, s85, 10
  s_add_u32 s17, s17, s85
  s_mul_i32 s86, s86, 49152
  s_add_u32 s17, s17, s86
  s_lshl_b32 s30, s87, 11
  s_cmp_ge_u32 s87, 88
  s_cbranch_scc1 rf1d_3
  s_add_u32 s84, s87, 680
  s_lshl_b32 s31, s84, 11
  s_lshl_b32 s84, s84, 1
  s_mul_i32 s18, s84, 683
  s_lshr_b32 s18, s18, 16
  s_mul_i32 s85, s18, 96
  s_sub_u32 s85, s84, s85
  s_mul_i32 s86, s85, 171
  s_lshr_b32 s86, s86, 9
  s_mul_i32 s88, s86, 3
  s_sub_u32 s85, s85, s88
  s_lshl_b32 s18, s18, 6
  s_lshl_b32 s85, s85, 10
  s_add_u32 s18, s18, s85
  s_mul_i32 s86, s86, 49152
  s_add_u32 s18, s18, s86
  s_add_u32 s84, s84, 1
  s_mul_i32 s19, s84, 683
  s_lshr_b32 s19, s19, 16
  s_mul_i32 s85, s19, 96
  s_sub_u32 s85, s84, s85
  s_mul_i32 s86, s85, 171
  s_lshr_b32 s86, s86, 9
  s_mul_i32 s88, s86, 3
  s_sub_u32 s85, s85, s88
  s_lshl_b32 s19, s19, 6
  s_lshl_b32 s85, s85, 10
  s_add_u32 s19, s19, s85
  s_mul_i32 s86, s86, 49152
  s_add_u32 s19, s19, s86
  s_branch rf1e_4
rf1d_3:
  s_sub_u32 s84, s87, 88
  s_mul_i32 s18, s84, 3049
  s_lshr_b32 s18, s18, 18
  s_mul_i32 s85, s18, 86
  s_sub_u32 s85, s84, s85
  s_lshl_b32 s85, s85, 14
  s_lshl_b32 s18, s18, 7
  s_add_u32 s18, s18, s85
  s_add_u32 s19, s18, 8192
  s_lshl_b32 s31, s84, 11
  s_add_u32 s31, s31, 0x1800000
  s_mov_b32 s35, 2
rf1e_4:
  s_cmp_ge_u32 s87, 96
  s_cbranch_scc1 rf2o_5
  s_add_u32 s84, s87, 592
  s_mul_i32 s22, s84, 3049
  s_lshr_b32 s22, s22, 18
  s_mul_i32 s85, s22, 86
  s_sub_u32 s85, s84, s85
  s_lshl_b32 s85, s85, 14
  s_lshl_b32 s22, s22, 7
  s_add_u32 s22, s22, s85
  s_add_u32 s23, s22, 8192
  s_lshl_b32 s32, s84, 11
  s_add_u32 s32, s32, 0x1800000
  s_branch rf2e_6
rf2o_5:
  s_sub_u32 s84, s87, 96
  s_lshr_b32 s22, s84, 5
  s_lshl_b32 s22, s22, 7
  s_and_b32 s85, s84, 31
  s_lshl_b32 s85, s85, 14
  s_add_u32 s22, s22, s85
  s_add_u32 s23, s22, 8192
  s_lshl_b32 s32, s84, 11
  s_add_u32 s32, s32, 0x1980000
  s_or_b32 s35, s35, 4
  s_cmp_ge_u32 s87, 352
  s_cselect_b32 s22, 0xf0000000, s22
  s_cselect_b32 s23, 0xf0000000, s23
  s_cselect_b32 s32, 0xf0000000, s32
rf2e_6:
  s_branch rfdone_2
rfgu_1:
  s_lshl_b32 s87, s2, 1
  s_add_u32 s87, s87, s3
  s_lshr_b32 s84, s87, 3
  s_and_b32 s85, s87, 7
  s_mul_i32 s16, s85, 176128
  s_lshl_b32 s86, s84, 6
  s_add_u32 s16, s16, s86
  s_lshl_b32 s30, s87, 13
  s_add_u32 s30, s30, 0x200000
  s_lshl_b32 s33, s84, 11
  s_add_u32 s33, s33, 0x4d0000
  s_lshr_b32 s86, s85, 2
  s_lshl_b32 s86, s86, 9
  s_add_u32 s33, s33, s86
  s_and_b32 s86, s85, 3
  s_lshl_b32 s86, s86, 2
  s_add_u32 s33, s33, s86
  s_lshl_b32 s34, s3, 13
rfdone_2:
  s_add_u32 s34, s34, 135168
  v_lshrrev_b32 v4, 5, v1
  v_lshl_add_u32 v5, v4, 8, v246
  v_add_u32 v6, 49152, v5
  v_mov_b32 v9, 0x3f803f80
  v_mov_b32 v16, 0
  v_mov_b32 v17, 0
  v_mov_b32 v20, 0x3f803f80
  v_mov_b32 v21, 0x3f803f80
  v_mov_b32 v22, 0x3f803f80
  v_mov_b32 v23, 0x3f803f80
  v_accvgpr_write_b32 a0, 0
  v_accvgpr_write_b32 a1, 0
  v_accvgpr_write_b32 a2, 0
  v_accvgpr_write_b32 a3, 0
  v_accvgpr_write_b32 a4, 0
  v_accvgpr_write_b32 a5, 0
  v_accvgpr_write_b32 a6, 0
  v_accvgpr_write_b32 a7, 0
  v_accvgpr_write_b32 a8, 0
  v_accvgpr_write_b32 a9, 0
  v_accvgpr_write_b32 a10, 0
  v_accvgpr_write_b32 a11, 0
  v_accvgpr_write_b32 a12, 0
  v_accvgpr_write_b32 a13, 0
  v_accvgpr_write_b32 a14, 0
  v_accvgpr_write_b32 a15, 0
  v_accvgpr_write_b32 a16, 0
  v_accvgpr_write_b32 a17, 0
  v_accvgpr_write_b32 a18, 0
  v_accvgpr_write_b32 a19, 0
  v_accvgpr_write_b32 a20, 0
  v_accvgpr_write_b32 a21, 0
  v_accvgpr_write_b32 a22, 0
  v_accvgpr_write_b32 a23, 0
  v_accvgpr_write_b32 a24, 0
  v_accvgpr_write_b32 a25, 0
  v_accvgpr_write_b32 a26, 0
  v_accvgpr_write_b32 a27, 0
  v_accvgpr_write_b32 a28, 0
  v_accvgpr_write_b32 a29, 0
  v_accvgpr_write_b32 a30, 0
  v_accvgpr_write_b32 a31, 0
  v_accvgpr_write_b32 a32, 0
  v_accvgpr_write_b32 a33, 0
  v_accvgpr_write_b32 a34, 0
  v_accvgpr_write_b32 a35, 0
  v_accvgpr_write_b32 a36, 0
  v_accvgpr_write_b32 a37, 0
  v_accvgpr_write_b32 a38, 0
  v_accvgpr_write_b32 a39, 0
  v_accvgpr_write_b32 a40, 0
  v_accvgpr_write_b32 a41, 0
  v_accvgpr_write_b32 a42, 0
  v_accvgpr_write_b32 a43, 0
  v_accvgpr_write_b32 a44, 0
  v_accvgpr_write_b32 a45, 0
  v_accvgpr_write_b32 a46, 0
  v_accvgpr_write_b32 a47, 0
  s_lshl_b32 s73, s72, 15
  s_add_u32 s73, s73, 512
  s_add_u32 m0, s79, 16384
  v_xor_b32 v10, 0, v7
  buffer_load_dwordx4 v10, s[60:63], s73 offen lds
  s_add_u32 s73, s73, 4096
  s_add_u32 m0, s79, 17408
  v_xor_b32 v11, 64, v7
  buffer_load_dwordx4 v11, s[60:63], s73 offen lds
  s_add_u32 s73, s73, 4096
  s_add_u32 m0, s79, 18432
  v_xor_b32 v10, 128, v7
  buffer_load_dwordx4 v10, s[60:63], s73 offen lds
  s_add_u32 s73, s73, 4096
  s_add_u32 m0, s79, 19456
  v_xor_b32 v11, 192, v7
  buffer_load_dwordx4 v11, s[60:63], s73 offen lds
  s_add_u32 s73, s73, 4096
  s_add_u32 m0, s79, 20480
  v_xor_b32 v10, 0, v7
  buffer_load_dwordx4 v10, s[60:63], s73 offen lds
  s_add_u32 s73, s73, 4096
  s_add_u32 m0, s79, 21504
  v_xor_b32 v11, 64, v7
  buffer_load_dwordx4 v11, s[60:63], s73 offen lds
  s_add_u32 s73, s73, 4096
  s_add_u32 m0, s79, 22528
  v_xor_b32 v10, 128, v7
  buffer_load_dwordx4 v10, s[60:63], s73 offen lds
  s_add_u32 s73, s73, 4096
  s_add_u32 m0, s79, 23552
  v_xor_b32 v11, 192, v7
  buffer_load_dwordx4 v11, s[60:63], s73 offen lds
  s_add_u32 s73, s73, 4096
  s_lshl_b32 s73, s72, 15
  s_add_u32 s73, s73, 768
  s_add_u32 m0, s79, 24576
  v_xor_b32 v10, 0, v7
  buffer_load_dwordx4 v10, s[60:63], s73 offen lds
  s_add_u32 s73, s73, 4096
  s_add_u32 m0, s79, 25600
  v_xor_b32 v11, 64, v7
  buffer_load_dwordx4 v11, s[60:63], s73 offen lds
  s_add_u32 s73, s73, 4096
  s_add_u32 m0, s79, 26624
  v_xor_b32 v10, 128, v7
  buffer_load_dwordx4 v10, s[60:63], s73 offen lds
  s_add_u32 s73, s73, 4096
  s_add_u32 m0, s79, 27648
  v_xor_b32 v11, 192, v7
  buffer_load_dwordx4 v11, s[60:63], s73 offen lds
  s_add_u32 s73, s73, 4096
  s_add_u32 m0, s79, 28672
  v_xor_b32 v10, 0, v7
  buffer_load_dwordx4 v10, s[60:63], s73 offen lds
  s_add_u32 s73, s73, 4096
  s_add_u32 m0, s79, 29696
  v_xor_b32 v11, 64, v7
  buffer_load_dwordx4 v11, s[60:63], s73 offen lds
  s_add_u32 s73, s73, 4096
  s_add_u32 m0, s79, 30720
  v_xor_b32 v10, 128, v7
  buffer_load_dwordx4 v10, s[60:63], s73 offen lds
  s_add_u32 s73, s73, 4096
  s_add_u32 m0, s79, 31744
  v_xor_b32 v11, 192, v7
  buffer_load_dwordx4 v11, s[60:63], s73 offen lds
  s_add_u32 s73, s73, 4096
  v_mul_u32_u24 v4, 43, v1
  v_lshrrev_b32 v4, 9, v4
  v_mul_u32_u24 v3, 12, v4
  v_sub_u32 v3, v1, v3
  v_mul_u32_u24 v4, 3072, v4
  v_lshrrev_b32 v12, 2, v3
  v_lshl_add_u32 v4, v12, 10, v4
  v_and_b32 v3, 3, v3
  v_lshl_add_u32 v4, v3, 7, v4
  s_lshl_b32 s73, s10, 2
  s_add_u32 s73, s73, s3
  s_mul_i32 s73, s73, 12288
  s_lshr_b32 s74, s9, 2
  s_lshl_b32 s74, s74, 9
  s_add_u32 s73, s73, s74
  s_mov_b32 exec_hi, 0xffff
  buffer_load_dword a64, v4, s[40:43], s73 offen
  s_mov_b32 exec_hi, -1
  s_waitcnt vmcnt(26)
  v_xor_b32 v10, 0, v8
  ds_read_b128 v[96:99], v10 offset:0
  v_xor_b32 v11, 32, v8
  ds_read_b128 v[100:103], v11 offset:0
  v_xor_b32 v10, 64, v8
  ds_read_b128 v[104:107], v10 offset:0
  v_xor_b32 v11, 96, v8
  ds_read_b128 v[108:111], v11 offset:0
  v_xor_b32 v10, 128, v8
  ds_read_b128 v[112:115], v10 offset:0
  v_xor_b32 v11, 160, v8
  ds_read_b128 v[116:119], v11 offset:0
  v_xor_b32 v10, 192, v8
  ds_read_b128 v[120:123], v10 offset:0
  v_xor_b32 v11, 224, v8
  ds_read_b128 v[124:127], v11 offset:0
  s_waitcnt lgkmcnt(0)
  v_dot2c_f32_bf16 v16, v96, v9
  v_dot2c_f32_bf16 v17, v96, v96
  v_dot2c_f32_bf16 v16, v97, v9
  v_dot2c_f32_bf16 v17, v97, v97
  v_dot2c_f32_bf16 v16, v98, v9
  v_dot2c_f32_bf16 v17, v98, v98
  v_dot2c_f32_bf16 v16, v99, v9
  v_dot2c_f32_bf16 v17, v99, v99
  v_dot2c_f32_bf16 v16, v100, v9
  v_dot2c_f32_bf16 v17, v100, v100
  v_dot2c_f32_bf16 v16, v101, v9
  v_dot2c_f32_bf16 v17, v101, v101
  v_dot2c_f32_bf16 v16, v102, v9
  v_dot2c_f32_bf16 v17, v102, v102
  v_dot2c_f32_bf16 v16, v103, v9
  v_dot2c_f32_bf16 v17, v103, v103
  v_dot2c_f32_bf16 v16, v104, v9
  v_dot2c_f32_bf16 v17, v104, v104
  v_dot2c_f32_bf16 v16, v105, v9
  v_dot2c_f32_bf16 v17, v105, v105
  v_dot2c_f32_bf16 v16, v106, v9
  v_dot2c_f32_bf16 v17, v106, v106
  v_dot2c_f32_bf16 v16, v107, v9
  v_dot2c_f32_bf16 v17, v107, v107
  v_dot2c_f32_bf16 v16, v108, v9
  v_dot2c_f32_bf16 v17, v108, v108
  v_dot2c_f32_bf16 v16, v109, v9
  v_dot2c_f32_bf16 v17, v109, v109
  v_dot2c_f32_bf16 v16, v110, v9
  v_dot2c_f32_bf16 v17, v110, v110
  v_dot2c_f32_bf16 v16, v111, v9
  v_dot2c_f32_bf16 v17, v111, v111
  v_dot2c_f32_bf16 v16, v112, v9
  v_dot2c_f32_bf16 v17, v112, v112
  v_dot2c_f32_bf16 v16, v113, v9
  v_dot2c_f32_bf16 v17, v113, v113
  v_dot2c_f32_bf16 v16, v114, v9
  v_dot2c_f32_bf16 v17, v114, v114
  v_dot2c_f32_bf16 v16, v115, v9
  v_dot2c_f32_bf16 v17, v115, v115
  v_dot2c_f32_bf16 v16, v116, v9
  v_dot2c_f32_bf16 v17, v116, v116
  v_dot2c_f32_bf16 v16, v117, v9
  v_dot2c_f32_bf16 v17, v117, v117
  v_dot2c_f32_bf16 v16, v118, v9
  v_dot2c_f32_bf16 v17, v118, v118
  v_dot2c_f32_bf16 v16, v119, v9
  v_dot2c_f32_bf16 v17, v119, v119
  v_dot2c_f32_bf16 v16, v120, v9
  v_dot2c_f32_bf16 v17, v120, v120
  v_dot2c_f32_bf16 v16, v121, v9
  v_dot2c_f32_bf16 v17, v121, v121
  v_dot2c_f32_bf16 v16, v122, v9
  v_dot2c_f32_bf16 v17, v122, v122
  v_dot2c_f32_bf16 v16, v123, v9
  v_dot2c_f32_bf16 v17, v123, v123
  v_dot2c_f32_bf16 v16, v124, v9
  v_dot2c_f32_bf16 v17, v124, v124
  v_dot2c_f32_bf16 v16, v125, v9
  v_dot2c_f32_bf16 v17, v125, v125
  v_dot2c_f32_bf16 v16, v126, v9
  v_dot2c_f32_bf16 v17, v126, v126
  v_dot2c_f32_bf16 v16, v127, v9
  v_dot2c_f32_bf16 v17, v127, v127
  s_waitcnt vmcnt(18)
  v_xor_b32 v10, 0, v8
  ds_read_b128 v[128:131], v10 offset:8192
  v_xor_b32 v11, 32, v8
  ds_read_b128 v[132:135], v11 offset:8192
  v_xor_b32 v10, 64, v8
  ds_read_b128 v[136:139], v10 offset:8192
  v_xor_b32 v11, 96, v8
  ds_read_b128 v[140:143], v11 offset:8192
  v_xor_b32 v10, 128, v8
  ds_read_b128 v[144:147], v10 offset:8192
  v_xor_b32 v11, 160, v8
  ds_read_b128 v[148:151], v11 offset:8192
  v_xor_b32 v10, 192, v8
  ds_read_b128 v[152:155], v10 offset:8192
  v_xor_b32 v11, 224, v8
  ds_read_b128 v[156:159], v11 offset:8192
  s_waitcnt lgkmcnt(0)
  v_dot2c_f32_bf16 v16, v128, v9
  v_dot2c_f32_bf16 v17, v128, v128
  v_dot2c_f32_bf16 v16, v129, v9
  v_dot2c_f32_bf16 v17, v129, v129
  v_dot2c_f32_bf16 v16, v130, v9
  v_dot2c_f32_bf16 v17, v130, v130
  v_dot2c_f32_bf16 v16, v131, v9
  v_dot2c_f32_bf16 v17, v131, v131
  v_dot2c_f32_bf16 v16, v132, v9
  v_dot2c_f32_bf16 v17, v132, v132
  v_dot2c_f32_bf16 v16, v133, v9
  v_dot2c_f32_bf16 v17, v133, v133
  v_dot2c_f32_bf16 v16, v134, v9
  v_dot2c_f32_bf16 v17, v134, v134
  v_dot2c_f32_bf16 v16, v135, v9
  v_dot2c_f32_bf16 v17, v135, v135
  v_dot2c_f32_bf16 v16, v136, v9
  v_dot2c_f32_bf16 v17, v136, v136
  v_dot2c_f32_bf16 v16, v137, v9
  v_dot2c_f32_bf16 v17, v137, v137
  v_dot2c_f32_bf16 v16, v138, v9
  v_dot2c_f32_bf16 v17, v138, v138
  v_dot2c_f32_bf16 v16, v139, v9
  v_dot2c_f32_bf16 v17, v139, v139
  v_dot2c_f32_bf16 v16, v140, v9
  v_dot2c_f32_bf16 v17, v140, v140
  v_dot2c_f32_bf16 v16, v141, v9
  v_dot2c_f32_bf16 v17, v141, v141
  v_dot2c_f32_bf16 v16, v142, v9
  v_dot2c_f32_bf16 v17, v142, v142
  v_dot2c_f32_bf16 v16, v143, v9
  v_dot2c_f32_bf16 v17, v143, v143
  v_dot2c_f32_bf16 v16, v144, v9
  v_dot2c_f32_bf16 v17, v144, v144
  v_dot2c_f32_bf16 v16, v145, v9
  v_dot2c_f32_bf16 v17, v145, v145
  v_dot2c_f32_bf16 v16, v146, v9
  v_dot2c_f32_bf16 v17, v146, v146
  v_dot2c_f32_bf16 v16, v147, v9
  v_dot2c_f32_bf16 v17, v147, v147
  v_dot2c_f32_bf16 v16, v148, v9
  v_dot2c_f32_bf16 v17, v148, v148
  v_dot2c_f32_bf16 v16, v149, v9
  v_dot2c_f32_bf16 v17, v149, v149
  v_dot2c_f32_bf16 v16, v150, v9
  v_dot2c_f32_bf16 v17, v150, v150
  v_dot2c_f32_bf16 v16, v151, v9
  v_dot2c_f32_bf16 v17, v151, v151
  v_dot2c_f32_bf16 v16, v152, v9
  v_dot2c_f32_bf16 v17, v152, v152
  v_dot2c_f32_bf16 v16, v153, v9
  v_dot2c_f32_bf16 v17, v153, v153
  v_dot2c_f32_bf16 v16, v154, v9
  v_dot2c_f32_bf16 v17, v154, v154
  v_dot2c_f32_bf16 v16, v155, v9
  v_dot2c_f32_bf16 v17, v155, v155
  v_dot2c_f32_bf16 v16, v156, v9
  v_dot2c_f32_bf16 v17, v156, v156
  v_dot2c_f32_bf16 v16, v157, v9
  v_dot2c_f32_bf16 v17, v157, v157
  v_dot2c_f32_bf16 v16, v158, v9
  v_dot2c_f32_bf16 v17, v158, v158
  v_dot2c_f32_bf16 v16, v159, v9
  v_dot2c_f32_bf16 v17, v159, v159
  s_waitcnt vmcnt(9)
  v_xor_b32 v10, 0, v8
  ds_read_b128 v[160:163], v10 offset:16384
  v_xor_b32 v11, 32, v8
  ds_read_b128 v[164:167], v11 offset:16384
  v_xor_b32 v10, 64, v8
  ds_read_b128 v[168:171], v10 offset:16384
  v_xor_b32 v11, 96, v8
  ds_read_b128 v[172:175], v11 offset:16384
  v_xor_b32 v10, 128, v8
  ds_read_b128 v[176:179], v10 offset:16384
  v_xor_b32 v11, 160, v8
  ds_read_b128 v[180:183], v11 offset:16384
  v_xor_b32 v10, 192, v8
  ds_read_b128 v[184:187], v10 offset:16384
  v_xor_b32 v11, 224, v8
  ds_read_b128 v[188:191], v11 offset:16384
  s_cmp_lg_u32 s3, 0
  s_cbranch_scc1 q0_na
  s_lshl_b32 s73, s11, 5
  v_mov_b32 v238, 1
  s_mov_b64 exec, 1
  buffer_atomic_add v238, off, s[4:7], s73 sc0 sc1
  s_mov_b64 exec, -1
q0_na:
  s_lshr_b32 s92, s10, 1
  s_lshl_b32 s92, s71, 6
  s_mul_i32 s93, s3, 49152
  s_add_u32 s92, s92, s93
  s_mul_i32 s93, s3, 3072
  s_add_u32 m0, s93, 0
  s_nop 0
  buffer_load_dwordx4 v244, s[40:43], s92 offen offset:0 lds
  s_add_u32 m0, s93, 0
  s_nop 0
  buffer_load_dwordx4 v244, s[40:43], s92 offen offset:1024 lds
  s_add_u32 m0, s93, 0
  s_nop 0
  buffer_load_dwordx4 v244, s[40:43], s92 offen offset:2048 lds
  s_add_u32 s92, s92, 196608
  s_add_u32 m0, s93, 12288
  s_nop 0
  buffer_load_dwordx4 v244, s[40:43], s92 offen offset:0 lds
  s_add_u32 m0, s93, 12288
  s_nop 0
  buffer_load_dwordx4 v244, s[40:43], s92 offen offset:1024 lds
  s_add_u32 m0, s93, 12288
  s_nop 0
  buffer_load_dwordx4 v244, s[40:43], s92 offen offset:2048 lds
  s_add_u32 s92, s92, 196608
  s_waitcnt lgkmcnt(0)
  v_dot2c_f32_bf16 v16, v160, v9
  v_dot2c_f32_bf16 v17, v160, v160
  v_dot2c_f32_bf16 v16, v161, v9
  v_dot2c_f32_bf16 v17, v161, v161
  v_dot2c_f32_bf16 v16, v162, v9
  v_dot2c_f32_bf16 v17, v162, v162
  v_dot2c_f32_bf16 v16, v163, v9
  v_dot2c_f32_bf16 v17, v163, v163
  v_dot2c_f32_bf16 v16, v164, v9
  v_dot2c_f32_bf16 v17, v164, v164
  v_dot2c_f32_bf16 v16, v165, v9
  v_dot2c_f32_bf16 v17, v165, v165
  v_dot2c_f32_bf16 v16, v166, v9
  v_dot2c_f32_bf16 v17, v166, v166
  v_dot2c_f32_bf16 v16, v167, v9
  v_dot2c_f32_bf16 v17, v167, v167
  v_dot2c_f32_bf16 v16, v168, v9
  v_dot2c_f32_bf16 v17, v168, v168
  v_dot2c_f32_bf16 v16, v169, v9
  v_dot2c_f32_bf16 v17, v169, v169
  v_dot2c_f32_bf16 v16, v170, v9
  v_dot2c_f32_bf16 v17, v170, v170
  v_dot2c_f32_bf16 v16, v171, v9
  v_dot2c_f32_bf16 v17, v171, v171
  v_dot2c_f32_bf16 v16, v172, v9
  v_dot2c_f32_bf16 v17, v172, v172
  v_dot2c_f32_bf16 v16, v173, v9
  v_dot2c_f32_bf16 v17, v173, v173
  v_dot2c_f32_bf16 v16, v174, v9
  v_dot2c_f32_bf16 v17, v174, v174
  v_dot2c_f32_bf16 v16, v175, v9
  v_dot2c_f32_bf16 v17, v175, v175
  v_dot2c_f32_bf16 v16, v176, v9
  v_dot2c_f32_bf16 v17, v176, v176
  v_dot2c_f32_bf16 v16, v177, v9
  v_dot2c_f32_bf16 v17, v177, v177
  v_dot2c_f32_bf16 v16, v178, v9
  v_dot2c_f32_bf16 v17, v178, v178
  v_dot2c_f32_bf16 v16, v179, v9
  v_dot2c_f32_bf16 v17, v179, v179
  v_dot2c_f32_bf16 v16, v180, v9
  v_dot2c_f32_bf16 v17, v180, v180
  v_dot2c_f32_bf16 v16, v181, v9
  v_dot2c_f32_bf16 v17, v181, v181
  v_dot2c_f32_bf16 v16, v182, v9
  v_dot2c_f32_bf16 v17, v182, v182
  v_dot2c_f32_bf16 v16, v183, v9
  v_dot2c_f32_bf16 v17, v183, v183
  v_dot2c_f32_bf16 v16, v184, v9
  v_dot2c_f32_bf16 v17, v184, v184
  v_dot2c_f32_bf16 v16, v185, v9
  v_dot2c_f32_bf16 v17, v185, v185
  v_dot2c_f32_bf16 v16, v186, v9
  v_dot2c_f32_bf16 v17, v186, v186
  v_dot2c_f32_bf16 v16, v187, v9
  v_dot2c_f32_bf16 v17, v187, v187
  v_dot2c_f32_bf16 v16, v188, v9
  v_dot2c_f32_bf16 v17, v188, v188
  v_dot2c_f32_bf16 v16, v189, v9
  v_dot2c_f32_bf16 v17, v189, v189
  v_dot2c_f32_bf16 v16, v190, v9
  v_dot2c_f32_bf16 v17, v190, v190
  v_dot2c_f32_bf16 v16, v191, v9
  v_dot2c_f32_bf16 v17, v191, v191
  s_waitcnt vmcnt(7)
  v_xor_b32 v10, 0, v8
  ds_read_b128 v[192:195], v10 offset:24576
  v_xor_b32 v11, 32, v8
  ds_read_b128 v[196:199], v11 offset:24576
  v_xor_b32 v10, 64, v8
  ds_read_b128 v[200:203], v10 offset:24576
  v_xor_b32 v11, 96, v8
  ds_read_b128 v[204:207], v11 offset:24576
  v_xor_b32 v10, 128, v8
  ds_read_b128 v[208:211], v10 offset:24576
  v_xor_b32 v11, 160, v8
  ds_read_b128 v[212:215], v11 offset:24576
  v_xor_b32 v10, 192, v8
  ds_read_b128 v[216:219], v10 offset:24576
  v_xor_b32 v11, 224, v8
  ds_read_b128 v[220:223], v11 offset:24576
  s_waitcnt lgkmcnt(0)
  s_barrier
  s_add_u32 m0, s93, 24576
  s_nop 0
  buffer_load_dwordx4 v244, s[40:43], s92 offen offset:0 lds
  s_add_u32 m0, s93, 24576
  s_nop 0
  buffer_load_dwordx4 v244, s[40:43], s92 offen offset:1024 lds
  s_add_u32 m0, s93, 24576
  s_nop 0
  buffer_load_dwordx4 v244, s[40:43], s92 offen offset:2048 lds
  s_add_u32 s92, s92, 196608
  s_add_u32 m0, s93, 36864
  s_nop 0
  buffer_load_dwordx4 v244, s[40:43], s92 offen offset:0 lds
  s_add_u32 m0, s93, 36864
  s_nop 0
  buffer_load_dwordx4 v244, s[40:43], s92 offen offset:1024 lds
  s_add_u32 m0, s93, 36864
  s_nop 0
  buffer_load_dwordx4 v244, s[40:43], s92 offen offset:2048 lds
  s_add_u32 s92, s92, 196608
  s_add_u32 m0, s93, 49152
  s_nop 0
  buffer_load_dwordx4 v244, s[40:43], s92 offen offset:0 lds
  s_add_u32 m0, s93, 49152
  s_nop 0
  buffer_load_dwordx4 v244, s[40:43], s92 offen offset:1024 lds
  s_add_u32 m0, s93, 49152
  s_nop 0
  buffer_load_dwordx4 v244, s[40:43], s92 offen offset:2048 lds
  s_add_u32 s92, s92, 196608
  s_waitcnt lgkmcnt(0)
  v_dot2c_f32_bf16 v16, v192, v9
  v_dot2c_f32_bf16 v17, v192, v192
  v_dot2c_f32_bf16 v16, v193, v9
  v_dot2c_f32_bf16 v17, v193, v193
  v_dot2c_f32_bf16 v16, v194, v9
  v_dot2c_f32_bf16 v17, v194, v194
  v_dot2c_f32_bf16 v16, v195, v9
  v_dot2c_f32_bf16 v17, v195, v195
  v_dot2c_f32_bf16 v16, v196, v9
  v_dot2c_f32_bf16 v17, v196, v196
  v_dot2c_f32_bf16 v16, v197, v9
  v_dot2c_f32_bf16 v17, v197, v197
  v_dot2c_f32_bf16 v16, v198, v9
  v_dot2c_f32_bf16 v17, v198, v198
  v_dot2c_f32_bf16 v16, v199, v9
  v_dot2c_f32_bf16 v17, v199, v199
  v_dot2c_f32_bf16 v16, v200, v9
  v_dot2c_f32_bf16 v17, v200, v200
  v_dot2c_f32_bf16 v16, v201, v9
  v_dot2c_f32_bf16 v17, v201, v201
  v_dot2c_f32_bf16 v16, v202, v9
  v_dot2c_f32_bf16 v17, v202, v202
  v_dot2c_f32_bf16 v16, v203, v9
  v_dot2c_f32_bf16 v17, v203, v203
  v_dot2c_f32_bf16 v16, v204, v9
  v_dot2c_f32_bf16 v17, v204, v204
  v_dot2c_f32_bf16 v16, v205, v9
  v_dot2c_f32_bf16 v17, v205, v205
  v_dot2c_f32_bf16 v16, v206, v9
  v_dot2c_f32_bf16 v17, v206, v206
  v_dot2c_f32_bf16 v16, v207, v9
  v_dot2c_f32_bf16 v17, v207, v207
  v_dot2c_f32_bf16 v16, v208, v9
  v_dot2c_f32_bf16 v17, v208, v208
  v_dot2c_f32_bf16 v16, v209, v9
  v_dot2c_f32_bf16 v17, v209, v209
  v_dot2c_f32_bf16 v16, v210, v9
  v_dot2c_f32_bf16 v17, v210, v210
  v_dot2c_f32_bf16 v16, v211, v9
  v_dot2c_f32_bf16 v17, v211, v211
  v_dot2c_f32_bf16 v16, v212, v9
  v_dot2c_f32_bf16 v17, v212, v212
  v_dot2c_f32_bf16 v16, v213, v9
  v_dot2c_f32_bf16 v17, v213, v213
  v_dot2c_f32_bf16 v16, v214, v9
  v_dot2c_f32_bf16 v17, v214, v214
  v_dot2c_f32_bf16 v16, v215, v9
  v_dot2c_f32_bf16 v17, v215, v215
  v_dot2c_f32_bf16 v16, v216, v9
  v_dot2c_f32_bf16 v17, v216, v216
  v_dot2c_f32_bf16 v16, v217, v9
  v_dot2c_f32_bf16 v17, v217, v217
  v_dot2c_f32_bf16 v16, v218, v9
  v_dot2c_f32_bf16 v17, v218, v218
  v_dot2c_f32_bf16 v16, v219, v9
  v_dot2c_f32_bf16 v17, v219, v219
  v_dot2c_f32_bf16 v16, v220, v9
  v_dot2c_f32_bf16 v17, v220, v220
  v_dot2c_f32_bf16 v16, v221, v9
  v_dot2c_f32_bf16 v17, v221, v221
  v_dot2c_f32_bf16 v16, v222, v9
  v_dot2c_f32_bf16 v17, v222, v222
  v_dot2c_f32_bf16 v16, v223, v9
  v_dot2c_f32_bf16 v17, v223, v223
  s_waitcnt vmcnt(9)
  s_barrier
  ds_read_b64_tr_b16 v[24:25], v5 offset:1024
  ds_read_b64_tr_b16 v[26:27], v5 offset:1280
  ds_read_b64_tr_b16 v[28:29], v5 offset:2048
  ds_read_b64_tr_b16 v[30:31], v5 offset:2304
  ds_read_b64_tr_b16 v[32:33], v5 offset:4096
  ds_read_b64_tr_b16 v[34:35], v5 offset:4352
  s_waitcnt lgkmcnt(4)
  s_add_u32 m0, s93, 61440
  v_mfma_f32_32x32x16_bf16 v[64:79], v[24:27], v[96:99], 0
  buffer_load_dwordx4 v244, s[40:43], s92 offen offset:0 lds
  ds_read_b64_tr_b16 v[36:37], v5 offset:5120
  ds_read_b64_tr_b16 v[38:39], v5 offset:5376
  s_waitcnt lgkmcnt(4)
  v_mfma_f32_32x32x16_bf16 v[80:95], v[96:99], v[28:31], 0
  s_cmp_lg_u32 s3, 0
  s_cbranch_scc1 q0cs_7
  ds_read_b64_tr_b16 v[40:41], v5 offset:0
  ds_read_b64_tr_b16 v[42:43], v5 offset:256
  v_mfma_f32_32x32x16_bf16 a[16:31], v[20:23], v[24:27], a[16:31]
  v_mfma_f32_32x32x16_bf16 a[32:47], v[20:23], v[28:31], a[32:47]
  s_waitcnt lgkmcnt(0)
  v_mfma_f32_32x32x16_bf16 a[0:15], v[20:23], v[40:43], a[0:15]
q0cs_7:
  ds_read_b64_tr_b16 v[24:25], v5 offset:7168
  ds_read_b64_tr_b16 v[26:27], v5 offset:7424
  s_waitcnt lgkmcnt(4)
  s_add_u32 m0, s93, 61440
  v_mfma_f32_32x32x16_bf16 v[64:79], v[32:35], v[100:103], v[64:79]
  buffer_load_dwordx4 v244, s[40:43], s92 offen offset:1024 lds
  ds_read_b64_tr_b16 v[28:29], v5 offset:8192
  ds_read_b64_tr_b16 v[30:31], v5 offset:8448
  s_waitcnt lgkmcnt(4)
  v_mfma_f32_32x32x16_bf16 v[80:95], v[100:103], v[36:39], v[80:95]
  s_cmp_lg_u32 s3, 1
  s_cbranch_scc1 q0cs_8
  ds_read_b64_tr_b16 v[40:41], v5 offset:3072
  ds_read_b64_tr_b16 v[42:43], v5 offset:3328
  v_mfma_f32_32x32x16_bf16 a[16:31], v[20:23], v[32:35], a[16:31]
  v_mfma_f32_32x32x16_bf16 a[32:47], v[20:23], v[36:39], a[32:47]
  s_waitcnt lgkmcnt(0)
  v_mfma_f32_32x32x16_bf16 a[0:15], v[20:23], v[40:43], a[0:15]
q0cs_8:
  ds_read_b64_tr_b16 v[32:33], v5 offset:10240
  ds_read_b64_tr_b16 v[34:35], v5 offset:10496
  s_waitcnt lgkmcnt(4)
  s_add_u32 m0, s93, 61440
  v_mfma_f32_32x32x16_bf16 v[64:79], v[24:27], v[104:107], v[64:79]
  buffer_load_dwordx4 v244, s[40:43], s92 offen offset:2048 lds
  ds_read_b64_tr_b16 v[36:37], v5 offset:11264
  ds_read_b64_tr_b16 v[38:39], v5 offset:11520
  s_add_u32 s92, s92, 196608
  s_waitcnt lgkmcnt(4)
  v_mfma_f32_32x32x16_bf16 v[80:95], v[104:107], v[28:31], v[80:95]
  s_cmp_lg_u32 s3, 2
  s_cbranch_scc1 q0cs_9
  ds_read_b64_tr_b16 v[40:41], v5 offset:6144
  ds_read_b64_tr_b16 v[42:43], v5 offset:6400
  v_mfma_f32_32x32x16_bf16 a[16:31], v[20:23], v[24:27], a[16:31]
  v_mfma_f32_32x32x16_bf16 a[32:47], v[20:23], v[28:31], a[32:47]
  s_waitcnt lgkmcnt(0)
  v_mfma_f32_32x32x16_bf16 a[0:15], v[20:23], v[40:43], a[0:15]
q0cs_9:
  ds_read_b64_tr_b16 v[24:25], v5 offset:13312
  ds_read_b64_tr_b16 v[26:27], v5 offset:13568
  s_waitcnt lgkmcnt(4)
  s_add_u32 m0, s93, 73728
  v_mfma_f32_32x32x16_bf16 v[64:79], v[32:35], v[108:111], v[64:79]
  buffer_load_dwordx4 v244, s[40:43], s92 offen offset:0 lds
  ds_read_b64_tr_b16 v[28:29], v5 offset:14336
  ds_read_b64_tr_b16 v[30:31], v5 offset:14592
  s_waitcnt lgkmcnt(4)
  v_mfma_f32_32x32x16_bf16 v[80:95], v[108:111], v[36:39], v[80:95]
  s_cmp_lg_u32 s3, 3
  s_cbranch_scc1 q0cs_10
  ds_read_b64_tr_b16 v[40:41], v5 offset:9216
  ds_read_b64_tr_b16 v[42:43], v5 offset:9472
  v_mfma_f32_32x32x16_bf16 a[16:31], v[20:23], v[32:35], a[16:31]
  v_mfma_f32_32x32x16_bf16 a[32:47], v[20:23], v[36:39], a[32:47]
  s_waitcnt lgkmcnt(0)
  v_mfma_f32_32x32x16_bf16 a[0:15], v[20:23], v[40:43], a[0:15]
q0cs_10:
  ds_read_b64_tr_b16 v[32:33], v5 offset:16384
  ds_read_b64_tr_b16 v[34:35], v5 offset:16640
  s_waitcnt lgkmcnt(4)
  s_add_u32 m0, s93, 73728
  v_mfma_f32_32x32x16_bf16 v[64:79], v[24:27], v[112:115], v[64:79]
  buffer_load_dwordx4 v244, s[40:43], s92 offen offset:1024 lds
  ds_read_b64_tr_b16 v[36:37], v5 offset:17408
  ds_read_b64_tr_b16 v[38:39], v5 offset:17664
  s_waitcnt lgkmcnt(4)
  v_mfma_f32_32x32x16_bf16 v[80:95], v[112:115], v[28:31], v[80:95]
  s_cmp_lg_u32 s3, 0
  s_cbranch_scc1 q0cs_11
  ds_read_b64_tr_b16 v[40:41], v5 offset:12288
  ds_read_b64_tr_b16 v[42:43], v5 offset:12544
  v_mfma_f32_32x32x16_bf16 a[16:31], v[20:23], v[24:27], a[16:31]
  v_mfma_f32_32x32x16_bf16 a[32:47], v[20:23], v[28:31], a[32:47]
  s_waitcnt lgkmcnt(0)
  v_mfma_f32_32x32x16_bf16 a[0:15], v[20:23], v[40:43], a[0:15]
q0cs_11:
  ds_read_b64_tr_b16 v[24:25], v5 offset:19456
  ds_read_b64_tr_b16 v[26:27], v5 offset:19712
  s_waitcnt lgkmcnt(4)
  s_add_u32 m0, s93, 73728
  v_mfma_f32_32x32x16_bf16 v[64:79], v[32:35], v[116:119], v[64:79]
  buffer_load_dwordx4 v244, s[40:43], s92 offen offset:2048 lds
  ds_read_b64_tr_b16 v[28:29], v5 offset:20480
  ds_read_b64_tr_b16 v[30:31], v5 offset:20736
  s_add_u32 s92, s92, 196608
  s_waitcnt lgkmcnt(4)
  v_mfma_f32_32x32x16_bf16 v[80:95], v[116:119], v[36:39], v[80:95]
  s_cmp_lg_u32 s3, 1
  s_cbranch_scc1 q0cs_12
  ds_read_b64_tr_b16 v[40:41], v5 offset:15360
  ds_read_b64_tr_b16 v[42:43], v5 offset:15616
  v_mfma_f32_32x32x16_bf16 a[16:31], v[20:23], v[32:35], a[16:31]
  v_mfma_f32_32x32x16_bf16 a[32:47], v[20:23], v[36:39], a[32:47]
  s_waitcnt lgkmcnt(0)
  v_mfma_f32_32x32x16_bf16 a[0:15], v[20:23], v[40:43], a[0:15]
q0cs_12:
  ds_read_b64_tr_b16 v[32:33], v5 offset:22528
  ds_read_b64_tr_b16 v[34:35], v5 offset:22784
  s_waitcnt lgkmcnt(4)
  s_add_u32 m0, s93, 86016
  v_mfma_f32_32x32x16_bf16 v[64:79], v[24:27], v[120:123], v[64:79]
  buffer_load_dwordx4 v244, s[40:43], s92 offen offset:0 lds
  ds_read_b64_tr_b16 v[36:37], v5 offset:23552
  ds_read_b64_tr_b16 v[38:39], v5 offset:23808
  s_waitcnt lgkmcnt(4)
  v_mfma_f32_32x32x16_bf16 v[80:95], v[120:123], v[28:31], v[80:95]
  s_cmp_lg_u32 s3, 2
  s_cbranch_scc1 q0cs_13
  ds_read_b64_tr_b16 v[40:41], v5 offset:18432
  ds_read_b64_tr_b16 v[42:43], v5 offset:18688
  v_mfma_f32_32x32x16_bf16 a[16:31], v[20:23], v[24:27], a[16:31]
  v_mfma_f32_32x32x16_bf16 a[32:47], v[20:23], v[28:31], a[32:47]
  s_waitcnt lgkmcnt(0)
  v_mfma_f32_32x32x16_bf16 a[0:15], v[20:23], v[40:43], a[0:15]
q0cs_13:
  s_waitcnt vmcnt(10)
  s_barrier
  ds_read_b64_tr_b16 v[24:25], v5 offset:25600
  ds_read_b64_tr_b16 v[26:27], v5 offset:25856
  s_waitcnt lgkmcnt(4)
  s_add_u32 m0, s93, 86016
  v_mfma_f32_32x32x16_bf16 v[64:79], v[32:35], v[124:127], v[64:79]
  buffer_load_dwordx4 v244, s[40:43], s92 offen offset:1024 lds
  ds_read_b64_tr_b16 v[28:29], v5 offset:26624
  ds_read_b64_tr_b16 v[30:31], v5 offset:26880
  s_waitcnt lgkmcnt(4)
  v_mfma_f32_32x32x16_bf16 v[80:95], v[124:127], v[36:39], v[80:95]
  s_cmp_lg_u32 s3, 3
  s_cbranch_scc1 q0cs_14
  ds_read_b64_tr_b16 v[40:41], v5 offset:21504
  ds_read_b64_tr_b16 v[42:43], v5 offset:21760
  v_mfma_f32_32x32x16_bf16 a[16:31], v[20:23], v[32:35], a[16:31]
  v_mfma_f32_32x32x16_bf16 a[32:47], v[20:23], v[36:39], a[32:47]
  s_waitcnt lgkmcnt(0)
  v_mfma_f32_32x32x16_bf16 a[0:15], v[20:23], v[40:43], a[0:15]
q0cs_14:
  ds_read_b64_tr_b16 v[32:33], v5 offset:28672
  ds_read_b64_tr_b16 v[34:35], v5 offset:28928
  s_waitcnt lgkmcnt(4)
  s_add_u32 m0, s93, 86016
  v_mfma_f32_32x32x16_bf16 v[64:79], v[24:27], v[128:131], v[64:79]
  buffer_load_dwordx4 v244, s[40:43], s92 offen offset:2048 lds
  ds_read_b64_tr_b16 v[36:37], v5 offset:29696
  ds_read_b64_tr_b16 v[38:39], v5 offset:29952
  v_mov_b32 v10, v16
  s_waitcnt lgkmcnt(4)
  v_mfma_f32_32x32x16_bf16 v[80:95], v[128:131], v[28:31], v[80:95]
  s_cmp_lg_u32 s3, 0
  s_cbranch_scc1 q0cs_15
  ds_read_b64_tr_b16 v[40:41], v5 offset:24576
  ds_read_b64_tr_b16 v[42:43], v5 offset:24832
  v_mfma_f32_32x32x16_bf16 a[16:31], v[20:23], v[24:27], a[16:31]
  v_mfma_f32_32x32x16_bf16 a[32:47], v[20:23], v[28:31], a[32:47]
  s_waitcnt lgkmcnt(0)
  v_mfma_f32_32x32x16_bf16 a[0:15], v[20:23], v[40:43], a[0:15]
q0cs_15:
  ds_read_b64_tr_b16 v[24:25], v5 offset:31744
  ds_read_b64_tr_b16 v[26:27], v5 offset:32000
  v_mov_b32 v11, v17
  s_waitcnt lgkmcnt(4)
  v_mfma_f32_32x32x16_bf16 v[64:79], v[32:35], v[132:135], v[64:79]
  ds_read_b64_tr_b16 v[28:29], v5 offset:32768
  ds_read_b64_tr_b16 v[30:31], v5 offset:33024
  s_lshl_b32 s74, s2, 2
  s_add_u32 s74, s74, s3
  s_mul_i32 s74, s74, 1376
  s_mov_b64 exec, 0xfff
  buffer_load_dword a64, v234, s[48:51], s74 offen
  buffer_load_dword a66, v234, s[52:55], s74 offen
  buffer_load_dword a67, v234, s[56:59], s74 offen
  buffer_load_dword a68, v234, s[44:47], s74 offen
  s_mov_b32 exec_lo, 0x1ffffff
  v_lshlrev_b32 v4, 20, v1
  s_mov_b64 exec, -1
  s_nop 0
  s_waitcnt lgkmcnt(4)
  v_mfma_f32_32x32x16_bf16 v[80:95], v[132:135], v[36:39], v[80:95]
  s_cmp_lg_u32 s3, 1
  s_cbranch_scc1 q0cs_16
  ds_read_b64_tr_b16 v[40:41], v5 offset:27648
  ds_read_b64_tr_b16 v[42:43], v5 offset:27904
  v_mfma_f32_32x32x16_bf16 a[16:31], v[20:23], v[32:35], a[16:31]
  v_mfma_f32_32x32x16_bf16 a[32:47], v[20:23], v[36:39], a[32:47]
  s_waitcnt lgkmcnt(0)
  v_mfma_f32_32x32x16_bf16 a[0:15], v[20:23], v[40:43], a[0:15]
q0cs_16:
  ds_read_b64_tr_b16 v[32:33], v5 offset:34816
  ds_read_b64_tr_b16 v[34:35], v5 offset:35072
  v_permlane32_swap_b32 v16, v10
  s_waitcnt lgkmcnt(4)
  v_mfma_f32_32x32x16_bf16 v[64:79], v[24:27], v[136:139], v[64:79]
  ds_read_b64_tr_b16 v[36:37], v5 offset:35840
  ds_read_b64_tr_b16 v[38:39], v5 offset:36096
  v_permlane32_swap_b32 v17, v11
  s_waitcnt lgkmcnt(4)
  v_mfma_f32_32x32x16_bf16 v[80:95], v[136:139], v[28:31], v[80:95]
  s_cmp_lg_u32 s3, 2
  s_cbranch_scc1 q0cs_17
  ds_read_b64_tr_b16 v[40:41], v5 offset:30720
  ds_read_b64_tr_b16 v[42:43], v5 offset:30976
  v_mfma_f32_32x32x16_bf16 a[16:31], v[20:23], v[24:27], a[16:31]
  v_mfma_f32_32x32x16_bf16 a[32:47], v[20:23], v[28:31], a[32:47]
  s_waitcnt lgkmcnt(0)
  v_mfma_f32_32x32x16_bf16 a[0:15], v[20:23], v[40:43], a[0:15]
q0cs_17:
  ds_read_b64_tr_b16 v[24:25], v5 offset:37888
  ds_read_b64_tr_b16 v[26:27], v5 offset:38144
  v_add_f32 v16, v16, v10
  s_waitcnt lgkmcnt(4)
  v_mfma_f32_32x32x16_bf16 v[64:79], v[32:35], v[140:143], v[64:79]
  ds_read_b64_tr_b16 v[28:29], v5 offset:38912
  ds_read_b64_tr_b16 v[30:31], v5 offset:39168
  v_add_f32 v17, v17, v11
  s_waitcnt lgkmcnt(4)
  v_mfma_f32_32x32x16_bf16 v[80:95], v[140:143], v[36:39], v[80:95]
  s_cmp_lg_u32 s3, 3
  s_cbranch_scc1 q0cs_18
  ds_read_b64_tr_b16 v[40:41], v5 offset:33792
  ds_read_b64_tr_b16 v[42:43], v5 offset:34048
  v_mfma_f32_32x32x16_bf16 a[16:31], v[20:23], v[32:35], a[16:31]
  v_mfma_f32_32x32x16_bf16 a[32:47], v[20:23], v[36:39], a[32:47]
  s_waitcnt lgkmcnt(0)
  v_mfma_f32_32x32x16_bf16 a[0:15], v[20:23], v[40:43], a[0:15]
q0cs_18:
  ds_read_b64_tr_b16 v[32:33], v5 offset:40960
  ds_read_b64_tr_b16 v[34:35], v5 offset:41216
  v_mul_f32 v18, 0.001953125, v16
  s_waitcnt lgkmcnt(4)
  v_mfma_f32_32x32x16_bf16 v[64:79], v[24:27], v[144:147], v[64:79]
  ds_read_b64_tr_b16 v[36:37], v5 offset:41984
  ds_read_b64_tr_b16 v[38:39], v5 offset:42240
  v_mul_f32 v17, 0.001953125, v17
  s_waitcnt lgkmcnt(4)
  v_mfma_f32_32x32x16_bf16 v[80:95], v[144:147], v[28:31], v[80:95]
  s_cmp_lg_u32 s3, 0
  s_cbranch_scc1 q0cs_19
  ds_read_b64_tr_b16 v[40:41], v5 offset:36864
  ds_read_b64_tr_b16 v[42:43], v5 offset:37120
  v_mfma_f32_32x32x16_bf16 a[16:31], v[20:23], v[24:27], a[16:31]
  v_mfma_f32_32x32x16_bf16 a[32:47], v[20:23], v[28:31], a[32:47]
  s_waitcnt lgkmcnt(0)
  v_mfma_f32_32x32x16_bf16 a[0:15], v[20:23], v[40:43], a[0:15]
q0cs_19:
  ds_read_b64_tr_b16 v[24:25], v5 offset:44032
  ds_read_b64_tr_b16 v[26:27], v5 offset:44288
  v_fma_f32 v17, -v18, v18, v17
  s_waitcnt lgkmcnt(4)
  v_mfma_f32_32x32x16_bf16 v[64:79], v[32:35], v[148:151], v[64:79]
  ds_read_b64_tr_b16 v[28:29], v5 offset:45056
  ds_read_b64_tr_b16 v[30:31], v5 offset:45312
  v_max_f32 v17, 0, v17
  s_waitcnt lgkmcnt(4)
  v_mfma_f32_32x32x16_bf16 v[80:95], v[148:151], v[36:39], v[80:95]
  s_cmp_lg_u32 s3, 1
  s_cbranch_scc1 q0cs_20
  ds_read_b64_tr_b16 v[40:41], v5 offset:39936
  ds_read_b64_tr_b16 v[42:43], v5 offset:40192
  v_mfma_f32_32x32x16_bf16 a[16:31], v[20:23], v[32:35], a[16:31]
  v_mfma_f32_32x32x16_bf16 a[32:47], v[20:23], v[36:39], a[32:47]
  s_waitcnt lgkmcnt(0)
  v_mfma_f32_32x32x16_bf16 a[0:15], v[20:23], v[40:43], a[0:15]
q0cs_20:
  ds_read_b64_tr_b16 v[32:33], v5 offset:47104
  ds_read_b64_tr_b16 v[34:35], v5 offset:47360
  v_cvt_pk_bf16_f32 v17, v17, v17
  s_waitcnt lgkmcnt(4)
  v_mfma_f32_32x32x16_bf16 v[64:79], v[24:27], v[152:155], v[64:79]
  ds_read_b64_tr_b16 v[36:37], v5 offset:48128
  ds_read_b64_tr_b16 v[38:39], v5 offset:48384
  v_and_b32 v17, 0xffff0000, v17
  s_waitcnt lgkmcnt(4)
  v_mfma_f32_32x32x16_bf16 v[80:95], v[152:155], v[28:31], v[80:95]
  s_cmp_lg_u32 s3, 2
  s_cbranch_scc1 q0cs_21
  ds_read_b64_tr_b16 v[40:41], v5 offset:43008
  ds_read_b64_tr_b16 v[42:43], v5 offset:43264
  v_mfma_f32_32x32x16_bf16 a[16:31], v[20:23], v[24:27], a[16:31]
  v_mfma_f32_32x32x16_bf16 a[32:47], v[20:23], v[28:31], a[32:47]
  s_waitcnt lgkmcnt(0)
  v_mfma_f32_32x32x16_bf16 a[0:15], v[20:23], v[40:43], a[0:15]
q0cs_21:
  s_waitcnt vmcnt(10)
  s_barrier
  ds_read_b64_tr_b16 v[24:25], v6 offset:1024
  ds_read_b64_tr_b16 v[26:27], v6 offset:1280
  v_add_f32 v17, 0x3727c5ac, v17
  s_waitcnt lgkmcnt(4)
  v_mfma_f32_32x32x16_bf16 v[64:79], v[32:35], v[156:159], v[64:79]
  ds_read_b64_tr_b16 v[28:29], v6 offset:2048
  ds_read_b64_tr_b16 v[30:31], v6 offset:2304
  v_cvt_pk_bf16_f32 v17, v17, v17
  s_waitcnt lgkmcnt(4)
  v_mfma_f32_32x32x16_bf16 v[80:95], v[156:159], v[36:39], v[80:95]
  s_cmp_lg_u32 s3, 3
  s_cbranch_scc1 q0cs_22
  ds_read_b64_tr_b16 v[40:41], v5 offset:46080
  ds_read_b64_tr_b16 v[42:43], v5 offset:46336
  v_mfma_f32_32x32x16_bf16 a[16:31], v[20:23], v[32:35], a[16:31]
  v_mfma_f32_32x32x16_bf16 a[32:47], v[20:23], v[36:39], a[32:47]
  s_waitcnt lgkmcnt(0)
  v_mfma_f32_32x32x16_bf16 a[0:15], v[20:23], v[40:43], a[0:15]
q0cs_22:
  ds_read_b64_tr_b16 v[32:33], v6 offset:4096
  ds_read_b64_tr_b16 v[34:35], v6 offset:4352
  v_and_b32 v17, 0xffff0000, v17
  s_waitcnt lgkmcnt(4)
  v_mfma_f32_32x32x16_bf16 v[64:79], v[24:27], v[160:163], v[64:79]
  ds_read_b64_tr_b16 v[36:37], v6 offset:5120
  ds_read_b64_tr_b16 v[38:39], v6 offset:5376
  v_sqrt_f32 v17, v17
  s_waitcnt lgkmcnt(4)
  v_mfma_f32_32x32x16_bf16 v[80:95], v[160:163], v[28:31], v[80:95]
  s_cmp_lg_u32 s3, 0
  s_cbranch_scc1 q0cs_23
  ds_read_b64_tr_b16 v[40:41], v6 offset:0
  ds_read_b64_tr_b16 v[42:43], v6 offset:256
  v_mfma_f32_32x32x16_bf16 a[16:31], v[20:23], v[24:27], a[16:31]
  v_mfma_f32_32x32x16_bf16 a[32:47], v[20:23], v[28:31], a[32:47]
  s_waitcnt lgkmcnt(0)
  v_mfma_f32_32x32x16_bf16 a[0:15], v[20:23], v[40:43], a[0:15]
q0cs_23:
  ds_read_b64_tr_b16 v[24:25], v6 offset:7168
  ds_read_b64_tr_b16 v[26:27], v6 offset:7424
  v_sub_f32 v10, 0, v18
  s_waitcnt lgkmcnt(4)
  v_mfma_f32_32x32x16_bf16 v[64:79], v[32:35], v[164:167], v[64:79]
  ds_read_b64_tr_b16 v[28:29], v6 offset:8192
  ds_read_b64_tr_b16 v[30:31], v6 offset:8448
  v_cvt_pk_bf16_f32 v17, v17, v17
  s_waitcnt lgkmcnt(4)
  v_mfma_f32_32x32x16_bf16 v[80:95], v[164:167], v[36:39], v[80:95]
  s_cmp_lg_u32 s3, 1
  s_cbranch_scc1 q0cs_24
  ds_read_b64_tr_b16 v[40:41], v6 offset:3072
  ds_read_b64_tr_b16 v[42:43], v6 offset:3328
  v_mfma_f32_32x32x16_bf16 a[16:31], v[20:23], v[32:35], a[16:31]
  v_mfma_f32_32x32x16_bf16 a[32:47], v[20:23], v[36:39], a[32:47]
  s_waitcnt lgkmcnt(0)
  v_mfma_f32_32x32x16_bf16 a[0:15], v[20:23], v[40:43], a[0:15]
q0cs_24:
  ds_read_b64_tr_b16 v[32:33], v6 offset:10240
  ds_read_b64_tr_b16 v[34:35], v6 offset:10496
  v_and_b32 v17, 0xffff0000, v17
  s_waitcnt lgkmcnt(4)
  v_mfma_f32_32x32x16_bf16 v[64:79], v[24:27], v[168:171], v[64:79]
  ds_read_b64_tr_b16 v[36:37], v6 offset:11264
  ds_read_b64_tr_b16 v[38:39], v6 offset:11520
  v_rcp_f32 v19, v17
  s_waitcnt lgkmcnt(4)
  v_mfma_f32_32x32x16_bf16 v[80:95], v[168:171], v[28:31], v[80:95]
  s_cmp_lg_u32 s3, 2
  s_cbranch_scc1 q0cs_25
  ds_read_b64_tr_b16 v[40:41], v6 offset:6144
  ds_read_b64_tr_b16 v[42:43], v6 offset:6400
  v_mfma_f32_32x32x16_bf16 a[16:31], v[20:23], v[24:27], a[16:31]
  v_mfma_f32_32x32x16_bf16 a[32:47], v[20:23], v[28:31], a[32:47]
  s_waitcnt lgkmcnt(0)
  v_mfma_f32_32x32x16_bf16 a[0:15], v[20:23], v[40:43], a[0:15]
q0cs_25:
  ds_read_b64_tr_b16 v[24:25], v6 offset:13312
  ds_read_b64_tr_b16 v[26:27], v6 offset:13568
  v_cvt_pk_bf16_f32 v44, v10, v10
  s_waitcnt lgkmcnt(4)
  v_mfma_f32_32x32x16_bf16 v[64:79], v[32:35], v[172:175], v[64:79]
  ds_read_b64_tr_b16 v[28:29], v6 offset:14336
  ds_read_b64_tr_b16 v[30:31], v6 offset:14592
  v_mov_b32 v45, v44
  s_waitcnt lgkmcnt(4)
  v_mfma_f32_32x32x16_bf16 v[80:95], v[172:175], v[36:39], v[80:95]
  s_cmp_lg_u32 s3, 3
  s_cbranch_scc1 q0cs_26
  ds_read_b64_tr_b16 v[40:41], v6 offset:9216
  ds_read_b64_tr_b16 v[42:43], v6 offset:9472
  v_mfma_f32_32x32x16_bf16 a[16:31], v[20:23], v[32:35], a[16:31]
  v_mfma_f32_32x32x16_bf16 a[32:47], v[20:23], v[36:39], a[32:47]
  s_waitcnt lgkmcnt(0)
  v_mfma_f32_32x32x16_bf16 a[0:15], v[20:23], v[40:43], a[0:15]
q0cs_26:
  ds_read_b64_tr_b16 v[32:33], v6 offset:16384
  ds_read_b64_tr_b16 v[34:35], v6 offset:16640
  v_mov_b32 v46, v44
  s_waitcnt lgkmcnt(4)
  v_mfma_f32_32x32x16_bf16 v[64:79], v[24:27], v[176:179], v[64:79]
  ds_read_b64_tr_b16 v[36:37], v6 offset:17408
  ds_read_b64_tr_b16 v[38:39], v6 offset:17664
  v_mov_b32 v47, v44
  s_waitcnt lgkmcnt(4)
  v_mfma_f32_32x32x16_bf16 v[80:95], v[176:179], v[28:31], v[80:95]
  s_cmp_lg_u32 s3, 0
  s_cbranch_scc1 q0cs_27
  ds_read_b64_tr_b16 v[40:41], v6 offset:12288
  ds_read_b64_tr_b16 v[42:43], v6 offset:12544
  v_mfma_f32_32x32x16_bf16 a[16:31], v[20:23], v[24:27], a[16:31]
  v_mfma_f32_32x32x16_bf16 a[32:47], v[20:23], v[28:31], a[32:47]
  s_waitcnt lgkmcnt(0)
  v_mfma_f32_32x32x16_bf16 a[0:15], v[20:23], v[40:43], a[0:15]
q0cs_27:
  ds_read_b64_tr_b16 v[24:25], v6 offset:19456
  ds_read_b64_tr_b16 v[26:27], v6 offset:19712
  s_lshl_b32 s88, s3, 7
  s_waitcnt lgkmcnt(4)
  v_mfma_f32_32x32x16_bf16 v[64:79], v[32:35], v[180:183], v[64:79]
  ds_read_b64_tr_b16 v[28:29], v6 offset:20480
  ds_read_b64_tr_b16 v[30:31], v6 offset:20736
  s_add_u32 s88, s88, 102400
  s_waitcnt lgkmcnt(4)
  v_mfma_f32_32x32x16_bf16 v[80:95], v[180:183], v[36:39], v[80:95]
  s_cmp_lg_u32 s3, 1
  s_cbranch_scc1 q0cs_28
  ds_read_b64_tr_b16 v[40:41], v6 offset:15360
  ds_read_b64_tr_b16 v[42:43], v6 offset:15616
  v_mfma_f32_32x32x16_bf16 a[16:31], v[20:23], v[32:35], a[16:31]
  v_mfma_f32_32x32x16_bf16 a[32:47], v[20:23], v[36:39], a[32:47]
  s_waitcnt lgkmcnt(0)
  v_mfma_f32_32x32x16_bf16 a[0:15], v[20:23], v[40:43], a[0:15]
q0cs_28:
  ds_read_b64_tr_b16 v[32:33], v6 offset:22528
  ds_read_b64_tr_b16 v[34:35], v6 offset:22784
  v_and_b32 v10, 31, v1
  s_waitcnt lgkmcnt(4)
  v_mfma_f32_32x32x16_bf16 v[64:79], v[24:27], v[184:187], v[64:79]
  ds_read_b64_tr_b16 v[36:37], v6 offset:23552
  ds_read_b64_tr_b16 v[38:39], v6 offset:23808
  v_lshlrev_b32 v10, 2, v10
  s_waitcnt lgkmcnt(4)
  v_mfma_f32_32x32x16_bf16 v[80:95], v[184:187], v[28:31], v[80:95]
  s_cmp_lg_u32 s3, 2
  s_cbranch_scc1 q0cs_29
  ds_read_b64_tr_b16 v[40:41], v6 offset:18432
  ds_read_b64_tr_b16 v[42:43], v6 offset:18688
  v_mfma_f32_32x32x16_bf16 a[16:31], v[20:23], v[24:27], a[16:31]
  v_mfma_f32_32x32x16_bf16 a[32:47], v[20:23], v[28:31], a[32:47]
  s_waitcnt lgkmcnt(0)
  v_mfma_f32_32x32x16_bf16 a[0:15], v[20:23], v[40:43], a[0:15]
q0cs_29:
  s_waitcnt vmcnt(4)
  s_barrier
  ds_read_b64_tr_b16 v[24:25], v6 offset:25600
  ds_read_b64_tr_b16 v[26:27], v6 offset:25856
  v_add_u32 v10, s88, v10
  s_waitcnt lgkmcnt(4)
  v_mfma_f32_32x32x16_bf16 v[64:79], v[32:35], v[188:191], v[64:79]
  ds_read_b64_tr_b16 v[28:29], v6 offset:26624
  ds_read_b64_tr_b16 v[30:31], v6 offset:26880
  ds_write_b32 v10, v19
  s_waitcnt lgkmcnt(5)
  v_mfma_f32_32x32x16_bf16 v[80:95], v[188:191], v[36:39], v[80:95]
  s_cmp_lg_u32 s3, 3
  s_cbranch_scc1 q0cs_30
  ds_read_b64_tr_b16 v[40:41], v6 offset:21504
  ds_read_b64_tr_b16 v[42:43], v6 offset:21760
  v_mfma_f32_32x32x16_bf16 a[16:31], v[20:23], v[32:35], a[16:31]
  v_mfma_f32_32x32x16_bf16 a[32:47], v[20:23], v[36:39], a[32:47]
  s_waitcnt lgkmcnt(0)
  v_mfma_f32_32x32x16_bf16 a[0:15], v[20:23], v[40:43], a[0:15]
q0cs_30:
  ds_read_b64_tr_b16 v[32:33], v6 offset:28672
  ds_read_b64_tr_b16 v[34:35], v6 offset:28928
  v_lshrrev_b32 v11, 5, v1
  s_waitcnt lgkmcnt(5)
  v_mfma_f32_32x32x16_bf16 v[64:79], v[24:27], v[192:195], v[64:79]
  ds_read_b64_tr_b16 v[36:37], v6 offset:29696
  ds_read_b64_tr_b16 v[38:39], v6 offset:29952
  v_lshlrev_b32 v11, 4, v11
  s_waitcnt lgkmcnt(5)
  v_mfma_f32_32x32x16_bf16 v[80:95], v[192:195], v[28:31], v[80:95]
  s_cmp_lg_u32 s3, 0
  s_cbranch_scc1 q0cs_31
  ds_read_b64_tr_b16 v[40:41], v6 offset:24576
  ds_read_b64_tr_b16 v[42:43], v6 offset:24832
  v_mfma_f32_32x32x16_bf16 a[16:31], v[20:23], v[24:27], a[16:31]
  v_mfma_f32_32x32x16_bf16 a[32:47], v[20:23], v[28:31], a[32:47]
  s_waitcnt lgkmcnt(0)
  v_mfma_f32_32x32x16_bf16 a[0:15], v[20:23], v[40:43], a[0:15]
q0cs_31:
  ds_read_b64_tr_b16 v[24:25], v6 offset:31744
  ds_read_b64_tr_b16 v[26:27], v6 offset:32000
  v_add_u32 v11, s88, v11
  s_waitcnt lgkmcnt(4)
  v_mfma_f32_32x32x16_bf16 v[64:79], v[32:35], v[196:199], v[64:79]
  ds_read_b64_tr_b16 v[28:29], v6 offset:32768
  ds_read_b64_tr_b16 v[30:31], v6 offset:33024
  v_mul_f32 v15, 0x3eb8aa3b, v19
  s_waitcnt lgkmcnt(4)
  v_mfma_f32_32x32x16_bf16 v[80:95], v[196:199], v[36:39], v[80:95]
  s_cmp_lg_u32 s3, 1
  s_cbranch_scc1 q0cs_32
  ds_read_b64_tr_b16 v[40:41], v6 offset:27648
  ds_read_b64_tr_b16 v[42:43], v6 offset:27904
  v_mfma_f32_32x32x16_bf16 a[16:31], v[20:23], v[32:35], a[16:31]
  v_mfma_f32_32x32x16_bf16 a[32:47], v[20:23], v[36:39], a[32:47]
  s_waitcnt lgkmcnt(0)
  v_mfma_f32_32x32x16_bf16 a[0:15], v[20:23], v[40:43], a[0:15]
q0cs_32:
  ds_read_b64_tr_b16 v[32:33], v6 offset:34816
  ds_read_b64_tr_b16 v[34:35], v6 offset:35072
  s_waitcnt lgkmcnt(4)
  v_mfma_f32_32x32x16_bf16 v[64:79], v[24:27], v[200:203], v[64:79]
  ds_read_b64_tr_b16 v[36:37], v6 offset:35840
  ds_read_b64_tr_b16 v[38:39], v6 offset:36096
  s_waitcnt lgkmcnt(4)
  v_mfma_f32_32x32x16_bf16 v[80:95], v[200:203], v[28:31], v[80:95]
  s_cmp_lg_u32 s3, 2
  s_cbranch_scc1 q0cs_33
  ds_read_b64_tr_b16 v[40:41], v6 offset:30720
  ds_read_b64_tr_b16 v[42:43], v6 offset:30976
  v_mfma_f32_32x32x16_bf16 a[16:31], v[20:23], v[24:27], a[16:31]
  v_mfma_f32_32x32x16_bf16 a[32:47], v[20:23], v[28:31], a[32:47]
  s_waitcnt lgkmcnt(0)
  v_mfma_f32_32x32x16_bf16 a[0:15], v[20:23], v[40:43], a[0:15]
q0cs_33:
  ds_read_b64_tr_b16 v[24:25], v6 offset:37888
  ds_read_b64_tr_b16 v[26:27], v6 offset:38144
  s_waitcnt lgkmcnt(4)
  v_mfma_f32_32x32x16_bf16 v[64:79], v[32:35], v[204:207], v[64:79]
  ds_read_b64_tr_b16 v[28:29], v6 offset:38912
  ds_read_b64_tr_b16 v[30:31], v6 offset:39168
  s_waitcnt lgkmcnt(4)
  v_mfma_f32_32x32x16_bf16 v[80:95], v[204:207], v[36:39], v[80:95]
  s_cmp_lg_u32 s3, 3
  s_cbranch_scc1 q0cs_34
  ds_read_b64_tr_b16 v[40:41], v6 offset:33792
  ds_read_b64_tr_b16 v[42:43], v6 offset:34048
  v_mfma_f32_32x32x16_bf16 a[16:31], v[20:23], v[32:35], a[16:31]
  v_mfma_f32_32x32x16_bf16 a[32:47], v[20:23], v[36:39], a[32:47]
  s_waitcnt lgkmcnt(0)
  v_mfma_f32_32x32x16_bf16 a[0:15], v[20:23], v[40:43], a[0:15]
q0cs_34:
  ds_read_b64_tr_b16 v[32:33], v6 offset:40960
  ds_read_b64_tr_b16 v[34:35], v6 offset:41216
  s_waitcnt lgkmcnt(4)
  v_mfma_f32_32x32x16_bf16 v[64:79], v[24:27], v[208:211], v[64:79]
  ds_read_b64_tr_b16 v[36:37], v6 offset:41984
  ds_read_b64_tr_b16 v[38:39], v6 offset:42240
  s_waitcnt lgkmcnt(4)
  v_mfma_f32_32x32x16_bf16 v[80:95], v[208:211], v[28:31], v[80:95]
  s_cmp_lg_u32 s3, 0
  s_cbranch_scc1 q0cs_35
  ds_read_b64_tr_b16 v[40:41], v6 offset:36864
  ds_read_b64_tr_b16 v[42:43], v6 offset:37120
  v_mfma_f32_32x32x16_bf16 a[16:31], v[20:23], v[24:27], a[16:31]
  v_mfma_f32_32x32x16_bf16 a[32:47], v[20:23], v[28:31], a[32:47]
  s_waitcnt lgkmcnt(0)
  v_mfma_f32_32x32x16_bf16 a[0:15], v[20:23], v[40:43], a[0:15]
q0cs_35:
  ds_read_b64_tr_b16 v[24:25], v6 offset:44032
  ds_read_b64_tr_b16 v[26:27], v6 offset:44288
  s_waitcnt lgkmcnt(4)
  v_mfma_f32_32x32x16_bf16 v[64:79], v[32:35], v[212:215], v[64:79]
  ds_read_b64_tr_b16 v[28:29], v6 offset:45056
  ds_read_b64_tr_b16 v[30:31], v6 offset:45312
  s_waitcnt lgkmcnt(4)
  v_mfma_f32_32x32x16_bf16 v[80:95], v[212:215], v[36:39], v[80:95]
  s_cmp_lg_u32 s3, 1
  s_cbranch_scc1 q0cs_36
  ds_read_b64_tr_b16 v[40:41], v6 offset:39936
  ds_read_b64_tr_b16 v[42:43], v6 offset:40192
  v_mfma_f32_32x32x16_bf16 a[16:31], v[20:23], v[32:35], a[16:31]
  v_mfma_f32_32x32x16_bf16 a[32:47], v[20:23], v[36:39], a[32:47]
  s_waitcnt lgkmcnt(0)
  v_mfma_f32_32x32x16_bf16 a[0:15], v[20:23], v[40:43], a[0:15]
q0cs_36:
  ds_read_b64_tr_b16 v[32:33], v6 offset:47104
  ds_read_b64_tr_b16 v[34:35], v6 offset:47360
  s_waitcnt lgkmcnt(4)
  v_mfma_f32_32x32x16_bf16 v[64:79], v[24:27], v[216:219], v[64:79]
  ds_read_b64_tr_b16 v[36:37], v6 offset:48128
  ds_read_b64_tr_b16 v[38:39], v6 offset:48384
  s_waitcnt lgkmcnt(4)
  v_mfma_f32_32x32x16_bf16 v[80:95], v[216:219], v[28:31], v[80:95]
  s_cmp_lg_u32 s3, 2
  s_cbranch_scc1 q0cs_37
  ds_read_b64_tr_b16 v[40:41], v6 offset:43008
  ds_read_b64_tr_b16 v[42:43], v6 offset:43264
  v_mfma_f32_32x32x16_bf16 a[16:31], v[20:23], v[24:27], a[16:31]
  v_mfma_f32_32x32x16_bf16 a[32:47], v[20:23], v[28:31], a[32:47]
  s_waitcnt lgkmcnt(0)
  v_mfma_f32_32x32x16_bf16 a[0:15], v[20:23], v[40:43], a[0:15]
q0cs_37:
  ds_read_b64_tr_b16 v[24:25], v5 offset:0
  ds_read_b64_tr_b16 v[26:27], v5 offset:256
  s_waitcnt lgkmcnt(4)
  v_mfma_f32_32x32x16_bf16 v[64:79], v[32:35], v[220:223], v[64:79]
  ds_read_b64_tr_b16 v[28:29], v5 offset:3072
  ds_read_b64_tr_b16 v[30:31], v5 offset:3328
  s_waitcnt lgkmcnt(4)
  v_mfma_f32_32x32x16_bf16 v[80:95], v[220:223], v[36:39], v[80:95]
  s_cmp_lg_u32 s3, 3
  s_cbranch_scc1 q0cs_38
  ds_read_b64_tr_b16 v[40:41], v6 offset:46080
  ds_read_b64_tr_b16 v[42:43], v6 offset:46336
  v_mfma_f32_32x32x16_bf16 a[16:31], v[20:23], v[32:35], a[16:31]
  v_mfma_f32_32x32x16_bf16 a[32:47], v[20:23], v[36:39], a[32:47]
  s_waitcnt lgkmcnt(0)
  v_mfma_f32_32x32x16_bf16 a[0:15], v[20:23], v[40:43], a[0:15]
q0cs_38:
  ds_read_b64_tr_b16 v[32:33], v5 offset:6144
  ds_read_b64_tr_b16 v[34:35], v5 offset:6400
  s_lshr_b32 s73, s3, 1
  s_lshl_b32 s73, s73, 9
  s_and_b32 s88, s3, 1
  s_lshl_b32 s88, s88, 3
  s_add_u32 s73, s73, s88
  s_add_u32 s73, s73, 98304
  v_and_b32 v14, 0x1ff, v2
  v_add_u32 v14, s73, v14
  v_accvgpr_read_b32 v10, a16
  v_cvt_pk_bf16_f32 v20, v10, v10
  v_and_b32 v21, 0xffff0000, v20
  v_sub_f32 v21, v10, v21
  v_cvt_pk_bf16_f32 v20, v10, v21
  v_mov_b32 v21, 0
  ds_write_b64 v14, v[20:21] offset:1024
  v_accvgpr_read_b32 v10, a32
  v_cvt_pk_bf16_f32 v22, v10, v10
  v_and_b32 v23, 0xffff0000, v22
  v_sub_f32 v23, v10, v23
  v_cvt_pk_bf16_f32 v22, v10, v23
  v_mov_b32 v23, 0
  ds_write_b64 v14, v[22:23] offset:2048
  v_accvgpr_read_b32 v10, a0
  v_cvt_pk_bf16_f32 v16, v10, v10
  v_and_b32 v17, 0xffff0000, v16
  v_sub_f32 v17, v10, v17
  v_cvt_pk_bf16_f32 v16, v10, v17
  v_mov_b32 v17, 0
  ds_write_b64 v14, v[16:17] offset:0
  s_lshl_b32 s74, s72, 15
  s_lshl_b32 s73, s71, 11
  s_add_u32 s74, s74, s73
  s_add_u32 s74, s74, 0x600000
  s_lshl_b32 s75, s71, 18
  s_lshl_b32 s73, s72, 11
  s_add_u32 s75, s75, s73
  s_lshl_b32 s73, s69, 22
  s_add_u32 s75, s75, s73
  s_add_u32 s75, s75, 0x1000000
  s_add_u32 s76, s75, 131072
  s_waitcnt lgkmcnt(0)
  s_barrier
  v_add_u32 v10, 98304, v2
  ds_read_b128 a[72:75], v10 offset:0
  ds_read_b128 a[76:79], v10 offset:1024
  ds_read_b128 a[80:83], v10 offset:2048
  v_lshlrev_b32 v4, 5, v1
  s_mov_b64 exec, 0xff
  buffer_load_dword v3, v4, s[4:7], 0 offen sc0 sc1
  s_mov_b64 exec, -1
  v_mfma_f32_32x32x16_bf16 v[48:63], v[24:27], v[96:99], 0
  ds_read_b64_tr_b16 v[36:37], v5 offset:9216
  ds_read_b64_tr_b16 v[38:39], v5 offset:9472
  v_mfma_f32_32x32x16_bf16 v[48:63], v[28:31], v[100:103], v[48:63]
  ds_read_b64_tr_b16 v[24:25], v5 offset:12288
  ds_read_b64_tr_b16 v[26:27], v5 offset:12544
  v_mfma_f32_32x32x16_bf16 v[48:63], v[32:35], v[104:107], v[48:63]
  ds_read_b64_tr_b16 v[28:29], v5 offset:15360
  ds_read_b64_tr_b16 v[30:31], v5 offset:15616
  s_waitcnt lgkmcnt(4)
  v_mfma_f32_32x32x16_bf16 v[48:63], v[36:39], v[108:111], v[48:63]
  ds_read_b64_tr_b16 v[32:33], v5 offset:18432
  ds_read_b64_tr_b16 v[34:35], v5 offset:18688
  v_mfma_f32_32x32x16_bf16 v[64:79], a[76:79], v[44:47], v[64:79]
  v_mfma_f32_32x32x16_bf16 v[80:95], v[44:47], a[80:83], v[80:95]
  s_waitcnt lgkmcnt(4)
  v_mfma_f32_32x32x16_bf16 v[48:63], v[24:27], v[112:115], v[48:63]
  ds_read_b64_tr_b16 v[36:37], v5 offset:21504
  ds_read_b64_tr_b16 v[38:39], v5 offset:21760
  s_waitcnt lgkmcnt(4)
  v_mfma_f32_32x32x16_bf16 v[48:63], v[28:31], v[116:119], v[48:63]
  ds_read_b64_tr_b16 v[24:25], v5 offset:24576
  ds_read_b64_tr_b16 v[26:27], v5 offset:24832
  s_waitcnt lgkmcnt(4)
  v_mfma_f32_32x32x16_bf16 v[48:63], v[32:35], v[120:123], v[48:63]
  ds_read_b64_tr_b16 v[28:29], v5 offset:27648
  ds_read_b64_tr_b16 v[30:31], v5 offset:27904
  s_waitcnt lgkmcnt(4)
  v_mfma_f32_32x32x16_bf16 v[48:63], v[36:39], v[124:127], v[48:63]
  ds_read_b64_tr_b16 v[32:33], v5 offset:30720
  ds_read_b64_tr_b16 v[34:35], v5 offset:30976
  s_waitcnt lgkmcnt(4)
  v_mfma_f32_32x32x16_bf16 v[48:63], v[24:27], v[128:131], v[48:63]
  ds_read_b64_tr_b16 v[36:37], v5 offset:33792
  ds_read_b64_tr_b16 v[38:39], v5 offset:34048
  ds_read_b128 v[96:99], v11 offset:0
  ds_read_b128 v[100:103], v11 offset:32
  ds_read_b128 v[104:107], v11 offset:64
  s_waitcnt lgkmcnt(7)
  v_mfma_f32_32x32x16_bf16 v[48:63], v[28:31], v[132:135], v[48:63]
  ds_read_b64_tr_b16 v[24:25], v5 offset:36864
  ds_read_b64_tr_b16 v[26:27], v5 offset:37120
  ds_read_b128 v[108:111], v11 offset:96
  v_mul_f32 v64, v64, v19
  v_mul_f32 v65, v65, v19
  s_waitcnt lgkmcnt(8)
  v_mfma_f32_32x32x16_bf16 v[48:63], v[32:35], v[136:139], v[48:63]
  ds_read_b64_tr_b16 v[28:29], v5 offset:39936
  ds_read_b64_tr_b16 v[30:31], v5 offset:40192
  v_mul_f32 v66, v66, v19
  v_mul_f32 v67, v67, v19
  v_mul_f32 v68, v68, v19
  s_waitcnt lgkmcnt(8)
  v_mfma_f32_32x32x16_bf16 v[48:63], v[36:39], v[140:143], v[48:63]
  ds_read_b64_tr_b16 v[32:33], v5 offset:43008
  ds_read_b64_tr_b16 v[34:35], v5 offset:43264
  v_mul_f32 v69, v69, v19
  v_mul_f32 v70, v70, v19
  v_mul_f32 v71, v71, v19
  s_waitcnt lgkmcnt(5)
  v_mfma_f32_32x32x16_bf16 v[48:63], v[24:27], v[144:147], v[48:63]
  ds_read_b64_tr_b16 v[36:37], v5 offset:46080
  ds_read_b64_tr_b16 v[38:39], v5 offset:46336
  v_cvt_pk_bf16_f32 v112, v64, v65
  v_cvt_pk_bf16_f32 v113, v66, v67
  v_cvt_pk_bf16_f32 v114, v68, v69
  s_waitcnt lgkmcnt(4)
  v_mfma_f32_32x32x16_bf16 v[48:63], v[28:31], v[148:151], v[48:63]
  ds_read_b64_tr_b16 v[24:25], v6 offset:0
  ds_read_b64_tr_b16 v[26:27], v6 offset:256
  v_cvt_pk_bf16_f32 v115, v70, v71
  buffer_store_dwordx4 v[112:115], v240, s[36:39], s75 offen sc1
  v_mul_f32 v72, v72, v19
  s_waitcnt lgkmcnt(4)
  v_mfma_f32_32x32x16_bf16 v[48:63], v[32:35], v[152:155], v[48:63]
  ds_read_b64_tr_b16 v[28:29], v6 offset:3072
  ds_read_b64_tr_b16 v[30:31], v6 offset:3328
  v_mul_f32 v73, v73, v19
  v_mul_f32 v74, v74, v19
  v_mul_f32 v75, v75, v19
  s_waitcnt lgkmcnt(4)
  v_mfma_f32_32x32x16_bf16 v[48:63], v[36:39], v[156:159], v[48:63]
  ds_read_b64_tr_b16 v[32:33], v6 offset:6144
  ds_read_b64_tr_b16 v[34:35], v6 offset:6400
  v_mul_f32 v76, v76, v19
  v_mul_f32 v77, v77, v19
  v_mul_f32 v78, v78, v19
  s_waitcnt lgkmcnt(4)
  v_mfma_f32_32x32x16_bf16 v[48:63], v[24:27], v[160:163], v[48:63]
  ds_read_b64_tr_b16 v[36:37], v6 offset:9216
  ds_read_b64_tr_b16 v[38:39], v6 offset:9472
  v_mul_f32 v79, v79, v19
  v_cvt_pk_bf16_f32 v116, v72, v73
  v_cvt_pk_bf16_f32 v117, v74, v75
  s_waitcnt lgkmcnt(4)
  v_mfma_f32_32x32x16_bf16 v[48:63], v[28:31], v[164:167], v[48:63]
  ds_read_b64_tr_b16 v[24:25], v6 offset:12288
  ds_read_b64_tr_b16 v[26:27], v6 offset:12544
  v_cvt_pk_bf16_f32 v118, v76, v77
  v_cvt_pk_bf16_f32 v119, v78, v79
  buffer_store_dwordx4 v[116:119], v240, s[36:39], s76 offen sc1
  s_waitcnt lgkmcnt(4)
  v_mfma_f32_32x32x16_bf16 v[48:63], v[32:35], v[168:171], v[48:63]
  ds_read_b64_tr_b16 v[28:29], v6 offset:15360
  ds_read_b64_tr_b16 v[30:31], v6 offset:15616
  v_mul_f32 v80, v80, v96
  v_mul_f32 v81, v81, v97
  v_mul_f32 v82, v82, v98
  s_waitcnt lgkmcnt(4)
  v_mfma_f32_32x32x16_bf16 v[48:63], v[36:39], v[172:175], v[48:63]
  ds_read_b64_tr_b16 v[32:33], v6 offset:18432
  ds_read_b64_tr_b16 v[34:35], v6 offset:18688
  v_mul_f32 v83, v83, v99
  v_mul_f32 v84, v84, v100
  v_mul_f32 v85, v85, v101
  s_waitcnt lgkmcnt(4)
  v_mfma_f32_32x32x16_bf16 v[48:63], v[24:27], v[176:179], v[48:63]
  ds_read_b64_tr_b16 v[36:37], v6 offset:21504
  ds_read_b64_tr_b16 v[38:39], v6 offset:21760
  v_mul_f32 v86, v86, v102
  v_mul_f32 v87, v87, v103
  v_cvt_pk_bf16_f32 v120, v80, v81
  s_waitcnt lgkmcnt(4)
  v_mfma_f32_32x32x16_bf16 v[48:63], v[28:31], v[180:183], v[48:63]
  ds_read_b64_tr_b16 v[24:25], v6 offset:24576
  ds_read_b64_tr_b16 v[26:27], v6 offset:24832
  v_cvt_pk_bf16_f32 v121, v82, v83
  v_cvt_pk_bf16_f32 v122, v84, v85
  v_cvt_pk_bf16_f32 v123, v86, v87
  s_waitcnt lgkmcnt(4)
  v_mfma_f32_32x32x16_bf16 v[48:63], v[32:35], v[184:187], v[48:63]
  ds_read_b64_tr_b16 v[28:29], v6 offset:27648
  ds_read_b64_tr_b16 v[30:31], v6 offset:27904
  buffer_store_dwordx4 v[120:123], v239, s[36:39], s75 offen offset:0 sc1
  v_mul_f32 v88, v88, v104
  v_mul_f32 v89, v89, v105
  s_waitcnt lgkmcnt(4)
  v_mfma_f32_32x32x16_bf16 v[48:63], v[36:39], v[188:191], v[48:63]
  ds_read_b64_tr_b16 v[32:33], v6 offset:30720
  ds_read_b64_tr_b16 v[34:35], v6 offset:30976
  v_mul_f32 v90, v90, v106
  v_mul_f32 v91, v91, v107
  v_mul_f32 v92, v92, v108
  s_waitcnt lgkmcnt(4)
  v_mfma_f32_32x32x16_bf16 v[48:63], v[24:27], v[192:195], v[48:63]
  ds_read_b64_tr_b16 v[36:37], v6 offset:33792
  ds_read_b64_tr_b16 v[38:39], v6 offset:34048
  v_mul_f32 v93, v93, v109
  v_mul_f32 v94, v94, v110
  v_mul_f32 v95, v95, v111
  s_waitcnt lgkmcnt(4)
  v_mfma_f32_32x32x16_bf16 v[48:63], v[28:31], v[196:199], v[48:63]
  ds_read_b64_tr_b16 v[24:25], v6 offset:36864
  ds_read_b64_tr_b16 v[26:27], v6 offset:37120
  v_cvt_pk_bf16_f32 v124, v88, v89
  v_cvt_pk_bf16_f32 v125, v90, v91
  v_cvt_pk_bf16_f32 v126, v92, v93
  s_waitcnt lgkmcnt(4)
  v_mfma_f32_32x32x16_bf16 v[48:63], v[32:35], v[200:203], v[48:63]
  ds_read_b64_tr_b16 v[28:29], v6 offset:39936
  ds_read_b64_tr_b16 v[30:31], v6 offset:40192
  v_cvt_pk_bf16_f32 v127, v94, v95
  buffer_store_dwordx4 v[124:127], v239, s[36:39], s75 offen offset:512 sc1
  s_waitcnt lgkmcnt(4)
  v_mfma_f32_32x32x16_bf16 v[48:63], v[36:39], v[204:207], v[48:63]
  ds_read_b64_tr_b16 v[32:33], v6 offset:43008
  ds_read_b64_tr_b16 v[34:35], v6 offset:43264
  s_waitcnt lgkmcnt(4)
  v_mfma_f32_32x32x16_bf16 v[48:63], v[24:27], v[208:211], v[48:63]
  ds_read_b64_tr_b16 v[36:37], v6 offset:46080
  ds_read_b64_tr_b16 v[38:39], v6 offset:46336
  s_waitcnt lgkmcnt(4)
  v_mfma_f32_32x32x16_bf16 v[48:63], v[28:31], v[212:215], v[48:63]
  s_waitcnt lgkmcnt(2)
  v_mfma_f32_32x32x16_bf16 v[48:63], v[32:35], v[216:219], v[48:63]
  s_waitcnt lgkmcnt(0)
  v_mfma_f32_32x32x16_bf16 v[48:63], v[36:39], v[220:223], v[48:63]
  v_mfma_f32_32x32x16_bf16 v[48:63], a[72:75], v[44:47], v[48:63]
  s_or_b32 s73, s70, s3
  s_cmp_lg_u32 s73, 0
  s_cbranch_scc1 q0_nocs
  s_lshl_b32 s73, s71, 10
  s_add_u32 s73, s73, 0x4c0000
  buffer_store_dwordx4 a[72:75], v2, s[36:39], s73 offen sc1
  s_add_u32 s73, s73, 16384
  buffer_store_dwordx4 a[76:79], v2, s[36:39], s73 offen sc1
  s_add_u32 s73, s73, 16384
  buffer_store_dwordx4 a[80:83], v2, s[36:39], s73 offen sc1
  s_add_u32 s73, s73, 16384
q0_nocs:
  s_nop 8
  v_mul_f32 v48, v48, v15
  v_mul_f32 v49, v49, v15
  v_mul_f32 v50, v50, v15
  v_mul_f32 v51, v51, v15
  v_mul_f32 v52, v52, v15
  v_mul_f32 v53, v53, v15
  v_mul_f32 v54, v54, v15
  v_mul_f32 v55, v55, v15
  v_cvt_pk_bf16_f32 v128, v48, v49
  v_cvt_pk_bf16_f32 v129, v50, v51
  v_cvt_pk_bf16_f32 v130, v52, v53
  v_cvt_pk_bf16_f32 v131, v54, v55
  buffer_store_dwordx4 v[128:131], v2, s[36:39], s74 offen offset:0 sc1
  v_mul_f32 v56, v56, v15
  v_mul_f32 v57, v57, v15
  v_mul_f32 v58, v58, v15
  v_mul_f32 v59, v59, v15
  v_mul_f32 v60, v60, v15
  v_mul_f32 v61, v61, v15
  v_mul_f32 v62, v62, v15
  v_mul_f32 v63, v63, v15
  v_cvt_pk_bf16_f32 v132, v56, v57
  v_cvt_pk_bf16_f32 v133, v58, v59
  v_cvt_pk_bf16_f32 v134, v60, v61
  v_cvt_pk_bf16_f32 v135, v62, v63
  buffer_store_dwordx4 v[132:135], v2, s[36:39], s74 offen offset:1024 sc1
  s_waitcnt vmcnt(0)
  s_cmp_lg_u32 s3, 0
  s_cbranch_scc1 q0_nr
  v_mov_b32 v10, 159744
  s_mov_b64 exec, 1
  ds_write_b32 v10, v238
  s_mov_b64 exec, -1
  s_waitcnt lgkmcnt(0)
q0_nr:
  s_barrier
  s_lshl_b32 s73, s71, 4
  s_add_u32 s73, s73, s70
  v_mov_b32 v10, 159744
  ds_read_b32 v238, v10
  s_mov_b32 s8, 0
  s_mov_b64 exec, 0xff
  s_branch q0_pc2
q0_pc:
  buffer_load_dword v3, v4, s[4:7], 0 offen sc0 sc1
  s_add_u32 s8, s8, 1
  s_cmp_gt_u32 s8, 0x80000
  s_cbranch_scc1 L_abort
q0_pc2:
  s_waitcnt vmcnt(0) lgkmcnt(0)
  v_cmp_eq_u32 vcc, 32, v3
  v_readlane_b32 s84, v3, 0
  v_readlane_b32 s85, v3, 1
  s_nop 0
  s_add_u32 s84, s84, s85
  v_readlane_b32 s85, v3, 2
  s_nop 0
  s_add_u32 s84, s84, s85
  v_readlane_b32 s85, v3, 3
  s_nop 0
  s_add_u32 s84, s84, s85
  v_readlane_b32 s85, v3, 4
  s_nop 0
  s_add_u32 s84, s84, s85
  v_readlane_b32 s85, v3, 5
  s_nop 0
  s_add_u32 s84, s84, s85
  v_readlane_b32 s85, v3, 6
  s_nop 0
  s_add_u32 s84, s84, s85
  v_readlane_b32 s85, v3, 7
  s_nop 0
  s_add_u32 s84, s84, s85
  s_cmp_lg_u32 s84, 256
  s_cbranch_scc1 q0_pc
  s_mov_b64 exec, -1
  s_lshl_b32 s96, s73, 2
  s_add_u32 s96, s96, s3
  s_lshl_b32 s96, s96, 2
  s_add_u32 s96, s96, s68
  s_add_u32 s96, s96, 0x4f0000
  s_mov_b64 exec, 1
  buffer_store_dword v229, off, s[36:39], s96 sc0 sc1
  s_mov_b64 exec, -1
  s_cmp_eq_u32 vcc_lo, 0xff
  s_cselect_b32 s84, 1, 0
  v_readfirstlane_b32 s85, v238
  s_cmp_eq_u32 s84, 1
  s_nop 1
  s_cselect_b32 s10, s85, s10
  s_cselect_b32 s9, s11, s9
  s_cmp_eq_u32 s84, 1
  s_cbranch_scc0 G_att
  s_branch L_att
L_end:
L_abort:
  s_endpgm
L_layer:
  s_lshr_b32 s74, s10, 1
  s_lshl_b32 s74, s74, 10
  s_add_u32 s74, s74, 0x4c0000
  buffer_load_dwordx4 v[24:27], v2, s[36:39], s74 offen sc1
  s_add_u32 s74, s74, 16384
  buffer_load_dwordx4 v[28:31], v2, s[36:39], s74 offen sc1
  s_add_u32 s74, s74, 16384
  buffer_load_dwordx4 v[32:35], v2, s[36:39], s74 offen sc1
  s_add_u32 s74, s74, 16384
  s_mov_b32 s73, s51
  s_mov_b32 s75, s58
  s_mov_b32 s76, s59
  s_add_u32 s77, s59, 131072
  s_sub_u32 s78, s51, 0x800000
  s_lshr_b32 s78, s78, 15
  s_mul_i32 s78, s78, 88064
  s_lshr_b32 s79, s10, 1
  s_lshl_b32 s79, s79, 12
  s_add_u32 s78, s78, s79
  s_add_u32 s78, s78, 0xa00000
  s_add_u32 s79, s56, 0x4000
  v_bfe_u32 v6, v1, 4, 1
  v_and_b32 v7, 0xffff, v239
  v_lshl_add_u32 v7, v6, 11, v7
  s_waitcnt vmcnt(0) lgkmcnt(0)
  buffer_load_dword v224, v225, s[36:39], s96 offen sc0 sc1
  s_barrier
  s_mov_b32 s8, 0
  s_waitcnt vmcnt(0)
  s_branch pchk_41
pl_39:
  buffer_load_dword v224, v225, s[36:39], s96 offen sc0 sc1
  s_add_u32 s8, s8, 1
  s_cmp_gt_u32 s8, 0x80000
  s_cbranch_scc1 L_abort
  s_waitcnt vmcnt(0)
pchk_41:
  v_cmp_ne_u32 vcc, 1, v224
  s_nop 3
  s_cbranch_vccnz pl_39
  buffer_load_dwordx4 a[0:3], v2, s[36:39], s73 offen offset:0 sc1
  buffer_load_dwordx4 a[4:7], v2, s[36:39], s73 offen offset:1024 sc1
  buffer_load_dwordx4 a[8:11], v2, s[36:39], s73 offen offset:2048 sc1
  buffer_load_dwordx4 a[12:15], v2, s[36:39], s73 offen offset:3072 sc1
  s_add_u32 s73, s73, 4096
  buffer_load_dwordx4 a[16:19], v2, s[36:39], s73 offen offset:0 sc1
  buffer_load_dwordx4 a[20:23], v2, s[36:39], s73 offen offset:1024 sc1
  buffer_load_dwordx4 v[8:11], v2, s[36:39], s52 offen offset:0 sc1
  buffer_load_dwordx4 v[12:15], v2, s[36:39], s52 offen offset:1024 sc1
  buffer_load_dwordx4 v[16:19], v2, s[36:39], s52 offen offset:2048 sc1
  buffer_load_dwordx4 v[20:23], v2, s[36:39], s52 offen offset:3072 sc1
  buffer_load_dwordx4 a[24:27], v2, s[36:39], s73 offen offset:2048 sc1
  buffer_load_dwordx4 a[28:31], v2, s[36:39], s73 offen offset:3072 sc1
  s_add_u32 s73, s73, 4096
  ds_read_b128 v[48:51], v222 offset:29696
  ds_read_b128 v[52:55], v222 offset:30720
  ds_read_b128 v[56:59], v222 offset:32768
  s_waitcnt vmcnt(11)
  s_waitcnt lgkmcnt(2)
  v_mfma_f32_32x32x16_bf16 v[88:103], v[48:51], a[0:3], 0
  buffer_load_dwordx4 a[32:35], v2, s[36:39], s73 offen offset:0 sc1
  ds_read_b128 v[60:63], v222 offset:33792
  s_waitcnt lgkmcnt(2)
  v_mfma_f32_32x32x16_bf16 v[104:119], a[0:3], v[52:55], 0
  ds_read_b128 v[48:51], v222 offset:35840
  s_waitcnt vmcnt(11)
  s_waitcnt lgkmcnt(2)
  v_mfma_f32_32x32x16_bf16 v[88:103], v[56:59], a[4:7], v[88:103]
  buffer_load_dwordx4 a[36:39], v2, s[36:39], s73 offen offset:1024 sc1
  ds_read_b128 v[52:55], v222 offset:36864
  s_waitcnt lgkmcnt(2)
  v_mfma_f32_32x32x16_bf16 v[104:119], a[4:7], v[60:63], v[104:119]
  ds_read_b128 v[56:59], v222 offset:38912
  s_waitcnt vmcnt(11)
  s_waitcnt lgkmcnt(2)
  v_mfma_f32_32x32x16_bf16 v[88:103], v[48:51], a[8:11], v[88:103]
  buffer_load_dwordx4 a[40:43], v2, s[36:39], s73 offen offset:2048 sc1
  ds_read_b128 v[60:63], v222 offset:39936
  s_waitcnt lgkmcnt(2)
  v_mfma_f32_32x32x16_bf16 v[104:119], a[8:11], v[52:55], v[104:119]
  ds_read_b128 v[48:51], v223 offset:13312
  s_waitcnt vmcnt(11)
  s_waitcnt lgkmcnt(2)
  v_mfma_f32_32x32x16_bf16 v[88:103], v[56:59], a[12:15], v[88:103]
  buffer_load_dwordx4 a[44:47], v2, s[36:39], s73 offen offset:3072 sc1
  ds_read_b128 v[52:55], v223 offset:14336
  s_add_u32 s73, s73, 4096
  s_waitcnt lgkmcnt(2)
  v_mfma_f32_32x32x16_bf16 v[104:119], a[12:15], v[60:63], v[104:119]
  ds_read_b128 v[56:59], v223 offset:16384
  s_waitcnt vmcnt(11)
  s_waitcnt lgkmcnt(2)
  v_mfma_f32_32x32x16_bf16 v[88:103], v[48:51], a[16:19], v[88:103]
  buffer_load_dwordx4 a[48:51], v2, s[36:39], s73 offen offset:0 sc1
  ds_read_b128 v[60:63], v223 offset:17408
  s_waitcnt lgkmcnt(2)
  v_mfma_f32_32x32x16_bf16 v[104:119], a[16:19], v[52:55], v[104:119]
  ds_read_b128 v[48:51], v223 offset:19456
  s_waitcnt vmcnt(11)
  s_waitcnt lgkmcnt(2)
  v_mfma_f32_32x32x16_bf16 v[88:103], v[56:59], a[20:23], v[88:103]
  buffer_load_dwordx4 a[52:55], v2, s[36:39], s73 offen offset:1024 sc1
  ds_read_b128 v[52:55], v223 offset:20480
  s_waitcnt lgkmcnt(2)
  v_mfma_f32_32x32x16_bf16 v[104:119], a[20:23], v[60:63], v[104:119]
  ds_read_b128 v[56:59], v223 offset:22528
  s_waitcnt vmcnt(7)
  s_waitcnt lgkmcnt(2)
  v_mfma_f32_32x32x16_bf16 v[88:103], v[48:51], a[24:27], v[88:103]
  buffer_load_dwordx4 a[56:59], v2, s[36:39], s73 offen offset:2048 sc1
  ds_read_b128 v[60:63], v223 offset:23552
  s_waitcnt lgkmcnt(2)
  v_mfma_f32_32x32x16_bf16 v[104:119], a[24:27], v[52:55], v[104:119]
  ds_read_b128 v[48:51], v223 offset:25600
  s_waitcnt vmcnt(7)
  s_waitcnt lgkmcnt(2)
  v_mfma_f32_32x32x16_bf16 v[88:103], v[56:59], a[28:31], v[88:103]
  buffer_load_dwordx4 a[60:63], v2, s[36:39], s73 offen offset:3072 sc1
  ds_read_b128 v[52:55], v223 offset:26624
  s_add_u32 s73, s73, 4096
  s_waitcnt lgkmcnt(2)
  v_mfma_f32_32x32x16_bf16 v[104:119], a[28:31], v[60:63], v[104:119]
  ds_read_b128 v[56:59], v223 offset:28672
  s_waitcnt vmcnt(7)
  s_waitcnt lgkmcnt(2)
  v_mfma_f32_32x32x16_bf16 v[88:103], v[48:51], a[32:35], v[88:103]
  buffer_load_dwordx4 a[64:67], v2, s[36:39], s73 offen offset:0 sc1
  ds_read_b128 v[60:63], v223 offset:29696
  v_add_f32 v8, v8, v16
  v_add_f32 v9, v9, v17
  s_waitcnt lgkmcnt(2)
  v_mfma_f32_32x32x16_bf16 v[104:119], a[32:35], v[52:55], v[104:119]
  ds_read_b128 v[48:51], v223 offset:31744
  v_add_f32 v10, v10, v18
  v_add_f32 v11, v11, v19
  s_waitcnt vmcnt(7)
  s_waitcnt lgkmcnt(2)
  v_mfma_f32_32x32x16_bf16 v[88:103], v[56:59], a[36:39], v[88:103]
  buffer_load_dwordx4 a[68:71], v2, s[36:39], s73 offen offset:1024 sc1
  ds_read_b128 v[52:55], v223 offset:32768
  v_add_f32 v12, v12, v20
  v_add_f32 v13, v13, v21
  s_waitcnt lgkmcnt(2)
  v_mfma_f32_32x32x16_bf16 v[104:119], a[36:39], v[60:63], v[104:119]
  ds_read_b128 v[56:59], v223 offset:34816
  v_add_f32 v14, v14, v22
  v_add_f32 v15, v15, v23
  s_waitcnt vmcnt(7)
  s_waitcnt lgkmcnt(2)
  v_mfma_f32_32x32x16_bf16 v[88:103], v[48:51], a[40:43], v[88:103]
  buffer_load_dwordx4 a[72:75], v2, s[36:39], s73 offen offset:2048 sc1
  ds_read_b128 v[60:63], v223 offset:35840
  v_add_f32 v8, v8, v12
  v_add_f32 v9, v9, v13
  s_waitcnt lgkmcnt(2)
  v_mfma_f32_32x32x16_bf16 v[104:119], a[40:43], v[52:55], v[104:119]
  ds_read_b128 v[48:51], v2 offset:1024
  v_add_f32 v10, v10, v14
  v_add_f32 v11, v11, v15
  s_waitcnt vmcnt(7)
  s_waitcnt lgkmcnt(2)
  v_mfma_f32_32x32x16_bf16 v[88:103], v[56:59], a[44:47], v[88:103]
  buffer_load_dwordx4 a[76:79], v2, s[36:39], s73 offen offset:3072 sc1
  ds_read_b128 v[52:55], v2 offset:2048
  s_add_u32 s73, s73, 4096
  v_add_f32 v8, v8, v10
  v_add_f32 v9, v9, v11
  s_waitcnt lgkmcnt(2)
  v_mfma_f32_32x32x16_bf16 v[104:119], a[44:47], v[60:63], v[104:119]
  ds_read_b128 v[56:59], v2 offset:4096
  v_mov_b32 v42, v8
  v_mov_b32 v43, v9
  s_waitcnt vmcnt(7)
  s_waitcnt lgkmcnt(2)
  v_mfma_f32_32x32x16_bf16 v[88:103], v[48:51], a[48:51], v[88:103]
  buffer_load_dwordx4 a[80:83], v2, s[36:39], s73 offen offset:0 sc1
  ds_read_b128 v[60:63], v2 offset:5120
  s_nop 0
  v_permlane32_swap_b32 v8, v42
  s_waitcnt lgkmcnt(2)
  v_mfma_f32_32x32x16_bf16 v[104:119], a[48:51], v[52:55], v[104:119]
  ds_read_b128 v[48:51], v2 offset:7168
  v_permlane32_swap_b32 v9, v43
  v_add_f32 v8, v8, v42
  s_waitcnt vmcnt(7)
  s_waitcnt lgkmcnt(2)
  v_mfma_f32_32x32x16_bf16 v[88:103], v[56:59], a[52:55], v[88:103]
  buffer_load_dwordx4 a[84:87], v2, s[36:39], s73 offen offset:1024 sc1
  ds_read_b128 v[52:55], v2 offset:8192
  v_add_f32 v9, v9, v43
  v_mul_f32 v40, 0.001953125, v8
  s_waitcnt lgkmcnt(2)
  v_mfma_f32_32x32x16_bf16 v[104:119], a[52:55], v[60:63], v[104:119]
  ds_read_b128 v[56:59], v2 offset:10240
  v_mul_f32 v9, 0.001953125, v9
  v_fma_f32 v9, -v40, v40, v9
  s_waitcnt vmcnt(7)
  s_waitcnt lgkmcnt(2)
  v_mfma_f32_32x32x16_bf16 v[88:103], v[48:51], a[56:59], v[88:103]
  buffer_load_dwordx4 a[88:91], v2, s[36:39], s73 offen offset:2048 sc1
  ds_read_b128 v[60:63], v2 offset:11264
  v_max_f32 v9, 0, v9
  v_cvt_pk_bf16_f32 v9, v9, v9
  s_waitcnt lgkmcnt(2)
  v_mfma_f32_32x32x16_bf16 v[104:119], a[56:59], v[52:55], v[104:119]
  ds_read_b128 v[48:51], v2 offset:13312
  v_and_b32 v9, 0xffff0000, v9
  v_add_f32 v9, 0x3727c5ac, v9
  s_waitcnt vmcnt(7)
  s_waitcnt lgkmcnt(2)
  v_mfma_f32_32x32x16_bf16 v[88:103], v[56:59], a[60:63], v[88:103]
  buffer_load_dwordx4 a[92:95], v2, s[36:39], s73 offen offset:3072 sc1
  ds_read_b128 v[52:55], v2 offset:14336
  s_add_u32 s73, s73, 4096
  v_cvt_pk_bf16_f32 v9, v9, v9
  v_and_b32 v9, 0xffff0000, v9
  s_waitcnt lgkmcnt(2)
  v_mfma_f32_32x32x16_bf16 v[104:119], a[60:63], v[60:63], v[104:119]
  ds_read_b128 v[56:59], v2 offset:16384
  v_sqrt_f32 v9, v9
  v_sub_f32 v42, 0, v40
  s_waitcnt vmcnt(7)
  s_waitcnt lgkmcnt(2)
  v_mfma_f32_32x32x16_bf16 v[88:103], v[48:51], a[64:67], v[88:103]
  buffer_load_dwordx4 a[96:99], v2, s[36:39], s73 offen offset:0 sc1
  ds_read_b128 v[60:63], v2 offset:17408
  v_cvt_pk_bf16_f32 v9, v9, v9
  v_and_b32 v9, 0xffff0000, v9
  s_waitcnt lgkmcnt(2)
  v_mfma_f32_32x32x16_bf16 v[104:119], a[64:67], v[52:55], v[104:119]
  ds_read_b128 v[48:51], v2 offset:19456
  v_rcp_f32 v41, v9
  v_cvt_pk_bf16_f32 v36, v42, v42
  s_waitcnt vmcnt(7)
  s_waitcnt lgkmcnt(2)
  v_mfma_f32_32x32x16_bf16 v[88:103], v[56:59], a[68:71], v[88:103]
  buffer_load_dwordx4 a[100:103], v2, s[36:39], s73 offen offset:1024 sc1
  ds_read_b128 v[52:55], v2 offset:20480
  v_mov_b32 v37, v36
  v_mov_b32 v38, v36
  s_waitcnt lgkmcnt(2)
  v_mfma_f32_32x32x16_bf16 v[104:119], a[68:71], v[60:63], v[104:119]
  ds_read_b128 v[56:59], v2 offset:22528
  v_mov_b32 v39, v36
  s_lshl_b32 s74, s3, 7
  s_waitcnt vmcnt(7)
  s_waitcnt lgkmcnt(2)
  v_mfma_f32_32x32x16_bf16 v[88:103], v[48:51], a[72:75], v[88:103]
  buffer_load_dwordx4 a[104:107], v2, s[36:39], s73 offen offset:2048 sc1
  ds_read_b128 v[60:63], v2 offset:23552
  s_add_u32 s74, s74, 159744
  v_and_b32 v42, 31, v1
  s_waitcnt lgkmcnt(2)
  v_mfma_f32_32x32x16_bf16 v[104:119], a[72:75], v[52:55], v[104:119]
  ds_read_b128 v[48:51], v2 offset:25600
  v_lshlrev_b32 v42, 2, v42
  v_add_u32 v42, s74, v42
  s_waitcnt vmcnt(7)
  s_waitcnt lgkmcnt(2)
  v_mfma_f32_32x32x16_bf16 v[88:103], v[56:59], a[76:79], v[88:103]
  buffer_load_dwordx4 a[108:111], v2, s[36:39], s73 offen offset:3072 sc1
  ds_read_b128 v[52:55], v2 offset:26624
  s_add_u32 s73, s73, 4096
  ds_write_b32 v42, v41
  v_lshrrev_b32 v43, 5, v1
  s_waitcnt lgkmcnt(3)
  v_mfma_f32_32x32x16_bf16 v[104:119], a[76:79], v[60:63], v[104:119]
  ds_read_b128 v[56:59], v2 offset:28672
  v_lshlrev_b32 v43, 4, v43
  v_add_u32 v43, s74, v43
  s_waitcnt vmcnt(7)
  s_waitcnt lgkmcnt(3)
  v_mfma_f32_32x32x16_bf16 v[88:103], v[48:51], a[80:83], v[88:103]
  buffer_load_dwordx4 a[112:115], v2, s[36:39], s73 offen offset:0 sc1
  ds_read_b128 v[60:63], v2 offset:29696
  ds_read_b128 v[120:123], v43 offset:0
  ds_read_b128 v[124:127], v43 offset:32
  s_waitcnt lgkmcnt(5)
  v_mfma_f32_32x32x16_bf16 v[104:119], a[80:83], v[52:55], v[104:119]
  ds_read_b128 v[48:51], v2 offset:31744
  ds_read_b128 v[128:131], v43 offset:64
  ds_read_b128 v[132:135], v43 offset:96
  s_waitcnt vmcnt(7)
  s_waitcnt lgkmcnt(6)
  v_mfma_f32_32x32x16_bf16 v[88:103], v[56:59], a[84:87], v[88:103]
  buffer_load_dwordx4 a[116:119], v2, s[36:39], s73 offen offset:1024 sc1
  ds_read_b128 v[52:55], v2 offset:32768
  v_mul_f32 v42, 0x3eb8aa3b, v41
  s_waitcnt lgkmcnt(6)
  v_mfma_f32_32x32x16_bf16 v[104:119], a[84:87], v[60:63], v[104:119]
  ds_read_b128 v[56:59], v2 offset:34816
  s_waitcnt vmcnt(7)
  s_waitcnt lgkmcnt(4)
  v_mfma_f32_32x32x16_bf16 v[88:103], v[48:51], a[88:91], v[88:103]
  buffer_load_dwordx4 a[120:123], v2, s[36:39], s73 offen offset:2048 sc1
  ds_read_b128 v[60:63], v2 offset:35840
  s_waitcnt lgkmcnt(2)
  v_mfma_f32_32x32x16_bf16 v[104:119], a[88:91], v[52:55], v[104:119]
  ds_read_b128 v[48:51], v2 offset:37888
  s_waitcnt vmcnt(7)
  s_waitcnt lgkmcnt(2)
  v_mfma_f32_32x32x16_bf16 v[88:103], v[56:59], a[92:95], v[88:103]
  buffer_load_dwordx4 a[124:127], v2, s[36:39], s73 offen offset:3072 sc1
  ds_read_b128 v[52:55], v2 offset:38912
  s_add_u32 s73, s73, 4096
  s_waitcnt lgkmcnt(2)
  v_mfma_f32_32x32x16_bf16 v[104:119], a[92:95], v[60:63], v[104:119]
  ds_read_b128 v[56:59], v2 offset:40960
  s_waitcnt vmcnt(7)
  s_waitcnt lgkmcnt(2)
  v_mfma_f32_32x32x16_bf16 v[88:103], v[48:51], a[96:99], v[88:103]
  ds_read_b128 v[60:63], v2 offset:41984
  s_waitcnt lgkmcnt(2)
  v_mfma_f32_32x32x16_bf16 v[104:119], a[96:99], v[52:55], v[104:119]
  ds_read_b128 v[48:51], v2 offset:44032
  s_waitcnt vmcnt(6)
  s_waitcnt lgkmcnt(2)
  v_mfma_f32_32x32x16_bf16 v[88:103], v[56:59], a[100:103], v[88:103]
  ds_read_b128 v[52:55], v2 offset:45056
  s_waitcnt lgkmcnt(2)
  v_mfma_f32_32x32x16_bf16 v[104:119], a[100:103], v[60:63], v[104:119]
  ds_read_b128 v[56:59], v2 offset:47104
  s_waitcnt vmcnt(5)
  s_waitcnt lgkmcnt(2)
  v_mfma_f32_32x32x16_bf16 v[88:103], v[48:51], a[104:107], v[88:103]
  ds_read_b128 v[60:63], v2 offset:48128
  s_waitcnt lgkmcnt(2)
  v_mfma_f32_32x32x16_bf16 v[104:119], a[104:107], v[52:55], v[104:119]
  ds_read_b128 v[48:51], v2 offset:50176
  s_waitcnt vmcnt(4)
  s_waitcnt lgkmcnt(2)
  v_mfma_f32_32x32x16_bf16 v[88:103], v[56:59], a[108:111], v[88:103]
  ds_read_b128 v[52:55], v2 offset:51200
  s_waitcnt lgkmcnt(2)
  v_mfma_f32_32x32x16_bf16 v[104:119], a[108:111], v[60:63], v[104:119]
  ds_read_b128 v[56:59], v2 offset:53248
  s_waitcnt vmcnt(3)
  s_waitcnt lgkmcnt(2)
  v_mfma_f32_32x32x16_bf16 v[88:103], v[48:51], a[112:115], v[88:103]
  ds_read_b128 v[60:63], v2 offset:54272
  s_waitcnt lgkmcnt(2)
  v_mfma_f32_32x32x16_bf16 v[104:119], a[112:115], v[52:55], v[104:119]
  ds_read_b128 v[48:51], v2 offset:56320
  s_waitcnt vmcnt(2)
  s_waitcnt lgkmcnt(2)
  v_mfma_f32_32x32x16_bf16 v[88:103], v[56:59], a[116:119], v[88:103]
  ds_read_b128 v[52:55], v2 offset:57344
  s_waitcnt lgkmcnt(2)
  v_mfma_f32_32x32x16_bf16 v[104:119], a[116:119], v[60:63], v[104:119]
  ds_read_b128 v[56:59], v2 offset:59392
  s_waitcnt vmcnt(1)
  s_waitcnt lgkmcnt(2)
  v_mfma_f32_32x32x16_bf16 v[88:103], v[48:51], a[120:123], v[88:103]
  ds_read_b128 v[60:63], v2 offset:60416
  s_waitcnt lgkmcnt(2)
  v_mfma_f32_32x32x16_bf16 v[104:119], a[120:123], v[52:55], v[104:119]
  ds_read_b128 v[48:51], v222 offset:28672
  s_waitcnt vmcnt(0)
  s_waitcnt lgkmcnt(2)
  v_mfma_f32_32x32x16_bf16 v[88:103], v[56:59], a[124:127], v[88:103]
  ds_read_b128 v[52:55], v222 offset:31744
  s_waitcnt lgkmcnt(2)
  v_mfma_f32_32x32x16_bf16 v[104:119], a[124:127], v[60:63], v[104:119]
  ds_read_b128 v[56:59], v222 offset:34816
  v_mfma_f32_32x32x16_bf16 v[88:103], v[28:31], v[36:39], v[88:103]
  v_mfma_f32_32x32x16_bf16 v[104:119], v[36:39], v[32:35], v[104:119]
  s_waitcnt lgkmcnt(2)
  v_mfma_f32_32x32x16_bf16 v[72:87], v[48:51], a[0:3], 0
  ds_read_b128 v[60:63], v222 offset:37888
  s_waitcnt lgkmcnt(2)
  v_mfma_f32_32x32x16_bf16 v[72:87], v[52:55], a[4:7], v[72:87]
  ds_read_b128 v[48:51], v223 offset:12288
  s_waitcnt lgkmcnt(2)
  v_mfma_f32_32x32x16_bf16 v[72:87], v[56:59], a[8:11], v[72:87]
  ds_read_b128 v[52:55], v223 offset:15360
  s_waitcnt lgkmcnt(2)
  v_mfma_f32_32x32x16_bf16 v[72:87], v[60:63], a[12:15], v[72:87]
  ds_read_b128 v[56:59], v223 offset:18432
  s_waitcnt lgkmcnt(2)
  v_mfma_f32_32x32x16_bf16 v[72:87], v[48:51], a[16:19], v[72:87]
  ds_read_b128 v[60:63], v223 offset:21504
  v_mul_f32 v88, v88, v41
  v_mul_f32 v89, v89, v41
  v_mul_f32 v90, v90, v41
  s_waitcnt lgkmcnt(2)
  v_mfma_f32_32x32x16_bf16 v[72:87], v[52:55], a[20:23], v[72:87]
  ds_read_b128 v[48:51], v223 offset:24576
  v_mul_f32 v91, v91, v41
  v_mul_f32 v92, v92, v41
  v_mul_f32 v93, v93, v41
  s_waitcnt lgkmcnt(2)
  v_mfma_f32_32x32x16_bf16 v[72:87], v[56:59], a[24:27], v[72:87]
  ds_read_b128 v[52:55], v223 offset:27648
  v_mul_f32 v94, v94, v41
  v_mul_f32 v95, v95, v41
  v_cvt_pk_bf16_f32 v136, v88, v89
  s_waitcnt lgkmcnt(2)
  v_mfma_f32_32x32x16_bf16 v[72:87], v[60:63], a[28:31], v[72:87]
  ds_read_b128 v[56:59], v223 offset:30720
  v_cvt_pk_bf16_f32 v137, v90, v91
  v_cvt_pk_bf16_f32 v138, v92, v93
  v_cvt_pk_bf16_f32 v139, v94, v95
  s_waitcnt lgkmcnt(2)
  v_mfma_f32_32x32x16_bf16 v[72:87], v[48:51], a[32:35], v[72:87]
  ds_read_b128 v[60:63], v223 offset:33792
  buffer_store_dwordx4 v[136:139], v240, s[36:39], s76 offen sc1
  v_mul_f32 v96, v96, v41
  v_mul_f32 v97, v97, v41
  s_waitcnt lgkmcnt(2)
  v_mfma_f32_32x32x16_bf16 v[72:87], v[52:55], a[36:39], v[72:87]
  ds_read_b128 v[48:51], v2 offset:0
  v_mul_f32 v98, v98, v41
  v_mul_f32 v99, v99, v41
  s_waitcnt lgkmcnt(2)
  v_mfma_f32_32x32x16_bf16 v[72:87], v[56:59], a[40:43], v[72:87]
  ds_read_b128 v[52:55], v2 offset:3072
  v_mul_f32 v100, v100, v41
  v_mul_f32 v101, v101, v41
  s_waitcnt lgkmcnt(2)
  v_mfma_f32_32x32x16_bf16 v[72:87], v[60:63], a[44:47], v[72:87]
  ds_read_b128 v[56:59], v2 offset:6144
  v_mul_f32 v102, v102, v41
  v_mul_f32 v103, v103, v41
  s_waitcnt lgkmcnt(2)
  v_mfma_f32_32x32x16_bf16 v[72:87], v[48:51], a[48:51], v[72:87]
  ds_read_b128 v[60:63], v2 offset:9216
  v_cvt_pk_bf16_f32 v140, v96, v97
  v_cvt_pk_bf16_f32 v141, v98, v99
  s_waitcnt lgkmcnt(2)
  v_mfma_f32_32x32x16_bf16 v[72:87], v[52:55], a[52:55], v[72:87]
  ds_read_b128 v[48:51], v2 offset:12288
  v_cvt_pk_bf16_f32 v142, v100, v101
  v_cvt_pk_bf16_f32 v143, v102, v103
  s_waitcnt lgkmcnt(2)
  v_mfma_f32_32x32x16_bf16 v[72:87], v[56:59], a[56:59], v[72:87]
  ds_read_b128 v[52:55], v2 offset:15360
  buffer_store_dwordx4 v[140:143], v240, s[36:39], s77 offen sc1
  v_mul_f32 v104, v104, v120
  s_waitcnt lgkmcnt(2)
  v_mfma_f32_32x32x16_bf16 v[72:87], v[60:63], a[60:63], v[72:87]
  ds_read_b128 v[56:59], v2 offset:18432
  v_mul_f32 v105, v105, v121
  v_mul_f32 v106, v106, v122
  s_waitcnt lgkmcnt(2)
  v_mfma_f32_32x32x16_bf16 v[72:87], v[48:51], a[64:67], v[72:87]
  ds_read_b128 v[60:63], v2 offset:21504
  v_mul_f32 v107, v107, v123
  v_mul_f32 v108, v108, v124
  s_waitcnt lgkmcnt(2)
  v_mfma_f32_32x32x16_bf16 v[72:87], v[52:55], a[68:71], v[72:87]
  ds_read_b128 v[48:51], v2 offset:24576
  v_mul_f32 v109, v109, v125
  v_mul_f32 v110, v110, v126
  s_waitcnt lgkmcnt(2)
  v_mfma_f32_32x32x16_bf16 v[72:87], v[56:59], a[72:75], v[72:87]
  ds_read_b128 v[52:55], v2 offset:27648
  v_mul_f32 v111, v111, v127
  v_cvt_pk_bf16_f32 v144, v104, v105
  s_waitcnt lgkmcnt(2)
  v_mfma_f32_32x32x16_bf16 v[72:87], v[60:63], a[76:79], v[72:87]
  ds_read_b128 v[56:59], v2 offset:30720
  v_cvt_pk_bf16_f32 v145, v106, v107
  v_cvt_pk_bf16_f32 v146, v108, v109
  s_waitcnt lgkmcnt(2)
  v_mfma_f32_32x32x16_bf16 v[72:87], v[48:51], a[80:83], v[72:87]
  ds_read_b128 v[60:63], v2 offset:33792
  v_cvt_pk_bf16_f32 v147, v110, v111
  buffer_store_dwordx4 v[144:147], v239, s[36:39], s76 offen offset:0 sc1
  s_waitcnt lgkmcnt(2)
  v_mfma_f32_32x32x16_bf16 v[72:87], v[52:55], a[84:87], v[72:87]
  ds_read_b128 v[48:51], v2 offset:36864
  v_mul_f32 v112, v112, v128
  v_mul_f32 v113, v113, v129
  s_waitcnt lgkmcnt(2)
  v_mfma_f32_32x32x16_bf16 v[72:87], v[56:59], a[88:91], v[72:87]
  ds_read_b128 v[52:55], v2 offset:39936
  v_mul_f32 v114, v114, v130
  v_mul_f32 v115, v115, v131
  s_waitcnt lgkmcnt(2)
  v_mfma_f32_32x32x16_bf16 v[72:87], v[60:63], a[92:95], v[72:87]
  ds_read_b128 v[56:59], v2 offset:43008
  v_mul_f32 v116, v116, v132
  v_mul_f32 v117, v117, v133
  s_waitcnt lgkmcnt(2)
  v_mfma_f32_32x32x16_bf16 v[72:87], v[48:51], a[96:99], v[72:87]
  ds_read_b128 v[60:63], v2 offset:46080
  v_mul_f32 v118, v118, v134
  v_mul_f32 v119, v119, v135
  s_waitcnt lgkmcnt(2)
  v_mfma_f32_32x32x16_bf16 v[72:87], v[52:55], a[100:103], v[72:87]
  ds_read_b128 v[48:51], v2 offset:49152
  v_cvt_pk_bf16_f32 v148, v112, v113
  v_cvt_pk_bf16_f32 v149, v114, v115
  s_waitcnt lgkmcnt(2)
  v_mfma_f32_32x32x16_bf16 v[72:87], v[56:59], a[104:107], v[72:87]
  ds_read_b128 v[52:55], v2 offset:52224
  v_cvt_pk_bf16_f32 v150, v116, v117
  v_cvt_pk_bf16_f32 v151, v118, v119
  s_waitcnt lgkmcnt(2)
  v_mfma_f32_32x32x16_bf16 v[72:87], v[60:63], a[108:111], v[72:87]
  ds_read_b128 v[56:59], v2 offset:55296
  buffer_store_dwordx4 v[148:151], v239, s[36:39], s76 offen offset:512 sc1
  s_waitcnt lgkmcnt(2)
  v_mfma_f32_32x32x16_bf16 v[72:87], v[48:51], a[112:115], v[72:87]
  ds_read_b128 v[60:63], v2 offset:58368
  s_waitcnt lgkmcnt(2)
  v_mfma_f32_32x32x16_bf16 v[72:87], v[52:55], a[116:119], v[72:87]
  s_waitcnt lgkmcnt(1)
  v_mfma_f32_32x32x16_bf16 v[72:87], v[56:59], a[120:123], v[72:87]
  s_waitcnt lgkmcnt(0)
  v_mfma_f32_32x32x16_bf16 v[72:87], v[60:63], a[124:127], v[72:87]
  v_mfma_f32_32x32x16_bf16 v[72:87], v[24:27], v[36:39], v[72:87]
  s_nop 11
  v_mul_f32 v72, v72, v42
  v_mul_f32 v73, v73, v42
  v_mul_f32 v74, v74, v42
  v_mul_f32 v75, v75, v42
  v_mul_f32 v76, v76, v42
  v_mul_f32 v77, v77, v42
  v_mul_f32 v78, v78, v42
  v_mul_f32 v79, v79, v42
  v_cvt_pk_bf16_f32 v152, v72, v73
  v_cvt_pk_bf16_f32 v153, v74, v75
  v_cvt_pk_bf16_f32 v154, v76, v77
  v_cvt_pk_bf16_f32 v155, v78, v79
  buffer_store_dwordx4 v[152:155], v2, s[36:39], s75 offen offset:0
  v_mul_f32 v80, v80, v42
  v_mul_f32 v81, v81, v42
  v_mul_f32 v82, v82, v42
  v_mul_f32 v83, v83, v42
  v_mul_f32 v84, v84, v42
  v_mul_f32 v85, v85, v42
  v_mul_f32 v86, v86, v42
  v_mul_f32 v87, v87, v42
  v_cvt_pk_bf16_f32 v156, v80, v81
  v_cvt_pk_bf16_f32 v157, v82, v83
  v_cvt_pk_bf16_f32 v158, v84, v85
  v_cvt_pk_bf16_f32 v159, v86, v87
  buffer_store_dwordx4 v[156:159], v2, s[36:39], s75 offen offset:1024
  s_waitcnt vmcnt(0)
  s_mov_b64 exec, 1
  buffer_store_dword v229, off, s[36:39], s56 sc0 sc1
  s_mov_b64 exec, -1
  s_barrier
L_att:
  s_mov_b32 s70, s10
  s_mov_b32 s71, s9
  v_mov_b32 v136, 0x3f803f80
  v_mov_b32 v137, 0x3f803f80
  v_mov_b32 v138, 0x3f803f80
  v_mov_b32 v139, 0x3f803f80
  v_mul_u32_u24 v140, 2080, v1
  ds_write_b128 v140, v[136:139] offset:2048
  v_mov_b32 v40, 0
  v_mov_b32 v41, 0
  v_mov_b32 v42, 0
  v_mov_b32 v43, 0
  ds_write_b128 v140, v[40:43] offset:2064
  v_mov_b32 v36, 0xdddddddd
  v_mov_b32 v144, v2
  v_and_b32 v145, 0xffff, v239
  v_add_u32 v146, 512, v145
  v_and_b32 v141, 27, v1
  v_cmp_ne_u32 vcc, 16, v141
  v_mov_b32 v142, 2048
  v_mov_b32 v143, 2064
  v_and_b32 v141, 16, v1
  v_cndmask_b32 v142, v142, v143, vcc
  v_cmp_ne_u32 vcc, 0, v141
  s_nop 1
  v_cndmask_b32 v145, v145, v142, vcc
  v_cndmask_b32 v146, v146, v142, vcc
  s_lshl_b32 s73, s70, 17
  s_lshl_b32 s72, s69, 22
  s_add_u32 s73, s73, s72
  s_add_u32 s73, s73, 0x1000000
  s_add_u32 s12, s36, s73
  s_addc_u32 s13, s37, 0
  s_mov_b32 s14, 131072
  s_mov_b32 s15, 0x20000
  s_lshl_b32 s79, s71, 18
  s_lshl_b32 s72, s3, 16
  s_add_u32 s79, s79, s72
  s_lshl_b32 s72, s70, 10
  s_add_u32 s79, s79, s72
  s_add_u32 s76, s79, 0x600000
  s_add_u32 s77, s76, 32768
  s_lshl_b32 s78, s71, 3
  s_add_u32 s78, s78, s3
  s_lshl_b32 s78, s78, 11
  s_mul_i32 s74, s3, 2080
  s_mul_i32 s83, s10, 44032
  s_mul_i32 s72, s3, 11264
  s_add_u32 s83, s83, s72
  v_mov_b32 v37, v144
  v_mov_b32 v38, v145
  v_mov_b32 v39, v146
  v_mov_b32 v72, 0
  v_mov_b32 v73, 0
  v_mov_b32 v74, 0
  v_mov_b32 v75, 0
  v_mov_b32 v76, 0
  v_mov_b32 v77, 0
  v_mov_b32 v78, 0
  v_mov_b32 v79, 0
  v_mov_b32 v80, 0
  v_mov_b32 v81, 0
  v_mov_b32 v82, 0
  v_mov_b32 v83, 0
  v_mov_b32 v84, 0
  v_mov_b32 v85, 0
  v_mov_b32 v86, 0
  v_mov_b32 v87, 0
  v_mov_b32 v88, 0
  v_mov_b32 v89, 0
  v_mov_b32 v90, 0
  v_mov_b32 v91, 0
  v_mov_b32 v92, 0
  v_mov_b32 v93, 0
  v_mov_b32 v94, 0
  v_mov_b32 v95, 0
  v_mov_b32 v96, 0
  v_mov_b32 v97, 0
  v_mov_b32 v98, 0
  v_mov_b32 v99, 0
  v_mov_b32 v100, 0
  v_mov_b32 v101, 0
  v_mov_b32 v102, 0
  v_mov_b32 v103, 0
  v_mov_b32 v64, 0
  v_mov_b32 v65, 0
  v_mov_b32 v66, 0
  v_mov_b32 v67, 0
  v_mov_b32 v68, 0
  v_mov_b32 v69, 0
  v_mov_b32 v70, 0
  v_mov_b32 v71, 0
  v_mov_b32 v32, 0
  v_mov_b32 v33, 0
  v_mov_b32 v34, 0
  v_mov_b32 v35, 0
  s_lshr_b32 s72, s70, 1
  s_lshl_b32 s72, s72, 4
  s_lshl_b32 s82, s72, 4
  s_add_u32 s82, s82, s68
  s_add_u32 s82, s82, 0x4f0000
  s_lshl_b32 s75, s9, 1
  s_add_u32 s72, s72, s75
  s_waitcnt lgkmcnt(0)
  s_add_u32 s94, s73, s78
  s_add_u32 s95, s94, 8192
  s_lshl_b32 s96, s72, 4
  s_add_u32 s96, s96, s68
  s_add_u32 s96, s96, 0x4f0000
  s_mov_b32 s8, 0
pl_42:
  buffer_load_dword v224, v226, s[36:39], s96 offen sc0 sc1
  s_add_u32 s8, s8, 1
  s_cmp_gt_u32 s8, 0x80000
  s_cbranch_scc1 L_abort
  s_waitcnt vmcnt(0)
pchk_44:
  v_cmp_ne_u32 vcc, 1, v224
  s_nop 3
  s_cbranch_vccnz pl_42
  buffer_load_dwordx4 v[4:7], v2, s[36:39], s76 offen sc1
  s_mov_b32 m0, s74
  s_add_u32 s74, s74, 8320
  buffer_load_dwordx4 v2, s[36:39], s94 offen sc1 lds
  buffer_load_dwordx4 v2, s[36:39], s94 offen offset:1024 sc1 lds
  s_add_u32 s78, s78, 8192
  s_and_b32 s78, s78, 0x1ffff
  buffer_load_dwordx4 v[8:11], v2, s[36:39], s77 offen sc1
  s_mov_b32 m0, s74
  s_add_u32 s74, s74, 8320
  buffer_load_dwordx4 v2, s[36:39], s95 offen sc1 lds
  buffer_load_dwordx4 v2, s[36:39], s95 offen offset:1024 sc1 lds
  s_add_u32 s78, s78, 8192
  s_and_b32 s78, s78, 0x1ffff
  buffer_load_dword v104, v247, s[36:39], s82 offen sc0 sc1
  s_cmp_lg_u32 s69, 0
  s_cbranch_scc1 norf_45
  s_lshl_b32 s92, s9, 1
  s_and_b32 s93, s10, 1
  s_add_u32 s92, s92, s93
  s_lshl_b32 s92, s92, 1
  s_bfe_u32 s93, s10, 0x10001
  s_add_u32 s92, s92, s93
  s_lshr_b32 s93, s10, 2
  s_lshl_b32 s92, s92, 1
  s_and_b32 s94, s3, 1
  s_add_u32 s92, s92, s94
  s_lshl_b32 s94, s92, 12
  s_lshl_b32 s95, s93, 9
  s_add_u32 s94, s94, s95
  s_lshl_b32 s92, s92, 15
  s_lshl_b32 s93, s93, 12
  s_add_u32 s92, s92, s93
  s_lshr_b32 s93, s3, 1
  s_lshl_b32 s93, s93, 11
  s_add_u32 s92, s92, s93
  v_and_b32 v148, 15, v1
  v_lshlrev_b32 v148, 7, v148
  s_lshl_b32 s93, s9, 18
  s_lshl_b32 s95, s3, 16
  s_add_u32 s93, s93, s95
  s_lshl_b32 s95, s10, 10
  s_add_u32 s93, s93, s95
  s_add_u32 s97, s93, 0x600000
  v_mov_b32 v233, s97
  s_add_u32 s97, s93, 0x600000
  s_mov_b32 exec_lo, 0xff
  s_mov_b32 exec_hi, 0x0
  v_add_u32 v233, s97, v234
  s_mov_b64 exec, -1
  s_add_u32 s97, s93, 0x607c00
  s_mov_b32 exec_lo, 0xff00
  s_mov_b32 exec_hi, 0x0
  v_add_u32 v233, s97, v234
  s_mov_b64 exec, -1
  s_add_u32 s97, s92, 0x7ff800
  s_mov_b32 exec_lo, 0xffff0000
  s_mov_b32 exec_hi, 0x0
  v_add_u32 v233, s97, v234
  s_mov_b64 exec, -1
  s_add_u32 s97, s94, 0x4ff000
  s_mov_b32 exec_lo, 0x0
  s_mov_b32 exec_hi, 0xf
  v_add_u32 v233, s97, v234
  s_mov_b64 exec, -1
  s_lshl_b32 s92, s9, 1
  s_and_b32 s93, s10, 1
  s_add_u32 s92, s92, s93
  s_lshr_b32 s93, s10, 1
  s_lshl_b32 s92, s92, 2
  s_add_u32 s92, s92, s3
  s_lshl_b32 s93, s93, 11
  s_lshl_b32 s94, s92, 15
  s_add_u32 s93, s93, s94
  s_add_u32 s97, s93, 0x600000
  v_mov_b32 v231, s97
  s_add_u32 s97, s93, 0x600000
  s_mov_b32 exec_lo, 0xffff
  s_mov_b32 exec_hi, 0x0
  v_add_u32 v231, s97, v234
  s_mov_b64 exec, -1
  s_mov_b32 exec_lo, 0x00ff0000
  s_mov_b32 exec_hi, 0
  v_lshlrev_b32 v231, 19, v1
  v_add_u32 v231, 0xc00000, v231
  s_mov_b64 exec, -1
  s_lshr_b32 s93, s10, 1
  s_mul_i32 s93, s93, 6
  s_min_u32 s93, s93, 80
  s_mul_i32 s92, s92, 86
  s_add_u32 s92, s92, s93
  s_lshl_b32 s92, s92, 10
  s_add_u32 s97, s92, 0xa00000
  v_mov_b32 v232, s97
  s_add_u32 s97, s92, 0xa00000
  s_mov_b32 exec_lo, 0xffffffff
  s_mov_b32 exec_hi, 0xffff
  v_add_u32 v232, s97, v234
  s_mov_b64 exec, -1
  s_lshl_b32 s86, s9, 1
  s_and_b32 s87, s10, 1
  s_add_u32 s86, s86, s87
  s_lshl_b32 s86, s86, 1
  s_bfe_u32 s87, s10, 0x10001
  s_add_u32 s86, s86, s87
  s_lshr_b32 s87, s10, 2
  s_lshr_b32 s88, s3, 1
  s_lshl_b32 s89, s86, 1
  s_and_b32 s90, s3, 1
  s_add_u32 s89, s89, s90
  s_lshl_b32 s46, s89, 15
  s_lshl_b32 s90, s88, 14
  s_add_u32 s46, s46, s90
  s_add_u32 s46, s46, 0x600000
  s_mul_i32 s47, s89, 88064
  s_mul_i32 s90, s88, 43008
  s_add_u32 s47, s47, s90
  s_add_u32 s47, s47, 0xa00000
  s_lshl_b32 s45, s89, 12
  s_lshl_b32 s90, s87, 9
  s_add_u32 s45, s45, s90
  s_lshl_b32 s90, s88, 3
  s_add_u32 s45, s45, s90
  s_add_u32 s45, s45, 0x500000
  s_lshl_b32 s44, s89, 15
  s_lshl_b32 s90, s87, 12
  s_add_u32 s44, s44, s90
  s_lshl_b32 s90, s88, 11
  s_add_u32 s44, s44, s90
  s_add_u32 s44, s44, 0x800000
  s_lshl_b32 s48, s86, 3
  s_add_u32 s48, s48, s87
  s_lshl_b32 s48, s48, 2
  s_add_u32 s48, s48, s3
  s_lshl_b32 s48, s48, 2
  s_add_u32 s48, s48, 0x4f2000
  s_lshl_b32 s49, s9, 9
  s_and_b32 s90, s86, 3
  s_lshl_b32 s90, s90, 2
  s_add_u32 s49, s49, s90
  s_add_u32 s49, s49, 0x4f1000
  s_lshr_b32 s50, s86, 1
  s_lshl_b32 s50, s50, 8
  s_and_b32 s90, s89, 3
  s_lshl_b32 s90, s90, 2
  s_add_u32 s50, s50, s90
  s_add_u32 s50, s50, 0x4f3000
  s_mul_i32 s90, s88, 3072
  v_add_u32 v208, s90, v2
  v_xor_b32 v209, 1024, v208
  v_add_u32 v210, 61440, v208
  v_add_u32 v212, 122880, v208
  v_add_u32 v211, 61440, v209
  v_add_u32 v213, 122880, v209
  s_lshl_b32 s90, s3, 12
  s_add_u32 s90, s90, 102400
  v_add_u32 v214, s90, v2
  s_xor_b32 s90, s3, 2
  s_lshl_b32 s90, s90, 12
  s_add_u32 s90, s90, 102400
  v_add_u32 v215, s90, v2
  s_lshl_b32 s86, s9, 1
  s_and_b32 s87, s10, 1
  s_add_u32 s86, s86, s87
  s_lshr_b32 s87, s10, 1
  s_lshr_b32 s88, s10, 1
  s_mul_i32 s88, s88, 6
  s_min_u32 s88, s88, 80
  s_lshl_b32 s89, s86, 2
  s_add_u32 s89, s89, s3
  s_lshl_b32 s51, s89, 15
  s_lshl_b32 s90, s87, 11
  s_add_u32 s58, s51, s90
  s_add_u32 s58, s58, 0x600000
  s_add_u32 s51, s51, 0x800000
  s_lshl_b32 s52, s89, 12
  s_add_u32 s52, s52, 0x500000
  s_mul_i32 s53, s89, 86
  s_add_u32 s53, s53, s88
  s_lshl_b32 s53, s53, 10
  s_add_u32 s53, s53, 0xa00000
  s_mul_i32 s54, s87, 6
  s_sub_u32 s54, s54, s88
  s_lshl_b32 s55, s86, 4
  s_add_u32 s55, s55, s87
  s_lshl_b32 s55, s55, 2
  s_add_u32 s55, s55, s3
  s_lshl_b32 s55, s55, 2
  s_add_u32 s55, s55, 0x4f3000
  s_lshl_b32 s56, s87, 4
  s_add_u32 s56, s56, s86
  s_lshl_b32 s56, s56, 2
  s_add_u32 s56, s56, s3
  s_lshl_b32 s56, s56, 2
  s_add_u32 s56, s56, 0x4f8000
  s_lshr_b32 s57, s89, 1
  s_lshl_b32 s57, s57, 7
  s_and_b32 s90, s3, 1
  s_lshl_b32 s90, s90, 2
  s_add_u32 s57, s57, s90
  s_add_u32 s57, s57, 0x4f2000
  s_lshl_b32 s59, s87, 18
  s_lshl_b32 s90, s89, 11
  s_add_u32 s59, s59, s90
  s_add_u32 s59, s59, 0x1400000
  v_add_u32 v222, 61440, v2
  v_add_u32 v223, 122880, v2
norf_45:
  s_waitcnt vmcnt(3)
  s_barrier
  ds_read_b128 v[12:15], v37
  ds_read_b128 v[20:23], v38
  ds_read_b128 v[24:27], v39
  s_waitcnt lgkmcnt(0)
  v_mfma_f32_32x32x16_bf16 v[40:55], v[12:15], v[4:7], 0
  s_nop 11
  v_exp_f32 v40, v40
  v_exp_f32 v41, v41
  v_smfmac_f32_32x32x32_bf16 v[88:103], v[32:35], v[64:71], v36
  ds_read_b128 v[16:19], v37 offset:2080
  v_exp_f32 v42, v42
  v_exp_f32 v43, v43
  v_exp_f32 v44, v44
  v_mfma_f32_32x32x16_bf16 v[56:71], v[12:15], v[8:11], 0
  ds_read_b128 v[28:31], v38 offset:2080
  v_exp_f32 v45, v45
  v_exp_f32 v46, v46
  v_exp_f32 v47, v47
  v_exp_f32 v48, v48
  v_exp_f32 v49, v49
  v_smfmac_f32_32x32x32_bf16 v[72:87], v[20:23], v[40:47], v36
  ds_read_b128 v[32:35], v39 offset:2080
  v_exp_f32 v50, v50
  v_exp_f32 v51, v51
  v_exp_f32 v52, v52
  v_exp_f32 v53, v53
  v_exp_f32 v54, v54
  v_exp_f32 v55, v55
  v_exp_f32 v56, v56
  v_exp_f32 v57, v57
  v_smfmac_f32_32x32x32_bf16 v[72:87], v[24:27], v[48:55], v36
  s_waitcnt lgkmcnt(0)
  v_exp_f32 v58, v58
  v_exp_f32 v59, v59
  v_exp_f32 v60, v60
  v_mfma_f32_32x32x16_bf16 v[40:55], v[16:19], v[4:7], 0
  v_exp_f32 v61, v61
  v_exp_f32 v62, v62
  v_exp_f32 v63, v63
  v_exp_f32 v64, v64
  v_exp_f32 v65, v65
  v_smfmac_f32_32x32x32_bf16 v[88:103], v[20:23], v[56:63], v36
  v_exp_f32 v66, v66
  v_exp_f32 v67, v67
  v_exp_f32 v68, v68
  v_exp_f32 v69, v69
  v_exp_f32 v70, v70
  v_exp_f32 v71, v71
  s_mov_b32 s8, 0
  s_waitcnt vmcnt(0)
  s_branch pchk_48
pl_46:
  buffer_load_dword v104, v247, s[36:39], s82 offen sc0 sc1
  s_add_u32 s8, s8, 1
  s_cmp_gt_u32 s8, 0x80000
  s_cbranch_scc1 L_abort
  s_waitcnt vmcnt(0)
pchk_48:
  v_cmp_ne_u32 vcc, 1, v104
  s_nop 3
  s_cbranch_vccnz pl_46
  s_barrier
  v_exp_f32 v40, v40
  v_exp_f32 v41, v41
  v_smfmac_f32_32x32x32_bf16 v[88:103], v[24:27], v[64:71], v36
  ds_read_b128 v[12:15], v37 offset:4160
  v_exp_f32 v42, v42
  v_exp_f32 v43, v43
  v_exp_f32 v44, v44
  v_mfma_f32_32x32x16_bf16 v[56:71], v[16:19], v[8:11], 0
  ds_read_b128 v[20:23], v38 offset:4160
  v_exp_f32 v45, v45
  v_exp_f32 v46, v46
  v_exp_f32 v47, v47
  v_exp_f32 v48, v48
  v_exp_f32 v49, v49
  v_smfmac_f32_32x32x32_bf16 v[72:87], v[28:31], v[40:47], v36
  ds_read_b128 v[24:27], v39 offset:4160
  v_exp_f32 v50, v50
  v_exp_f32 v51, v51
  v_exp_f32 v52, v52
  v_exp_f32 v53, v53
  v_exp_f32 v54, v54
  v_exp_f32 v55, v55
  v_exp_f32 v56, v56
  v_exp_f32 v57, v57
  s_mov_b32 m0, s74
  s_add_u32 s74, s74, 8320
  v_smfmac_f32_32x32x32_bf16 v[72:87], v[32:35], v[48:55], v36
  buffer_load_dwordx4 v2, s[12:15], s78 offen sc1 lds
  s_waitcnt lgkmcnt(0)
  v_exp_f32 v58, v58
  v_exp_f32 v59, v59
  v_exp_f32 v60, v60
  v_mfma_f32_32x32x16_bf16 v[40:55], v[12:15], v[4:7], 0
  v_exp_f32 v61, v61
  v_exp_f32 v62, v62
  v_exp_f32 v63, v63
  v_exp_f32 v64, v64
  v_exp_f32 v65, v65
  v_smfmac_f32_32x32x32_bf16 v[88:103], v[28:31], v[56:63], v36
  buffer_load_dwordx4 v2, s[12:15], s78 offen offset:1024 sc1 lds
  s_add_u32 s78, s78, 8192
  s_and_b32 s78, s78, 0x1ffff
  v_exp_f32 v66, v66
  v_exp_f32 v67, v67
  v_exp_f32 v68, v68
  v_exp_f32 v69, v69
  v_exp_f32 v70, v70
  v_exp_f32 v71, v71
  v_exp_f32 v40, v40
  v_exp_f32 v41, v41
  v_smfmac_f32_32x32x32_bf16 v[88:103], v[32:35], v[64:71], v36
  ds_read_b128 v[16:19], v37 offset:6240
  v_exp_f32 v42, v42
  v_exp_f32 v43, v43
  v_exp_f32 v44, v44
  v_mfma_f32_32x32x16_bf16 v[56:71], v[12:15], v[8:11], 0
  ds_read_b128 v[28:31], v38 offset:6240
  v_exp_f32 v45, v45
  v_exp_f32 v46, v46
  v_exp_f32 v47, v47
  v_exp_f32 v48, v48
  v_exp_f32 v49, v49
  v_smfmac_f32_32x32x32_bf16 v[72:87], v[20:23], v[40:47], v36
  ds_read_b128 v[32:35], v39 offset:6240
  v_exp_f32 v50, v50
  v_exp_f32 v51, v51
  v_exp_f32 v52, v52
  v_exp_f32 v53, v53
  v_exp_f32 v54, v54
  v_exp_f32 v55, v55
  v_exp_f32 v56, v56
  v_exp_f32 v57, v57
  s_mov_b32 m0, s74
  s_add_u32 s74, s74, 8320
  v_smfmac_f32_32x32x32_bf16 v[72:87], v[24:27], v[48:55], v36
  buffer_load_dwordx4 v2, s[12:15], s78 offen sc1 lds
  s_waitcnt lgkmcnt(0)
  v_exp_f32 v58, v58
  v_exp_f32 v59, v59
  v_exp_f32 v60, v60
  v_mfma_f32_32x32x16_bf16 v[40:55], v[16:19], v[4:7], 0
  v_exp_f32 v61, v61
  v_exp_f32 v62, v62
  v_exp_f32 v63, v63
  v_exp_f32 v64, v64
  v_exp_f32 v65, v65
  v_smfmac_f32_32x32x32_bf16 v[88:103], v[20:23], v[56:63], v36
  buffer_load_dwordx4 v2, s[12:15], s78 offen offset:1024 sc1 lds
  s_add_u32 s78, s78, 8192
  s_and_b32 s78, s78, 0x1ffff
  v_exp_f32 v66, v66
  v_exp_f32 v67, v67
  v_exp_f32 v68, v68
  v_exp_f32 v69, v69
  v_exp_f32 v70, v70
  v_exp_f32 v71, v71
  v_exp_f32 v40, v40
  v_exp_f32 v41, v41
  v_smfmac_f32_32x32x32_bf16 v[88:103], v[24:27], v[64:71], v36
  ds_read_b128 v[12:15], v37 offset:8320
  v_exp_f32 v42, v42
  v_exp_f32 v43, v43
  v_exp_f32 v44, v44
  v_mfma_f32_32x32x16_bf16 v[56:71], v[16:19], v[8:11], 0
  ds_read_b128 v[20:23], v38 offset:8320
  v_exp_f32 v45, v45
  v_exp_f32 v46, v46
  v_exp_f32 v47, v47
  v_exp_f32 v48, v48
  v_exp_f32 v49, v49
  v_smfmac_f32_32x32x32_bf16 v[72:87], v[28:31], v[40:47], v36
  ds_read_b128 v[24:27], v39 offset:8320
  v_exp_f32 v50, v50
  v_exp_f32 v51, v51
  v_exp_f32 v52, v52
  v_exp_f32 v53, v53
  v_exp_f32 v54, v54
  v_exp_f32 v55, v55
  v_exp_f32 v56, v56
  v_exp_f32 v57, v57
  v_smfmac_f32_32x32x32_bf16 v[72:87], v[32:35], v[48:55], v36
  s_waitcnt lgkmcnt(0)
  v_exp_f32 v58, v58
  v_exp_f32 v59, v59
  v_exp_f32 v60, v60
  v_mfma_f32_32x32x16_bf16 v[40:55], v[12:15], v[4:7], 0
  v_exp_f32 v61, v61
  v_exp_f32 v62, v62
  v_exp_f32 v63, v63
  v_exp_f32 v64, v64
  v_exp_f32 v65, v65
  v_smfmac_f32_32x32x32_bf16 v[88:103], v[28:31], v[56:63], v36
  v_exp_f32 v66, v66
  v_exp_f32 v67, v67
  v_exp_f32 v68, v68
  v_exp_f32 v69, v69
  v_exp_f32 v70, v70
  v_exp_f32 v71, v71
  v_exp_f32 v40, v40
  v_exp_f32 v41, v41
  v_smfmac_f32_32x32x32_bf16 v[88:103], v[32:35], v[64:71], v36
  ds_read_b128 v[16:19], v37 offset:10400
  v_exp_f32 v42, v42
  v_exp_f32 v43, v43
  v_exp_f32 v44, v44
  v_mfma_f32_32x32x16_bf16 v[56:71], v[12:15], v[8:11], 0
  ds_read_b128 v[28:31], v38 offset:10400
  v_exp_f32 v45, v45
  v_exp_f32 v46, v46
  v_exp_f32 v47, v47
  v_exp_f32 v48, v48
  v_exp_f32 v49, v49
  v_smfmac_f32_32x32x32_bf16 v[72:87], v[20:23], v[40:47], v36
  ds_read_b128 v[32:35], v39 offset:10400
  v_exp_f32 v50, v50
  v_exp_f32 v51, v51
  v_exp_f32 v52, v52
  v_exp_f32 v53, v53
  v_exp_f32 v54, v54
  v_exp_f32 v55, v55
  v_exp_f32 v56, v56
  v_exp_f32 v57, v57
  s_mov_b32 m0, s74
  s_add_u32 s74, s74, 8320
  v_smfmac_f32_32x32x32_bf16 v[72:87], v[24:27], v[48:55], v36
  buffer_load_dwordx4 v2, s[12:15], s78 offen sc1 lds
  s_waitcnt lgkmcnt(0)
  v_exp_f32 v58, v58
  v_exp_f32 v59, v59
  v_exp_f32 v60, v60
  v_mfma_f32_32x32x16_bf16 v[40:55], v[16:19], v[4:7], 0
  v_exp_f32 v61, v61
  v_exp_f32 v62, v62
  v_exp_f32 v63, v63
  v_exp_f32 v64, v64
  v_exp_f32 v65, v65
  v_smfmac_f32_32x32x32_bf16 v[88:103], v[20:23], v[56:63], v36
  buffer_load_dwordx4 v2, s[12:15], s78 offen offset:1024 sc1 lds
  s_add_u32 s78, s78, 8192
  s_and_b32 s78, s78, 0x1ffff
  v_exp_f32 v66, v66
  v_exp_f32 v67, v67
  v_exp_f32 v68, v68
  v_exp_f32 v69, v69
  v_exp_f32 v70, v70
  v_exp_f32 v71, v71
  v_exp_f32 v40, v40
  v_exp_f32 v41, v41
  v_smfmac_f32_32x32x32_bf16 v[88:103], v[24:27], v[64:71], v36
  ds_read_b128 v[12:15], v37 offset:12480
  v_exp_f32 v42, v42
  v_exp_f32 v43, v43
  v_exp_f32 v44, v44
  v_mfma_f32_32x32x16_bf16 v[56:71], v[16:19], v[8:11], 0
  ds_read_b128 v[20:23], v38 offset:12480
  v_exp_f32 v45, v45
  v_exp_f32 v46, v46
  v_exp_f32 v47, v47
  v_exp_f32 v48, v48
  v_exp_f32 v49, v49
  v_smfmac_f32_32x32x32_bf16 v[72:87], v[28:31], v[40:47], v36
  ds_read_b128 v[24:27], v39 offset:12480
  v_exp_f32 v50, v50
  v_exp_f32 v51, v51
  v_exp_f32 v52, v52
  v_exp_f32 v53, v53
  v_exp_f32 v54, v54
  v_exp_f32 v55, v55
  v_exp_f32 v56, v56
  v_exp_f32 v57, v57
  s_mov_b32 m0, s74
  s_add_u32 s74, s74, 8320
  v_smfmac_f32_32x32x32_bf16 v[72:87], v[32:35], v[48:55], v36
  buffer_load_dwordx4 v2, s[12:15], s78 offen sc1 lds
  s_waitcnt lgkmcnt(0)
  v_exp_f32 v58, v58
  v_exp_f32 v59, v59
  v_exp_f32 v60, v60
  v_mfma_f32_32x32x16_bf16 v[40:55], v[12:15], v[4:7], 0
  v_exp_f32 v61, v61
  v_exp_f32 v62, v62
  v_exp_f32 v63, v63
  v_exp_f32 v64, v64
  v_exp_f32 v65, v65
  v_smfmac_f32_32x32x32_bf16 v[88:103], v[28:31], v[56:63], v36
  buffer_load_dwordx4 v2, s[12:15], s78 offen offset:1024 sc1 lds
  s_add_u32 s78, s78, 8192
  s_and_b32 s78, s78, 0x1ffff
  v_exp_f32 v66, v66
  v_exp_f32 v67, v67
  v_exp_f32 v68, v68
  v_exp_f32 v69, v69
  v_exp_f32 v70, v70
  v_exp_f32 v71, v71
  v_exp_f32 v40, v40
  v_exp_f32 v41, v41
  v_smfmac_f32_32x32x32_bf16 v[88:103], v[32:35], v[64:71], v36
  ds_read_b128 v[16:19], v37 offset:14560
  v_exp_f32 v42, v42
  v_exp_f32 v43, v43
  v_exp_f32 v44, v44
  v_mfma_f32_32x32x16_bf16 v[56:71], v[12:15], v[8:11], 0
  ds_read_b128 v[28:31], v38 offset:14560
  v_exp_f32 v45, v45
  v_exp_f32 v46, v46
  v_exp_f32 v47, v47
  v_exp_f32 v48, v48
  v_exp_f32 v49, v49
  v_smfmac_f32_32x32x32_bf16 v[72:87], v[20:23], v[40:47], v36
  ds_read_b128 v[32:35], v39 offset:14560
  v_exp_f32 v50, v50
  v_exp_f32 v51, v51
  v_exp_f32 v52, v52
  v_exp_f32 v53, v53
  v_exp_f32 v54, v54
  v_exp_f32 v55, v55
  v_exp_f32 v56, v56
  v_exp_f32 v57, v57
  s_mov_b32 m0, s74
  s_add_u32 s74, s74, 8320
  v_smfmac_f32_32x32x32_bf16 v[72:87], v[24:27], v[48:55], v36
  buffer_load_dwordx4 v2, s[12:15], s78 offen sc1 lds
  s_waitcnt lgkmcnt(0)
  v_exp_f32 v58, v58
  v_exp_f32 v59, v59
  v_exp_f32 v60, v60
  v_mfma_f32_32x32x16_bf16 v[40:55], v[16:19], v[4:7], 0
  v_exp_f32 v61, v61
  v_exp_f32 v62, v62
  v_exp_f32 v63, v63
  v_exp_f32 v64, v64
  v_exp_f32 v65, v65
  v_smfmac_f32_32x32x32_bf16 v[88:103], v[20:23], v[56:63], v36
  buffer_load_dwordx4 v2, s[12:15], s78 offen offset:1024 sc1 lds
  s_add_u32 s78, s78, 8192
  s_and_b32 s78, s78, 0x1ffff
  v_exp_f32 v66, v66
  v_exp_f32 v67, v67
  v_exp_f32 v68, v68
  v_exp_f32 v69, v69
  v_exp_f32 v70, v70
  v_exp_f32 v71, v71
  s_waitcnt vmcnt(6)
  s_barrier
  v_exp_f32 v40, v40
  v_exp_f32 v41, v41
  v_smfmac_f32_32x32x32_bf16 v[88:103], v[24:27], v[64:71], v36
  ds_read_b128 v[12:15], v37 offset:16640
  v_exp_f32 v42, v42
  v_exp_f32 v43, v43
  v_exp_f32 v44, v44
  v_mfma_f32_32x32x16_bf16 v[56:71], v[16:19], v[8:11], 0
  ds_read_b128 v[20:23], v38 offset:16640
  v_exp_f32 v45, v45
  v_exp_f32 v46, v46
  v_exp_f32 v47, v47
  v_exp_f32 v48, v48
  v_exp_f32 v49, v49
  v_smfmac_f32_32x32x32_bf16 v[72:87], v[28:31], v[40:47], v36
  ds_read_b128 v[24:27], v39 offset:16640
  v_exp_f32 v50, v50
  v_exp_f32 v51, v51
  v_exp_f32 v52, v52
  v_exp_f32 v53, v53
  v_exp_f32 v54, v54
  v_exp_f32 v55, v55
  v_exp_f32 v56, v56
  v_exp_f32 v57, v57
  s_mov_b32 m0, s74
  s_add_u32 s74, s74, 8320
  v_smfmac_f32_32x32x32_bf16 v[72:87], v[32:35], v[48:55], v36
  buffer_load_dwordx4 v2, s[12:15], s78 offen sc1 lds
  s_waitcnt lgkmcnt(0)
  v_exp_f32 v58, v58
  v_exp_f32 v59, v59
  v_exp_f32 v60, v60
  v_mfma_f32_32x32x16_bf16 v[40:55], v[12:15], v[4:7], 0
  v_exp_f32 v61, v61
  v_exp_f32 v62, v62
  v_exp_f32 v63, v63
  v_exp_f32 v64, v64
  v_exp_f32 v65, v65
  v_smfmac_f32_32x32x32_bf16 v[88:103], v[28:31], v[56:63], v36
  buffer_load_dwordx4 v2, s[12:15], s78 offen offset:1024 sc1 lds
  s_add_u32 s78, s78, 8192
  s_and_b32 s78, s78, 0x1ffff
  v_exp_f32 v66, v66
  v_exp_f32 v67, v67
  v_exp_f32 v68, v68
  v_exp_f32 v69, v69
  v_exp_f32 v70, v70
  v_exp_f32 v71, v71
  s_cmp_lg_u32 s69, 0
  s_cbranch_scc1 l0_49
  s_cmp_lg_u32 s33, 0
  s_cbranch_scc1 rlgu_50
  s_add_u32 m0, s34, 0
  s_nop 0
  buffer_load_dwordx4 v244, s[40:43], s16 offen lds
  s_add_u32 m0, s34, 1024
  s_nop 0
  buffer_load_dwordx4 v244, s[40:43], s17 offen lds
  s_bitcmp1_b32 s35, 1
  s_cbranch_scc1 rl1_52
  s_add_u32 m0, s34, 2048
  s_nop 0
  buffer_load_dwordx4 v244, s[40:43], s18 offen lds
  s_add_u32 m0, s34, 3072
  s_nop 0
  buffer_load_dwordx4 v244, s[40:43], s19 offen lds
  s_branch rl2_53
rl1_52:
  s_mov_b32 s92, s28
  s_and_b32 s93, s29, 0xffff
  s_mov_b32 s94, 0x158000
  s_mov_b32 s95, 0x20000
  s_add_u32 m0, s34, 2048
  s_nop 0
  buffer_load_dwordx4 v243, s[92:95], s18 offen lds
  s_add_u32 m0, s34, 3072
  s_nop 0
  buffer_load_dwordx4 v243, s[92:95], s19 offen lds
rl2_53:
  s_branch rldone_51
rlgu_50:
  s_mov_b32 s92, s24
  s_and_b32 s93, s25, 0xffff
  s_mov_b32 s94, 0x158000
  s_mov_b32 s95, 0x20000
  s_add_u32 m0, s34, 0
  s_add_u32 s84, s16, 0
  buffer_load_dwordx4 v242, s[92:95], s84 offen lds
  s_add_u32 m0, s34, 2048
  s_add_u32 s84, s16, 44032
  buffer_load_dwordx4 v242, s[92:95], s84 offen lds
  s_add_u32 m0, s34, 4096
  s_add_u32 s84, s16, 88064
  buffer_load_dwordx4 v242, s[92:95], s84 offen lds
  s_add_u32 m0, s34, 6144
  s_add_u32 s84, s16, 132096
  buffer_load_dwordx4 v242, s[92:95], s84 offen lds
rldone_51:
l0_49:
  v_exp_f32 v40, v40
  v_exp_f32 v41, v41
  v_smfmac_f32_32x32x32_bf16 v[88:103], v[32:35], v[64:71], v36
  ds_read_b128 v[16:19], v37 offset:18720
  v_exp_f32 v42, v42
  v_exp_f32 v43, v43
  v_exp_f32 v44, v44
  v_mfma_f32_32x32x16_bf16 v[56:71], v[12:15], v[8:11], 0
  ds_read_b128 v[28:31], v38 offset:18720
  v_exp_f32 v45, v45
  v_exp_f32 v46, v46
  v_exp_f32 v47, v47
  v_exp_f32 v48, v48
  v_exp_f32 v49, v49
  v_smfmac_f32_32x32x32_bf16 v[72:87], v[20:23], v[40:47], v36
  ds_read_b128 v[32:35], v39 offset:18720
  v_exp_f32 v50, v50
  v_exp_f32 v51, v51
  v_exp_f32 v52, v52
  v_exp_f32 v53, v53
  v_exp_f32 v54, v54
  v_exp_f32 v55, v55
  v_exp_f32 v56, v56
  v_exp_f32 v57, v57
  v_smfmac_f32_32x32x32_bf16 v[72:87], v[24:27], v[48:55], v36
  s_waitcnt lgkmcnt(0)
  v_exp_f32 v58, v58
  v_exp_f32 v59, v59
  v_exp_f32 v60, v60
  v_mfma_f32_32x32x16_bf16 v[40:55], v[16:19], v[4:7], 0
  v_exp_f32 v61, v61
  v_exp_f32 v62, v62
  v_exp_f32 v63, v63
  v_exp_f32 v64, v64
  v_exp_f32 v65, v65
  s_mov_b32 m0, s74
  s_add_u32 s74, s74, 8320
  v_smfmac_f32_32x32x32_bf16 v[88:103], v[20:23], v[56:63], v36
  buffer_load_dwordx4 v2, s[12:15], s78 offen sc1 lds
  v_exp_f32 v66, v66
  v_exp_f32 v67, v67
  v_exp_f32 v68, v68
  v_exp_f32 v69, v69
  v_exp_f32 v70, v70
  v_exp_f32 v71, v71
  v_exp_f32 v40, v40
  v_exp_f32 v41, v41
  v_smfmac_f32_32x32x32_bf16 v[88:103], v[24:27], v[64:71], v36
  ds_read_b128 v[12:15], v37 offset:20800
  v_exp_f32 v42, v42
  v_exp_f32 v43, v43
  v_exp_f32 v44, v44
  v_mfma_f32_32x32x16_bf16 v[56:71], v[16:19], v[8:11], 0
  ds_read_b128 v[20:23], v38 offset:20800
  v_exp_f32 v45, v45
  v_exp_f32 v46, v46
  v_exp_f32 v47, v47
  v_exp_f32 v48, v48
  v_exp_f32 v49, v49
  v_smfmac_f32_32x32x32_bf16 v[72:87], v[28:31], v[40:47], v36
  ds_read_b128 v[24:27], v39 offset:20800
  v_exp_f32 v50, v50
  v_exp_f32 v51, v51
  v_exp_f32 v52, v52
  v_exp_f32 v53, v53
  v_exp_f32 v54, v54
  v_exp_f32 v55, v55
  v_exp_f32 v56, v56
  v_exp_f32 v57, v57
  v_smfmac_f32_32x32x32_bf16 v[72:87], v[32:35], v[48:55], v36
  s_waitcnt lgkmcnt(0)
  v_exp_f32 v58, v58
  v_exp_f32 v59, v59
  v_exp_f32 v60, v60
  v_mfma_f32_32x32x16_bf16 v[40:55], v[12:15], v[4:7], 0
  v_exp_f32 v61, v61
  v_exp_f32 v62, v62
  v_exp_f32 v63, v63
  v_exp_f32 v64, v64
  v_exp_f32 v65, v65
  v_smfmac_f32_32x32x32_bf16 v[88:103], v[28:31], v[56:63], v36
  buffer_load_dwordx4 v2, s[12:15], s78 offen offset:1024 sc1 lds
  s_add_u32 s78, s78, 8192
  s_and_b32 s78, s78, 0x1ffff
  v_exp_f32 v66, v66
  v_exp_f32 v67, v67
  v_exp_f32 v68, v68
  v_exp_f32 v69, v69
  v_exp_f32 v70, v70
  v_exp_f32 v71, v71
  v_exp_f32 v40, v40
  v_exp_f32 v41, v41
  v_smfmac_f32_32x32x32_bf16 v[88:103], v[32:35], v[64:71], v36
  ds_read_b128 v[16:19], v37 offset:22880
  v_exp_f32 v42, v42
  v_exp_f32 v43, v43
  v_exp_f32 v44, v44
  v_mfma_f32_32x32x16_bf16 v[56:71], v[12:15], v[8:11], 0
  ds_read_b128 v[28:31], v38 offset:22880
  v_exp_f32 v45, v45
  v_exp_f32 v46, v46
  v_exp_f32 v47, v47
  v_exp_f32 v48, v48
  v_exp_f32 v49, v49
  v_smfmac_f32_32x32x32_bf16 v[72:87], v[20:23], v[40:47], v36
  ds_read_b128 v[32:35], v39 offset:22880
  v_exp_f32 v50, v50
  v_exp_f32 v51, v51
  v_exp_f32 v52, v52
  v_exp_f32 v53, v53
  v_exp_f32 v54, v54
  v_exp_f32 v55, v55
  v_exp_f32 v56, v56
  v_exp_f32 v57, v57
  v_smfmac_f32_32x32x32_bf16 v[72:87], v[24:27], v[48:55], v36
  s_waitcnt lgkmcnt(0)
  v_exp_f32 v58, v58
  v_exp_f32 v59, v59
  v_exp_f32 v60, v60
  v_mfma_f32_32x32x16_bf16 v[40:55], v[16:19], v[4:7], 0
  v_exp_f32 v61, v61
  v_exp_f32 v62, v62
  v_exp_f32 v63, v63
  v_exp_f32 v64, v64
  v_exp_f32 v65, v65
  s_mov_b32 m0, s74
  s_add_u32 s74, s74, 8320
  v_smfmac_f32_32x32x32_bf16 v[88:103], v[20:23], v[56:63], v36
  buffer_load_dwordx4 v2, s[12:15], s78 offen sc1 lds
  v_exp_f32 v66, v66
  v_exp_f32 v67, v67
  v_exp_f32 v68, v68
  v_exp_f32 v69, v69
  v_exp_f32 v70, v70
  v_exp_f32 v71, v71
  v_exp_f32 v40, v40
  v_exp_f32 v41, v41
  v_smfmac_f32_32x32x32_bf16 v[88:103], v[24:27], v[64:71], v36
  ds_read_b128 v[12:15], v37 offset:24960
  v_exp_f32 v42, v42
  v_exp_f32 v43, v43
  v_exp_f32 v44, v44
  v_mfma_f32_32x32x16_bf16 v[56:71], v[16:19], v[8:11], 0
  ds_read_b128 v[20:23], v38 offset:24960
  v_exp_f32 v45, v45
  v_exp_f32 v46, v46
  v_exp_f32 v47, v47
  v_exp_f32 v48, v48
  v_exp_f32 v49, v49
  v_smfmac_f32_32x32x32_bf16 v[72:87], v[28:31], v[40:47], v36
  ds_read_b128 v[24:27], v39 offset:24960
  v_exp_f32 v50, v50
  v_exp_f32 v51, v51
  v_exp_f32 v52, v52
  v_exp_f32 v53, v53
  v_exp_f32 v54, v54
  v_exp_f32 v55, v55
  v_exp_f32 v56, v56
  v_exp_f32 v57, v57
  v_smfmac_f32_32x32x32_bf16 v[72:87], v[32:35], v[48:55], v36
  s_waitcnt lgkmcnt(0)
  v_exp_f32 v58, v58
  v_exp_f32 v59, v59
  v_exp_f32 v60, v60
  v_mfma_f32_32x32x16_bf16 v[40:55], v[12:15], v[4:7], 0
  v_exp_f32 v61, v61
  v_exp_f32 v62, v62
  v_exp_f32 v63, v63
  v_exp_f32 v64, v64
  v_exp_f32 v65, v65
  v_smfmac_f32_32x32x32_bf16 v[88:103], v[28:31], v[56:63], v36
  buffer_load_dwordx4 v2, s[12:15], s78 offen offset:1024 sc1 lds
  s_add_u32 s78, s78, 8192
  s_and_b32 s78, s78, 0x1ffff
  v_exp_f32 v66, v66
  v_exp_f32 v67, v67
  v_exp_f32 v68, v68
  v_exp_f32 v69, v69
  v_exp_f32 v70, v70
  v_exp_f32 v71, v71
  s_waitcnt vmcnt(4)
  s_barrier
  s_cmp_lg_u32 s69, 0
  s_cbranch_scc1 l0_54
  s_cmp_lg_u32 s33, 0
  s_cbranch_scc1 rlgu_55
  s_bitcmp1_b32 s35, 2
  s_cselect_b32 s92, s20, s28
  s_cselect_b32 s93, s21, s29
  s_mov_b32 s94, 0x158000
  s_cselect_b32 s94, 0x80000, s94
  s_and_b32 s93, s93, 0xffff
  s_mov_b32 s95, 0x20000
  s_add_u32 m0, s34, 4096
  s_nop 0
  buffer_load_dwordx4 v243, s[92:95], s22 offen lds
  s_add_u32 m0, s34, 5120
  s_nop 0
  buffer_load_dwordx4 v243, s[92:95], s23 offen lds
  s_branch rldone_56
rlgu_55:
  s_mov_b32 s92, s26
  s_and_b32 s93, s27, 0xffff
  s_mov_b32 s94, 0x158000
  s_mov_b32 s95, 0x20000
  s_add_u32 m0, s34, 1024
  s_add_u32 s84, s16, 0
  buffer_load_dwordx4 v241, s[92:95], s84 offen lds
  s_add_u32 m0, s34, 3072
  s_add_u32 s84, s16, 44032
  buffer_load_dwordx4 v241, s[92:95], s84 offen lds
  s_add_u32 m0, s34, 5120
  s_add_u32 s84, s16, 88064
  buffer_load_dwordx4 v241, s[92:95], s84 offen lds
  s_add_u32 m0, s34, 7168
  s_add_u32 s84, s16, 132096
  buffer_load_dwordx4 v241, s[92:95], s84 offen lds
rldone_56:
l0_54:
  v_exp_f32 v40, v40
  v_exp_f32 v41, v41
  v_smfmac_f32_32x32x32_bf16 v[88:103], v[32:35], v[64:71], v36
  ds_read_b128 v[16:19], v37 offset:27040
  v_exp_f32 v42, v42
  v_exp_f32 v43, v43
  v_exp_f32 v44, v44
  v_mfma_f32_32x32x16_bf16 v[56:71], v[12:15], v[8:11], 0
  ds_read_b128 v[28:31], v38 offset:27040
  v_exp_f32 v45, v45
  v_exp_f32 v46, v46
  v_exp_f32 v47, v47
  v_exp_f32 v48, v48
  v_exp_f32 v49, v49
  v_smfmac_f32_32x32x32_bf16 v[72:87], v[20:23], v[40:47], v36
  ds_read_b128 v[32:35], v39 offset:27040
  v_exp_f32 v50, v50
  v_exp_f32 v51, v51
  v_exp_f32 v52, v52
  v_exp_f32 v53, v53
  v_exp_f32 v54, v54
  v_exp_f32 v55, v55
  v_exp_f32 v56, v56
  v_exp_f32 v57, v57
  v_smfmac_f32_32x32x32_bf16 v[72:87], v[24:27], v[48:55], v36
  s_waitcnt lgkmcnt(0)
  v_exp_f32 v58, v58
  v_exp_f32 v59, v59
  v_exp_f32 v60, v60
  v_mfma_f32_32x32x16_bf16 v[40:55], v[16:19], v[4:7], 0
  v_exp_f32 v61, v61
  v_exp_f32 v62, v62
  v_exp_f32 v63, v63
  v_exp_f32 v64, v64
  v_exp_f32 v65, v65
  s_mov_b32 m0, s74
  s_add_u32 s74, s74, 8320
  v_smfmac_f32_32x32x32_bf16 v[88:103], v[20:23], v[56:63], v36
  buffer_load_dwordx4 v2, s[12:15], s78 offen sc1 lds
  v_exp_f32 v66, v66
  v_exp_f32 v67, v67
  v_exp_f32 v68, v68
  v_exp_f32 v69, v69
  v_exp_f32 v70, v70
  v_exp_f32 v71, v71
  v_exp_f32 v40, v40
  v_exp_f32 v41, v41
  v_smfmac_f32_32x32x32_bf16 v[88:103], v[24:27], v[64:71], v36
  ds_read_b128 v[12:15], v37 offset:29120
  v_exp_f32 v42, v42
  v_exp_f32 v43, v43
  v_exp_f32 v44, v44
  v_mfma_f32_32x32x16_bf16 v[56:71], v[16:19], v[8:11], 0
  ds_read_b128 v[20:23], v38 offset:29120
  v_exp_f32 v45, v45
  v_exp_f32 v46, v46
  v_exp_f32 v47, v47
  v_exp_f32 v48, v48
  v_exp_f32 v49, v49
  v_smfmac_f32_32x32x32_bf16 v[72:87], v[28:31], v[40:47], v36
  ds_read_b128 v[24:27], v39 offset:29120
  v_exp_f32 v50, v50
  v_exp_f32 v51, v51
  v_exp_f32 v52, v52
  v_exp_f32 v53, v53
  v_exp_f32 v54, v54
  v_exp_f32 v55, v55
  v_exp_f32 v56, v56
  v_exp_f32 v57, v57
  v_smfmac_f32_32x32x32_bf16 v[72:87], v[32:35], v[48:55], v36
  s_waitcnt lgkmcnt(0)
  v_exp_f32 v58, v58
  v_exp_f32 v59, v59
  v_exp_f32 v60, v60
  v_mfma_f32_32x32x16_bf16 v[40:55], v[12:15], v[4:7], 0
  v_exp_f32 v61, v61
  v_exp_f32 v62, v62
  v_exp_f32 v63, v63
  v_exp_f32 v64, v64
  v_exp_f32 v65, v65
  v_smfmac_f32_32x32x32_bf16 v[88:103], v[28:31], v[56:63], v36
  buffer_load_dwordx4 v2, s[12:15], s78 offen offset:1024 sc1 lds
  s_add_u32 s78, s78, 8192
  s_and_b32 s78, s78, 0x1ffff
  v_exp_f32 v66, v66
  v_exp_f32 v67, v67
  v_exp_f32 v68, v68
  v_exp_f32 v69, v69
  v_exp_f32 v70, v70
  v_exp_f32 v71, v71
  v_exp_f32 v40, v40
  v_exp_f32 v41, v41
  v_smfmac_f32_32x32x32_bf16 v[88:103], v[32:35], v[64:71], v36
  ds_read_b128 v[16:19], v37 offset:31200
  v_exp_f32 v42, v42
  v_exp_f32 v43, v43
  v_exp_f32 v44, v44
  v_mfma_f32_32x32x16_bf16 v[56:71], v[12:15], v[8:11], 0
  ds_read_b128 v[28:31], v38 offset:31200
  v_exp_f32 v45, v45
  v_exp_f32 v46, v46
  v_exp_f32 v47, v47
  v_exp_f32 v48, v48
  v_exp_f32 v49, v49
  v_smfmac_f32_32x32x32_bf16 v[72:87], v[20:23], v[40:47], v36
  ds_read_b128 v[32:35], v39 offset:31200
  v_exp_f32 v50, v50
  v_exp_f32 v51, v51
  v_exp_f32 v52, v52
  v_exp_f32 v53, v53
  v_exp_f32 v54, v54
  v_exp_f32 v55, v55
  v_exp_f32 v56, v56
  v_exp_f32 v57, v57
  v_smfmac_f32_32x32x32_bf16 v[72:87], v[24:27], v[48:55], v36
  s_waitcnt lgkmcnt(0)
  v_exp_f32 v58, v58
  v_exp_f32 v59, v59
  v_exp_f32 v60, v60
  v_mfma_f32_32x32x16_bf16 v[40:55], v[16:19], v[4:7], 0
  v_exp_f32 v61, v61
  v_exp_f32 v62, v62
  v_exp_f32 v63, v63
  v_exp_f32 v64, v64
  v_exp_f32 v65, v65
  s_mov_b32 m0, s74
  s_add_u32 s74, s74, 8320
  v_smfmac_f32_32x32x32_bf16 v[88:103], v[20:23], v[56:63], v36
  buffer_load_dwordx4 v2, s[12:15], s78 offen sc1 lds
  v_exp_f32 v66, v66
  v_exp_f32 v67, v67
  v_exp_f32 v68, v68
  v_exp_f32 v69, v69
  v_exp_f32 v70, v70
  v_exp_f32 v71, v71
  v_exp_f32 v40, v40
  v_exp_f32 v41, v41
  v_smfmac_f32_32x32x32_bf16 v[88:103], v[24:27], v[64:71], v36
  ds_read_b128 v[12:15], v37 offset:33280
  v_exp_f32 v42, v42
  v_exp_f32 v43, v43
  v_exp_f32 v44, v44
  v_mfma_f32_32x32x16_bf16 v[56:71], v[16:19], v[8:11], 0
  ds_read_b128 v[20:23], v38 offset:33280
  v_exp_f32 v45, v45
  v_exp_f32 v46, v46
  v_exp_f32 v47, v47
  v_exp_f32 v48, v48
  v_exp_f32 v49, v49
  v_smfmac_f32_32x32x32_bf16 v[72:87], v[28:31], v[40:47], v36
  ds_read_b128 v[24:27], v39 offset:33280
  v_exp_f32 v50, v50
  v_exp_f32 v51, v51
  v_exp_f32 v52, v52
  v_exp_f32 v53, v53
  v_exp_f32 v54, v54
  v_exp_f32 v55, v55
  v_exp_f32 v56, v56
  v_exp_f32 v57, v57
  v_smfmac_f32_32x32x32_bf16 v[72:87], v[32:35], v[48:55], v36
  s_waitcnt lgkmcnt(0)
  v_exp_f32 v58, v58
  v_exp_f32 v59, v59
  v_exp_f32 v60, v60
  v_mfma_f32_32x32x16_bf16 v[40:55], v[12:15], v[4:7], 0
  v_exp_f32 v61, v61
  v_exp_f32 v62, v62
  v_exp_f32 v63, v63
  v_exp_f32 v64, v64
  v_exp_f32 v65, v65
  v_smfmac_f32_32x32x32_bf16 v[88:103], v[28:31], v[56:63], v36
  buffer_load_dwordx4 v2, s[12:15], s78 offen offset:1024 sc1 lds
  s_add_u32 s78, s78, 8192
  s_and_b32 s78, s78, 0x1ffff
  v_exp_f32 v66, v66
  v_exp_f32 v67, v67
  v_exp_f32 v68, v68
  v_exp_f32 v69, v69
  v_exp_f32 v70, v70
  v_exp_f32 v71, v71
  v_exp_f32 v40, v40
  v_exp_f32 v41, v41
  v_smfmac_f32_32x32x32_bf16 v[88:103], v[32:35], v[64:71], v36
  ds_read_b128 v[16:19], v37 offset:35360
  v_exp_f32 v42, v42
  v_exp_f32 v43, v43
  v_exp_f32 v44, v44
  v_mfma_f32_32x32x16_bf16 v[56:71], v[12:15], v[8:11], 0
  ds_read_b128 v[28:31], v38 offset:35360
  v_exp_f32 v45, v45
  v_exp_f32 v46, v46
  v_exp_f32 v47, v47
  v_exp_f32 v48, v48
  v_exp_f32 v49, v49
  v_smfmac_f32_32x32x32_bf16 v[72:87], v[20:23], v[40:47], v36
  ds_read_b128 v[32:35], v39 offset:35360
  v_exp_f32 v50, v50
  v_exp_f32 v51, v51
  v_exp_f32 v52, v52
  v_exp_f32 v53, v53
  v_exp_f32 v54, v54
  v_exp_f32 v55, v55
  v_exp_f32 v56, v56
  v_exp_f32 v57, v57
  v_smfmac_f32_32x32x32_bf16 v[72:87], v[24:27], v[48:55], v36
  s_waitcnt lgkmcnt(0)
  v_exp_f32 v58, v58
  v_exp_f32 v59, v59
  v_exp_f32 v60, v60
  v_mfma_f32_32x32x16_bf16 v[40:55], v[16:19], v[4:7], 0
  v_exp_f32 v61, v61
  v_exp_f32 v62, v62
  v_exp_f32 v63, v63
  v_exp_f32 v64, v64
  v_exp_f32 v65, v65
  s_mov_b32 m0, s74
  s_add_u32 s74, s74, 8320
  v_smfmac_f32_32x32x32_bf16 v[88:103], v[20:23], v[56:63], v36
  buffer_load_dwordx4 v2, s[12:15], s78 offen sc1 lds
  v_exp_f32 v66, v66
  v_exp_f32 v67, v67
  v_exp_f32 v68, v68
  v_exp_f32 v69, v69
  v_exp_f32 v70, v70
  v_exp_f32 v71, v71
  v_exp_f32 v40, v40
  v_exp_f32 v41, v41
  v_smfmac_f32_32x32x32_bf16 v[88:103], v[24:27], v[64:71], v36
  ds_read_b128 v[12:15], v37 offset:37440
  v_exp_f32 v42, v42
  v_exp_f32 v43, v43
  v_exp_f32 v44, v44
  v_mfma_f32_32x32x16_bf16 v[56:71], v[16:19], v[8:11], 0
  ds_read_b128 v[20:23], v38 offset:37440
  v_exp_f32 v45, v45
  v_exp_f32 v46, v46
  v_exp_f32 v47, v47
  v_exp_f32 v48, v48
  v_exp_f32 v49, v49
  v_smfmac_f32_32x32x32_bf16 v[72:87], v[28:31], v[40:47], v36
  ds_read_b128 v[24:27], v39 offset:37440
  v_exp_f32 v50, v50
  v_exp_f32 v51, v51
  v_exp_f32 v52, v52
  v_exp_f32 v53, v53
  v_exp_f32 v54, v54
  v_exp_f32 v55, v55
  v_exp_f32 v56, v56
  v_exp_f32 v57, v57
  v_smfmac_f32_32x32x32_bf16 v[72:87], v[32:35], v[48:55], v36
  s_waitcnt lgkmcnt(0)
  v_exp_f32 v58, v58
  v_exp_f32 v59, v59
  v_exp_f32 v60, v60
  v_mfma_f32_32x32x16_bf16 v[40:55], v[12:15], v[4:7], 0
  v_exp_f32 v61, v61
  v_exp_f32 v62, v62
  v_exp_f32 v63, v63
  v_exp_f32 v64, v64
  v_exp_f32 v65, v65
  v_smfmac_f32_32x32x32_bf16 v[88:103], v[28:31], v[56:63], v36
  buffer_load_dwordx4 v2, s[12:15], s78 offen offset:1024 sc1 lds
  s_add_u32 s78, s78, 8192
  s_and_b32 s78, s78, 0x1ffff
  v_exp_f32 v66, v66
  v_exp_f32 v67, v67
  v_exp_f32 v68, v68
  v_exp_f32 v69, v69
  v_exp_f32 v70, v70
  v_exp_f32 v71, v71
  v_exp_f32 v40, v40
  v_exp_f32 v41, v41
  v_smfmac_f32_32x32x32_bf16 v[88:103], v[32:35], v[64:71], v36
  ds_read_b128 v[16:19], v37 offset:39520
  v_exp_f32 v42, v42
  v_exp_f32 v43, v43
  v_exp_f32 v44, v44
  v_mfma_f32_32x32x16_bf16 v[56:71], v[12:15], v[8:11], 0
  ds_read_b128 v[28:31], v38 offset:39520
  v_exp_f32 v45, v45
  v_exp_f32 v46, v46
  v_exp_f32 v47, v47
  v_exp_f32 v48, v48
  v_exp_f32 v49, v49
  v_smfmac_f32_32x32x32_bf16 v[72:87], v[20:23], v[40:47], v36
  ds_read_b128 v[32:35], v39 offset:39520
  v_exp_f32 v50, v50
  v_exp_f32 v51, v51
  v_exp_f32 v52, v52
  v_exp_f32 v53, v53
  v_exp_f32 v54, v54
  v_exp_f32 v55, v55
  v_exp_f32 v56, v56
  v_exp_f32 v57, v57
  v_smfmac_f32_32x32x32_bf16 v[72:87], v[24:27], v[48:55], v36
  s_waitcnt lgkmcnt(0)
  v_exp_f32 v58, v58
  v_exp_f32 v59, v59
  v_exp_f32 v60, v60
  v_mfma_f32_32x32x16_bf16 v[40:55], v[16:19], v[4:7], 0
  v_exp_f32 v61, v61
  v_exp_f32 v62, v62
  v_exp_f32 v63, v63
  v_exp_f32 v64, v64
  v_exp_f32 v65, v65
  s_mov_b32 m0, s74
  s_add_u32 s74, s74, 8320
  v_smfmac_f32_32x32x32_bf16 v[88:103], v[20:23], v[56:63], v36
  buffer_load_dwordx4 v2, s[12:15], s78 offen sc1 lds
  v_exp_f32 v66, v66
  v_exp_f32 v67, v67
  v_exp_f32 v68, v68
  v_exp_f32 v69, v69
  v_exp_f32 v70, v70
  v_exp_f32 v71, v71
  v_exp_f32 v40, v40
  v_exp_f32 v41, v41
  v_smfmac_f32_32x32x32_bf16 v[88:103], v[24:27], v[64:71], v36
  ds_read_b128 v[12:15], v37 offset:41600
  v_exp_f32 v42, v42
  v_exp_f32 v43, v43
  v_exp_f32 v44, v44
  v_mfma_f32_32x32x16_bf16 v[56:71], v[16:19], v[8:11], 0
  ds_read_b128 v[20:23], v38 offset:41600
  v_exp_f32 v45, v45
  v_exp_f32 v46, v46
  v_exp_f32 v47, v47
  v_exp_f32 v48, v48
  v_exp_f32 v49, v49
  v_smfmac_f32_32x32x32_bf16 v[72:87], v[28:31], v[40:47], v36
  ds_read_b128 v[24:27], v39 offset:41600
  v_exp_f32 v50, v50
  v_exp_f32 v51, v51
  v_exp_f32 v52, v52
  v_exp_f32 v53, v53
  v_exp_f32 v54, v54
  v_exp_f32 v55, v55
  v_exp_f32 v56, v56
  v_exp_f32 v57, v57
  v_smfmac_f32_32x32x32_bf16 v[72:87], v[32:35], v[48:55], v36
  s_waitcnt lgkmcnt(0)
  v_exp_f32 v58, v58
  v_exp_f32 v59, v59
  v_exp_f32 v60, v60
  v_mfma_f32_32x32x16_bf16 v[40:55], v[12:15], v[4:7], 0
  v_exp_f32 v61, v61
  v_exp_f32 v62, v62
  v_exp_f32 v63, v63
  v_exp_f32 v64, v64
  v_exp_f32 v65, v65
  v_smfmac_f32_32x32x32_bf16 v[88:103], v[28:31], v[56:63], v36
  buffer_load_dwordx4 v2, s[12:15], s78 offen offset:1024 sc1 lds
  s_add_u32 s78, s78, 8192
  s_and_b32 s78, s78, 0x1ffff
  v_exp_f32 v66, v66
  v_exp_f32 v67, v67
  v_exp_f32 v68, v68
  v_exp_f32 v69, v69
  v_exp_f32 v70, v70
  v_exp_f32 v71, v71
  v_exp_f32 v40, v40
  v_exp_f32 v41, v41
  v_smfmac_f32_32x32x32_bf16 v[88:103], v[32:35], v[64:71], v36
  ds_read_b128 v[16:19], v37 offset:43680
  v_exp_f32 v42, v42
  v_exp_f32 v43, v43
  v_exp_f32 v44, v44
  v_mfma_f32_32x32x16_bf16 v[56:71], v[12:15], v[8:11], 0
  ds_read_b128 v[28:31], v38 offset:43680
  v_exp_f32 v45, v45
  v_exp_f32 v46, v46
  v_exp_f32 v47, v47
  v_exp_f32 v48, v48
  v_exp_f32 v49, v49
  v_smfmac_f32_32x32x32_bf16 v[72:87], v[20:23], v[40:47], v36
  ds_read_b128 v[32:35], v39 offset:43680
  v_exp_f32 v50, v50
  v_exp_f32 v51, v51
  v_exp_f32 v52, v52
  v_exp_f32 v53, v53
  v_exp_f32 v54, v54
  v_exp_f32 v55, v55
  v_exp_f32 v56, v56
  v_exp_f32 v57, v57
  v_smfmac_f32_32x32x32_bf16 v[72:87], v[24:27], v[48:55], v36
  s_waitcnt lgkmcnt(0)
  v_exp_f32 v58, v58
  v_exp_f32 v59, v59
  v_exp_f32 v60, v60
  v_mfma_f32_32x32x16_bf16 v[40:55], v[16:19], v[4:7], 0
  v_exp_f32 v61, v61
  v_exp_f32 v62, v62
  v_exp_f32 v63, v63
  v_exp_f32 v64, v64
  v_exp_f32 v65, v65
  s_mov_b32 m0, s74
  s_add_u32 s74, s74, 8320
  v_smfmac_f32_32x32x32_bf16 v[88:103], v[20:23], v[56:63], v36
  buffer_load_dwordx4 v2, s[12:15], s78 offen sc1 lds
  v_exp_f32 v66, v66
  v_exp_f32 v67, v67
  v_exp_f32 v68, v68
  v_exp_f32 v69, v69
  v_exp_f32 v70, v70
  v_exp_f32 v71, v71
  v_exp_f32 v40, v40
  v_exp_f32 v41, v41
  v_smfmac_f32_32x32x32_bf16 v[88:103], v[24:27], v[64:71], v36
  ds_read_b128 v[12:15], v37 offset:45760
  v_exp_f32 v42, v42
  v_exp_f32 v43, v43
  v_exp_f32 v44, v44
  v_mfma_f32_32x32x16_bf16 v[56:71], v[16:19], v[8:11], 0
  ds_read_b128 v[20:23], v38 offset:45760
  v_exp_f32 v45, v45
  v_exp_f32 v46, v46
  v_exp_f32 v47, v47
  v_exp_f32 v48, v48
  v_exp_f32 v49, v49
  v_smfmac_f32_32x32x32_bf16 v[72:87], v[28:31], v[40:47], v36
  ds_read_b128 v[24:27], v39 offset:45760
  v_exp_f32 v50, v50
  v_exp_f32 v51, v51
  v_exp_f32 v52, v52
  v_exp_f32 v53, v53
  v_exp_f32 v54, v54
  v_exp_f32 v55, v55
  v_exp_f32 v56, v56
  v_exp_f32 v57, v57
  v_smfmac_f32_32x32x32_bf16 v[72:87], v[32:35], v[48:55], v36
  s_waitcnt lgkmcnt(0)
  v_exp_f32 v58, v58
  v_exp_f32 v59, v59
  v_exp_f32 v60, v60
  v_mfma_f32_32x32x16_bf16 v[40:55], v[12:15], v[4:7], 0
  v_exp_f32 v61, v61
  v_exp_f32 v62, v62
  v_exp_f32 v63, v63
  v_exp_f32 v64, v64
  v_exp_f32 v65, v65
  v_smfmac_f32_32x32x32_bf16 v[88:103], v[28:31], v[56:63], v36
  buffer_load_dwordx4 v2, s[12:15], s78 offen offset:1024 sc1 lds
  s_add_u32 s78, s78, 8192
  s_and_b32 s78, s78, 0x1ffff
  v_exp_f32 v66, v66
  v_exp_f32 v67, v67
  v_exp_f32 v68, v68
  v_exp_f32 v69, v69
  v_exp_f32 v70, v70
  v_exp_f32 v71, v71
  v_exp_f32 v40, v40
  v_exp_f32 v41, v41
  v_smfmac_f32_32x32x32_bf16 v[88:103], v[32:35], v[64:71], v36
  ds_read_b128 v[16:19], v37 offset:47840
  v_exp_f32 v42, v42
  v_exp_f32 v43, v43
  v_exp_f32 v44, v44
  v_mfma_f32_32x32x16_bf16 v[56:71], v[12:15], v[8:11], 0
  ds_read_b128 v[28:31], v38 offset:47840
  v_exp_f32 v45, v45
  v_exp_f32 v46, v46
  v_exp_f32 v47, v47
  v_exp_f32 v48, v48
  v_exp_f32 v49, v49
  v_smfmac_f32_32x32x32_bf16 v[72:87], v[20:23], v[40:47], v36
  ds_read_b128 v[32:35], v39 offset:47840
  v_exp_f32 v50, v50
  v_exp_f32 v51, v51
  v_exp_f32 v52, v52
  v_exp_f32 v53, v53
  v_exp_f32 v54, v54
  v_exp_f32 v55, v55
  v_exp_f32 v56, v56
  v_exp_f32 v57, v57
  v_smfmac_f32_32x32x32_bf16 v[72:87], v[24:27], v[48:55], v36
  s_waitcnt lgkmcnt(0)
  v_exp_f32 v58, v58
  v_exp_f32 v59, v59
  v_exp_f32 v60, v60
  v_mfma_f32_32x32x16_bf16 v[40:55], v[16:19], v[4:7], 0
  v_exp_f32 v61, v61
  v_exp_f32 v62, v62
  v_exp_f32 v63, v63
  v_exp_f32 v64, v64
  v_exp_f32 v65, v65
  s_mov_b32 m0, s74
  s_add_u32 s74, s74, 8320
  v_smfmac_f32_32x32x32_bf16 v[88:103], v[20:23], v[56:63], v36
  buffer_load_dwordx4 v2, s[12:15], s78 offen sc1 lds
  v_exp_f32 v66, v66
  v_exp_f32 v67, v67
  v_exp_f32 v68, v68
  v_exp_f32 v69, v69
  v_exp_f32 v70, v70
  v_exp_f32 v71, v71
  v_exp_f32 v40, v40
  v_exp_f32 v41, v41
  v_smfmac_f32_32x32x32_bf16 v[88:103], v[24:27], v[64:71], v36
  ds_read_b128 v[12:15], v37 offset:49920
  v_exp_f32 v42, v42
  v_exp_f32 v43, v43
  v_exp_f32 v44, v44
  v_mfma_f32_32x32x16_bf16 v[56:71], v[16:19], v[8:11], 0
  ds_read_b128 v[20:23], v38 offset:49920
  v_exp_f32 v45, v45
  v_exp_f32 v46, v46
  v_exp_f32 v47, v47
  v_exp_f32 v48, v48
  v_exp_f32 v49, v49
  v_smfmac_f32_32x32x32_bf16 v[72:87], v[28:31], v[40:47], v36
  ds_read_b128 v[24:27], v39 offset:49920
  v_exp_f32 v50, v50
  v_exp_f32 v51, v51
  v_exp_f32 v52, v52
  v_exp_f32 v53, v53
  v_exp_f32 v54, v54
  v_exp_f32 v55, v55
  v_exp_f32 v56, v56
  v_exp_f32 v57, v57
  v_smfmac_f32_32x32x32_bf16 v[72:87], v[32:35], v[48:55], v36
  s_waitcnt lgkmcnt(0)
  v_exp_f32 v58, v58
  v_exp_f32 v59, v59
  v_exp_f32 v60, v60
  v_mfma_f32_32x32x16_bf16 v[40:55], v[12:15], v[4:7], 0
  v_exp_f32 v61, v61
  v_exp_f32 v62, v62
  v_exp_f32 v63, v63
  v_exp_f32 v64, v64
  v_exp_f32 v65, v65
  v_smfmac_f32_32x32x32_bf16 v[88:103], v[28:31], v[56:63], v36
  buffer_load_dwordx4 v2, s[12:15], s78 offen offset:1024 sc1 lds
  s_add_u32 s78, s78, 8192
  s_and_b32 s78, s78, 0x1ffff
  v_exp_f32 v66, v66
  v_exp_f32 v67, v67
  v_exp_f32 v68, v68
  v_exp_f32 v69, v69
  v_exp_f32 v70, v70
  v_exp_f32 v71, v71
  s_cmp_lg_u32 s69, 0
  s_cbranch_scc1 l0_57
  s_waitcnt vmcnt(12)
  s_cmp_lg_u32 s33, 0
  s_cbranch_scc1 rfg_58
  v_add_u32 v152, s34, v246
  v_add_u32 v153, s34, v245
  v_xor_b32 v154, 64, v245
  v_add_u32 v154, s34, v154
  ds_read_b64_tr_b16 v[160:161], v152 offset:0
  ds_read_b64_tr_b16 v[162:163], v152 offset:512
  ds_read_b64_tr_b16 v[164:165], v152 offset:1024
  ds_read_b64_tr_b16 v[166:167], v152 offset:1536
  s_bitcmp1_b32 s35, 1
  s_cbranch_scc1 rf1_60
  ds_read_b64_tr_b16 v[168:169], v152 offset:2048
  ds_read_b64_tr_b16 v[170:171], v152 offset:2560
  ds_read_b64_tr_b16 v[172:173], v152 offset:3072
  ds_read_b64_tr_b16 v[174:175], v152 offset:3584
  s_branch rf2_61
rf1_60:
  ds_read_b64_tr_b16 v[168:169], v153 offset:2048
  ds_read_b64_tr_b16 v[170:171], v153 offset:3072
  ds_read_b64_tr_b16 v[172:173], v154 offset:2048
  ds_read_b64_tr_b16 v[174:175], v154 offset:3072
rf2_61:
  ds_read_b64_tr_b16 v[176:177], v153 offset:4096
  ds_read_b64_tr_b16 v[178:179], v153 offset:5120
  ds_read_b64_tr_b16 v[180:181], v154 offset:4096
  ds_read_b64_tr_b16 v[182:183], v154 offset:5120
  s_waitcnt lgkmcnt(0)
  buffer_store_dwordx4 v[160:163], v2, s[36:39], s30 offen offset:0 sc1
  buffer_store_dwordx4 v[164:167], v2, s[36:39], s30 offen offset:1024 sc1
  buffer_store_dwordx4 v[168:171], v2, s[36:39], s31 offen offset:0 sc1
  buffer_store_dwordx4 v[172:175], v2, s[36:39], s31 offen offset:1024 sc1
  buffer_store_dwordx4 v[176:179], v2, s[36:39], s32 offen offset:0 sc1
  buffer_store_dwordx4 v[180:183], v2, s[36:39], s32 offen offset:1024 sc1
  s_branch rfd_59
rfg_58:
  v_bfe_u32 v153, v1, 4, 1
  v_lshl_add_u32 v152, v153, 10, v246
  v_xor_b32 v153, 32, v152
  v_add_u32 v152, s34, v152
  v_add_u32 v153, s34, v153
  ds_read_b64_tr_b16 v[160:161], v152 offset:0
  ds_read_b64_tr_b16 v[162:163], v152 offset:512
  ds_read_b64_tr_b16 v[164:165], v153 offset:0
  ds_read_b64_tr_b16 v[166:167], v153 offset:512
  ds_read_b64_tr_b16 v[168:169], v152 offset:2048
  ds_read_b64_tr_b16 v[170:171], v152 offset:2560
  ds_read_b64_tr_b16 v[172:173], v153 offset:2048
  ds_read_b64_tr_b16 v[174:175], v153 offset:2560
  s_waitcnt lgkmcnt(0)
  ds_read_b64_tr_b16 v[176:177], v152 offset:4096
  ds_read_b64_tr_b16 v[178:179], v152 offset:4608
  ds_read_b64_tr_b16 v[180:181], v153 offset:4096
  ds_read_b64_tr_b16 v[182:183], v153 offset:4608
  ds_read_b64_tr_b16 v[184:185], v152 offset:6144
  ds_read_b64_tr_b16 v[186:187], v152 offset:6656
  ds_read_b64_tr_b16 v[188:189], v153 offset:6144
  ds_read_b64_tr_b16 v[190:191], v153 offset:6656
  s_add_u32 s84, s30, 4096
  s_waitcnt lgkmcnt(0)
  v_mfma_f32_32x32x16_bf16 v[104:119], v[136:139], v[160:163], 0
  buffer_store_dwordx4 v[160:163], v2, s[36:39], s30 offen offset:0 sc1
  v_mfma_f32_32x32x16_bf16 v[120:135], v[136:139], v[164:167], 0
  buffer_store_dwordx4 v[164:167], v2, s[36:39], s30 offen offset:1024 sc1
  v_mfma_f32_32x32x16_bf16 v[104:119], v[136:139], v[168:171], v[104:119]
  buffer_store_dwordx4 v[168:171], v2, s[36:39], s30 offen offset:2048 sc1
  v_mfma_f32_32x32x16_bf16 v[120:135], v[136:139], v[172:175], v[120:135]
  buffer_store_dwordx4 v[172:175], v2, s[36:39], s30 offen offset:3072 sc1
  v_mfma_f32_32x32x16_bf16 v[104:119], v[136:139], v[176:179], v[104:119]
  buffer_store_dwordx4 v[176:179], v2, s[36:39], s84 offen offset:0 sc1
  v_mfma_f32_32x32x16_bf16 v[120:135], v[136:139], v[180:183], v[120:135]
  buffer_store_dwordx4 v[180:183], v2, s[36:39], s84 offen offset:1024 sc1
  v_mfma_f32_32x32x16_bf16 v[104:119], v[136:139], v[184:187], v[104:119]
  buffer_store_dwordx4 v[184:187], v2, s[36:39], s84 offen offset:2048 sc1
  v_mfma_f32_32x32x16_bf16 v[120:135], v[136:139], v[188:191], v[120:135]
  buffer_store_dwordx4 v[188:191], v2, s[36:39], s84 offen offset:3072 sc1
  s_nop 11
  s_mov_b32 exec_hi, 0
  v_cvt_pk_bf16_f32 v154, v104, v104
  v_and_b32 v154, 0xffff0000, v154
  v_sub_f32 v154, v104, v154
  v_cvt_pk_bf16_f32 v155, v104, v154
  buffer_store_dword v155, v2, s[36:39], s33 offen offset:0 sc1
  v_cvt_pk_bf16_f32 v154, v120, v120
  v_and_b32 v154, 0xffff0000, v154
  v_sub_f32 v154, v120, v154
  v_cvt_pk_bf16_f32 v156, v120, v154
  buffer_store_dword v156, v2, s[36:39], s33 offen offset:1024 sc1
  s_mov_b32 exec_hi, -1
rfd_59:
l0_57:
  v_exp_f32 v40, v40
  v_exp_f32 v41, v41
  v_smfmac_f32_32x32x32_bf16 v[88:103], v[32:35], v[64:71], v36
  ds_read_b128 v[16:19], v37 offset:52000
  v_exp_f32 v42, v42
  v_exp_f32 v43, v43
  v_exp_f32 v44, v44
  v_mfma_f32_32x32x16_bf16 v[56:71], v[12:15], v[8:11], 0
  ds_read_b128 v[28:31], v38 offset:52000
  v_exp_f32 v45, v45
  v_exp_f32 v46, v46
  v_exp_f32 v47, v47
  v_exp_f32 v48, v48
  v_exp_f32 v49, v49
  v_smfmac_f32_32x32x32_bf16 v[72:87], v[20:23], v[40:47], v36
  ds_read_b128 v[32:35], v39 offset:52000
  v_exp_f32 v50, v50
  v_exp_f32 v51, v51
  v_exp_f32 v52, v52
  v_exp_f32 v53, v53
  v_exp_f32 v54, v54
  v_exp_f32 v55, v55
  v_exp_f32 v56, v56
  v_exp_f32 v57, v57
  v_smfmac_f32_32x32x32_bf16 v[72:87], v[24:27], v[48:55], v36
  s_waitcnt lgkmcnt(0)
  v_exp_f32 v58, v58
  v_exp_f32 v59, v59
  v_exp_f32 v60, v60
  v_mfma_f32_32x32x16_bf16 v[40:55], v[16:19], v[4:7], 0
  v_exp_f32 v61, v61
  v_exp_f32 v62, v62
  v_exp_f32 v63, v63
  v_exp_f32 v64, v64
  v_exp_f32 v65, v65
  v_smfmac_f32_32x32x32_bf16 v[88:103], v[20:23], v[56:63], v36
  v_exp_f32 v66, v66
  v_exp_f32 v67, v67
  v_exp_f32 v68, v68
  v_exp_f32 v69, v69
  v_exp_f32 v70, v70
  v_exp_f32 v71, v71
  v_exp_f32 v40, v40
  v_exp_f32 v41, v41
  v_smfmac_f32_32x32x32_bf16 v[88:103], v[24:27], v[64:71], v36
  ds_read_b128 v[12:15], v37 offset:54080
  v_exp_f32 v42, v42
  v_exp_f32 v43, v43
  v_exp_f32 v44, v44
  v_mfma_f32_32x32x16_bf16 v[56:71], v[16:19], v[8:11], 0
  ds_read_b128 v[20:23], v38 offset:54080
  v_exp_f32 v45, v45
  v_exp_f32 v46, v46
  v_exp_f32 v47, v47
  v_exp_f32 v48, v48
  v_exp_f32 v49, v49
  v_smfmac_f32_32x32x32_bf16 v[72:87], v[28:31], v[40:47], v36
  ds_read_b128 v[24:27], v39 offset:54080
  v_exp_f32 v50, v50
  v_exp_f32 v51, v51
  v_exp_f32 v52, v52
  v_exp_f32 v53, v53
  v_exp_f32 v54, v54
  v_exp_f32 v55, v55
  v_exp_f32 v56, v56
  v_exp_f32 v57, v57
  v_smfmac_f32_32x32x32_bf16 v[72:87], v[32:35], v[48:55], v36
  s_waitcnt lgkmcnt(0)
  v_exp_f32 v58, v58
  v_exp_f32 v59, v59
  v_exp_f32 v60, v60
  v_mfma_f32_32x32x16_bf16 v[40:55], v[12:15], v[4:7], 0
  v_exp_f32 v61, v61
  v_exp_f32 v62, v62
  v_exp_f32 v63, v63
  v_exp_f32 v64, v64
  v_exp_f32 v65, v65
  v_smfmac_f32_32x32x32_bf16 v[88:103], v[28:31], v[56:63], v36
  v_exp_f32 v66, v66
  v_exp_f32 v67, v67
  v_exp_f32 v68, v68
  v_exp_f32 v69, v69
  v_exp_f32 v70, v70
  v_exp_f32 v71, v71
  v_exp_f32 v40, v40
  v_exp_f32 v41, v41
  v_smfmac_f32_32x32x32_bf16 v[88:103], v[32:35], v[64:71], v36
  ds_read_b128 v[16:19], v37 offset:56160
  v_exp_f32 v42, v42
  v_exp_f32 v43, v43
  v_exp_f32 v44, v44
  v_mfma_f32_32x32x16_bf16 v[56:71], v[12:15], v[8:11], 0
  ds_read_b128 v[28:31], v38 offset:56160
  v_exp_f32 v45, v45
  v_exp_f32 v46, v46
  v_exp_f32 v47, v47
  v_exp_f32 v48, v48
  v_exp_f32 v49, v49
  v_smfmac_f32_32x32x32_bf16 v[72:87], v[20:23], v[40:47], v36
  ds_read_b128 v[32:35], v39 offset:56160
  v_exp_f32 v50, v50
  v_exp_f32 v51, v51
  v_exp_f32 v52, v52
  v_exp_f32 v53, v53
  v_exp_f32 v54, v54
  v_exp_f32 v55, v55
  v_exp_f32 v56, v56
  v_exp_f32 v57, v57
  v_smfmac_f32_32x32x32_bf16 v[72:87], v[24:27], v[48:55], v36
  s_waitcnt lgkmcnt(0)
  v_exp_f32 v58, v58
  v_exp_f32 v59, v59
  v_exp_f32 v60, v60
  v_mfma_f32_32x32x16_bf16 v[40:55], v[16:19], v[4:7], 0
  v_exp_f32 v61, v61
  v_exp_f32 v62, v62
  v_exp_f32 v63, v63
  v_exp_f32 v64, v64
  v_exp_f32 v65, v65
  v_smfmac_f32_32x32x32_bf16 v[88:103], v[20:23], v[56:63], v36
  v_exp_f32 v66, v66
  v_exp_f32 v67, v67
  v_exp_f32 v68, v68
  v_exp_f32 v69, v69
  v_exp_f32 v70, v70
  v_exp_f32 v71, v71
  v_exp_f32 v40, v40
  v_exp_f32 v41, v41
  v_smfmac_f32_32x32x32_bf16 v[88:103], v[24:27], v[64:71], v36
  ds_read_b128 v[12:15], v37 offset:58240
  v_exp_f32 v42, v42
  v_exp_f32 v43, v43
  v_exp_f32 v44, v44
  v_mfma_f32_32x32x16_bf16 v[56:71], v[16:19], v[8:11], 0
  ds_read_b128 v[20:23], v38 offset:58240
  v_exp_f32 v45, v45
  v_exp_f32 v46, v46
  v_exp_f32 v47, v47
  v_exp_f32 v48, v48
  v_exp_f32 v49, v49
  v_smfmac_f32_32x32x32_bf16 v[72:87], v[28:31], v[40:47], v36
  ds_read_b128 v[24:27], v39 offset:58240
  v_exp_f32 v50, v50
  v_exp_f32 v51, v51
  v_exp_f32 v52, v52
  v_exp_f32 v53, v53
  v_exp_f32 v54, v54
  v_exp_f32 v55, v55
  v_exp_f32 v56, v56
  v_exp_f32 v57, v57
  v_smfmac_f32_32x32x32_bf16 v[72:87], v[32:35], v[48:55], v36
  s_waitcnt lgkmcnt(0)
  v_exp_f32 v58, v58
  v_exp_f32 v59, v59
  v_exp_f32 v60, v60
  v_mfma_f32_32x32x16_bf16 v[40:55], v[12:15], v[4:7], 0
  v_exp_f32 v61, v61
  v_exp_f32 v62, v62
  v_exp_f32 v63, v63
  v_exp_f32 v64, v64
  v_exp_f32 v65, v65
  v_smfmac_f32_32x32x32_bf16 v[88:103], v[28:31], v[56:63], v36
  v_add_u32 v37, 58240, v37
  v_add_u32 v38, 58240, v38
  v_add_u32 v39, 58240, v39
  v_exp_f32 v66, v66
  v_exp_f32 v67, v67
  v_exp_f32 v68, v68
  v_exp_f32 v69, v69
  v_exp_f32 v70, v70
  v_exp_f32 v71, v71
  s_waitcnt vmcnt(6)
  s_cmp_eq_u32 s69, 0
  s_cbranch_scc1 kvw_62
  s_waitcnt vmcnt(0)
kvw_62:
  s_barrier
  s_cmp_lg_u32 s69, 0
  s_cbranch_scc1 nores_63
  s_lshl_b32 s72, s9, 1
  s_and_b32 s79, s10, 1
  s_add_u32 s72, s72, s79
  s_lshl_b32 s72, s72, 1
  s_bfe_u32 s79, s10, 0x10001
  s_add_u32 s72, s72, s79
  s_lshr_b32 s79, s10, 2
  s_lshl_b32 s72, s72, 1
  s_and_b32 s74, s3, 1
  s_add_u32 s72, s72, s74
  s_lshl_b32 s72, s72, 15
  s_lshl_b32 s79, s79, 1
  s_lshr_b32 s74, s3, 1
  s_add_u32 s79, s79, s74
  s_lshl_b32 s79, s79, 6
  s_add_u32 s72, s72, s79
  buffer_load_dwordx2 v[248:249], v237, s[60:63], s72 offen offset:0
  buffer_load_dwordx2 v[250:251], v237, s[60:63], s72 offen offset:16
  buffer_load_dwordx2 v[252:253], v237, s[60:63], s72 offen offset:32
  buffer_load_dwordx2 v[254:255], v237, s[60:63], s72 offen offset:48
  s_lshl_b32 s75, s10, 3
  s_add_u32 s75, s75, s9
  s_lshl_b32 s75, s75, 2
  s_add_u32 s75, s75, s3
  s_mul_i32 s74, s75, 1376
  s_mul_i32 s75, s75, 1536
  s_mov_b64 exec, 0xfff
  s_mov_b64 exec, -1
nores_63:
  v_exp_f32 v40, v40
  v_exp_f32 v41, v41
  v_smfmac_f32_32x32x32_bf16 v[88:103], v[32:35], v[64:71], v36
  ds_read_b128 v[16:19], v37 offset:2080
  v_exp_f32 v42, v42
  v_exp_f32 v43, v43
  v_exp_f32 v44, v44
  v_mfma_f32_32x32x16_bf16 v[56:71], v[12:15], v[8:11], 0
  ds_read_b128 v[28:31], v38 offset:2080
  v_exp_f32 v45, v45
  v_exp_f32 v46, v46
  v_exp_f32 v47, v47
  v_exp_f32 v48, v48
  v_exp_f32 v49, v49
  v_smfmac_f32_32x32x32_bf16 v[72:87], v[20:23], v[40:47], v36
  ds_read_b128 v[32:35], v39 offset:2080
  v_exp_f32 v50, v50
  v_exp_f32 v51, v51
  v_exp_f32 v52, v52
  v_exp_f32 v53, v53
  v_exp_f32 v54, v54
  v_exp_f32 v55, v55
  v_exp_f32 v56, v56
  v_exp_f32 v57, v57
  v_smfmac_f32_32x32x32_bf16 v[72:87], v[24:27], v[48:55], v36
  s_waitcnt lgkmcnt(0)
  v_exp_f32 v58, v58
  v_exp_f32 v59, v59
  v_exp_f32 v60, v60
  v_mfma_f32_32x32x16_bf16 v[40:55], v[16:19], v[4:7], 0
  buffer_load_dword a6, v233, s[36:39], 0 offen sc1
  v_exp_f32 v61, v61
  v_exp_f32 v62, v62
  v_exp_f32 v63, v63
  v_exp_f32 v64, v64
  v_exp_f32 v65, v65
  v_smfmac_f32_32x32x32_bf16 v[88:103], v[20:23], v[56:63], v36
  v_exp_f32 v66, v66
  v_exp_f32 v67, v67
  v_exp_f32 v68, v68
  v_exp_f32 v69, v69
  v_exp_f32 v70, v70
  v_exp_f32 v71, v71
  v_exp_f32 v40, v40
  v_exp_f32 v41, v41
  v_smfmac_f32_32x32x32_bf16 v[88:103], v[24:27], v[64:71], v36
  ds_read_b128 v[12:15], v37 offset:4160
  v_exp_f32 v42, v42
  v_exp_f32 v43, v43
  v_exp_f32 v44, v44
  v_mfma_f32_32x32x16_bf16 v[56:71], v[16:19], v[8:11], 0
  ds_read_b128 v[20:23], v38 offset:4160
  v_exp_f32 v45, v45
  v_exp_f32 v46, v46
  v_exp_f32 v47, v47
  v_exp_f32 v48, v48
  v_exp_f32 v49, v49
  v_smfmac_f32_32x32x32_bf16 v[72:87], v[28:31], v[40:47], v36
  ds_read_b128 v[24:27], v39 offset:4160
  v_exp_f32 v50, v50
  v_exp_f32 v51, v51
  v_exp_f32 v52, v52
  v_exp_f32 v53, v53
  v_exp_f32 v54, v54
  v_exp_f32 v55, v55
  v_exp_f32 v56, v56
  v_exp_f32 v57, v57
  v_smfmac_f32_32x32x32_bf16 v[72:87], v[32:35], v[48:55], v36
  s_waitcnt lgkmcnt(0)
  v_exp_f32 v58, v58
  v_exp_f32 v59, v59
  v_exp_f32 v60, v60
  v_mfma_f32_32x32x16_bf16 v[40:55], v[12:15], v[4:7], 0
  v_exp_f32 v61, v61
  v_exp_f32 v62, v62
  v_exp_f32 v63, v63
  v_exp_f32 v64, v64
  v_exp_f32 v65, v65
  v_smfmac_f32_32x32x32_bf16 v[88:103], v[28:31], v[56:63], v36
  v_exp_f32 v66, v66
  v_exp_f32 v67, v67
  v_exp_f32 v68, v68
  v_exp_f32 v69, v69
  v_exp_f32 v70, v70
  v_exp_f32 v71, v71
  v_exp_f32 v40, v40
  v_exp_f32 v41, v41
  v_smfmac_f32_32x32x32_bf16 v[88:103], v[32:35], v[64:71], v36
  ds_read_b128 v[16:19], v37 offset:6240
  v_exp_f32 v42, v42
  v_exp_f32 v43, v43
  v_exp_f32 v44, v44
  v_mfma_f32_32x32x16_bf16 v[56:71], v[12:15], v[8:11], 0
  ds_read_b128 v[28:31], v38 offset:6240
  v_exp_f32 v45, v45
  v_exp_f32 v46, v46
  v_exp_f32 v47, v47
  v_exp_f32 v48, v48
  v_exp_f32 v49, v49
  v_smfmac_f32_32x32x32_bf16 v[72:87], v[20:23], v[40:47], v36
  ds_read_b128 v[32:35], v39 offset:6240
  v_exp_f32 v50, v50
  v_exp_f32 v51, v51
  v_exp_f32 v52, v52
  v_exp_f32 v53, v53
  v_exp_f32 v54, v54
  v_exp_f32 v55, v55
  v_exp_f32 v56, v56
  v_exp_f32 v57, v57
  v_smfmac_f32_32x32x32_bf16 v[72:87], v[24:27], v[48:55], v36
  s_waitcnt lgkmcnt(0)
  v_exp_f32 v58, v58
  v_exp_f32 v59, v59
  v_exp_f32 v60, v60
  v_mfma_f32_32x32x16_bf16 v[40:55], v[16:19], v[4:7], 0
  buffer_load_dword a7, v232, s[36:39], 0 offen sc1
  v_exp_f32 v61, v61
  v_exp_f32 v62, v62
  v_exp_f32 v63, v63
  v_exp_f32 v64, v64
  v_exp_f32 v65, v65
  v_smfmac_f32_32x32x32_bf16 v[88:103], v[20:23], v[56:63], v36
  v_exp_f32 v66, v66
  v_exp_f32 v67, v67
  v_exp_f32 v68, v68
  v_exp_f32 v69, v69
  v_exp_f32 v70, v70
  v_exp_f32 v71, v71
  v_exp_f32 v40, v40
  v_exp_f32 v41, v41
  v_smfmac_f32_32x32x32_bf16 v[88:103], v[24:27], v[64:71], v36
  ds_read_b128 v[12:15], v37 offset:8320
  v_exp_f32 v42, v42
  v_exp_f32 v43, v43
  v_exp_f32 v44, v44
  v_mfma_f32_32x32x16_bf16 v[56:71], v[16:19], v[8:11], 0
  ds_read_b128 v[20:23], v38 offset:8320
  v_exp_f32 v45, v45
  v_exp_f32 v46, v46
  v_exp_f32 v47, v47
  v_exp_f32 v48, v48
  v_exp_f32 v49, v49
  v_smfmac_f32_32x32x32_bf16 v[72:87], v[28:31], v[40:47], v36
  ds_read_b128 v[24:27], v39 offset:8320
  v_exp_f32 v50, v50
  v_exp_f32 v51, v51
  v_exp_f32 v52, v52
  v_exp_f32 v53, v53
  v_exp_f32 v54, v54
  v_exp_f32 v55, v55
  v_exp_f32 v56, v56
  v_exp_f32 v57, v57
  v_smfmac_f32_32x32x32_bf16 v[72:87], v[32:35], v[48:55], v36
  s_waitcnt lgkmcnt(0)
  v_exp_f32 v58, v58
  v_exp_f32 v59, v59
  v_exp_f32 v60, v60
  v_mfma_f32_32x32x16_bf16 v[40:55], v[12:15], v[4:7], 0
  v_exp_f32 v61, v61
  v_exp_f32 v62, v62
  v_exp_f32 v63, v63
  v_exp_f32 v64, v64
  v_exp_f32 v65, v65
  v_smfmac_f32_32x32x32_bf16 v[88:103], v[28:31], v[56:63], v36
  v_exp_f32 v66, v66
  v_exp_f32 v67, v67
  v_exp_f32 v68, v68
  v_exp_f32 v69, v69
  v_exp_f32 v70, v70
  v_exp_f32 v71, v71
  s_cmp_lg_u32 s69, 0
  s_cbranch_scc1 l0_64
  s_lshl_b32 s96, s2, 2
  s_add_u32 s96, s96, s3
  s_lshl_b32 s96, s96, 2
  s_add_u32 s96, s96, 0x4f5000
  s_waitcnt vmcnt(6)
  s_mov_b64 exec, 1
  buffer_store_dword v229, off, s[36:39], s96 sc0 sc1
  s_mov_b64 exec, -1
l0_64:
  v_exp_f32 v40, v40
  v_exp_f32 v41, v41
  v_smfmac_f32_32x32x32_bf16 v[88:103], v[32:35], v[64:71], v36
  ds_read_b128 v[16:19], v37 offset:10400
  v_exp_f32 v42, v42
  v_exp_f32 v43, v43
  v_exp_f32 v44, v44
  v_mfma_f32_32x32x16_bf16 v[56:71], v[12:15], v[8:11], 0
  ds_read_b128 v[28:31], v38 offset:10400
  v_exp_f32 v45, v45
  v_exp_f32 v46, v46
  v_exp_f32 v47, v47
  v_exp_f32 v48, v48
  v_exp_f32 v49, v49
  v_smfmac_f32_32x32x32_bf16 v[72:87], v[20:23], v[40:47], v36
  ds_read_b128 v[32:35], v39 offset:10400
  v_exp_f32 v50, v50
  v_exp_f32 v51, v51
  v_exp_f32 v52, v52
  v_exp_f32 v53, v53
  v_exp_f32 v54, v54
  v_exp_f32 v55, v55
  v_exp_f32 v56, v56
  v_exp_f32 v57, v57
  v_smfmac_f32_32x32x32_bf16 v[72:87], v[24:27], v[48:55], v36
  s_waitcnt lgkmcnt(0)
  v_exp_f32 v58, v58
  v_exp_f32 v59, v59
  v_exp_f32 v60, v60
  v_mfma_f32_32x32x16_bf16 v[40:55], v[16:19], v[4:7], 0
  v_exp_f32 v61, v61
  v_exp_f32 v62, v62
  v_exp_f32 v63, v63
  v_exp_f32 v64, v64
  v_exp_f32 v65, v65
  v_smfmac_f32_32x32x32_bf16 v[88:103], v[20:23], v[56:63], v36
  v_exp_f32 v66, v66
  v_exp_f32 v67, v67
  v_exp_f32 v68, v68
  v_exp_f32 v69, v69
  v_exp_f32 v70, v70
  v_exp_f32 v71, v71
  v_exp_f32 v40, v40
  v_exp_f32 v41, v41
  v_smfmac_f32_32x32x32_bf16 v[88:103], v[24:27], v[64:71], v36
  ds_read_b128 v[12:15], v37 offset:12480
  v_exp_f32 v42, v42
  v_exp_f32 v43, v43
  v_exp_f32 v44, v44
  v_mfma_f32_32x32x16_bf16 v[56:71], v[16:19], v[8:11], 0
  ds_read_b128 v[20:23], v38 offset:12480
  v_exp_f32 v45, v45
  v_exp_f32 v46, v46
  v_exp_f32 v47, v47
  v_exp_f32 v48, v48
  v_exp_f32 v49, v49
  v_smfmac_f32_32x32x32_bf16 v[72:87], v[28:31], v[40:47], v36
  ds_read_b128 v[24:27], v39 offset:12480
  v_exp_f32 v50, v50
  v_exp_f32 v51, v51
  v_exp_f32 v52, v52
  v_exp_f32 v53, v53
  v_exp_f32 v54, v54
  v_exp_f32 v55, v55
  v_exp_f32 v56, v56
  v_exp_f32 v57, v57
  v_smfmac_f32_32x32x32_bf16 v[72:87], v[32:35], v[48:55], v36
  s_waitcnt lgkmcnt(0)
  v_exp_f32 v58, v58
  v_exp_f32 v59, v59
  v_exp_f32 v60, v60
  v_mfma_f32_32x32x16_bf16 v[40:55], v[12:15], v[4:7], 0
  v_exp_f32 v61, v61
  v_exp_f32 v62, v62
  v_exp_f32 v63, v63
  v_exp_f32 v64, v64
  v_exp_f32 v65, v65
  v_smfmac_f32_32x32x32_bf16 v[88:103], v[28:31], v[56:63], v36
  v_exp_f32 v66, v66
  v_exp_f32 v67, v67
  v_exp_f32 v68, v68
  v_exp_f32 v69, v69
  v_exp_f32 v70, v70
  v_exp_f32 v71, v71
  v_exp_f32 v40, v40
  v_exp_f32 v41, v41
  v_smfmac_f32_32x32x32_bf16 v[88:103], v[32:35], v[64:71], v36
  ds_read_b128 v[16:19], v37 offset:14560
  v_exp_f32 v42, v42
  v_exp_f32 v43, v43
  v_exp_f32 v44, v44
  v_mfma_f32_32x32x16_bf16 v[56:71], v[12:15], v[8:11], 0
  ds_read_b128 v[28:31], v38 offset:14560
  v_exp_f32 v45, v45
  v_exp_f32 v46, v46
  v_exp_f32 v47, v47
  v_exp_f32 v48, v48
  v_exp_f32 v49, v49
  v_smfmac_f32_32x32x32_bf16 v[72:87], v[20:23], v[40:47], v36
  ds_read_b128 v[32:35], v39 offset:14560
  v_exp_f32 v50, v50
  v_exp_f32 v51, v51
  v_exp_f32 v52, v52
  v_exp_f32 v53, v53
  v_exp_f32 v54, v54
  v_exp_f32 v55, v55
  v_exp_f32 v56, v56
  v_exp_f32 v57, v57
  v_smfmac_f32_32x32x32_bf16 v[72:87], v[24:27], v[48:55], v36
  s_waitcnt lgkmcnt(0)
  v_exp_f32 v58, v58
  v_exp_f32 v59, v59
  v_exp_f32 v60, v60
  v_mfma_f32_32x32x16_bf16 v[40:55], v[16:19], v[4:7], 0
  v_exp_f32 v61, v61
  v_exp_f32 v62, v62
  v_exp_f32 v63, v63
  v_exp_f32 v64, v64
  v_exp_f32 v65, v65
  v_smfmac_f32_32x32x32_bf16 v[88:103], v[20:23], v[56:63], v36
  v_exp_f32 v66, v66
  v_exp_f32 v67, v67
  v_exp_f32 v68, v68
  v_exp_f32 v69, v69
  v_exp_f32 v70, v70
  v_exp_f32 v71, v71
  v_exp_f32 v40, v40
  v_exp_f32 v41, v41
  v_smfmac_f32_32x32x32_bf16 v[88:103], v[24:27], v[64:71], v36
  ds_read_b128 v[12:15], v37 offset:16640
  v_exp_f32 v42, v42
  v_exp_f32 v43, v43
  v_exp_f32 v44, v44
  v_mfma_f32_32x32x16_bf16 v[56:71], v[16:19], v[8:11], 0
  ds_read_b128 v[20:23], v38 offset:16640
  v_exp_f32 v45, v45
  v_exp_f32 v46, v46
  v_exp_f32 v47, v47
  v_exp_f32 v48, v48
  v_exp_f32 v49, v49
  v_smfmac_f32_32x32x32_bf16 v[72:87], v[28:31], v[40:47], v36
  ds_read_b128 v[24:27], v39 offset:16640
  v_exp_f32 v50, v50
  v_exp_f32 v51, v51
  v_exp_f32 v52, v52
  v_exp_f32 v53, v53
  v_exp_f32 v54, v54
  v_exp_f32 v55, v55
  v_exp_f32 v56, v56
  v_exp_f32 v57, v57
  v_smfmac_f32_32x32x32_bf16 v[72:87], v[32:35], v[48:55], v36
  s_waitcnt lgkmcnt(0)
  v_exp_f32 v58, v58
  v_exp_f32 v59, v59
  v_exp_f32 v60, v60
  v_mfma_f32_32x32x16_bf16 v[40:55], v[12:15], v[4:7], 0
  v_exp_f32 v61, v61
  v_exp_f32 v62, v62
  v_exp_f32 v63, v63
  v_exp_f32 v64, v64
  v_exp_f32 v65, v65
  v_smfmac_f32_32x32x32_bf16 v[88:103], v[28:31], v[56:63], v36
  v_exp_f32 v66, v66
  v_exp_f32 v67, v67
  v_exp_f32 v68, v68
  v_exp_f32 v69, v69
  v_exp_f32 v70, v70
  v_exp_f32 v71, v71
  v_exp_f32 v40, v40
  v_exp_f32 v41, v41
  v_smfmac_f32_32x32x32_bf16 v[88:103], v[32:35], v[64:71], v36
  ds_read_b128 v[16:19], v37 offset:18720
  v_exp_f32 v42, v42
  v_exp_f32 v43, v43
  v_exp_f32 v44, v44
  v_mfma_f32_32x32x16_bf16 v[56:71], v[12:15], v[8:11], 0
  ds_read_b128 v[28:31], v38 offset:18720
  v_exp_f32 v45, v45
  v_exp_f32 v46, v46
  v_exp_f32 v47, v47
  v_exp_f32 v48, v48
  v_exp_f32 v49, v49
  v_smfmac_f32_32x32x32_bf16 v[72:87], v[20:23], v[40:47], v36
  ds_read_b128 v[32:35], v39 offset:18720
  v_exp_f32 v50, v50
  v_exp_f32 v51, v51
  v_exp_f32 v52, v52
  v_exp_f32 v53, v53
  v_exp_f32 v54, v54
  v_exp_f32 v55, v55
  v_exp_f32 v56, v56
  v_exp_f32 v57, v57
  v_smfmac_f32_32x32x32_bf16 v[72:87], v[24:27], v[48:55], v36
  s_waitcnt lgkmcnt(0)
  v_exp_f32 v58, v58
  v_exp_f32 v59, v59
  v_exp_f32 v60, v60
  v_mfma_f32_32x32x16_bf16 v[40:55], v[16:19], v[4:7], 0
  v_exp_f32 v61, v61
  v_exp_f32 v62, v62
  v_exp_f32 v63, v63
  v_exp_f32 v64, v64
  v_exp_f32 v65, v65
  v_smfmac_f32_32x32x32_bf16 v[88:103], v[20:23], v[56:63], v36
  v_exp_f32 v66, v66
  v_exp_f32 v67, v67
  v_exp_f32 v68, v68
  v_exp_f32 v69, v69
  v_exp_f32 v70, v70
  v_exp_f32 v71, v71
  v_exp_f32 v40, v40
  v_exp_f32 v41, v41
  v_smfmac_f32_32x32x32_bf16 v[88:103], v[24:27], v[64:71], v36
  ds_read_b128 v[12:15], v37 offset:20800
  v_exp_f32 v42, v42
  v_exp_f32 v43, v43
  v_exp_f32 v44, v44
  v_mfma_f32_32x32x16_bf16 v[56:71], v[16:19], v[8:11], 0
  ds_read_b128 v[20:23], v38 offset:20800
  v_exp_f32 v45, v45
  v_exp_f32 v46, v46
  v_exp_f32 v47, v47
  v_exp_f32 v48, v48
  v_exp_f32 v49, v49
  v_smfmac_f32_32x32x32_bf16 v[72:87], v[28:31], v[40:47], v36
  ds_read_b128 v[24:27], v39 offset:20800
  v_exp_f32 v50, v50
  v_exp_f32 v51, v51
  v_exp_f32 v52, v52
  v_exp_f32 v53, v53
  v_exp_f32 v54, v54
  v_exp_f32 v55, v55
  v_exp_f32 v56, v56
  v_exp_f32 v57, v57
  v_smfmac_f32_32x32x32_bf16 v[72:87], v[32:35], v[48:55], v36
  s_waitcnt lgkmcnt(0)
  v_exp_f32 v58, v58
  v_exp_f32 v59, v59
  v_exp_f32 v60, v60
  v_mfma_f32_32x32x16_bf16 v[40:55], v[12:15], v[4:7], 0
  v_exp_f32 v61, v61
  v_exp_f32 v62, v62
  v_exp_f32 v63, v63
  v_exp_f32 v64, v64
  v_exp_f32 v65, v65
  v_smfmac_f32_32x32x32_bf16 v[88:103], v[28:31], v[56:63], v36
  v_exp_f32 v66, v66
  v_exp_f32 v67, v67
  v_exp_f32 v68, v68
  v_exp_f32 v69, v69
  v_exp_f32 v70, v70
  v_exp_f32 v71, v71
  v_exp_f32 v40, v40
  v_exp_f32 v41, v41
  v_smfmac_f32_32x32x32_bf16 v[88:103], v[32:35], v[64:71], v36
  ds_read_b128 v[16:19], v37 offset:22880
  v_exp_f32 v42, v42
  v_exp_f32 v43, v43
  v_exp_f32 v44, v44
  v_mfma_f32_32x32x16_bf16 v[56:71], v[12:15], v[8:11], 0
  ds_read_b128 v[28:31], v38 offset:22880
  v_exp_f32 v45, v45
  v_exp_f32 v46, v46
  v_exp_f32 v47, v47
  v_exp_f32 v48, v48
  v_exp_f32 v49, v49
  v_smfmac_f32_32x32x32_bf16 v[72:87], v[20:23], v[40:47], v36
  ds_read_b128 v[32:35], v39 offset:22880
  v_exp_f32 v50, v50
  v_exp_f32 v51, v51
  v_exp_f32 v52, v52
  v_exp_f32 v53, v53
  v_exp_f32 v54, v54
  v_exp_f32 v55, v55
  v_exp_f32 v56, v56
  v_exp_f32 v57, v57
  v_smfmac_f32_32x32x32_bf16 v[72:87], v[24:27], v[48:55], v36
  s_waitcnt lgkmcnt(0)
  v_exp_f32 v58, v58
  v_exp_f32 v59, v59
  v_exp_f32 v60, v60
  v_mfma_f32_32x32x16_bf16 v[40:55], v[16:19], v[4:7], 0
  v_exp_f32 v61, v61
  v_exp_f32 v62, v62
  v_exp_f32 v63, v63
  v_exp_f32 v64, v64
  v_exp_f32 v65, v65
  v_smfmac_f32_32x32x32_bf16 v[88:103], v[20:23], v[56:63], v36
  v_exp_f32 v66, v66
  v_exp_f32 v67, v67
  v_exp_f32 v68, v68
  v_exp_f32 v69, v69
  v_exp_f32 v70, v70
  v_exp_f32 v71, v71
  v_exp_f32 v40, v40
  v_exp_f32 v41, v41
  v_smfmac_f32_32x32x32_bf16 v[88:103], v[24:27], v[64:71], v36
  ds_read_b128 v[12:15], v37 offset:24960
  v_exp_f32 v42, v42
  v_exp_f32 v43, v43
  v_exp_f32 v44, v44
  v_mfma_f32_32x32x16_bf16 v[56:71], v[16:19], v[8:11], 0
  ds_read_b128 v[20:23], v38 offset:24960
  v_exp_f32 v45, v45
  v_exp_f32 v46, v46
  v_exp_f32 v47, v47
  v_exp_f32 v48, v48
  v_exp_f32 v49, v49
  v_smfmac_f32_32x32x32_bf16 v[72:87], v[28:31], v[40:47], v36
  ds_read_b128 v[24:27], v39 offset:24960
  v_exp_f32 v50, v50
  v_exp_f32 v51, v51
  v_exp_f32 v52, v52
  v_exp_f32 v53, v53
  v_exp_f32 v54, v54
  v_exp_f32 v55, v55
  v_exp_f32 v56, v56
  v_exp_f32 v57, v57
  v_smfmac_f32_32x32x32_bf16 v[72:87], v[32:35], v[48:55], v36
  s_waitcnt lgkmcnt(0)
  v_exp_f32 v58, v58
  v_exp_f32 v59, v59
  v_exp_f32 v60, v60
  v_mfma_f32_32x32x16_bf16 v[40:55], v[12:15], v[4:7], 0
  v_exp_f32 v61, v61
  v_exp_f32 v62, v62
  v_exp_f32 v63, v63
  v_exp_f32 v64, v64
  v_exp_f32 v65, v65
  v_smfmac_f32_32x32x32_bf16 v[88:103], v[28:31], v[56:63], v36
  v_exp_f32 v66, v66
  v_exp_f32 v67, v67
  v_exp_f32 v68, v68
  v_exp_f32 v69, v69
  v_exp_f32 v70, v70
  v_exp_f32 v71, v71
  v_exp_f32 v40, v40
  v_exp_f32 v41, v41
  v_smfmac_f32_32x32x32_bf16 v[88:103], v[32:35], v[64:71], v36
  ds_read_b128 v[16:19], v37 offset:27040
  v_exp_f32 v42, v42
  v_exp_f32 v43, v43
  v_exp_f32 v44, v44
  v_mfma_f32_32x32x16_bf16 v[56:71], v[12:15], v[8:11], 0
  ds_read_b128 v[28:31], v38 offset:27040
  v_exp_f32 v45, v45
  v_exp_f32 v46, v46
  v_exp_f32 v47, v47
  v_exp_f32 v48, v48
  v_exp_f32 v49, v49
  v_smfmac_f32_32x32x32_bf16 v[72:87], v[20:23], v[40:47], v36
  ds_read_b128 v[32:35], v39 offset:27040
  v_exp_f32 v50, v50
  v_exp_f32 v51, v51
  v_exp_f32 v52, v52
  v_exp_f32 v53, v53
  v_exp_f32 v54, v54
  v_exp_f32 v55, v55
  v_exp_f32 v56, v56
  v_exp_f32 v57, v57
  v_smfmac_f32_32x32x32_bf16 v[72:87], v[24:27], v[48:55], v36
  s_waitcnt lgkmcnt(0)
  v_exp_f32 v58, v58
  v_exp_f32 v59, v59
  v_exp_f32 v60, v60
  v_mfma_f32_32x32x16_bf16 v[40:55], v[16:19], v[4:7], 0
  v_exp_f32 v61, v61
  v_exp_f32 v62, v62
  v_exp_f32 v63, v63
  v_exp_f32 v64, v64
  v_exp_f32 v65, v65
  v_smfmac_f32_32x32x32_bf16 v[88:103], v[20:23], v[56:63], v36
  v_exp_f32 v66, v66
  v_exp_f32 v67, v67
  v_exp_f32 v68, v68
  v_exp_f32 v69, v69
  v_exp_f32 v70, v70
  v_exp_f32 v71, v71
  v_exp_f32 v40, v40
  v_exp_f32 v41, v41
  v_smfmac_f32_32x32x32_bf16 v[88:103], v[24:27], v[64:71], v36
  ds_read_b128 v[12:15], v37 offset:29120
  v_exp_f32 v42, v42
  v_exp_f32 v43, v43
  v_exp_f32 v44, v44
  v_mfma_f32_32x32x16_bf16 v[56:71], v[16:19], v[8:11], 0
  ds_read_b128 v[20:23], v38 offset:29120
  v_exp_f32 v45, v45
  v_exp_f32 v46, v46
  v_exp_f32 v47, v47
  v_exp_f32 v48, v48
  v_exp_f32 v49, v49
  v_smfmac_f32_32x32x32_bf16 v[72:87], v[28:31], v[40:47], v36
  ds_read_b128 v[24:27], v39 offset:29120
  v_exp_f32 v50, v50
  v_exp_f32 v51, v51
  v_exp_f32 v52, v52
  v_exp_f32 v53, v53
  v_exp_f32 v54, v54
  v_exp_f32 v55, v55
  v_exp_f32 v56, v56
  v_exp_f32 v57, v57
  v_smfmac_f32_32x32x32_bf16 v[72:87], v[32:35], v[48:55], v36
  s_waitcnt lgkmcnt(0)
  v_exp_f32 v58, v58
  v_exp_f32 v59, v59
  v_exp_f32 v60, v60
  v_mfma_f32_32x32x16_bf16 v[40:55], v[12:15], v[4:7], 0
  v_exp_f32 v61, v61
  v_exp_f32 v62, v62
  v_exp_f32 v63, v63
  v_exp_f32 v64, v64
  v_exp_f32 v65, v65
  v_smfmac_f32_32x32x32_bf16 v[88:103], v[28:31], v[56:63], v36
  v_exp_f32 v66, v66
  v_exp_f32 v67, v67
  v_exp_f32 v68, v68
  v_exp_f32 v69, v69
  v_exp_f32 v70, v70
  v_exp_f32 v71, v71
  v_exp_f32 v40, v40
  v_exp_f32 v41, v41
  v_smfmac_f32_32x32x32_bf16 v[88:103], v[32:35], v[64:71], v36
  ds_read_b128 v[16:19], v37 offset:31200
  v_exp_f32 v42, v42
  v_exp_f32 v43, v43
  v_exp_f32 v44, v44
  v_mfma_f32_32x32x16_bf16 v[56:71], v[12:15], v[8:11], 0
  ds_read_b128 v[28:31], v38 offset:31200
  v_exp_f32 v45, v45
  v_exp_f32 v46, v46
  v_exp_f32 v47, v47
  v_exp_f32 v48, v48
  v_exp_f32 v49, v49
  v_smfmac_f32_32x32x32_bf16 v[72:87], v[20:23], v[40:47], v36
  ds_read_b128 v[32:35], v39 offset:31200
  v_exp_f32 v50, v50
  v_exp_f32 v51, v51
  v_exp_f32 v52, v52
  v_exp_f32 v53, v53
  v_exp_f32 v54, v54
  v_exp_f32 v55, v55
  v_exp_f32 v56, v56
  v_exp_f32 v57, v57
  v_smfmac_f32_32x32x32_bf16 v[72:87], v[24:27], v[48:55], v36
  s_waitcnt lgkmcnt(0)
  v_exp_f32 v58, v58
  v_exp_f32 v59, v59
  v_exp_f32 v60, v60
  v_mfma_f32_32x32x16_bf16 v[40:55], v[16:19], v[4:7], 0
  v_exp_f32 v61, v61
  v_exp_f32 v62, v62
  v_exp_f32 v63, v63
  v_exp_f32 v64, v64
  v_exp_f32 v65, v65
  v_smfmac_f32_32x32x32_bf16 v[88:103], v[20:23], v[56:63], v36
  v_exp_f32 v66, v66
  v_exp_f32 v67, v67
  v_exp_f32 v68, v68
  v_exp_f32 v69, v69
  v_exp_f32 v70, v70
  v_exp_f32 v71, v71
  v_exp_f32 v40, v40
  v_exp_f32 v41, v41
  v_smfmac_f32_32x32x32_bf16 v[88:103], v[24:27], v[64:71], v36
  ds_read_b128 v[12:15], v37 offset:33280
  v_exp_f32 v42, v42
  v_exp_f32 v43, v43
  v_exp_f32 v44, v44
  v_mfma_f32_32x32x16_bf16 v[56:71], v[16:19], v[8:11], 0
  ds_read_b128 v[20:23], v38 offset:33280
  v_exp_f32 v45, v45
  v_exp_f32 v46, v46
  v_exp_f32 v47, v47
  v_exp_f32 v48, v48
  v_exp_f32 v49, v49
  v_smfmac_f32_32x32x32_bf16 v[72:87], v[28:31], v[40:47], v36
  ds_read_b128 v[24:27], v39 offset:33280
  v_exp_f32 v50, v50
  v_exp_f32 v51, v51
  v_exp_f32 v52, v52
  v_exp_f32 v53, v53
  v_exp_f32 v54, v54
  v_exp_f32 v55, v55
  v_exp_f32 v56, v56
  v_exp_f32 v57, v57
  v_smfmac_f32_32x32x32_bf16 v[72:87], v[32:35], v[48:55], v36
  s_waitcnt lgkmcnt(0)
  v_exp_f32 v58, v58
  v_exp_f32 v59, v59
  v_exp_f32 v60, v60
  v_mfma_f32_32x32x16_bf16 v[40:55], v[12:15], v[4:7], 0
  v_exp_f32 v61, v61
  v_exp_f32 v62, v62
  v_exp_f32 v63, v63
  v_exp_f32 v64, v64
  v_exp_f32 v65, v65
  v_smfmac_f32_32x32x32_bf16 v[88:103], v[28:31], v[56:63], v36
  v_exp_f32 v66, v66
  v_exp_f32 v67, v67
  v_exp_f32 v68, v68
  v_exp_f32 v69, v69
  v_exp_f32 v70, v70
  v_exp_f32 v71, v71
  s_mov_b32 s79, 0x4f5000
  s_cmp_lg_u32 s69, 0
  s_cbranch_scc1 l0_65
  buffer_load_dwordx4 v[104:107], v2, s[36:39], s79 offen offset:0 sc0 sc1
  buffer_load_dwordx4 v[108:111], v2, s[36:39], s79 offen offset:1024 sc0 sc1
  buffer_load_dwordx4 v[112:115], v2, s[36:39], s79 offen offset:2048 sc0 sc1
  buffer_load_dwordx4 v[116:119], v2, s[36:39], s79 offen offset:3072 sc0 sc1
l0_65:
  v_exp_f32 v40, v40
  v_exp_f32 v41, v41
  v_smfmac_f32_32x32x32_bf16 v[88:103], v[32:35], v[64:71], v36
  ds_read_b128 v[16:19], v37 offset:35360
  v_exp_f32 v42, v42
  v_exp_f32 v43, v43
  v_exp_f32 v44, v44
  v_mfma_f32_32x32x16_bf16 v[56:71], v[12:15], v[8:11], 0
  ds_read_b128 v[28:31], v38 offset:35360
  v_exp_f32 v45, v45
  v_exp_f32 v46, v46
  v_exp_f32 v47, v47
  v_exp_f32 v48, v48
  v_exp_f32 v49, v49
  v_smfmac_f32_32x32x32_bf16 v[72:87], v[20:23], v[40:47], v36
  ds_read_b128 v[32:35], v39 offset:35360
  v_exp_f32 v50, v50
  v_exp_f32 v51, v51
  v_exp_f32 v52, v52
  v_exp_f32 v53, v53
  v_exp_f32 v54, v54
  v_exp_f32 v55, v55
  v_exp_f32 v56, v56
  v_exp_f32 v57, v57
  v_smfmac_f32_32x32x32_bf16 v[72:87], v[24:27], v[48:55], v36
  s_waitcnt lgkmcnt(0)
  v_exp_f32 v58, v58
  v_exp_f32 v59, v59
  v_exp_f32 v60, v60
  v_mfma_f32_32x32x16_bf16 v[40:55], v[16:19], v[4:7], 0
  v_exp_f32 v61, v61
  v_exp_f32 v62, v62
  v_exp_f32 v63, v63
  v_exp_f32 v64, v64
  v_exp_f32 v65, v65
  v_smfmac_f32_32x32x32_bf16 v[88:103], v[20:23], v[56:63], v36
  v_exp_f32 v66, v66
  v_exp_f32 v67, v67
  v_exp_f32 v68, v68
  v_exp_f32 v69, v69
  v_exp_f32 v70, v70
  v_exp_f32 v71, v71
  v_exp_f32 v40, v40
  v_exp_f32 v41, v41
  v_smfmac_f32_32x32x32_bf16 v[88:103], v[24:27], v[64:71], v36
  ds_read_b128 v[12:15], v37 offset:37440
  v_exp_f32 v42, v42
  v_exp_f32 v43, v43
  v_exp_f32 v44, v44
  v_mfma_f32_32x32x16_bf16 v[56:71], v[16:19], v[8:11], 0
  ds_read_b128 v[20:23], v38 offset:37440
  v_exp_f32 v45, v45
  v_exp_f32 v46, v46
  v_exp_f32 v47, v47
  v_exp_f32 v48, v48
  v_exp_f32 v49, v49
  v_smfmac_f32_32x32x32_bf16 v[72:87], v[28:31], v[40:47], v36
  ds_read_b128 v[24:27], v39 offset:37440
  v_exp_f32 v50, v50
  v_exp_f32 v51, v51
  v_exp_f32 v52, v52
  v_exp_f32 v53, v53
  v_exp_f32 v54, v54
  v_exp_f32 v55, v55
  v_exp_f32 v56, v56
  v_exp_f32 v57, v57
  v_smfmac_f32_32x32x32_bf16 v[72:87], v[32:35], v[48:55], v36
  s_waitcnt lgkmcnt(0)
  v_exp_f32 v58, v58
  v_exp_f32 v59, v59
  v_exp_f32 v60, v60
  v_mfma_f32_32x32x16_bf16 v[40:55], v[12:15], v[4:7], 0
  v_exp_f32 v61, v61
  v_exp_f32 v62, v62
  v_exp_f32 v63, v63
  v_exp_f32 v64, v64
  v_exp_f32 v65, v65
  v_smfmac_f32_32x32x32_bf16 v[88:103], v[28:31], v[56:63], v36
  v_exp_f32 v66, v66
  v_exp_f32 v67, v67
  v_exp_f32 v68, v68
  v_exp_f32 v69, v69
  v_exp_f32 v70, v70
  v_exp_f32 v71, v71
  v_exp_f32 v40, v40
  v_exp_f32 v41, v41
  v_smfmac_f32_32x32x32_bf16 v[88:103], v[32:35], v[64:71], v36
  ds_read_b128 v[16:19], v37 offset:39520
  v_exp_f32 v42, v42
  v_exp_f32 v43, v43
  v_exp_f32 v44, v44
  v_mfma_f32_32x32x16_bf16 v[56:71], v[12:15], v[8:11], 0
  ds_read_b128 v[28:31], v38 offset:39520
  v_exp_f32 v45, v45
  v_exp_f32 v46, v46
  v_exp_f32 v47, v47
  v_exp_f32 v48, v48
  v_exp_f32 v49, v49
  v_smfmac_f32_32x32x32_bf16 v[72:87], v[20:23], v[40:47], v36
  ds_read_b128 v[32:35], v39 offset:39520
  v_exp_f32 v50, v50
  v_exp_f32 v51, v51
  v_exp_f32 v52, v52
  v_exp_f32 v53, v53
  v_exp_f32 v54, v54
  v_exp_f32 v55, v55
  v_exp_f32 v56, v56
  v_exp_f32 v57, v57
  v_smfmac_f32_32x32x32_bf16 v[72:87], v[24:27], v[48:55], v36
  s_waitcnt lgkmcnt(0)
  v_exp_f32 v58, v58
  v_exp_f32 v59, v59
  v_exp_f32 v60, v60
  v_mfma_f32_32x32x16_bf16 v[40:55], v[16:19], v[4:7], 0
  v_exp_f32 v61, v61
  v_exp_f32 v62, v62
  v_exp_f32 v63, v63
  v_exp_f32 v64, v64
  v_exp_f32 v65, v65
  v_smfmac_f32_32x32x32_bf16 v[88:103], v[20:23], v[56:63], v36
  v_exp_f32 v66, v66
  v_exp_f32 v67, v67
  v_exp_f32 v68, v68
  v_exp_f32 v69, v69
  v_exp_f32 v70, v70
  v_exp_f32 v71, v71
  v_exp_f32 v40, v40
  v_exp_f32 v41, v41
  v_smfmac_f32_32x32x32_bf16 v[88:103], v[24:27], v[64:71], v36
  ds_read_b128 v[12:15], v37 offset:41600
  v_exp_f32 v42, v42
  v_exp_f32 v43, v43
  v_exp_f32 v44, v44
  v_mfma_f32_32x32x16_bf16 v[56:71], v[16:19], v[8:11], 0
  ds_read_b128 v[20:23], v38 offset:41600
  v_exp_f32 v45, v45
  v_exp_f32 v46, v46
  v_exp_f32 v47, v47
  v_exp_f32 v48, v48
  v_exp_f32 v49, v49
  v_smfmac_f32_32x32x32_bf16 v[72:87], v[28:31], v[40:47], v36
  ds_read_b128 v[24:27], v39 offset:41600
  v_exp_f32 v50, v50
  v_exp_f32 v51, v51
  v_exp_f32 v52, v52
  v_exp_f32 v53, v53
  v_exp_f32 v54, v54
  v_exp_f32 v55, v55
  v_exp_f32 v56, v56
  v_exp_f32 v57, v57
  v_smfmac_f32_32x32x32_bf16 v[72:87], v[32:35], v[48:55], v36
  s_waitcnt lgkmcnt(0)
  v_exp_f32 v58, v58
  v_exp_f32 v59, v59
  v_exp_f32 v60, v60
  v_mfma_f32_32x32x16_bf16 v[40:55], v[12:15], v[4:7], 0
  v_exp_f32 v61, v61
  v_exp_f32 v62, v62
  v_exp_f32 v63, v63
  v_exp_f32 v64, v64
  v_exp_f32 v65, v65
  v_smfmac_f32_32x32x32_bf16 v[88:103], v[28:31], v[56:63], v36
  v_exp_f32 v66, v66
  v_exp_f32 v67, v67
  v_exp_f32 v68, v68
  v_exp_f32 v69, v69
  v_exp_f32 v70, v70
  v_exp_f32 v71, v71
  s_cmp_lg_u32 s69, 0
  s_cbranch_scc1 l0_66
  s_mov_b32 s8, 0
  s_branch rf2c_68
rf2p_67:
  buffer_load_dwordx4 v[104:107], v2, s[36:39], s79 offen offset:0 sc0 sc1
  buffer_load_dwordx4 v[108:111], v2, s[36:39], s79 offen offset:1024 sc0 sc1
  buffer_load_dwordx4 v[112:115], v2, s[36:39], s79 offen offset:2048 sc0 sc1
  buffer_load_dwordx4 v[116:119], v2, s[36:39], s79 offen offset:3072 sc0 sc1
  s_add_u32 s8, s8, 1
  s_cmp_gt_u32 s8, 0x80000
  s_cbranch_scc1 L_abort
rf2c_68:
  s_waitcnt vmcnt(0)
  v_and_b32 v104, v104, v112
  v_and_b32 v105, v105, v113
  v_and_b32 v106, v106, v114
  v_and_b32 v107, v107, v115
  v_and_b32 v108, v108, v116
  v_and_b32 v109, v109, v117
  v_and_b32 v110, v110, v118
  v_and_b32 v111, v111, v119
  v_and_b32 v104, v104, v108
  v_and_b32 v105, v105, v109
  v_and_b32 v106, v106, v110
  v_and_b32 v107, v107, v111
  v_and_b32 v104, v104, v106
  v_and_b32 v105, v105, v107
  v_and_b32 v104, v104, v105
  v_cmp_ne_u32 vcc, 1, v104
  s_nop 3
  s_cbranch_vccnz rf2p_67
l0_66:
  s_barrier
  v_exp_f32 v40, v40
  v_exp_f32 v41, v41
  v_smfmac_f32_32x32x32_bf16 v[88:103], v[32:35], v[64:71], v36
  ds_read_b128 v[16:19], v37 offset:43680
  v_exp_f32 v42, v42
  v_exp_f32 v43, v43
  v_exp_f32 v44, v44
  v_mfma_f32_32x32x16_bf16 v[56:71], v[12:15], v[8:11], 0
  ds_read_b128 v[28:31], v38 offset:43680
  v_exp_f32 v45, v45
  v_exp_f32 v46, v46
  v_exp_f32 v47, v47
  v_exp_f32 v48, v48
  v_exp_f32 v49, v49
  v_smfmac_f32_32x32x32_bf16 v[72:87], v[20:23], v[40:47], v36
  ds_read_b128 v[32:35], v39 offset:43680
  v_exp_f32 v50, v50
  v_exp_f32 v51, v51
  v_exp_f32 v52, v52
  v_exp_f32 v53, v53
  v_exp_f32 v54, v54
  v_exp_f32 v55, v55
  v_exp_f32 v56, v56
  v_exp_f32 v57, v57
  s_lshr_b32 s82, s3, 1
  s_mul_i32 s82, s82, 32768
  s_and_b32 s81, s3, 1
  s_lshl_b32 s81, s81, 10
  s_add_u32 s82, s82, s81
  s_lshr_b32 s81, s10, 2
  s_mul_i32 s81, s81, 65536
  s_add_u32 s82, s82, s81
  s_lshl_b32 s81, s3, 10
  s_add_u32 m0, s81, 135168
  s_add_u32 s80, s82, 0x1980000
  v_smfmac_f32_32x32x32_bf16 v[72:87], v[24:27], v[48:55], v36
  buffer_load_dwordx4 v2, s[36:39], s80 offen sc1 lds
  s_waitcnt lgkmcnt(0)
  v_exp_f32 v58, v58
  v_exp_f32 v59, v59
  v_exp_f32 v60, v60
  v_mfma_f32_32x32x16_bf16 v[40:55], v[16:19], v[4:7], 0
  v_exp_f32 v61, v61
  v_exp_f32 v62, v62
  v_exp_f32 v63, v63
  v_exp_f32 v64, v64
  v_exp_f32 v65, v65
  s_add_u32 m0, s81, 139264
  s_add_u32 s80, s82, 0x1980800
  v_smfmac_f32_32x32x32_bf16 v[88:103], v[20:23], v[56:63], v36
  buffer_load_dwordx4 v2, s[36:39], s80 offen sc1 lds
  v_exp_f32 v66, v66
  v_exp_f32 v67, v67
  v_exp_f32 v68, v68
  v_exp_f32 v69, v69
  v_exp_f32 v70, v70
  v_exp_f32 v71, v71
  v_exp_f32 v40, v40
  v_exp_f32 v41, v41
  v_smfmac_f32_32x32x32_bf16 v[88:103], v[24:27], v[64:71], v36
  ds_read_b128 v[12:15], v37 offset:45760
  v_exp_f32 v42, v42
  v_exp_f32 v43, v43
  v_exp_f32 v44, v44
  v_mfma_f32_32x32x16_bf16 v[56:71], v[16:19], v[8:11], 0
  ds_read_b128 v[20:23], v38 offset:45760
  v_exp_f32 v45, v45
  v_exp_f32 v46, v46
  v_exp_f32 v47, v47
  v_exp_f32 v48, v48
  v_exp_f32 v49, v49
  v_smfmac_f32_32x32x32_bf16 v[72:87], v[28:31], v[40:47], v36
  ds_read_b128 v[24:27], v39 offset:45760
  v_exp_f32 v50, v50
  v_exp_f32 v51, v51
  v_exp_f32 v52, v52
  v_exp_f32 v53, v53
  v_exp_f32 v54, v54
  v_exp_f32 v55, v55
  v_exp_f32 v56, v56
  v_exp_f32 v57, v57
  s_add_u32 m0, s81, 143360
  s_add_u32 s80, s82, 0x1981000
  v_smfmac_f32_32x32x32_bf16 v[72:87], v[32:35], v[48:55], v36
  buffer_load_dwordx4 v2, s[36:39], s80 offen sc1 lds
  s_waitcnt lgkmcnt(0)
  v_exp_f32 v58, v58
  v_exp_f32 v59, v59
  v_exp_f32 v60, v60
  s_add_u32 m0, s81, 147456
  s_add_u32 s80, s82, 0x1981800
  v_mfma_f32_32x32x16_bf16 v[40:55], v[12:15], v[4:7], 0
  buffer_load_dwordx4 v2, s[36:39], s80 offen sc1 lds
  v_exp_f32 v61, v61
  v_exp_f32 v62, v62
  v_exp_f32 v63, v63
  v_exp_f32 v64, v64
  v_exp_f32 v65, v65
  s_add_u32 m0, s81, 151552
  s_add_u32 s80, s82, 0x1982000
  v_smfmac_f32_32x32x32_bf16 v[88:103], v[28:31], v[56:63], v36
  buffer_load_dwordx4 v2, s[36:39], s80 offen sc1 lds
  v_exp_f32 v66, v66
  v_exp_f32 v67, v67
  v_exp_f32 v68, v68
  v_exp_f32 v69, v69
  v_exp_f32 v70, v70
  v_exp_f32 v71, v71
  v_exp_f32 v40, v40
  v_exp_f32 v41, v41
  v_smfmac_f32_32x32x32_bf16 v[88:103], v[32:35], v[64:71], v36
  ds_read_b128 v[16:19], v37 offset:47840
  v_exp_f32 v42, v42
  v_exp_f32 v43, v43
  v_exp_f32 v44, v44
  v_mfma_f32_32x32x16_bf16 v[56:71], v[12:15], v[8:11], 0
  ds_read_b128 v[28:31], v38 offset:47840
  v_exp_f32 v45, v45
  v_exp_f32 v46, v46
  v_exp_f32 v47, v47
  v_exp_f32 v48, v48
  v_exp_f32 v49, v49
  v_smfmac_f32_32x32x32_bf16 v[72:87], v[20:23], v[40:47], v36
  ds_read_b128 v[32:35], v39 offset:47840
  v_exp_f32 v50, v50
  v_exp_f32 v51, v51
  v_exp_f32 v52, v52
  v_exp_f32 v53, v53
  v_exp_f32 v54, v54
  v_exp_f32 v55, v55
  v_exp_f32 v56, v56
  v_exp_f32 v57, v57
  s_add_u32 m0, s81, 155648
  s_add_u32 s80, s82, 0x1982800
  v_smfmac_f32_32x32x32_bf16 v[72:87], v[24:27], v[48:55], v36
  buffer_load_dwordx4 v2, s[36:39], s80 offen sc1 lds
  s_waitcnt lgkmcnt(0)
  v_exp_f32 v58, v58
  v_exp_f32 v59, v59
  v_exp_f32 v60, v60
  v_mfma_f32_32x32x16_bf16 v[40:55], v[16:19], v[4:7], 0
  v_exp_f32 v61, v61
  v_exp_f32 v62, v62
  v_exp_f32 v63, v63
  v_exp_f32 v64, v64
  v_exp_f32 v65, v65
  s_add_u32 m0, s81, 159744
  s_add_u32 s80, s82, 0x1983000
  v_smfmac_f32_32x32x32_bf16 v[88:103], v[20:23], v[56:63], v36
  buffer_load_dwordx4 v2, s[36:39], s80 offen sc1 lds
  v_exp_f32 v66, v66
  v_exp_f32 v67, v67
  v_exp_f32 v68, v68
  v_exp_f32 v69, v69
  v_exp_f32 v70, v70
  v_exp_f32 v71, v71
  v_exp_f32 v40, v40
  v_exp_f32 v41, v41
  v_smfmac_f32_32x32x32_bf16 v[88:103], v[24:27], v[64:71], v36
  ds_read_b128 v[12:15], v37 offset:49920
  v_exp_f32 v42, v42
  v_exp_f32 v43, v43
  v_exp_f32 v44, v44
  v_mfma_f32_32x32x16_bf16 v[56:71], v[16:19], v[8:11], 0
  ds_read_b128 v[20:23], v38 offset:49920
  v_exp_f32 v45, v45
  v_exp_f32 v46, v46
  v_exp_f32 v47, v47
  v_exp_f32 v48, v48
  v_exp_f32 v49, v49
  v_smfmac_f32_32x32x32_bf16 v[72:87], v[28:31], v[40:47], v36
  ds_read_b128 v[24:27], v39 offset:49920
  v_exp_f32 v50, v50
  v_exp_f32 v51, v51
  v_exp_f32 v52, v52
  v_exp_f32 v53, v53
  v_exp_f32 v54, v54
  v_exp_f32 v55, v55
  v_exp_f32 v56, v56
  v_exp_f32 v57, v57
  s_add_u32 m0, s81, 0
  s_add_u32 s80, s82, 0x1983800
  v_smfmac_f32_32x32x32_bf16 v[72:87], v[32:35], v[48:55], v36
  buffer_load_dwordx4 v2, s[36:39], s80 offen sc1 lds
  s_waitcnt lgkmcnt(0)
  v_exp_f32 v58, v58
  v_exp_f32 v59, v59
  v_exp_f32 v60, v60
  s_add_u32 m0, s81, 4096
  s_add_u32 s80, s82, 0x1984000
  v_mfma_f32_32x32x16_bf16 v[40:55], v[12:15], v[4:7], 0
  buffer_load_dwordx4 v2, s[36:39], s80 offen sc1 lds
  v_exp_f32 v61, v61
  v_exp_f32 v62, v62
  v_exp_f32 v63, v63
  v_exp_f32 v64, v64
  v_exp_f32 v65, v65
  s_add_u32 m0, s81, 8192
  s_add_u32 s80, s82, 0x1984800
  v_smfmac_f32_32x32x32_bf16 v[88:103], v[28:31], v[56:63], v36
  buffer_load_dwordx4 v2, s[36:39], s80 offen sc1 lds
  v_exp_f32 v66, v66
  v_exp_f32 v67, v67
  v_exp_f32 v68, v68
  v_exp_f32 v69, v69
  v_exp_f32 v70, v70
  v_exp_f32 v71, v71
  v_exp_f32 v40, v40
  v_exp_f32 v41, v41
  v_smfmac_f32_32x32x32_bf16 v[88:103], v[32:35], v[64:71], v36
  ds_read_b128 v[16:19], v37 offset:52000
  v_exp_f32 v42, v42
  v_exp_f32 v43, v43
  v_exp_f32 v44, v44
  v_mfma_f32_32x32x16_bf16 v[56:71], v[12:15], v[8:11], 0
  ds_read_b128 v[28:31], v38 offset:52000
  v_exp_f32 v45, v45
  v_exp_f32 v46, v46
  v_exp_f32 v47, v47
  v_exp_f32 v48, v48
  v_exp_f32 v49, v49
  v_smfmac_f32_32x32x32_bf16 v[72:87], v[20:23], v[40:47], v36
  ds_read_b128 v[32:35], v39 offset:52000
  v_exp_f32 v50, v50
  v_exp_f32 v51, v51
  v_exp_f32 v52, v52
  v_exp_f32 v53, v53
  v_exp_f32 v54, v54
  v_exp_f32 v55, v55
  v_exp_f32 v56, v56
  v_exp_f32 v57, v57
  s_add_u32 m0, s81, 12288
  s_add_u32 s80, s82, 0x1985000
  v_smfmac_f32_32x32x32_bf16 v[72:87], v[24:27], v[48:55], v36
  buffer_load_dwordx4 v2, s[36:39], s80 offen sc1 lds
  s_waitcnt lgkmcnt(0)
  v_exp_f32 v58, v58
  v_exp_f32 v59, v59
  v_exp_f32 v60, v60
  v_mfma_f32_32x32x16_bf16 v[40:55], v[16:19], v[4:7], 0
  v_exp_f32 v61, v61
  v_exp_f32 v62, v62
  v_exp_f32 v63, v63
  v_exp_f32 v64, v64
  v_exp_f32 v65, v65
  s_add_u32 m0, s81, 16384
  s_add_u32 s80, s82, 0x1985800
  v_smfmac_f32_32x32x32_bf16 v[88:103], v[20:23], v[56:63], v36
  buffer_load_dwordx4 v2, s[36:39], s80 offen sc1 lds
  v_exp_f32 v66, v66
  v_exp_f32 v67, v67
  v_exp_f32 v68, v68
  v_exp_f32 v69, v69
  v_exp_f32 v70, v70
  v_exp_f32 v71, v71
  v_exp_f32 v40, v40
  v_exp_f32 v41, v41
  v_smfmac_f32_32x32x32_bf16 v[88:103], v[24:27], v[64:71], v36
  ds_read_b128 v[12:15], v37 offset:54080
  v_exp_f32 v42, v42
  v_exp_f32 v43, v43
  v_exp_f32 v44, v44
  v_mfma_f32_32x32x16_bf16 v[56:71], v[16:19], v[8:11], 0
  ds_read_b128 v[20:23], v38 offset:54080
  v_exp_f32 v45, v45
  v_exp_f32 v46, v46
  v_exp_f32 v47, v47
  v_exp_f32 v48, v48
  v_exp_f32 v49, v49
  v_smfmac_f32_32x32x32_bf16 v[72:87], v[28:31], v[40:47], v36
  ds_read_b128 v[24:27], v39 offset:54080
  v_exp_f32 v50, v50
  v_exp_f32 v51, v51
  v_exp_f32 v52, v52
  v_exp_f32 v53, v53
  v_exp_f32 v54, v54
  v_exp_f32 v55, v55
  v_exp_f32 v56, v56
  v_exp_f32 v57, v57
  s_add_u32 m0, s81, 20480
  s_add_u32 s80, s82, 0x1986000
  v_smfmac_f32_32x32x32_bf16 v[72:87], v[32:35], v[48:55], v36
  buffer_load_dwordx4 v2, s[36:39], s80 offen sc1 lds
  s_waitcnt lgkmcnt(0)
  v_exp_f32 v58, v58
  v_exp_f32 v59, v59
  v_exp_f32 v60, v60
  s_lshr_b32 s84, s10, 1
  s_mul_i32 s84, s84, 6
  s_min_u32 s84, s84, 80
  s_lshl_b32 s84, s84, 15
  s_lshl_b32 s85, s3, 11
  s_add_u32 s84, s84, s85
  s_add_u32 s84, s84, 0x200000
  s_cmp_gt_u32 s54, 0
  s_cselect_b32 s84, 0xf0000000, s84
  s_add_u32 m0, s85, 36864
  v_mfma_f32_32x32x16_bf16 v[40:55], v[12:15], v[4:7], 0
  buffer_load_dwordx4 v2, s[36:39], s84 offen offset:0 sc1 lds
  v_exp_f32 v61, v61
  v_exp_f32 v62, v62
  v_exp_f32 v63, v63
  v_exp_f32 v64, v64
  v_exp_f32 v65, v65
  s_add_u32 m0, s81, 24576
  s_add_u32 s80, s82, 0x1986800
  v_smfmac_f32_32x32x32_bf16 v[88:103], v[28:31], v[56:63], v36
  buffer_load_dwordx4 v2, s[36:39], s80 offen sc1 lds
  v_exp_f32 v66, v66
  v_exp_f32 v67, v67
  v_exp_f32 v68, v68
  v_exp_f32 v69, v69
  v_exp_f32 v70, v70
  v_exp_f32 v71, v71
  v_exp_f32 v40, v40
  v_exp_f32 v41, v41
  v_smfmac_f32_32x32x32_bf16 v[88:103], v[32:35], v[64:71], v36
  ds_read_b128 v[16:19], v37 offset:56160
  v_exp_f32 v42, v42
  v_exp_f32 v43, v43
  v_exp_f32 v44, v44
  v_mfma_f32_32x32x16_bf16 v[56:71], v[12:15], v[8:11], 0
  ds_read_b128 v[28:31], v38 offset:56160
  v_exp_f32 v45, v45
  v_exp_f32 v46, v46
  v_exp_f32 v47, v47
  v_exp_f32 v48, v48
  v_exp_f32 v49, v49
  v_smfmac_f32_32x32x32_bf16 v[72:87], v[20:23], v[40:47], v36
  ds_read_b128 v[32:35], v39 offset:56160
  v_exp_f32 v50, v50
  v_exp_f32 v51, v51
  v_exp_f32 v52, v52
  v_exp_f32 v53, v53
  v_exp_f32 v54, v54
  v_exp_f32 v55, v55
  v_exp_f32 v56, v56
  v_exp_f32 v57, v57
  s_add_u32 m0, s81, 28672
  s_add_u32 s80, s82, 0x1987000
  v_smfmac_f32_32x32x32_bf16 v[72:87], v[24:27], v[48:55], v36
  buffer_load_dwordx4 v2, s[36:39], s80 offen sc1 lds
  s_waitcnt lgkmcnt(0)
  v_exp_f32 v58, v58
  v_exp_f32 v59, v59
  v_exp_f32 v60, v60
  v_mfma_f32_32x32x16_bf16 v[40:55], v[16:19], v[4:7], 0
  v_exp_f32 v61, v61
  v_exp_f32 v62, v62
  v_exp_f32 v63, v63
  v_exp_f32 v64, v64
  v_exp_f32 v65, v65
  s_add_u32 m0, s81, 32768
  s_add_u32 s80, s82, 0x1987800
  v_smfmac_f32_32x32x32_bf16 v[88:103], v[20:23], v[56:63], v36
  buffer_load_dwordx4 v2, s[36:39], s80 offen sc1 lds
  v_exp_f32 v66, v66
  v_exp_f32 v67, v67
  v_exp_f32 v68, v68
  v_exp_f32 v69, v69
  v_exp_f32 v70, v70
  v_exp_f32 v71, v71
  v_exp_f32 v40, v40
  v_exp_f32 v41, v41
  v_smfmac_f32_32x32x32_bf16 v[88:103], v[24:27], v[64:71], v36
  ds_read_b128 v[12:15], v37 offset:58240
  v_exp_f32 v42, v42
  v_exp_f32 v43, v43
  v_exp_f32 v44, v44
  v_mfma_f32_32x32x16_bf16 v[56:71], v[16:19], v[8:11], 0
  ds_read_b128 v[20:23], v38 offset:58240
  v_exp_f32 v45, v45
  v_exp_f32 v46, v46
  v_exp_f32 v47, v47
  v_exp_f32 v48, v48
  v_exp_f32 v49, v49
  v_smfmac_f32_32x32x32_bf16 v[72:87], v[28:31], v[40:47], v36
  ds_read_b128 v[24:27], v39 offset:58240
  v_exp_f32 v50, v50
  v_exp_f32 v51, v51
  v_exp_f32 v52, v52
  v_exp_f32 v53, v53
  v_exp_f32 v54, v54
  v_exp_f32 v55, v55
  v_exp_f32 v56, v56
  v_exp_f32 v57, v57
  s_add_u32 m0, s85, 36864
  v_smfmac_f32_32x32x32_bf16 v[72:87], v[32:35], v[48:55], v36
  buffer_load_dwordx4 v2, s[36:39], s84 offen offset:1024 sc1 lds
  s_add_u32 s84, s84, 8192
  s_waitcnt lgkmcnt(0)
  v_exp_f32 v58, v58
  v_exp_f32 v59, v59
  v_exp_f32 v60, v60
  s_add_u32 m0, s85, 45056
  v_mfma_f32_32x32x16_bf16 v[40:55], v[12:15], v[4:7], 0
  buffer_load_dwordx4 v2, s[36:39], s84 offen offset:0 sc1 lds
  v_exp_f32 v61, v61
  v_exp_f32 v62, v62
  v_exp_f32 v63, v63
  v_exp_f32 v64, v64
  v_exp_f32 v65, v65
  s_add_u32 m0, s85, 45056
  v_smfmac_f32_32x32x32_bf16 v[88:103], v[28:31], v[56:63], v36
  buffer_load_dwordx4 v2, s[36:39], s84 offen offset:1024 sc1 lds
  s_add_u32 s84, s84, 8192
  v_add_u32 v37, 58240, v37
  v_add_u32 v38, 58240, v38
  v_add_u32 v39, 58240, v39
  v_exp_f32 v66, v66
  v_exp_f32 v67, v67
  v_exp_f32 v68, v68
  v_exp_f32 v69, v69
  v_exp_f32 v70, v70
  v_exp_f32 v71, v71
  v_exp_f32 v40, v40
  v_exp_f32 v41, v41
  v_smfmac_f32_32x32x32_bf16 v[88:103], v[32:35], v[64:71], v36
  ds_read_b128 v[16:19], v37 offset:2080
  v_exp_f32 v42, v42
  v_exp_f32 v43, v43
  v_exp_f32 v44, v44
  v_mfma_f32_32x32x16_bf16 v[56:71], v[12:15], v[8:11], 0
  ds_read_b128 v[28:31], v38 offset:2080
  v_exp_f32 v45, v45
  v_exp_f32 v46, v46
  v_exp_f32 v47, v47
  v_exp_f32 v48, v48
  v_exp_f32 v49, v49
  v_smfmac_f32_32x32x32_bf16 v[72:87], v[20:23], v[40:47], v36
  ds_read_b128 v[32:35], v39 offset:2080
  v_exp_f32 v50, v50
  v_exp_f32 v51, v51
  v_exp_f32 v52, v52
  v_exp_f32 v53, v53
  v_exp_f32 v54, v54
  v_exp_f32 v55, v55
  v_exp_f32 v56, v56
  v_exp_f32 v57, v57
  s_add_u32 m0, s85, 53248
  v_smfmac_f32_32x32x32_bf16 v[72:87], v[24:27], v[48:55], v36
  buffer_load_dwordx4 v2, s[36:39], s84 offen offset:0 sc1 lds
  s_waitcnt lgkmcnt(0)
  v_exp_f32 v58, v58
  v_exp_f32 v59, v59
  v_exp_f32 v60, v60
  v_mfma_f32_32x32x16_bf16 v[40:55], v[16:19], v[4:7], 0
  v_exp_f32 v61, v61
  v_exp_f32 v62, v62
  v_exp_f32 v63, v63
  v_exp_f32 v64, v64
  v_exp_f32 v65, v65
  s_add_u32 m0, s85, 53248
  v_smfmac_f32_32x32x32_bf16 v[88:103], v[20:23], v[56:63], v36
  buffer_load_dwordx4 v2, s[36:39], s84 offen offset:1024 sc1 lds
  s_add_u32 s84, s84, 8192
  v_exp_f32 v66, v66
  v_exp_f32 v67, v67
  v_exp_f32 v68, v68
  v_exp_f32 v69, v69
  v_exp_f32 v70, v70
  v_exp_f32 v71, v71
  v_exp_f32 v40, v40
  v_exp_f32 v41, v41
  v_smfmac_f32_32x32x32_bf16 v[88:103], v[24:27], v[64:71], v36
  ds_read_b128 v[12:15], v37 offset:4160
  v_exp_f32 v42, v42
  v_exp_f32 v43, v43
  v_exp_f32 v44, v44
  v_mfma_f32_32x32x16_bf16 v[56:71], v[16:19], v[8:11], 0
  ds_read_b128 v[20:23], v38 offset:4160
  v_exp_f32 v45, v45
  v_exp_f32 v46, v46
  v_exp_f32 v47, v47
  v_exp_f32 v48, v48
  v_exp_f32 v49, v49
  v_smfmac_f32_32x32x32_bf16 v[72:87], v[28:31], v[40:47], v36
  ds_read_b128 v[24:27], v39 offset:4160
  v_exp_f32 v50, v50
  v_exp_f32 v51, v51
  v_exp_f32 v52, v52
  v_exp_f32 v53, v53
  v_exp_f32 v54, v54
  v_exp_f32 v55, v55
  v_exp_f32 v56, v56
  v_exp_f32 v57, v57
  s_add_u32 m0, s85, 61440
  v_smfmac_f32_32x32x32_bf16 v[72:87], v[32:35], v[48:55], v36
  buffer_load_dwordx4 v2, s[36:39], s84 offen offset:0 sc1 lds
  s_waitcnt lgkmcnt(0)
  v_exp_f32 v58, v58
  v_exp_f32 v59, v59
  v_exp_f32 v60, v60
  s_add_u32 m0, s85, 61440
  v_mfma_f32_32x32x16_bf16 v[40:55], v[12:15], v[4:7], 0
  buffer_load_dwordx4 v2, s[36:39], s84 offen offset:1024 sc1 lds
  s_add_u32 s84, s84, 8192
  v_exp_f32 v61, v61
  v_exp_f32 v62, v62
  v_exp_f32 v63, v63
  v_exp_f32 v64, v64
  v_exp_f32 v65, v65
  s_add_u32 m0, s85, 69632
  v_smfmac_f32_32x32x32_bf16 v[88:103], v[28:31], v[56:63], v36
  buffer_load_dwordx4 v2, s[36:39], s84 offen offset:0 sc1 lds
  v_exp_f32 v66, v66
  v_exp_f32 v67, v67
  v_exp_f32 v68, v68
  v_exp_f32 v69, v69
  v_exp_f32 v70, v70
  v_exp_f32 v71, v71
  v_exp_f32 v40, v40
  v_exp_f32 v41, v41
  v_smfmac_f32_32x32x32_bf16 v[88:103], v[32:35], v[64:71], v36
  ds_read_b128 v[16:19], v37 offset:6240
  v_exp_f32 v42, v42
  v_exp_f32 v43, v43
  v_exp_f32 v44, v44
  v_mfma_f32_32x32x16_bf16 v[56:71], v[12:15], v[8:11], 0
  ds_read_b128 v[28:31], v38 offset:6240
  v_exp_f32 v45, v45
  v_exp_f32 v46, v46
  v_exp_f32 v47, v47
  v_exp_f32 v48, v48
  v_exp_f32 v49, v49
  v_smfmac_f32_32x32x32_bf16 v[72:87], v[20:23], v[40:47], v36
  ds_read_b128 v[32:35], v39 offset:6240
  v_exp_f32 v50, v50
  v_exp_f32 v51, v51
  v_exp_f32 v52, v52
  v_exp_f32 v53, v53
  v_exp_f32 v54, v54
  v_exp_f32 v55, v55
  v_exp_f32 v56, v56
  v_exp_f32 v57, v57
  s_add_u32 m0, s85, 69632
  v_smfmac_f32_32x32x32_bf16 v[72:87], v[24:27], v[48:55], v36
  buffer_load_dwordx4 v2, s[36:39], s84 offen offset:1024 sc1 lds
  s_add_u32 s84, s84, 8192
  s_waitcnt lgkmcnt(0)
  v_exp_f32 v58, v58
  v_exp_f32 v59, v59
  v_exp_f32 v60, v60
  v_mfma_f32_32x32x16_bf16 v[40:55], v[16:19], v[4:7], 0
  v_exp_f32 v61, v61
  v_exp_f32 v62, v62
  v_exp_f32 v63, v63
  v_exp_f32 v64, v64
  v_exp_f32 v65, v65
  s_add_u32 m0, s85, 77824
  v_smfmac_f32_32x32x32_bf16 v[88:103], v[20:23], v[56:63], v36
  buffer_load_dwordx4 v2, s[36:39], s84 offen offset:0 sc1 lds
  v_exp_f32 v66, v66
  v_exp_f32 v67, v67
  v_exp_f32 v68, v68
  v_exp_f32 v69, v69
  v_exp_f32 v70, v70
  v_exp_f32 v71, v71
  v_exp_f32 v40, v40
  v_exp_f32 v41, v41
  v_smfmac_f32_32x32x32_bf16 v[88:103], v[24:27], v[64:71], v36
  ds_read_b128 v[12:15], v37 offset:8320
  v_exp_f32 v42, v42
  v_exp_f32 v43, v43
  v_exp_f32 v44, v44
  v_mfma_f32_32x32x16_bf16 v[56:71], v[16:19], v[8:11], 0
  ds_read_b128 v[20:23], v38 offset:8320
  v_exp_f32 v45, v45
  v_exp_f32 v46, v46
  v_exp_f32 v47, v47
  v_exp_f32 v48, v48
  v_exp_f32 v49, v49
  v_smfmac_f32_32x32x32_bf16 v[72:87], v[28:31], v[40:47], v36
  ds_read_b128 v[24:27], v39 offset:8320
  v_exp_f32 v50, v50
  v_exp_f32 v51, v51
  v_exp_f32 v52, v52
  v_exp_f32 v53, v53
  v_exp_f32 v54, v54
  v_exp_f32 v55, v55
  v_exp_f32 v56, v56
  v_exp_f32 v57, v57
  s_add_u32 m0, s85, 77824
  v_smfmac_f32_32x32x32_bf16 v[72:87], v[32:35], v[48:55], v36
  buffer_load_dwordx4 v2, s[36:39], s84 offen offset:1024 sc1 lds
  s_add_u32 s84, s84, 8192
  s_waitcnt lgkmcnt(0)
  v_exp_f32 v58, v58
  v_exp_f32 v59, v59
  v_exp_f32 v60, v60
  s_add_u32 m0, s85, 86016
  v_mfma_f32_32x32x16_bf16 v[40:55], v[12:15], v[4:7], 0
  buffer_load_dwordx4 v2, s[36:39], s84 offen offset:0 sc1 lds
  v_exp_f32 v61, v61
  v_exp_f32 v62, v62
  v_exp_f32 v63, v63
  v_exp_f32 v64, v64
  v_exp_f32 v65, v65
  s_add_u32 m0, s85, 86016
  v_smfmac_f32_32x32x32_bf16 v[88:103], v[28:31], v[56:63], v36
  buffer_load_dwordx4 v2, s[36:39], s84 offen offset:1024 sc1 lds
  s_add_u32 s84, s84, 8192
  v_exp_f32 v66, v66
  v_exp_f32 v67, v67
  v_exp_f32 v68, v68
  v_exp_f32 v69, v69
  v_exp_f32 v70, v70
  v_exp_f32 v71, v71
  s_waitcnt vmcnt(13)
  s_barrier
  s_mov_b32 s90, s46
  v_lshlrev_b32 v176, 16, v248
  v_and_b32 v177, 0xffff0000, v248
  v_lshlrev_b32 v178, 16, v249
  v_and_b32 v179, 0xffff0000, v249
  v_exp_f32 v40, v40
  v_exp_f32 v41, v41
  v_smfmac_f32_32x32x32_bf16 v[88:103], v[32:35], v[64:71], v36
  ds_read_b128 v[16:19], v37 offset:10400
  v_exp_f32 v42, v42
  v_exp_f32 v43, v43
  v_exp_f32 v44, v44
  v_mfma_f32_32x32x16_bf16 v[56:71], v[12:15], v[8:11], 0
  ds_read_b128 v[28:31], v38 offset:10400
  v_exp_f32 v45, v45
  v_exp_f32 v46, v46
  v_exp_f32 v47, v47
  v_exp_f32 v48, v48
  v_exp_f32 v49, v49
  v_smfmac_f32_32x32x32_bf16 v[72:87], v[20:23], v[40:47], v36
  ds_read_b128 v[32:35], v39 offset:10400
  v_exp_f32 v50, v50
  v_exp_f32 v51, v51
  v_exp_f32 v52, v52
  v_exp_f32 v53, v53
  v_exp_f32 v54, v54
  v_exp_f32 v55, v55
  v_exp_f32 v56, v56
  v_exp_f32 v57, v57
  s_add_u32 m0, s85, 94208
  v_smfmac_f32_32x32x32_bf16 v[72:87], v[24:27], v[48:55], v36
  buffer_load_dwordx4 v2, s[36:39], s84 offen offset:0 sc1 lds
  s_waitcnt lgkmcnt(0)
  v_exp_f32 v58, v58
  v_exp_f32 v59, v59
  v_exp_f32 v60, v60
  v_mfma_f32_32x32x16_bf16 v[40:55], v[16:19], v[4:7], 0
  v_exp_f32 v61, v61
  v_exp_f32 v62, v62
  v_exp_f32 v63, v63
  v_exp_f32 v64, v64
  v_exp_f32 v65, v65
  s_add_u32 m0, s85, 94208
  v_smfmac_f32_32x32x32_bf16 v[88:103], v[20:23], v[56:63], v36
  buffer_load_dwordx4 v2, s[36:39], s84 offen offset:1024 sc1 lds
  s_add_u32 s84, s84, 8192
  v_exp_f32 v66, v66
  v_exp_f32 v67, v67
  v_exp_f32 v68, v68
  v_exp_f32 v69, v69
  v_exp_f32 v70, v70
  v_exp_f32 v71, v71
  v_lshlrev_b32 v180, 16, v250
  v_and_b32 v181, 0xffff0000, v250
  v_lshlrev_b32 v182, 16, v251
  v_and_b32 v183, 0xffff0000, v251
  v_lshlrev_b32 v184, 16, v252
  v_exp_f32 v40, v40
  v_exp_f32 v41, v41
  v_smfmac_f32_32x32x32_bf16 v[88:103], v[24:27], v[64:71], v36
  ds_read_b128 v[12:15], v37 offset:12480
  v_exp_f32 v42, v42
  v_exp_f32 v43, v43
  v_exp_f32 v44, v44
  v_mfma_f32_32x32x16_bf16 v[56:71], v[16:19], v[8:11], 0
  ds_read_b128 v[20:23], v38 offset:12480
  v_exp_f32 v45, v45
  v_exp_f32 v46, v46
  v_exp_f32 v47, v47
  v_exp_f32 v48, v48
  v_exp_f32 v49, v49
  v_smfmac_f32_32x32x32_bf16 v[72:87], v[28:31], v[40:47], v36
  ds_read_b128 v[24:27], v39 offset:12480
  v_exp_f32 v50, v50
  v_exp_f32 v51, v51
  v_exp_f32 v52, v52
  v_exp_f32 v53, v53
  v_exp_f32 v54, v54
  v_exp_f32 v55, v55
  v_exp_f32 v56, v56
  v_exp_f32 v57, v57
  s_add_u32 m0, s85, 102400
  v_smfmac_f32_32x32x32_bf16 v[72:87], v[32:35], v[48:55], v36
  buffer_load_dwordx4 v2, s[36:39], s84 offen offset:0 sc1 lds
  s_waitcnt lgkmcnt(0)
  v_exp_f32 v58, v58
  v_exp_f32 v59, v59
  v_exp_f32 v60, v60
  v_mfma_f32_32x32x16_bf16 v[40:55], v[12:15], v[4:7], 0
  v_exp_f32 v61, v61
  v_exp_f32 v62, v62
  v_exp_f32 v63, v63
  v_exp_f32 v64, v64
  v_exp_f32 v65, v65
  s_add_u32 m0, s85, 102400
  v_smfmac_f32_32x32x32_bf16 v[88:103], v[28:31], v[56:63], v36
  buffer_load_dwordx4 v2, s[36:39], s84 offen offset:1024 sc1 lds
  s_add_u32 s84, s84, 8192
  v_exp_f32 v66, v66
  v_exp_f32 v67, v67
  v_exp_f32 v68, v68
  v_exp_f32 v69, v69
  v_exp_f32 v70, v70
  v_exp_f32 v71, v71
  v_and_b32 v185, 0xffff0000, v252
  v_lshlrev_b32 v186, 16, v253
  v_and_b32 v187, 0xffff0000, v253
  v_lshlrev_b32 v188, 16, v254
  v_and_b32 v189, 0xffff0000, v254
  v_exp_f32 v40, v40
  v_exp_f32 v41, v41
  v_smfmac_f32_32x32x32_bf16 v[88:103], v[32:35], v[64:71], v36
  ds_read_b128 v[16:19], v37 offset:14560
  v_exp_f32 v42, v42
  v_exp_f32 v43, v43
  v_exp_f32 v44, v44
  v_mfma_f32_32x32x16_bf16 v[56:71], v[12:15], v[8:11], 0
  ds_read_b128 v[28:31], v38 offset:14560
  v_exp_f32 v45, v45
  v_exp_f32 v46, v46
  v_exp_f32 v47, v47
  v_exp_f32 v48, v48
  v_exp_f32 v49, v49
  v_smfmac_f32_32x32x32_bf16 v[72:87], v[20:23], v[40:47], v36
  ds_read_b128 v[32:35], v39 offset:14560
  v_exp_f32 v50, v50
  v_exp_f32 v51, v51
  v_exp_f32 v52, v52
  v_exp_f32 v53, v53
  v_exp_f32 v54, v54
  v_exp_f32 v55, v55
  v_exp_f32 v56, v56
  v_exp_f32 v57, v57
  s_add_u32 m0, s85, 110592
  v_smfmac_f32_32x32x32_bf16 v[72:87], v[24:27], v[48:55], v36
  buffer_load_dwordx4 v2, s[36:39], s84 offen offset:0 sc1 lds
  s_waitcnt lgkmcnt(0)
  v_exp_f32 v58, v58
  v_exp_f32 v59, v59
  v_exp_f32 v60, v60
  v_mfma_f32_32x32x16_bf16 v[40:55], v[16:19], v[4:7], 0
  v_exp_f32 v61, v61
  v_exp_f32 v62, v62
  v_exp_f32 v63, v63
  v_exp_f32 v64, v64
  v_exp_f32 v65, v65
  s_add_u32 m0, s85, 110592
  v_smfmac_f32_32x32x32_bf16 v[88:103], v[20:23], v[56:63], v36
  buffer_load_dwordx4 v2, s[36:39], s84 offen offset:1024 sc1 lds
  s_add_u32 s84, s84, 8192
  v_exp_f32 v66, v66
  v_exp_f32 v67, v67
  v_exp_f32 v68, v68
  v_exp_f32 v69, v69
  v_exp_f32 v70, v70
  v_exp_f32 v71, v71
  v_lshlrev_b32 v190, 16, v255
  v_and_b32 v191, 0xffff0000, v255
  v_exp_f32 v40, v40
  v_exp_f32 v41, v41
  v_smfmac_f32_32x32x32_bf16 v[88:103], v[24:27], v[64:71], v36
  ds_read_b128 v[12:15], v37 offset:16640
  v_exp_f32 v42, v42
  v_exp_f32 v43, v43
  v_exp_f32 v44, v44
  v_mfma_f32_32x32x16_bf16 v[56:71], v[16:19], v[8:11], 0
  ds_read_b128 v[20:23], v38 offset:16640
  v_exp_f32 v45, v45
  v_exp_f32 v46, v46
  v_exp_f32 v47, v47
  v_exp_f32 v48, v48
  v_exp_f32 v49, v49
  v_smfmac_f32_32x32x32_bf16 v[72:87], v[28:31], v[40:47], v36
  ds_read_b128 v[24:27], v39 offset:16640
  v_exp_f32 v50, v50
  v_exp_f32 v51, v51
  v_exp_f32 v52, v52
  v_exp_f32 v53, v53
  v_exp_f32 v54, v54
  v_exp_f32 v55, v55
  v_exp_f32 v56, v56
  v_exp_f32 v57, v57
  v_smfmac_f32_32x32x32_bf16 v[72:87], v[32:35], v[48:55], v36
  s_waitcnt lgkmcnt(0)
  v_exp_f32 v58, v58
  v_exp_f32 v59, v59
  v_exp_f32 v60, v60
  v_mfma_f32_32x32x16_bf16 v[40:55], v[12:15], v[4:7], 0
  v_exp_f32 v61, v61
  v_exp_f32 v62, v62
  v_exp_f32 v63, v63
  v_exp_f32 v64, v64
  v_exp_f32 v65, v65
  v_smfmac_f32_32x32x32_bf16 v[88:103], v[28:31], v[56:63], v36
  v_exp_f32 v66, v66
  v_exp_f32 v67, v67
  v_exp_f32 v68, v68
  v_exp_f32 v69, v69
  v_exp_f32 v70, v70
  v_exp_f32 v71, v71
  s_nop 1
  v_smfmac_f32_32x32x32_bf16 v[88:103], v[32:35], v[64:71], v36
  s_mov_b32 s96, 0x33800000
  s_lshl_b32 s72, s71, 5
  s_add_u32 s72, s72, s70
  s_lshl_b32 s79, s72, 2
  s_add_u32 s79, s79, s3
  s_lshl_b32 s79, s79, 2
  s_add_u32 s79, s79, s68
  s_add_u32 s79, s79, 0x4f1000
  s_nop 4
  v_add_f32 v138, v80, v96
  v_min_f32 v139, v80, v96
  v_pk_mul_f32 v[40:41], v[72:73], 0 op_sel_hi:[1,0]
  v_pk_mul_f32 v[42:43], v[74:75], 0 op_sel_hi:[1,0]
  v_pk_mul_f32 v[44:45], v[76:77], 0 op_sel_hi:[1,0]
  v_pk_mul_f32 v[46:47], v[78:79], 0 op_sel_hi:[1,0]
  v_pk_fma_f32 v[40:41], v[88:89], 0, v[40:41] op_sel_hi:[1,0,1]
  v_pk_fma_f32 v[42:43], v[90:91], 0, v[42:43] op_sel_hi:[1,0,1]
  v_pk_fma_f32 v[44:45], v[92:93], 0, v[44:45] op_sel_hi:[1,0,1]
  v_pk_fma_f32 v[46:47], v[94:95], 0, v[46:47] op_sel_hi:[1,0,1]
  v_pk_add_f32 v[40:41], v[40:41], v[42:43]
  v_pk_add_f32 v[44:45], v[44:45], v[46:47]
  v_pk_add_f32 v[40:41], v[40:41], v[44:45]
  v_add_f32 v40, v40, v41
  v_add_f32 v138, v138, v40
  v_cmp_ge_f32 vcc, 0x5f800000, v138
  v_cmp_le_f32 s[94:95], s96, v139
  v_rcp_f32 v136, v80
  v_rcp_f32 v137, v96
  s_and_b64 vcc, vcc, s[94:95]
  s_cmp_eq_u64 vcc, exec
  s_cbranch_scc0 L_aslow
L_afin:
  v_mul_f32 v72, v72, v136
  v_mul_f32 v73, v73, v136
  v_mul_f32 v74, v74, v136
  v_mul_f32 v75, v75, v136
  v_mul_f32 v76, v76, v136
  v_mul_f32 v77, v77, v136
  v_mul_f32 v78, v78, v136
  v_mul_f32 v79, v79, v136
  v_cvt_pk_bf16_f32 v40, v72, v73
  v_cvt_pk_bf16_f32 v41, v74, v75
  v_cvt_pk_bf16_f32 v42, v76, v77
  v_cvt_pk_bf16_f32 v43, v78, v79
  buffer_store_dwordx4 v[40:43], v2, s[36:39], s76 offen
  v_mul_f32 v88, v88, v137
  v_mul_f32 v89, v89, v137
  v_mul_f32 v90, v90, v137
  v_mul_f32 v91, v91, v137
  v_mul_f32 v92, v92, v137
  v_mul_f32 v93, v93, v137
  v_mul_f32 v94, v94, v137
  v_mul_f32 v95, v95, v137
  v_cvt_pk_bf16_f32 v44, v88, v89
  v_cvt_pk_bf16_f32 v45, v90, v91
  v_cvt_pk_bf16_f32 v46, v92, v93
  v_cvt_pk_bf16_f32 v47, v94, v95
  buffer_store_dwordx4 v[44:47], v2, s[36:39], s77 offen
  s_waitcnt vmcnt(0)
  s_mov_b64 exec, 1
  buffer_store_dword v229, off, s[36:39], s79
  s_mov_b64 exec, -1
  s_mov_b32 s8, 0
pl_69:
  buffer_load_dword v224, v228, s[36:39], s49 offen sc0 sc1
  s_add_u32 s8, s8, 1
  s_cmp_gt_u32 s8, 0x80000
  s_cbranch_scc1 L_abort
  s_waitcnt vmcnt(0)
pchk_71:
  v_cmp_ne_u32 vcc, 1, v224
  s_nop 3
  s_cbranch_vccnz pl_69
  buffer_load_dwordx4 a[0:3], v2, s[36:39], s90 offen offset:0 sc1
  buffer_load_dwordx4 a[4:7], v2, s[36:39], s90 offen offset:1024 sc1
  buffer_load_dwordx4 a[8:11], v2, s[36:39], s90 offen offset:2048 sc1
  buffer_load_dwordx4 a[12:15], v2, s[36:39], s90 offen offset:3072 sc1
  s_add_u32 s90, s90, 4096
  buffer_load_dwordx4 a[16:19], v2, s[36:39], s90 offen offset:0 sc1
  buffer_load_dwordx4 a[20:23], v2, s[36:39], s90 offen offset:1024 sc1
  buffer_load_dwordx4 a[24:27], v2, s[36:39], s90 offen offset:2048 sc1
  buffer_load_dwordx4 a[28:31], v2, s[36:39], s90 offen offset:3072 sc1
  s_add_u32 s90, s90, 4096
  buffer_load_dwordx4 a[32:35], v2, s[36:39], s90 offen offset:0 sc1
  buffer_load_dwordx4 a[36:39], v2, s[36:39], s90 offen offset:1024 sc1
  buffer_load_dwordx4 a[40:43], v2, s[36:39], s90 offen offset:2048 sc1
  buffer_load_dwordx4 a[44:47], v2, s[36:39], s90 offen offset:3072 sc1
  s_add_u32 s90, s90, 4096
  s_barrier
  s_lshr_b32 s95, s10, 1
  s_mul_i32 s95, s95, 6
  s_min_u32 s95, s95, 80
  s_lshl_b32 s95, s95, 10
  s_add_u32 s95, s95, 0x4d0000
  s_mov_b32 s74, s51
  s_cmp_gt_u32 s54, 4
  s_cselect_b32 s74, 0xf0000000, s74
  s_mov_b32 s76, s53
  s_add_u32 s78, s55, 0x3000
  ds_read_b128 v[160:163], v212 offset:12288
  ds_read_b128 v[164:167], v213 offset:12288
  ds_read_b128 v[168:171], v212 offset:16384
  s_waitcnt vmcnt(11)
  s_waitcnt lgkmcnt(2)
  v_mfma_f32_32x32x16_bf16 v[176:191], v[160:163], a[0:3], v[176:191]
  buffer_load_dwordx4 a[48:51], v2, s[36:39], s90 offen offset:0 sc1
  ds_read_b128 v[172:175], v213 offset:16384
  s_waitcnt lgkmcnt(2)
  v_mfma_f32_32x32x16_bf16 v[192:207], v[164:167], a[0:3], 0
  ds_read_b128 v[160:163], v212 offset:20480
  s_waitcnt vmcnt(11)
  s_waitcnt lgkmcnt(2)
  v_mfma_f32_32x32x16_bf16 v[176:191], v[168:171], a[4:7], v[176:191]
  buffer_load_dwordx4 a[52:55], v2, s[36:39], s90 offen offset:1024 sc1
  ds_read_b128 v[164:167], v213 offset:20480
  s_waitcnt lgkmcnt(2)
  v_mfma_f32_32x32x16_bf16 v[192:207], v[172:175], a[4:7], v[192:207]
  ds_read_b128 v[168:171], v212 offset:24576
  s_waitcnt vmcnt(11)
  s_waitcnt lgkmcnt(2)
  v_mfma_f32_32x32x16_bf16 v[176:191], v[160:163], a[8:11], v[176:191]
  buffer_load_dwordx4 a[56:59], v2, s[36:39], s90 offen offset:2048 sc1
  ds_read_b128 v[172:175], v213 offset:24576
  s_waitcnt lgkmcnt(2)
  v_mfma_f32_32x32x16_bf16 v[192:207], v[164:167], a[8:11], v[192:207]
  ds_read_b128 v[160:163], v212 offset:28672
  s_waitcnt vmcnt(11)
  s_waitcnt lgkmcnt(2)
  v_mfma_f32_32x32x16_bf16 v[176:191], v[168:171], a[12:15], v[176:191]
  buffer_load_dwordx4 a[60:63], v2, s[36:39], s90 offen offset:3072 sc1
  ds_read_b128 v[164:167], v213 offset:28672
  s_add_u32 s90, s90, 4096
  s_waitcnt lgkmcnt(2)
  v_mfma_f32_32x32x16_bf16 v[192:207], v[172:175], a[12:15], v[192:207]
  ds_read_b128 v[168:171], v212 offset:32768
  s_waitcnt vmcnt(11)
  s_waitcnt lgkmcnt(2)
  v_mfma_f32_32x32x16_bf16 v[176:191], v[160:163], a[16:19], v[176:191]
  buffer_load_dwordx4 v[28:31], v2, s[36:39], s95 offen offset:0 sc1
  ds_read_b128 v[172:175], v213 offset:32768
  s_waitcnt lgkmcnt(2)
  v_mfma_f32_32x32x16_bf16 v[192:207], v[164:167], a[16:19], v[192:207]
  ds_read_b128 v[160:163], v212 offset:36864
  s_waitcnt vmcnt(11)
  s_waitcnt lgkmcnt(2)
  v_mfma_f32_32x32x16_bf16 v[176:191], v[168:171], a[20:23], v[176:191]
  buffer_load_dwordx4 v[32:35], v2, s[36:39], s95 offen offset:1024 sc1
  ds_read_b128 v[164:167], v213 offset:36864
  s_waitcnt lgkmcnt(2)
  v_mfma_f32_32x32x16_bf16 v[192:207], v[172:175], a[20:23], v[192:207]
  ds_read_b128 v[168:171], v208 offset:0
  s_waitcnt vmcnt(11)
  s_waitcnt lgkmcnt(2)
  v_mfma_f32_32x32x16_bf16 v[176:191], v[160:163], a[24:27], v[176:191]
  buffer_load_dwordx4 v[36:39], v2, s[36:39], s95 offen offset:2048 sc1
  ds_read_b128 v[172:175], v209 offset:0
  s_waitcnt lgkmcnt(2)
  v_mfma_f32_32x32x16_bf16 v[192:207], v[164:167], a[24:27], v[192:207]
  ds_read_b128 v[160:163], v208 offset:4096
  s_waitcnt vmcnt(11)
  s_waitcnt lgkmcnt(2)
  v_mfma_f32_32x32x16_bf16 v[176:191], v[168:171], a[28:31], v[176:191]
  buffer_load_dwordx4 v[40:43], v2, s[36:39], s95 offen offset:3072 sc1
  ds_read_b128 v[164:167], v209 offset:4096
  s_waitcnt lgkmcnt(2)
  v_mfma_f32_32x32x16_bf16 v[192:207], v[172:175], a[28:31], v[192:207]
  ds_read_b128 v[168:171], v208 offset:8192
  s_waitcnt vmcnt(11)
  s_waitcnt lgkmcnt(2)
  s_add_u32 s95, s95, 4096
  v_mfma_f32_32x32x16_bf16 v[176:191], v[160:163], a[32:35], v[176:191]
  buffer_load_dwordx4 v[44:47], v2, s[36:39], s95 offen offset:0 sc1
  ds_read_b128 v[172:175], v209 offset:8192
  s_waitcnt lgkmcnt(2)
  v_mfma_f32_32x32x16_bf16 v[192:207], v[164:167], a[32:35], v[192:207]
  ds_read_b128 v[160:163], v208 offset:12288
  s_waitcnt vmcnt(11)
  s_waitcnt lgkmcnt(2)
  v_mfma_f32_32x32x16_bf16 v[176:191], v[168:171], a[36:39], v[176:191]
  buffer_load_dwordx4 v[48:51], v2, s[36:39], s95 offen offset:1024 sc1
  ds_read_b128 v[164:167], v209 offset:12288
  s_waitcnt lgkmcnt(2)
  v_mfma_f32_32x32x16_bf16 v[192:207], v[172:175], a[36:39], v[192:207]
  ds_read_b128 v[168:171], v208 offset:16384
  s_waitcnt vmcnt(11)
  s_waitcnt lgkmcnt(2)
  v_mfma_f32_32x32x16_bf16 v[176:191], v[160:163], a[40:43], v[176:191]
  ds_read_b128 v[172:175], v209 offset:16384
  s_waitcnt lgkmcnt(2)
  v_mfma_f32_32x32x16_bf16 v[192:207], v[164:167], a[40:43], v[192:207]
  ds_read_b128 v[160:163], v208 offset:20480
  s_waitcnt vmcnt(10)
  s_waitcnt lgkmcnt(2)
  v_mfma_f32_32x32x16_bf16 v[176:191], v[168:171], a[44:47], v[176:191]
  ds_read_b128 v[164:167], v209 offset:20480
  s_waitcnt lgkmcnt(2)
  v_mfma_f32_32x32x16_bf16 v[192:207], v[172:175], a[44:47], v[192:207]
  ds_read_b128 v[168:171], v208 offset:24576
  s_waitcnt vmcnt(9)
  s_waitcnt lgkmcnt(2)
  v_mfma_f32_32x32x16_bf16 v[176:191], v[160:163], a[48:51], v[176:191]
  ds_read_b128 v[172:175], v209 offset:24576
  s_waitcnt lgkmcnt(2)
  v_mfma_f32_32x32x16_bf16 v[192:207], v[164:167], a[48:51], v[192:207]
  ds_read_b128 v[160:163], v208 offset:28672
  s_waitcnt vmcnt(8)
  s_waitcnt lgkmcnt(2)
  v_mfma_f32_32x32x16_bf16 v[176:191], v[168:171], a[52:55], v[176:191]
  ds_read_b128 v[164:167], v209 offset:28672
  s_waitcnt lgkmcnt(2)
  v_mfma_f32_32x32x16_bf16 v[192:207], v[172:175], a[52:55], v[192:207]
  ds_read_b128 v[168:171], v208 offset:32768
  s_waitcnt vmcnt(7)
  s_waitcnt lgkmcnt(2)
  v_mfma_f32_32x32x16_bf16 v[176:191], v[160:163], a[56:59], v[176:191]
  ds_read_b128 v[172:175], v209 offset:32768
  s_waitcnt lgkmcnt(2)
  v_mfma_f32_32x32x16_bf16 v[192:207], v[164:167], a[56:59], v[192:207]
  s_waitcnt vmcnt(6)
  s_waitcnt lgkmcnt(1)
  v_mfma_f32_32x32x16_bf16 v[176:191], v[168:171], a[60:63], v[176:191]
  s_waitcnt lgkmcnt(0)
  v_mfma_f32_32x32x16_bf16 v[192:207], v[172:175], a[60:63], v[192:207]
  s_nop 11
  ds_write_b128 v214, v[192:195] offset:16384
  ds_write_b128 v214, v[196:199] offset:17408
  ds_write_b128 v214, v[200:203] offset:18432
  ds_write_b128 v214, v[204:207] offset:19456
  s_waitcnt lgkmcnt(0)
  s_barrier
  ds_read_b128 v[192:195], v215 offset:16384
  ds_read_b128 v[196:199], v215 offset:17408
  ds_read_b128 v[200:203], v215 offset:18432
  ds_read_b128 v[204:207], v215 offset:19456
  s_add_u32 m0, s85, 135168
  s_nop 0
  buffer_load_dwordx4 v2, s[36:39], s84 offen offset:0 sc1 lds
  s_add_u32 m0, s85, 135168
  s_nop 0
  buffer_load_dwordx4 v2, s[36:39], s84 offen offset:1024 sc1 lds
  s_add_u32 s84, s84, 8192
  s_add_u32 m0, s85, 143360
  s_nop 0
  buffer_load_dwordx4 v2, s[36:39], s84 offen offset:0 sc1 lds
  s_add_u32 m0, s85, 143360
  s_nop 0
  buffer_load_dwordx4 v2, s[36:39], s84 offen offset:1024 sc1 lds
  s_add_u32 s84, s84, 8192
  s_waitcnt lgkmcnt(3)
  v_pk_add_f32 v[176:177], v[176:177], v[192:193]
  v_pk_add_f32 v[178:179], v[178:179], v[194:195]
  v_cvt_pk_bf16_f32 v248, v176, v177
  v_cvt_pk_bf16_f32 v249, v178, v179
  v_pk_add_f32 v[152:153], v[176:177], v[178:179]
  v_pk_mul_f32 v[154:155], v[176:177], v[176:177]
  v_pk_fma_f32 v[154:155], v[178:179], v[178:179], v[154:155]
  s_waitcnt lgkmcnt(2)
  v_pk_add_f32 v[180:181], v[180:181], v[196:197]
  v_pk_add_f32 v[182:183], v[182:183], v[198:199]
  v_cvt_pk_bf16_f32 v250, v180, v181
  v_cvt_pk_bf16_f32 v251, v182, v183
  buffer_store_dwordx4 v[248:251], v2, s[36:39], s44 offen offset:0
  v_pk_add_f32 v[152:153], v[152:153], v[180:181]
  v_pk_fma_f32 v[154:155], v[180:181], v[180:181], v[154:155]
  v_pk_add_f32 v[152:153], v[152:153], v[182:183]
  v_pk_fma_f32 v[154:155], v[182:183], v[182:183], v[154:155]
  s_waitcnt lgkmcnt(1)
  v_pk_add_f32 v[184:185], v[184:185], v[200:201]
  v_pk_add_f32 v[186:187], v[186:187], v[202:203]
  v_cvt_pk_bf16_f32 v252, v184, v185
  v_cvt_pk_bf16_f32 v253, v186, v187
  v_pk_add_f32 v[152:153], v[152:153], v[184:185]
  v_pk_fma_f32 v[154:155], v[184:185], v[184:185], v[154:155]
  v_pk_add_f32 v[152:153], v[152:153], v[186:187]
  v_pk_fma_f32 v[154:155], v[186:187], v[186:187], v[154:155]
  s_waitcnt lgkmcnt(0)
  v_pk_add_f32 v[188:189], v[188:189], v[204:205]
  v_pk_add_f32 v[190:191], v[190:191], v[206:207]
  v_cvt_pk_bf16_f32 v254, v188, v189
  v_cvt_pk_bf16_f32 v255, v190, v191
  buffer_store_dwordx4 v[252:255], v2, s[36:39], s44 offen offset:1024
  v_pk_add_f32 v[152:153], v[152:153], v[188:189]
  v_pk_fma_f32 v[154:155], v[188:189], v[188:189], v[154:155]
  v_pk_add_f32 v[152:153], v[152:153], v[190:191]
  v_pk_fma_f32 v[154:155], v[190:191], v[190:191], v[154:155]
  v_add_f32 v152, v152, v153
  v_add_f32 v153, v154, v155
  v_mov_b32 v154, v152
  v_mov_b32 v155, v153
  s_nop 0
  v_permlane32_swap_b32 v152, v154
  v_permlane32_swap_b32 v153, v155
  s_mov_b32 exec_hi, 0
  v_pk_add_f32 v[152:153], v[152:153], v[154:155]
  buffer_store_dwordx2 v[152:153], v2, s[36:39], s45 offen
  s_mov_b32 exec_hi, -1
  s_add_u32 m0, s85, 151552
  s_nop 0
  buffer_load_dwordx4 v2, s[36:39], s84 offen offset:0 sc1 lds
  s_add_u32 m0, s85, 151552
  s_nop 0
  buffer_load_dwordx4 v2, s[36:39], s84 offen offset:1024 sc1 lds
  s_add_u32 s84, s84, 8192
  s_waitcnt vmcnt(2)
  s_mov_b64 exec, 1
  buffer_store_dword v229, off, s[36:39], s48
  s_mov_b64 exec, -1
  s_mov_b32 s8, 0
pl_72:
  buffer_load_dword v224, v225, s[36:39], s57 offen sc0 sc1
  s_add_u32 s8, s8, 1
  s_cmp_gt_u32 s8, 0x80000
  s_cbranch_scc1 L_abort
  s_waitcnt vmcnt(0)
pchk_74:
  v_cmp_ne_u32 vcc, 1, v224
  s_nop 3
  s_cbranch_vccnz pl_72
  buffer_load_dwordx4 a[0:3], v2, s[36:39], s74 offen offset:0 sc1
  buffer_load_dwordx4 a[4:7], v2, s[36:39], s74 offen offset:1024 sc1
  buffer_load_dwordx4 a[8:11], v2, s[36:39], s74 offen offset:2048 sc1
  buffer_load_dwordx4 a[12:15], v2, s[36:39], s74 offen offset:3072 sc1
  s_add_u32 s74, s74, 4096
  buffer_load_dwordx4 a[16:19], v2, s[36:39], s74 offen offset:0 sc1
  buffer_load_dwordx4 a[20:23], v2, s[36:39], s74 offen offset:1024 sc1
  buffer_load_dwordx4 v[12:15], v2, s[36:39], s52 offen offset:0 sc1
  buffer_load_dwordx4 v[16:19], v2, s[36:39], s52 offen offset:1024 sc1
  buffer_load_dwordx4 v[20:23], v2, s[36:39], s52 offen offset:2048 sc1
  buffer_load_dwordx4 v[24:27], v2, s[36:39], s52 offen offset:3072 sc1
  buffer_load_dwordx4 a[24:27], v2, s[36:39], s74 offen offset:2048 sc1
  buffer_load_dwordx4 a[28:31], v2, s[36:39], s74 offen offset:3072 sc1
  s_add_u32 s74, s74, 4096
  ds_read_b128 v[64:67], v2 offset:36864
  ds_read_b128 v[68:71], v2 offset:37888
  ds_read_b128 v[72:75], v2 offset:38912
  s_waitcnt vmcnt(11)
  s_waitcnt lgkmcnt(2)
  v_mfma_f32_32x32x16_bf16 v[112:127], v[64:67], a[0:3], 0
  buffer_load_dwordx4 a[32:35], v2, s[36:39], s74 offen offset:0 sc1
  ds_read_b128 v[76:79], v2 offset:39936
  s_waitcnt lgkmcnt(2)
  v_mfma_f32_32x32x16_bf16 v[128:143], v[68:71], a[0:3], 0
  ds_read_b128 v[64:67], v2 offset:40960
  s_waitcnt vmcnt(11)
  s_waitcnt lgkmcnt(2)
  v_mfma_f32_32x32x16_bf16 v[112:127], v[72:75], a[4:7], v[112:127]
  buffer_load_dwordx4 a[36:39], v2, s[36:39], s74 offen offset:1024 sc1
  ds_read_b128 v[68:71], v2 offset:41984
  s_waitcnt lgkmcnt(2)
  v_mfma_f32_32x32x16_bf16 v[128:143], v[76:79], a[4:7], v[128:143]
  ds_read_b128 v[72:75], v2 offset:43008
  s_waitcnt vmcnt(11)
  s_waitcnt lgkmcnt(2)
  v_mfma_f32_32x32x16_bf16 v[112:127], v[64:67], a[8:11], v[112:127]
  buffer_load_dwordx4 a[40:43], v2, s[36:39], s74 offen offset:2048 sc1
  ds_read_b128 v[76:79], v2 offset:44032
  s_waitcnt lgkmcnt(2)
  v_mfma_f32_32x32x16_bf16 v[128:143], v[68:71], a[8:11], v[128:143]
  ds_read_b128 v[64:67], v2 offset:45056
  s_waitcnt vmcnt(11)
  s_waitcnt lgkmcnt(2)
  v_mfma_f32_32x32x16_bf16 v[112:127], v[72:75], a[12:15], v[112:127]
  buffer_load_dwordx4 a[44:47], v2, s[36:39], s74 offen offset:3072 sc1
  ds_read_b128 v[68:71], v2 offset:46080
  s_add_u32 s74, s74, 4096
  s_waitcnt lgkmcnt(2)
  v_mfma_f32_32x32x16_bf16 v[128:143], v[76:79], a[12:15], v[128:143]
  ds_read_b128 v[72:75], v2 offset:47104
  s_waitcnt vmcnt(11)
  s_waitcnt lgkmcnt(2)
  v_mfma_f32_32x32x16_bf16 v[112:127], v[64:67], a[16:19], v[112:127]
  buffer_load_dwordx4 a[48:51], v2, s[36:39], s74 offen offset:0 sc1
  ds_read_b128 v[76:79], v2 offset:48128
  s_waitcnt lgkmcnt(2)
  v_mfma_f32_32x32x16_bf16 v[128:143], v[68:71], a[16:19], v[128:143]
  ds_read_b128 v[64:67], v2 offset:49152
  s_waitcnt vmcnt(11)
  s_waitcnt lgkmcnt(2)
  v_mfma_f32_32x32x16_bf16 v[112:127], v[72:75], a[20:23], v[112:127]
  buffer_load_dwordx4 a[52:55], v2, s[36:39], s74 offen offset:1024 sc1
  ds_read_b128 v[68:71], v2 offset:50176
  s_waitcnt lgkmcnt(2)
  v_mfma_f32_32x32x16_bf16 v[128:143], v[76:79], a[20:23], v[128:143]
  ds_read_b128 v[72:75], v2 offset:51200
  s_waitcnt vmcnt(7)
  s_waitcnt lgkmcnt(2)
  v_mfma_f32_32x32x16_bf16 v[112:127], v[64:67], a[24:27], v[112:127]
  buffer_load_dwordx4 a[56:59], v2, s[36:39], s74 offen offset:2048 sc1
  ds_read_b128 v[76:79], v2 offset:52224
  s_waitcnt lgkmcnt(2)
  v_mfma_f32_32x32x16_bf16 v[128:143], v[68:71], a[24:27], v[128:143]
  ds_read_b128 v[64:67], v2 offset:53248
  s_waitcnt vmcnt(7)
  s_waitcnt lgkmcnt(2)
  v_mfma_f32_32x32x16_bf16 v[112:127], v[72:75], a[28:31], v[112:127]
  buffer_load_dwordx4 a[60:63], v2, s[36:39], s74 offen offset:3072 sc1
  ds_read_b128 v[68:71], v2 offset:54272
  s_add_u32 s74, s74, 4096
  s_waitcnt lgkmcnt(2)
  v_mfma_f32_32x32x16_bf16 v[128:143], v[76:79], a[28:31], v[128:143]
  ds_read_b128 v[72:75], v2 offset:55296
  s_waitcnt vmcnt(7)
  s_waitcnt lgkmcnt(2)
  v_mfma_f32_32x32x16_bf16 v[112:127], v[64:67], a[32:35], v[112:127]
  buffer_load_dwordx4 a[64:67], v2, s[36:39], s74 offen offset:0 sc1
  ds_read_b128 v[76:79], v2 offset:56320
  v_add_f32 v12, v12, v20
  v_add_f32 v13, v13, v21
  s_waitcnt lgkmcnt(2)
  v_mfma_f32_32x32x16_bf16 v[128:143], v[68:71], a[32:35], v[128:143]
  ds_read_b128 v[64:67], v2 offset:57344
  v_add_f32 v14, v14, v22
  v_add_f32 v15, v15, v23
  s_waitcnt vmcnt(7)
  s_waitcnt lgkmcnt(2)
  v_mfma_f32_32x32x16_bf16 v[112:127], v[72:75], a[36:39], v[112:127]
  buffer_load_dwordx4 a[68:71], v2, s[36:39], s74 offen offset:1024 sc1
  ds_read_b128 v[68:71], v2 offset:58368
  v_add_f32 v16, v16, v24
  v_add_f32 v17, v17, v25
  s_waitcnt lgkmcnt(2)
  v_mfma_f32_32x32x16_bf16 v[128:143], v[76:79], a[36:39], v[128:143]
  ds_read_b128 v[72:75], v2 offset:59392
  v_add_f32 v18, v18, v26
  v_add_f32 v19, v19, v27
  s_waitcnt vmcnt(7)
  s_waitcnt lgkmcnt(2)
  v_mfma_f32_32x32x16_bf16 v[112:127], v[64:67], a[40:43], v[112:127]
  buffer_load_dwordx4 a[72:75], v2, s[36:39], s74 offen offset:2048 sc1
  ds_read_b128 v[76:79], v2 offset:60416
  v_add_f32 v12, v12, v16
  v_add_f32 v13, v13, v17
  s_waitcnt lgkmcnt(2)
  v_mfma_f32_32x32x16_bf16 v[128:143], v[68:71], a[40:43], v[128:143]
  ds_read_b128 v[64:67], v222 offset:0
  v_add_f32 v14, v14, v18
  v_add_f32 v15, v15, v19
  s_waitcnt vmcnt(7)
  s_waitcnt lgkmcnt(2)
  v_mfma_f32_32x32x16_bf16 v[112:127], v[72:75], a[44:47], v[112:127]
  buffer_load_dwordx4 a[76:79], v2, s[36:39], s74 offen offset:3072 sc1
  ds_read_b128 v[68:71], v222 offset:1024
  s_add_u32 s74, s74, 4096
  v_add_f32 v12, v12, v14
  v_add_f32 v13, v13, v15
  s_waitcnt lgkmcnt(2)
  v_mfma_f32_32x32x16_bf16 v[128:143], v[76:79], a[44:47], v[128:143]
  ds_read_b128 v[72:75], v222 offset:2048
  v_mov_b32 v58, v12
  v_mov_b32 v59, v13
  s_waitcnt vmcnt(7)
  s_waitcnt lgkmcnt(2)
  v_mfma_f32_32x32x16_bf16 v[112:127], v[64:67], a[48:51], v[112:127]
  buffer_load_dwordx4 a[80:83], v2, s[36:39], s74 offen offset:0 sc1
  ds_read_b128 v[76:79], v222 offset:3072
  s_nop 0
  v_permlane32_swap_b32 v12, v58
  s_waitcnt lgkmcnt(2)
  v_mfma_f32_32x32x16_bf16 v[128:143], v[68:71], a[48:51], v[128:143]
  ds_read_b128 v[64:67], v222 offset:4096
  v_permlane32_swap_b32 v13, v59
  v_add_f32 v12, v12, v58
  s_waitcnt vmcnt(7)
  s_waitcnt lgkmcnt(2)
  v_mfma_f32_32x32x16_bf16 v[112:127], v[72:75], a[52:55], v[112:127]
  buffer_load_dwordx4 a[84:87], v2, s[36:39], s74 offen offset:1024 sc1
  ds_read_b128 v[68:71], v222 offset:5120
  v_add_f32 v13, v13, v59
  v_mul_f32 v56, 0.001953125, v12
  s_waitcnt lgkmcnt(2)
  v_mfma_f32_32x32x16_bf16 v[128:143], v[76:79], a[52:55], v[128:143]
  ds_read_b128 v[72:75], v222 offset:6144
  v_mul_f32 v13, 0.001953125, v13
  v_fma_f32 v13, -v56, v56, v13
  s_waitcnt vmcnt(7)
  s_waitcnt lgkmcnt(2)
  v_mfma_f32_32x32x16_bf16 v[112:127], v[64:67], a[56:59], v[112:127]
  buffer_load_dwordx4 a[88:91], v2, s[36:39], s74 offen offset:2048 sc1
  ds_read_b128 v[76:79], v222 offset:7168
  v_max_f32 v13, 0, v13
  v_cvt_pk_bf16_f32 v13, v13, v13
  s_waitcnt lgkmcnt(2)
  v_mfma_f32_32x32x16_bf16 v[128:143], v[68:71], a[56:59], v[128:143]
  ds_read_b128 v[64:67], v222 offset:8192
  v_and_b32 v13, 0xffff0000, v13
  v_add_f32 v13, 0x3727c5ac, v13
  s_waitcnt vmcnt(7)
  s_waitcnt lgkmcnt(2)
  v_mfma_f32_32x32x16_bf16 v[112:127], v[72:75], a[60:63], v[112:127]
  buffer_load_dwordx4 a[92:95], v2, s[36:39], s74 offen offset:3072 sc1
  ds_read_b128 v[68:71], v222 offset:9216
  s_add_u32 s74, s74, 4096
  v_cvt_pk_bf16_f32 v13, v13, v13
  v_and_b32 v13, 0xffff0000, v13
  s_waitcnt lgkmcnt(2)
  v_mfma_f32_32x32x16_bf16 v[128:143], v[76:79], a[60:63], v[128:143]
  ds_read_b128 v[72:75], v222 offset:10240
  v_sqrt_f32 v13, v13
  v_sub_f32 v58, 0, v56
  s_waitcnt vmcnt(7)
  s_waitcnt lgkmcnt(2)
  v_mfma_f32_32x32x16_bf16 v[112:127], v[64:67], a[64:67], v[112:127]
  buffer_load_dwordx4 a[96:99], v2, s[36:39], s74 offen offset:0 sc1
  ds_read_b128 v[76:79], v222 offset:11264
  v_cvt_pk_bf16_f32 v13, v13, v13
  v_and_b32 v13, 0xffff0000, v13
  s_waitcnt lgkmcnt(2)
  v_mfma_f32_32x32x16_bf16 v[128:143], v[68:71], a[64:67], v[128:143]
  ds_read_b128 v[64:67], v222 offset:12288
  v_rcp_f32 v57, v13
  v_cvt_pk_bf16_f32 v52, v58, v58
  s_waitcnt vmcnt(7)
  s_waitcnt lgkmcnt(2)
  v_mfma_f32_32x32x16_bf16 v[112:127], v[72:75], a[68:71], v[112:127]
  buffer_load_dwordx4 a[100:103], v2, s[36:39], s74 offen offset:1024 sc1
  ds_read_b128 v[68:71], v222 offset:13312
  v_mov_b32 v53, v52
  v_mov_b32 v54, v52
  s_waitcnt lgkmcnt(2)
  v_mfma_f32_32x32x16_bf16 v[128:143], v[76:79], a[68:71], v[128:143]
  ds_read_b128 v[72:75], v222 offset:14336
  v_mov_b32 v55, v52
  s_nop 0
  s_waitcnt vmcnt(7)
  s_waitcnt lgkmcnt(2)
  v_mfma_f32_32x32x16_bf16 v[112:127], v[64:67], a[72:75], v[112:127]
  buffer_load_dwordx4 a[104:107], v2, s[36:39], s74 offen offset:2048 sc1
  ds_read_b128 v[76:79], v222 offset:15360
  v_mul_f32 v58, v57, v57
  s_waitcnt lgkmcnt(2)
  v_mfma_f32_32x32x16_bf16 v[128:143], v[68:71], a[72:75], v[128:143]
  ds_read_b128 v[64:67], v222 offset:16384
  s_waitcnt vmcnt(7)
  s_waitcnt lgkmcnt(2)
  v_mfma_f32_32x32x16_bf16 v[112:127], v[72:75], a[76:79], v[112:127]
  buffer_load_dwordx4 a[108:111], v2, s[36:39], s74 offen offset:3072 sc1
  ds_read_b128 v[68:71], v222 offset:17408
  s_add_u32 s74, s74, 4096
  s_waitcnt lgkmcnt(2)
  v_mfma_f32_32x32x16_bf16 v[128:143], v[76:79], a[76:79], v[128:143]
  ds_read_b128 v[72:75], v222 offset:18432
  s_waitcnt vmcnt(7)
  s_waitcnt lgkmcnt(2)
  v_mfma_f32_32x32x16_bf16 v[112:127], v[64:67], a[80:83], v[112:127]
  buffer_load_dwordx4 a[112:115], v2, s[36:39], s74 offen offset:0 sc1
  ds_read_b128 v[76:79], v222 offset:19456
  s_waitcnt lgkmcnt(2)
  v_mfma_f32_32x32x16_bf16 v[128:143], v[68:71], a[80:83], v[128:143]
  ds_read_b128 v[64:67], v222 offset:20480
  s_waitcnt vmcnt(7)
  s_waitcnt lgkmcnt(2)
  v_mfma_f32_32x32x16_bf16 v[112:127], v[72:75], a[84:87], v[112:127]
  buffer_load_dwordx4 a[116:119], v2, s[36:39], s74 offen offset:1024 sc1
  ds_read_b128 v[68:71], v222 offset:21504
  s_waitcnt lgkmcnt(2)
  v_mfma_f32_32x32x16_bf16 v[128:143], v[76:79], a[84:87], v[128:143]
  ds_read_b128 v[72:75], v222 offset:22528
  s_waitcnt vmcnt(7)
  s_waitcnt lgkmcnt(2)
  v_mfma_f32_32x32x16_bf16 v[112:127], v[64:67], a[88:91], v[112:127]
  buffer_load_dwordx4 a[120:123], v2, s[36:39], s74 offen offset:2048 sc1
  ds_read_b128 v[76:79], v222 offset:23552
  s_waitcnt lgkmcnt(2)
  v_mfma_f32_32x32x16_bf16 v[128:143], v[68:71], a[88:91], v[128:143]
  ds_read_b128 v[64:67], v222 offset:24576
  s_waitcnt vmcnt(7)
  s_waitcnt lgkmcnt(2)
  v_mfma_f32_32x32x16_bf16 v[112:127], v[72:75], a[92:95], v[112:127]
  buffer_load_dwordx4 a[124:127], v2, s[36:39], s74 offen offset:3072 sc1
  ds_read_b128 v[68:71], v222 offset:25600
  s_add_u32 s74, s74, 4096
  s_waitcnt lgkmcnt(2)
  v_mfma_f32_32x32x16_bf16 v[128:143], v[76:79], a[92:95], v[128:143]
  ds_read_b128 v[72:75], v222 offset:26624
  s_waitcnt vmcnt(7)
  s_waitcnt lgkmcnt(2)
  v_mfma_f32_32x32x16_bf16 v[112:127], v[64:67], a[96:99], v[112:127]
  ds_read_b128 v[76:79], v222 offset:27648
  s_waitcnt lgkmcnt(2)
  v_mfma_f32_32x32x16_bf16 v[128:143], v[68:71], a[96:99], v[128:143]
  ds_read_b128 v[64:67], v222 offset:28672
  s_waitcnt vmcnt(6)
  s_waitcnt lgkmcnt(2)
  s_add_u32 m0, s85, 0
  v_mfma_f32_32x32x16_bf16 v[112:127], v[72:75], a[100:103], v[112:127]
  buffer_load_dwordx4 v2, s[36:39], s84 offen offset:0 sc1 lds
  ds_read_b128 v[68:71], v222 offset:29696
  s_waitcnt lgkmcnt(2)
  s_add_u32 m0, s85, 0
  v_mfma_f32_32x32x16_bf16 v[128:143], v[76:79], a[100:103], v[128:143]
  buffer_load_dwordx4 v2, s[36:39], s84 offen offset:1024 sc1 lds
  ds_read_b128 v[72:75], v222 offset:30720
  s_add_u32 s84, s84, 8192
  s_waitcnt vmcnt(7)
  s_waitcnt lgkmcnt(2)
  s_add_u32 m0, s85, 8192
  v_mfma_f32_32x32x16_bf16 v[112:127], v[64:67], a[104:107], v[112:127]
  buffer_load_dwordx4 v2, s[36:39], s84 offen offset:0 sc1 lds
  ds_read_b128 v[76:79], v222 offset:31744
  s_waitcnt lgkmcnt(2)
  s_add_u32 m0, s85, 8192
  v_mfma_f32_32x32x16_bf16 v[128:143], v[68:71], a[104:107], v[128:143]
  buffer_load_dwordx4 v2, s[36:39], s84 offen offset:1024 sc1 lds
  ds_read_b128 v[64:67], v222 offset:32768
  s_add_u32 s84, s84, 8192
  s_waitcnt vmcnt(8)
  s_waitcnt lgkmcnt(2)
  s_add_u32 m0, s85, 16384
  v_mfma_f32_32x32x16_bf16 v[112:127], v[72:75], a[108:111], v[112:127]
  buffer_load_dwordx4 v2, s[36:39], s84 offen offset:0 sc1 lds
  ds_read_b128 v[68:71], v222 offset:33792
  s_waitcnt lgkmcnt(2)
  s_add_u32 m0, s85, 16384
  v_mfma_f32_32x32x16_bf16 v[128:143], v[76:79], a[108:111], v[128:143]
  buffer_load_dwordx4 v2, s[36:39], s84 offen offset:1024 sc1 lds
  ds_read_b128 v[72:75], v222 offset:34816
  s_add_u32 s84, s84, 8192
  s_waitcnt vmcnt(9)
  s_waitcnt lgkmcnt(2)
  s_lshr_b32 s84, s10, 1
  s_mul_i32 s84, s84, 6
  s_min_u32 s84, s84, 80
  s_lshl_b32 s84, s84, 15
  s_lshl_b32 s85, s3, 11
  s_add_u32 s84, s84, s85
  s_add_u32 s84, s84, 0x220000
  s_cmp_gt_u32 s54, 4
  s_cselect_b32 s84, 0xf0000000, s84
  s_add_u32 m0, s85, 24576
  v_mfma_f32_32x32x16_bf16 v[112:127], v[64:67], a[112:115], v[112:127]
  buffer_load_dwordx4 v2, s[36:39], s84 offen offset:0 sc1 lds
  ds_read_b128 v[76:79], v222 offset:35840
  s_waitcnt lgkmcnt(2)
  s_add_u32 m0, s85, 24576
  v_mfma_f32_32x32x16_bf16 v[128:143], v[68:71], a[112:115], v[128:143]
  buffer_load_dwordx4 v2, s[36:39], s84 offen offset:1024 sc1 lds
  ds_read_b128 v[64:67], v222 offset:36864
  s_add_u32 s84, s84, 8192
  s_waitcnt vmcnt(10)
  s_waitcnt lgkmcnt(2)
  v_mfma_f32_32x32x16_bf16 v[112:127], v[72:75], a[116:119], v[112:127]
  ds_read_b128 v[68:71], v222 offset:37888
  s_waitcnt lgkmcnt(2)
  v_mfma_f32_32x32x16_bf16 v[128:143], v[76:79], a[116:119], v[128:143]
  ds_read_b128 v[72:75], v222 offset:38912
  s_waitcnt vmcnt(9)
  s_waitcnt lgkmcnt(2)
  v_mfma_f32_32x32x16_bf16 v[112:127], v[64:67], a[120:123], v[112:127]
  ds_read_b128 v[76:79], v222 offset:39936
  s_waitcnt lgkmcnt(2)
  v_mfma_f32_32x32x16_bf16 v[128:143], v[68:71], a[120:123], v[128:143]
  ds_read_b128 v[64:67], v222 offset:40960
  s_waitcnt vmcnt(8)
  s_waitcnt lgkmcnt(2)
  v_mfma_f32_32x32x16_bf16 v[112:127], v[72:75], a[124:127], v[112:127]
  ds_read_b128 v[68:71], v222 offset:41984
  s_waitcnt lgkmcnt(2)
  v_mfma_f32_32x32x16_bf16 v[128:143], v[76:79], a[124:127], v[128:143]
  ds_read_b128 v[72:75], v222 offset:43008
  v_mfma_f32_32x32x16_bf16 v[112:127], v[28:31], v[52:55], v[112:127]
  v_mfma_f32_32x32x16_bf16 v[128:143], v[32:35], v[52:55], v[128:143]
  s_waitcnt lgkmcnt(2)
  v_mfma_f32_32x32x16_bf16 v[144:159], v[64:67], a[0:3], 0
  ds_read_b128 v[76:79], v222 offset:44032
  s_waitcnt lgkmcnt(2)
  v_mfma_f32_32x32x16_bf16 v[160:175], v[68:71], a[0:3], 0
  ds_read_b128 v[64:67], v222 offset:45056
  s_waitcnt lgkmcnt(2)
  v_mfma_f32_32x32x16_bf16 v[144:159], v[72:75], a[4:7], v[144:159]
  ds_read_b128 v[68:71], v222 offset:46080
  s_waitcnt lgkmcnt(2)
  v_mfma_f32_32x32x16_bf16 v[160:175], v[76:79], a[4:7], v[160:175]
  ds_read_b128 v[72:75], v222 offset:47104
  s_barrier
  s_waitcnt lgkmcnt(2)
  s_lshr_b32 s90, s3, 1
  s_mul_i32 s90, s90, 86016
  s_and_b32 s89, s3, 1
  s_lshl_b32 s89, s89, 10
  s_add_u32 s90, s90, s89
  s_lshr_b32 s89, s10, 2
  s_mul_i32 s89, s89, 176128
  s_add_u32 s90, s90, s89
  s_lshl_b32 s89, s3, 10
  s_add_u32 m0, s89, 77824
  s_add_u32 s88, s90, 0x1800000
  v_mfma_f32_32x32x16_bf16 v[144:159], v[64:67], a[8:11], v[144:159]
  buffer_load_dwordx4 v2, s[36:39], s88 offen sc1 lds
  ds_read_b128 v[76:79], v222 offset:48128
  s_waitcnt lgkmcnt(2)
  v_mfma_f32_32x32x16_bf16 v[160:175], v[68:71], a[8:11], v[160:175]
  ds_read_b128 v[64:67], v222 offset:49152
  s_waitcnt lgkmcnt(2)
  v_mfma_f32_32x32x16_bf16 v[144:159], v[72:75], a[12:15], v[144:159]
  ds_read_b128 v[68:71], v222 offset:50176
  v_mul_f32 v112, v112, v58
  v_mul_f32 v113, v113, v58
  s_add_u32 m0, s85, 118784
  s_nop 0
  buffer_load_dwordx4 v2, s[36:39], s84 offen offset:0 sc1 lds
  s_waitcnt lgkmcnt(2)
  v_mfma_f32_32x32x16_bf16 v[160:175], v[76:79], a[12:15], v[160:175]
  ds_read_b128 v[72:75], v222 offset:51200
  v_mul_f32 v114, v114, v58
  v_mul_f32 v115, v115, v58
  s_waitcnt lgkmcnt(2)
  v_mfma_f32_32x32x16_bf16 v[144:159], v[64:67], a[16:19], v[144:159]
  ds_read_b128 v[76:79], v222 offset:52224
  v_mul_f32 v116, v116, v58
  v_mul_f32 v117, v117, v58
  s_add_u32 m0, s89, 81920
  s_add_u32 s88, s90, 0x1800800
  buffer_load_dwordx4 v2, s[36:39], s88 offen sc1 lds
  s_waitcnt lgkmcnt(2)
  v_mfma_f32_32x32x16_bf16 v[160:175], v[68:71], a[16:19], v[160:175]
  ds_read_b128 v[64:67], v222 offset:53248
  v_mul_f32 v118, v118, v58
  v_mul_f32 v119, v119, v58
  s_waitcnt lgkmcnt(2)
  v_mfma_f32_32x32x16_bf16 v[144:159], v[72:75], a[20:23], v[144:159]
  ds_read_b128 v[68:71], v222 offset:54272
  v_mul_f32 v112, v112, v120
  v_mul_f32 v113, v113, v121
  s_add_u32 m0, s85, 118784
  s_nop 0
  buffer_load_dwordx4 v2, s[36:39], s84 offen offset:1024 sc1 lds
  s_add_u32 s84, s84, 8192
  s_waitcnt lgkmcnt(2)
  v_mfma_f32_32x32x16_bf16 v[160:175], v[76:79], a[20:23], v[160:175]
  ds_read_b128 v[72:75], v222 offset:55296
  v_mul_f32 v114, v114, v122
  v_mul_f32 v115, v115, v123
  s_waitcnt lgkmcnt(2)
  v_mfma_f32_32x32x16_bf16 v[144:159], v[64:67], a[24:27], v[144:159]
  ds_read_b128 v[76:79], v222 offset:56320
  v_mul_f32 v116, v116, v124
  v_mul_f32 v117, v117, v125
  s_add_u32 m0, s89, 86016
  s_add_u32 s88, s90, 0x1803000
  buffer_load_dwordx4 v2, s[36:39], s88 offen sc1 lds
  s_waitcnt lgkmcnt(2)
  v_mfma_f32_32x32x16_bf16 v[160:175], v[68:71], a[24:27], v[160:175]
  ds_read_b128 v[64:67], v223 offset:12288
  v_mul_f32 v118, v118, v126
  v_mul_f32 v119, v119, v127
  s_waitcnt lgkmcnt(2)
  v_mfma_f32_32x32x16_bf16 v[144:159], v[72:75], a[28:31], v[144:159]
  ds_read_b128 v[68:71], v223 offset:13312
  v_cvt_pk_bf16_f32 v80, v112, v113
  v_cvt_pk_bf16_f32 v81, v114, v115
  s_add_u32 m0, s85, 126976
  s_nop 0
  buffer_load_dwordx4 v2, s[36:39], s84 offen offset:0 sc1 lds
  s_waitcnt lgkmcnt(2)
  v_mfma_f32_32x32x16_bf16 v[160:175], v[76:79], a[28:31], v[160:175]
  ds_read_b128 v[72:75], v223 offset:14336
  v_cvt_pk_bf16_f32 v82, v116, v117
  v_cvt_pk_bf16_f32 v83, v118, v119
  s_waitcnt lgkmcnt(2)
  v_mfma_f32_32x32x16_bf16 v[144:159], v[64:67], a[32:35], v[144:159]
  ds_read_b128 v[76:79], v223 offset:15360
  s_cmp_gt_u32 s54, 0
  s_cselect_b32 s97, 0xf0000000, s76
  buffer_store_dwordx4 v[80:83], v2, s[36:39], s97 offen offset:0
  v_mul_f32 v128, v128, v58
  s_add_u32 m0, s89, 90112
  s_add_u32 s88, s90, 0x1803800
  buffer_load_dwordx4 v2, s[36:39], s88 offen sc1 lds
  s_waitcnt lgkmcnt(2)
  v_mfma_f32_32x32x16_bf16 v[160:175], v[68:71], a[32:35], v[160:175]
  ds_read_b128 v[64:67], v223 offset:16384
  v_mul_f32 v129, v129, v58
  v_mul_f32 v130, v130, v58
  s_waitcnt lgkmcnt(2)
  v_mfma_f32_32x32x16_bf16 v[144:159], v[72:75], a[36:39], v[144:159]
  ds_read_b128 v[68:71], v223 offset:17408
  v_mul_f32 v131, v131, v58
  v_mul_f32 v132, v132, v58
  s_add_u32 m0, s85, 126976
  s_nop 0
  buffer_load_dwordx4 v2, s[36:39], s84 offen offset:1024 sc1 lds
  s_add_u32 s84, s84, 8192
  s_waitcnt lgkmcnt(2)
  v_mfma_f32_32x32x16_bf16 v[160:175], v[76:79], a[36:39], v[160:175]
  ds_read_b128 v[72:75], v223 offset:18432
  v_mul_f32 v133, v133, v58
  v_mul_f32 v134, v134, v58
  s_waitcnt lgkmcnt(2)
  v_mfma_f32_32x32x16_bf16 v[144:159], v[64:67], a[40:43], v[144:159]
  ds_read_b128 v[76:79], v223 offset:19456
  v_mul_f32 v135, v135, v58
  v_mul_f32 v128, v128, v136
  s_add_u32 m0, s89, 94208
  s_add_u32 s88, s90, 0x1806000
  buffer_load_dwordx4 v2, s[36:39], s88 offen sc1 lds
  s_waitcnt lgkmcnt(2)
  v_mfma_f32_32x32x16_bf16 v[160:175], v[68:71], a[40:43], v[160:175]
  ds_read_b128 v[64:67], v223 offset:20480
  v_mul_f32 v129, v129, v137
  v_mul_f32 v130, v130, v138
  s_waitcnt lgkmcnt(2)
  v_mfma_f32_32x32x16_bf16 v[144:159], v[72:75], a[44:47], v[144:159]
  ds_read_b128 v[68:71], v223 offset:21504
  v_mul_f32 v131, v131, v139
  v_mul_f32 v132, v132, v140
  s_add_u32 m0, s85, 36864
  s_nop 0
  buffer_load_dwordx4 v2, s[36:39], s84 offen offset:0 sc1 lds
  s_waitcnt lgkmcnt(2)
  v_mfma_f32_32x32x16_bf16 v[160:175], v[76:79], a[44:47], v[160:175]
  ds_read_b128 v[72:75], v223 offset:22528
  v_mul_f32 v133, v133, v141
  v_mul_f32 v134, v134, v142
  s_waitcnt lgkmcnt(2)
  v_mfma_f32_32x32x16_bf16 v[144:159], v[64:67], a[48:51], v[144:159]
  ds_read_b128 v[76:79], v223 offset:23552
  v_mul_f32 v135, v135, v143
  v_cvt_pk_bf16_f32 v84, v128, v129
  s_add_u32 m0, s89, 98304
  s_add_u32 s88, s90, 0x1806800
  buffer_load_dwordx4 v2, s[36:39], s88 offen sc1 lds
  s_waitcnt lgkmcnt(2)
  v_mfma_f32_32x32x16_bf16 v[160:175], v[68:71], a[48:51], v[160:175]
  ds_read_b128 v[64:67], v223 offset:24576
  v_cvt_pk_bf16_f32 v85, v130, v131
  v_cvt_pk_bf16_f32 v86, v132, v133
  s_waitcnt lgkmcnt(2)
  v_mfma_f32_32x32x16_bf16 v[144:159], v[72:75], a[52:55], v[144:159]
  ds_read_b128 v[68:71], v223 offset:25600
  v_cvt_pk_bf16_f32 v87, v134, v135
  s_cmp_gt_u32 s54, 1
  s_cselect_b32 s97, 0xf0000000, s76
  buffer_store_dwordx4 v[84:87], v2, s[36:39], s97 offen offset:1024
  s_add_u32 m0, s85, 36864
  s_nop 0
  buffer_load_dwordx4 v2, s[36:39], s84 offen offset:1024 sc1 lds
  s_add_u32 s84, s84, 8192
  s_waitcnt lgkmcnt(2)
  v_mfma_f32_32x32x16_bf16 v[160:175], v[76:79], a[52:55], v[160:175]
  ds_read_b128 v[72:75], v223 offset:26624
  s_waitcnt lgkmcnt(2)
  s_add_u32 m0, s85, 45056
  v_mfma_f32_32x32x16_bf16 v[144:159], v[64:67], a[56:59], v[144:159]
  buffer_load_dwordx4 v2, s[36:39], s84 offen offset:0 sc1 lds
  ds_read_b128 v[76:79], v223 offset:27648
  s_waitcnt lgkmcnt(2)
  v_mfma_f32_32x32x16_bf16 v[160:175], v[68:71], a[56:59], v[160:175]
  ds_read_b128 v[64:67], v223 offset:28672
  s_waitcnt lgkmcnt(2)
  s_add_u32 s12, s48, 0x2000
  s_add_u32 m0, s85, 45056
  v_mfma_f32_32x32x16_bf16 v[144:159], v[72:75], a[60:63], v[144:159]
  buffer_load_dwordx4 v2, s[36:39], s84 offen offset:1024 sc1 lds
  ds_read_b128 v[68:71], v223 offset:29696
  s_add_u32 s84, s84, 8192
  s_waitcnt lgkmcnt(2)
  v_mfma_f32_32x32x16_bf16 v[160:175], v[76:79], a[60:63], v[160:175]
  ds_read_b128 v[72:75], v223 offset:30720
  s_add_u32 s13, s50, 0x3000
  s_waitcnt lgkmcnt(2)
  s_mov_b32 s14, s50
  s_add_u32 m0, s85, 53248
  v_mfma_f32_32x32x16_bf16 v[144:159], v[64:67], a[64:67], v[144:159]
  buffer_load_dwordx4 v2, s[36:39], s84 offen offset:0 sc1 lds
  ds_read_b128 v[76:79], v223 offset:31744
  s_waitcnt lgkmcnt(2)
  v_mfma_f32_32x32x16_bf16 v[160:175], v[68:71], a[64:67], v[160:175]
  ds_read_b128 v[64:67], v223 offset:32768
  s_add_u32 s15, s50, 0x4000
  s_waitcnt lgkmcnt(2)
  s_lshl_b32 s86, s3, 12
  s_add_u32 m0, s85, 53248
  v_mfma_f32_32x32x16_bf16 v[144:159], v[72:75], a[68:71], v[144:159]
  buffer_load_dwordx4 v2, s[36:39], s84 offen offset:1024 sc1 lds
  ds_read_b128 v[68:71], v223 offset:33792
  s_add_u32 s84, s84, 8192
  s_waitcnt lgkmcnt(2)
  v_mfma_f32_32x32x16_bf16 v[160:175], v[76:79], a[68:71], v[160:175]
  ds_read_b128 v[72:75], v223 offset:34816
  s_add_u32 s86, s86, 135168
  s_waitcnt lgkmcnt(2)
  v_mfma_f32_32x32x16_bf16 v[144:159], v[64:67], a[72:75], v[144:159]
  ds_read_b128 v[76:79], v223 offset:35840
  v_and_b32 v90, 31, v1
  s_add_u32 m0, s85, 61440
  s_nop 0
  buffer_load_dwordx4 v2, s[36:39], s84 offen offset:0 sc1 lds
  s_waitcnt lgkmcnt(2)
  v_mfma_f32_32x32x16_bf16 v[160:175], v[68:71], a[72:75], v[160:175]
  s_waitcnt vmcnt(10)
  s_barrier
  ds_read_b128 v[64:67], v2 offset:0
  v_mul_u32_u24 v90, 80, v90
  s_waitcnt lgkmcnt(2)
  v_mfma_f32_32x32x16_bf16 v[144:159], v[72:75], a[76:79], v[144:159]
  ds_read_b128 v[68:71], v2 offset:1024
  v_lshrrev_b32 v91, 5, v1
  s_add_u32 m0, s85, 61440
  s_nop 0
  buffer_load_dwordx4 v2, s[36:39], s84 offen offset:1024 sc1 lds
  s_add_u32 s84, s84, 8192
  s_waitcnt lgkmcnt(2)
  v_mfma_f32_32x32x16_bf16 v[160:175], v[76:79], a[76:79], v[160:175]
  ds_read_b128 v[72:75], v2 offset:2048
  v_lshl_add_u32 v90, v91, 4, v90
  s_waitcnt lgkmcnt(2)
  v_mfma_f32_32x32x16_bf16 v[144:159], v[64:67], a[80:83], v[144:159]
  ds_read_b128 v[76:79], v2 offset:3072
  v_add_u32 v90, s86, v90
  s_add_u32 m0, s89, 102400
  s_add_u32 s88, s90, 0x1809000
  buffer_load_dwordx4 v2, s[36:39], s88 offen sc1 lds
  s_waitcnt lgkmcnt(2)
  v_mfma_f32_32x32x16_bf16 v[160:175], v[68:71], a[80:83], v[160:175]
  ds_read_b128 v[64:67], v2 offset:4096
  v_lshrrev_b32 v92, 2, v1
  s_waitcnt lgkmcnt(2)
  v_mfma_f32_32x32x16_bf16 v[144:159], v[72:75], a[84:87], v[144:159]
  ds_read_b128 v[68:71], v2 offset:5120
  v_mul_u32_u24 v91, 80, v92
  s_add_u32 m0, s85, 69632
  s_nop 0
  buffer_load_dwordx4 v2, s[36:39], s84 offen offset:0 sc1 lds
  s_waitcnt lgkmcnt(2)
  v_mfma_f32_32x32x16_bf16 v[160:175], v[76:79], a[84:87], v[160:175]
  ds_read_b128 v[72:75], v2 offset:6144
  v_and_b32 v93, 3, v1
  s_waitcnt lgkmcnt(2)
  v_mfma_f32_32x32x16_bf16 v[144:159], v[64:67], a[88:91], v[144:159]
  ds_read_b128 v[76:79], v2 offset:7168
  v_lshl_add_u32 v91, v93, 4, v91
  s_add_u32 m0, s89, 106496
  s_add_u32 s88, s90, 0x1809800
  buffer_load_dwordx4 v2, s[36:39], s88 offen sc1 lds
  s_waitcnt lgkmcnt(2)
  v_mfma_f32_32x32x16_bf16 v[160:175], v[68:71], a[88:91], v[160:175]
  ds_read_b128 v[64:67], v2 offset:8192
  v_add_u32 v91, s86, v91
  s_waitcnt lgkmcnt(2)
  v_mfma_f32_32x32x16_bf16 v[144:159], v[72:75], a[92:95], v[144:159]
  ds_read_b128 v[68:71], v2 offset:9216
  v_lshlrev_b32 v92, 10, v92
  s_add_u32 m0, s89, 110592
  s_add_u32 s88, s90, 0x180c000
  buffer_load_dwordx4 v2, s[36:39], s88 offen sc1 lds
  s_waitcnt lgkmcnt(2)
  v_mfma_f32_32x32x16_bf16 v[160:175], v[76:79], a[92:95], v[160:175]
  ds_read_b128 v[72:75], v2 offset:10240
  v_lshl_add_u32 v92, v93, 4, v92
  s_waitcnt lgkmcnt(2)
  v_mfma_f32_32x32x16_bf16 v[144:159], v[64:67], a[96:99], v[144:159]
  ds_read_b128 v[76:79], v2 offset:11264
  v_lshlrev_b32 v112, 16, v248
  s_add_u32 m0, s85, 69632
  s_nop 0
  buffer_load_dwordx4 v2, s[36:39], s84 offen offset:1024 sc1 lds
  s_add_u32 s84, s84, 8192
  s_waitcnt lgkmcnt(2)
  v_mfma_f32_32x32x16_bf16 v[160:175], v[68:71], a[96:99], v[160:175]
  ds_read_b128 v[64:67], v2 offset:12288
  v_and_b32 v113, 0xffff0000, v248
  s_add_u32 s97, s55, 0x4000
  s_waitcnt vmcnt(12)
  s_mov_b64 exec, 1
  buffer_store_dword v229, off, s[36:39], s97
  s_mov_b64 exec, -1
  s_waitcnt lgkmcnt(2)
  v_mfma_f32_32x32x16_bf16 v[144:159], v[72:75], a[100:103], v[144:159]
  ds_read_b128 v[68:71], v2 offset:13312
  v_lshlrev_b32 v114, 16, v249
  s_add_u32 m0, s89, 114688
  s_add_u32 s88, s90, 0x180c800
  buffer_load_dwordx4 v2, s[36:39], s88 offen sc1 lds
  s_waitcnt lgkmcnt(2)
  v_mfma_f32_32x32x16_bf16 v[160:175], v[76:79], a[100:103], v[160:175]
  ds_read_b128 v[72:75], v2 offset:14336
  v_and_b32 v115, 0xffff0000, v249
  s_waitcnt lgkmcnt(2)
  v_mfma_f32_32x32x16_bf16 v[144:159], v[64:67], a[104:107], v[144:159]
  ds_read_b128 v[76:79], v2 offset:15360
  v_lshlrev_b32 v116, 16, v250
  s_add_u32 m0, s89, 135168
  s_add_u32 s88, s90, 0x180f000
  buffer_load_dwordx4 v2, s[36:39], s88 offen sc1 lds
  s_waitcnt lgkmcnt(2)
  v_mfma_f32_32x32x16_bf16 v[160:175], v[68:71], a[104:107], v[160:175]
  ds_read_b128 v[64:67], v2 offset:16384
  v_and_b32 v117, 0xffff0000, v250
  s_waitcnt lgkmcnt(2)
  v_mfma_f32_32x32x16_bf16 v[144:159], v[72:75], a[108:111], v[144:159]
  ds_read_b128 v[68:71], v2 offset:17408
  v_lshlrev_b32 v118, 16, v251
  s_waitcnt lgkmcnt(2)
  v_mfma_f32_32x32x16_bf16 v[160:175], v[76:79], a[108:111], v[160:175]
  ds_read_b128 v[72:75], v2 offset:18432
  v_and_b32 v119, 0xffff0000, v251
  s_waitcnt lgkmcnt(2)
  v_mfma_f32_32x32x16_bf16 v[144:159], v[64:67], a[112:115], v[144:159]
  ds_read_b128 v[76:79], v2 offset:19456
  v_lshlrev_b32 v120, 16, v252
  s_add_u32 m0, s89, 139264
  s_add_u32 s88, s90, 0x180f800
  buffer_load_dwordx4 v2, s[36:39], s88 offen sc1 lds
  s_waitcnt lgkmcnt(2)
  v_mfma_f32_32x32x16_bf16 v[160:175], v[68:71], a[112:115], v[160:175]
  ds_read_b128 v[64:67], v2 offset:20480
  v_and_b32 v121, 0xffff0000, v252
  s_waitcnt lgkmcnt(2)
  v_mfma_f32_32x32x16_bf16 v[144:159], v[72:75], a[116:119], v[144:159]
  ds_read_b128 v[68:71], v2 offset:21504
  v_lshlrev_b32 v122, 16, v253
  s_add_u32 m0, s89, 143360
  s_add_u32 s88, s90, 0x1812000
  buffer_load_dwordx4 v2, s[36:39], s88 offen sc1 lds
  s_waitcnt lgkmcnt(2)
  v_mfma_f32_32x32x16_bf16 v[160:175], v[76:79], a[116:119], v[160:175]
  ds_read_b128 v[72:75], v2 offset:22528
  v_and_b32 v123, 0xffff0000, v253
  s_waitcnt lgkmcnt(2)
  v_mfma_f32_32x32x16_bf16 v[144:159], v[64:67], a[120:123], v[144:159]
  ds_read_b128 v[76:79], v2 offset:23552
  v_lshlrev_b32 v124, 16, v254
  s_waitcnt lgkmcnt(2)
  v_mfma_f32_32x32x16_bf16 v[160:175], v[68:71], a[120:123], v[160:175]
  ds_read_b128 v[64:67], v2 offset:24576
  v_and_b32 v125, 0xffff0000, v254
  s_waitcnt lgkmcnt(2)
  v_mfma_f32_32x32x16_bf16 v[144:159], v[72:75], a[124:127], v[144:159]
  ds_read_b128 v[68:71], v2 offset:25600
  v_lshlrev_b32 v126, 16, v255
  s_add_u32 m0, s89, 147456
  s_add_u32 s88, s90, 0x1812800
  buffer_load_dwordx4 v2, s[36:39], s88 offen sc1 lds
  s_waitcnt lgkmcnt(2)
  v_mfma_f32_32x32x16_bf16 v[160:175], v[76:79], a[124:127], v[160:175]
  ds_read_b128 v[72:75], v2 offset:26624
  v_and_b32 v127, 0xffff0000, v255
  buffer_load_dword v224, v227, s[36:39], s15 offen sc0 sc1
  v_mfma_f32_32x32x16_bf16 v[144:159], v[36:39], v[52:55], v[144:159]
  v_mfma_f32_32x32x16_bf16 v[160:175], v[40:43], v[52:55], v[160:175]
  s_waitcnt lgkmcnt(2)
  v_mfma_f32_32x32x16_bf16 v[176:191], v[64:67], a[0:3], 0
  ds_read_b128 v[76:79], v2 offset:27648
  s_waitcnt lgkmcnt(2)
  v_mfma_f32_32x32x16_bf16 v[192:207], v[68:71], a[0:3], 0
  ds_read_b128 v[64:67], v2 offset:28672
  s_waitcnt lgkmcnt(2)
  v_mfma_f32_32x32x16_bf16 v[176:191], v[72:75], a[4:7], v[176:191]
  ds_read_b128 v[68:71], v2 offset:29696
  s_waitcnt lgkmcnt(2)
  v_mfma_f32_32x32x16_bf16 v[192:207], v[76:79], a[4:7], v[192:207]
  ds_read_b128 v[72:75], v2 offset:30720
  s_barrier
  s_waitcnt lgkmcnt(2)
  s_add_u32 m0, s89, 151552
  s_add_u32 s88, s90, 0x1801000
  v_mfma_f32_32x32x16_bf16 v[176:191], v[64:67], a[8:11], v[176:191]
  buffer_load_dwordx4 v2, s[36:39], s88 offen sc1 lds
  ds_read_b128 v[76:79], v2 offset:31744
  s_waitcnt lgkmcnt(2)
  v_mfma_f32_32x32x16_bf16 v[192:207], v[68:71], a[8:11], v[192:207]
  ds_read_b128 v[64:67], v222 offset:57344
  s_waitcnt lgkmcnt(2)
  v_mfma_f32_32x32x16_bf16 v[176:191], v[72:75], a[12:15], v[176:191]
  ds_read_b128 v[68:71], v222 offset:58368
  v_mul_f32 v144, v144, v58
  v_mul_f32 v145, v145, v58
  s_add_u32 m0, s89, 155648
  s_add_u32 s88, s90, 0x1801800
  buffer_load_dwordx4 v2, s[36:39], s88 offen sc1 lds
  s_waitcnt lgkmcnt(2)
  v_mfma_f32_32x32x16_bf16 v[192:207], v[76:79], a[12:15], v[192:207]
  ds_read_b128 v[72:75], v222 offset:59392
  v_mul_f32 v146, v146, v58
  v_mul_f32 v147, v147, v58
  s_waitcnt lgkmcnt(2)
  v_mfma_f32_32x32x16_bf16 v[176:191], v[64:67], a[16:19], v[176:191]
  ds_read_b128 v[76:79], v222 offset:60416
  v_mul_f32 v148, v148, v58
  v_mul_f32 v149, v149, v58
  s_waitcnt lgkmcnt(2)
  v_mfma_f32_32x32x16_bf16 v[192:207], v[68:71], a[16:19], v[192:207]
  ds_read_b128 v[64:67], v223 offset:0
  v_mul_f32 v150, v150, v58
  v_mul_f32 v151, v151, v58
  s_mov_b32 s8, 0
  s_waitcnt vmcnt(2)
  s_branch pchk_77
pl_75:
  buffer_load_dword v224, v227, s[36:39], s15 offen sc0 sc1
  s_add_u32 s8, s8, 1
  s_cmp_gt_u32 s8, 0x80000
  s_cbranch_scc1 L_abort
  s_waitcnt vmcnt(0)
pchk_77:
  v_cmp_ne_u32 vcc, 1, v224
  s_nop 3
  s_cbranch_vccnz pl_75
  s_waitcnt lgkmcnt(2)
  v_mfma_f32_32x32x16_bf16 v[176:191], v[72:75], a[20:23], v[176:191]
  ds_read_b128 v[68:71], v223 offset:1024
  v_mul_f32 v144, v144, v152
  v_mul_f32 v145, v145, v153
  s_add_u32 m0, s89, 159744
  s_add_u32 s88, s90, 0x1804000
  buffer_load_dwordx4 v2, s[36:39], s88 offen sc1 lds
  s_waitcnt lgkmcnt(2)
  v_mfma_f32_32x32x16_bf16 v[192:207], v[76:79], a[20:23], v[192:207]
  ds_read_b128 v[72:75], v223 offset:2048
  v_mul_f32 v146, v146, v154
  v_mul_f32 v147, v147, v155
  s_add_u32 s87, s47, 0
  buffer_load_dwordx4 a[128:131], v2, s[36:39], s87 offen offset:0 sc1
  s_waitcnt lgkmcnt(2)
  v_mfma_f32_32x32x16_bf16 v[176:191], v[64:67], a[24:27], v[176:191]
  ds_read_b128 v[76:79], v223 offset:3072
  v_mul_f32 v148, v148, v156
  v_mul_f32 v149, v149, v157
  s_add_u32 m0, s89, 0
  s_add_u32 s88, s90, 0x1804800
  buffer_load_dwordx4 v2, s[36:39], s88 offen sc1 lds
  s_waitcnt lgkmcnt(2)
  v_mfma_f32_32x32x16_bf16 v[192:207], v[68:71], a[24:27], v[192:207]
  ds_read_b128 v[64:67], v223 offset:4096
  v_mul_f32 v150, v150, v158
  v_mul_f32 v151, v151, v159
  buffer_load_dwordx4 a[132:135], v2, s[36:39], s87 offen offset:1024 sc1
  s_waitcnt lgkmcnt(2)
  v_mfma_f32_32x32x16_bf16 v[176:191], v[72:75], a[28:31], v[176:191]
  ds_read_b128 v[68:71], v223 offset:5120
  v_cvt_pk_bf16_f32 v80, v144, v145
  v_cvt_pk_bf16_f32 v81, v146, v147
  s_waitcnt lgkmcnt(2)
  v_mfma_f32_32x32x16_bf16 v[192:207], v[76:79], a[28:31], v[192:207]
  ds_read_b128 v[72:75], v223 offset:6144
  v_cvt_pk_bf16_f32 v82, v148, v149
  v_cvt_pk_bf16_f32 v83, v150, v151
  s_add_u32 s87, s47, 6144
  buffer_load_dwordx4 a[136:139], v2, s[36:39], s87 offen offset:0 sc1
  s_waitcnt lgkmcnt(2)
  v_mfma_f32_32x32x16_bf16 v[176:191], v[64:67], a[32:35], v[176:191]
  ds_read_b128 v[76:79], v223 offset:7168
  s_cmp_gt_u32 s54, 2
  s_cselect_b32 s97, 0xf0000000, s76
  buffer_store_dwordx4 v[80:83], v2, s[36:39], s97 offen offset:2048
  v_mul_f32 v160, v160, v58
  s_add_u32 m0, s89, 4096
  s_add_u32 s88, s90, 0x1807000
  buffer_load_dwordx4 v2, s[36:39], s88 offen sc1 lds
  s_waitcnt lgkmcnt(2)
  v_mfma_f32_32x32x16_bf16 v[192:207], v[68:71], a[32:35], v[192:207]
  ds_read_b128 v[64:67], v223 offset:8192
  v_mul_f32 v161, v161, v58
  v_mul_f32 v162, v162, v58
  s_waitcnt lgkmcnt(2)
  v_mfma_f32_32x32x16_bf16 v[176:191], v[72:75], a[36:39], v[176:191]
  ds_read_b128 v[68:71], v223 offset:9216
  v_mul_f32 v163, v163, v58
  v_mul_f32 v164, v164, v58
  s_add_u32 m0, s89, 8192
  s_add_u32 s88, s90, 0x1807800
  buffer_load_dwordx4 v2, s[36:39], s88 offen sc1 lds
  s_waitcnt lgkmcnt(2)
  v_mfma_f32_32x32x16_bf16 v[192:207], v[76:79], a[36:39], v[192:207]
  ds_read_b128 v[72:75], v223 offset:10240
  v_mul_f32 v165, v165, v58
  v_mul_f32 v166, v166, v58
  buffer_load_dwordx4 a[140:143], v2, s[36:39], s87 offen offset:1024 sc1
  s_waitcnt lgkmcnt(2)
  v_mfma_f32_32x32x16_bf16 v[176:191], v[64:67], a[40:43], v[176:191]
  ds_read_b128 v[76:79], v223 offset:11264
  v_mul_f32 v167, v167, v58
  v_mul_f32 v160, v160, v168
  s_waitcnt lgkmcnt(2)
  v_mfma_f32_32x32x16_bf16 v[192:207], v[68:71], a[40:43], v[192:207]
  s_barrier
  ds_read_b128 v[64:67], v2 offset:36864
  v_mul_f32 v161, v161, v169
  v_mul_f32 v162, v162, v170
  s_waitcnt lgkmcnt(2)
  v_mfma_f32_32x32x16_bf16 v[176:191], v[72:75], a[44:47], v[176:191]
  ds_read_b128 v[68:71], v2 offset:37888
  v_mul_f32 v163, v163, v171
  v_mul_f32 v164, v164, v172
  s_add_u32 m0, s89, 12288
  s_add_u32 s88, s90, 0x180a000
  buffer_load_dwordx4 v2, s[36:39], s88 offen sc1 lds
  s_waitcnt lgkmcnt(2)
  v_mfma_f32_32x32x16_bf16 v[192:207], v[76:79], a[44:47], v[192:207]
  ds_read_b128 v[72:75], v2 offset:38912
  v_mul_f32 v165, v165, v173
  v_mul_f32 v166, v166, v174
  s_add_u32 s87, s47, 12288
  buffer_load_dwordx4 a[144:147], v2, s[36:39], s87 offen offset:0 sc1
  s_waitcnt lgkmcnt(2)
  v_mfma_f32_32x32x16_bf16 v[176:191], v[64:67], a[48:51], v[176:191]
  ds_read_b128 v[76:79], v2 offset:39936
  v_mul_f32 v167, v167, v175
  v_cvt_pk_bf16_f32 v84, v160, v161
  s_add_u32 m0, s89, 16384
  s_add_u32 s88, s90, 0x180a800
  buffer_load_dwordx4 v2, s[36:39], s88 offen sc1 lds
  s_waitcnt lgkmcnt(2)
  v_mfma_f32_32x32x16_bf16 v[192:207], v[68:71], a[48:51], v[192:207]
  ds_read_b128 v[64:67], v2 offset:40960
  v_cvt_pk_bf16_f32 v85, v162, v163
  v_cvt_pk_bf16_f32 v86, v164, v165
  s_waitcnt lgkmcnt(2)
  v_mfma_f32_32x32x16_bf16 v[176:191], v[72:75], a[52:55], v[176:191]
  ds_read_b128 v[68:71], v2 offset:41984
  v_cvt_pk_bf16_f32 v87, v166, v167
  s_cmp_gt_u32 s54, 3
  s_cselect_b32 s97, 0xf0000000, s76
  buffer_store_dwordx4 v[84:87], v2, s[36:39], s97 offen offset:3072
  s_add_u32 s76, s76, 4096
  s_waitcnt lgkmcnt(2)
  v_mfma_f32_32x32x16_bf16 v[192:207], v[76:79], a[52:55], v[192:207]
  buffer_load_dwordx4 a[148:151], v2, s[36:39], s87 offen offset:1024 sc1
  ds_read_b128 v[72:75], v2 offset:43008
  s_waitcnt lgkmcnt(2)
  s_add_u32 m0, s89, 20480
  s_add_u32 s88, s90, 0x180d000
  v_mfma_f32_32x32x16_bf16 v[176:191], v[64:67], a[56:59], v[176:191]
  buffer_load_dwordx4 v2, s[36:39], s88 offen sc1 lds
  ds_read_b128 v[76:79], v2 offset:44032
  s_waitcnt lgkmcnt(2)
  v_mfma_f32_32x32x16_bf16 v[192:207], v[68:71], a[56:59], v[192:207]
  ds_read_b128 v[64:67], v2 offset:45056
  s_waitcnt lgkmcnt(2)
  s_add_u32 m0, s89, 32768
  s_add_u32 s88, s90, 0x180d800
  v_mfma_f32_32x32x16_bf16 v[176:191], v[72:75], a[60:63], v[176:191]
  buffer_load_dwordx4 v2, s[36:39], s88 offen sc1 lds
  ds_read_b128 v[68:71], v2 offset:46080
  s_waitcnt lgkmcnt(2)
  s_add_u32 s87, s47, 18432
  v_mfma_f32_32x32x16_bf16 v[192:207], v[76:79], a[60:63], v[192:207]
  buffer_load_dwordx4 a[152:155], v2, s[36:39], s87 offen offset:0 sc1
  ds_read_b128 v[72:75], v2 offset:47104
  s_waitcnt lgkmcnt(2)
  v_mfma_f32_32x32x16_bf16 v[176:191], v[64:67], a[64:67], v[176:191]
  ds_read_b128 v[76:79], v2 offset:48128
  s_waitcnt lgkmcnt(2)
  v_mfma_f32_32x32x16_bf16 v[192:207], v[68:71], a[64:67], v[192:207]
  ds_read_b128 v[64:67], v2 offset:49152
  s_waitcnt lgkmcnt(2)
  s_add_u32 m0, s89, 24576
  s_add_u32 s88, s90, 0x1810000
  v_mfma_f32_32x32x16_bf16 v[176:191], v[72:75], a[68:71], v[176:191]
  buffer_load_dwordx4 v2, s[36:39], s88 offen sc1 lds
  ds_read_b128 v[68:71], v2 offset:50176
  s_waitcnt lgkmcnt(2)
  v_mfma_f32_32x32x16_bf16 v[192:207], v[76:79], a[68:71], v[192:207]
  buffer_load_dwordx4 a[156:159], v2, s[36:39], s87 offen offset:1024 sc1
  ds_read_b128 v[72:75], v2 offset:51200
  s_waitcnt lgkmcnt(2)
  s_add_u32 m0, s89, 28672
  s_add_u32 s88, s90, 0x1810800
  v_mfma_f32_32x32x16_bf16 v[176:191], v[64:67], a[72:75], v[176:191]
  buffer_load_dwordx4 v2, s[36:39], s88 offen sc1 lds
  ds_read_b128 v[76:79], v2 offset:52224
  s_waitcnt lgkmcnt(2)
  v_mfma_f32_32x32x16_bf16 v[192:207], v[68:71], a[72:75], v[192:207]
  ds_read_b128 v[64:67], v2 offset:53248
  s_waitcnt lgkmcnt(2)
  v_mfma_f32_32x32x16_bf16 v[176:191], v[72:75], a[76:79], v[176:191]
  ds_read_b128 v[68:71], v2 offset:54272
  s_waitcnt lgkmcnt(2)
  s_add_u32 s87, s47, 24576
  v_mfma_f32_32x32x16_bf16 v[192:207], v[76:79], a[76:79], v[192:207]
  buffer_load_dwordx4 a[160:163], v2, s[36:39], s87 offen offset:0 sc1
  ds_read_b128 v[72:75], v2 offset:55296
  s_waitcnt lgkmcnt(2)
  s_add_u32 m0, s89, 118784
  s_add_u32 s88, s90, 0x1813000
  v_mfma_f32_32x32x16_bf16 v[176:191], v[64:67], a[80:83], v[176:191]
  buffer_load_dwordx4 v2, s[36:39], s88 offen sc1 lds
  ds_read_b128 v[76:79], v2 offset:56320
  s_waitcnt lgkmcnt(2)
  v_mfma_f32_32x32x16_bf16 v[192:207], v[68:71], a[80:83], v[192:207]
  ds_read_b128 v[64:67], v2 offset:57344
  s_waitcnt lgkmcnt(2)
  s_add_u32 m0, s89, 122880
  s_add_u32 s88, s90, 0x1813800
  v_mfma_f32_32x32x16_bf16 v[176:191], v[72:75], a[84:87], v[176:191]
  buffer_load_dwordx4 v2, s[36:39], s88 offen sc1 lds
  ds_read_b128 v[68:71], v2 offset:58368
  s_waitcnt lgkmcnt(2)
  v_mfma_f32_32x32x16_bf16 v[192:207], v[76:79], a[84:87], v[192:207]
  buffer_load_dwordx4 a[164:167], v2, s[36:39], s87 offen offset:1024 sc1
  ds_read_b128 v[72:75], v2 offset:59392
  s_waitcnt lgkmcnt(2)
  v_mfma_f32_32x32x16_bf16 v[176:191], v[64:67], a[88:91], v[176:191]
  ds_read_b128 v[76:79], v2 offset:60416
  s_waitcnt lgkmcnt(2)
  v_mfma_f32_32x32x16_bf16 v[192:207], v[68:71], a[88:91], v[192:207]
  ds_read_b128 v[64:67], v222 offset:0
  s_waitcnt vmcnt(11)
  s_mov_b64 exec, 1
  buffer_store_dword v229, off, s[36:39], s78
  s_mov_b64 exec, -1
  s_barrier
  s_waitcnt lgkmcnt(2)
  s_add_u32 m0, s89, 126976
  s_add_u32 s88, s90, 0x1802000
  v_mfma_f32_32x32x16_bf16 v[176:191], v[72:75], a[92:95], v[176:191]
  buffer_load_dwordx4 v2, s[36:39], s88 offen sc1 lds
  ds_read_b128 v[68:71], v222 offset:1024
  s_waitcnt lgkmcnt(2)
  s_add_u32 s87, s47, 30720
  v_mfma_f32_32x32x16_bf16 v[192:207], v[76:79], a[92:95], v[192:207]
  buffer_load_dwordx4 a[168:171], v2, s[36:39], s87 offen offset:0 sc1
  ds_read_b128 v[72:75], v222 offset:2048
  s_waitcnt lgkmcnt(2)
  s_add_u32 m0, s89, 131072
  s_add_u32 s88, s90, 0x1802800
  v_mfma_f32_32x32x16_bf16 v[176:191], v[64:67], a[96:99], v[176:191]
  buffer_load_dwordx4 v2, s[36:39], s88 offen sc1 lds
  ds_read_b128 v[76:79], v222 offset:3072
  s_waitcnt lgkmcnt(2)
  v_mfma_f32_32x32x16_bf16 v[192:207], v[68:71], a[96:99], v[192:207]
  ds_read_b128 v[64:67], v222 offset:4096
  s_waitcnt lgkmcnt(2)
  v_mfma_f32_32x32x16_bf16 v[176:191], v[72:75], a[100:103], v[176:191]
  ds_read_b128 v[68:71], v222 offset:5120
  s_waitcnt lgkmcnt(2)
  v_mfma_f32_32x32x16_bf16 v[192:207], v[76:79], a[100:103], v[192:207]
  buffer_load_dwordx4 a[172:175], v2, s[36:39], s87 offen offset:1024 sc1
  ds_read_b128 v[72:75], v222 offset:6144
  s_waitcnt lgkmcnt(2)
  s_add_u32 m0, s89, 36864
  s_add_u32 s88, s90, 0x1805000
  v_mfma_f32_32x32x16_bf16 v[176:191], v[64:67], a[104:107], v[176:191]
  buffer_load_dwordx4 v2, s[36:39], s88 offen sc1 lds
  ds_read_b128 v[76:79], v222 offset:7168
  s_waitcnt lgkmcnt(2)
  v_mfma_f32_32x32x16_bf16 v[192:207], v[68:71], a[104:107], v[192:207]
  ds_read_b128 v[64:67], v222 offset:8192
  s_waitcnt lgkmcnt(2)
  s_add_u32 m0, s89, 40960
  s_add_u32 s88, s90, 0x1805800
  v_mfma_f32_32x32x16_bf16 v[176:191], v[72:75], a[108:111], v[176:191]
  buffer_load_dwordx4 v2, s[36:39], s88 offen sc1 lds
  ds_read_b128 v[68:71], v222 offset:9216
  s_waitcnt lgkmcnt(2)
  s_add_u32 s87, s47, 36864
  v_mfma_f32_32x32x16_bf16 v[192:207], v[76:79], a[108:111], v[192:207]
  buffer_load_dwordx4 a[176:179], v2, s[36:39], s87 offen offset:0 sc1
  ds_read_b128 v[72:75], v222 offset:10240
  s_waitcnt lgkmcnt(2)
  v_mfma_f32_32x32x16_bf16 v[176:191], v[64:67], a[112:115], v[176:191]
  ds_read_b128 v[76:79], v222 offset:11264
  s_waitcnt lgkmcnt(2)
  v_mfma_f32_32x32x16_bf16 v[192:207], v[68:71], a[112:115], v[192:207]
  ds_read_b128 v[64:67], v222 offset:12288
  s_waitcnt lgkmcnt(2)
  v_mfma_f32_32x32x16_bf16 v[176:191], v[72:75], a[116:119], v[176:191]
  ds_read_b128 v[68:71], v222 offset:13312
  s_waitcnt lgkmcnt(2)
  v_mfma_f32_32x32x16_bf16 v[192:207], v[76:79], a[116:119], v[192:207]
  buffer_load_dwordx4 a[180:183], v2, s[36:39], s87 offen offset:1024 sc1
  ds_read_b128 v[72:75], v222 offset:14336
  s_waitcnt lgkmcnt(2)
  v_mfma_f32_32x32x16_bf16 v[176:191], v[64:67], a[120:123], v[176:191]
  ds_read_b128 v[76:79], v222 offset:15360
  s_waitcnt lgkmcnt(2)
  v_mfma_f32_32x32x16_bf16 v[192:207], v[68:71], a[120:123], v[192:207]
  buffer_load_dword v224, v227, s[36:39], s13 offen sc0 sc1
  s_waitcnt lgkmcnt(1)
  v_mfma_f32_32x32x16_bf16 v[176:191], v[72:75], a[124:127], v[176:191]
  s_waitcnt lgkmcnt(0)
  v_mfma_f32_32x32x16_bf16 v[192:207], v[76:79], a[124:127], v[192:207]
  v_mfma_f32_32x32x16_bf16 v[176:191], v[44:47], v[52:55], v[176:191]
  v_mfma_f32_32x32x16_bf16 v[192:207], v[48:51], v[52:55], v[192:207]
  s_nop 10
  v_mul_f32 v176, v176, v58
  v_mul_f32 v177, v177, v58
  v_mul_f32 v178, v178, v58
  v_mul_f32 v179, v179, v58
  v_mul_f32 v180, v180, v58
  v_mul_f32 v181, v181, v58
  v_mul_f32 v182, v182, v58
  v_mul_f32 v183, v183, v58
  v_mul_f32 v176, v176, v184
  v_mul_f32 v177, v177, v185
  v_mul_f32 v178, v178, v186
  v_mul_f32 v179, v179, v187
  v_mul_f32 v180, v180, v188
  v_mul_f32 v181, v181, v189
  v_mul_f32 v182, v182, v190
  v_mul_f32 v183, v183, v191
  v_cvt_pk_bf16_f32 v80, v176, v177
  v_cvt_pk_bf16_f32 v81, v178, v179
  v_cvt_pk_bf16_f32 v82, v180, v181
  v_cvt_pk_bf16_f32 v83, v182, v183
  s_cmp_gt_u32 s54, 4
  s_cselect_b32 s97, 0xf0000000, s76
  buffer_store_dwordx4 v[80:83], v2, s[36:39], s97 offen offset:0
  v_mul_f32 v192, v192, v58
  v_mul_f32 v193, v193, v58
  v_mul_f32 v194, v194, v58
  v_mul_f32 v195, v195, v58
  v_mul_f32 v196, v196, v58
  v_mul_f32 v197, v197, v58
  v_mul_f32 v198, v198, v58
  v_mul_f32 v199, v199, v58
  v_mul_f32 v192, v192, v200
  v_mul_f32 v193, v193, v201
  v_mul_f32 v194, v194, v202
  v_mul_f32 v195, v195, v203
  v_mul_f32 v196, v196, v204
  v_mul_f32 v197, v197, v205
  v_mul_f32 v198, v198, v206
  v_mul_f32 v199, v199, v207
  v_cvt_pk_bf16_f32 v84, v192, v193
  v_cvt_pk_bf16_f32 v85, v194, v195
  v_cvt_pk_bf16_f32 v86, v196, v197
  v_cvt_pk_bf16_f32 v87, v198, v199
  s_cmp_gt_u32 s54, 5
  s_cselect_b32 s97, 0xf0000000, s76
  buffer_store_dwordx4 v[84:87], v2, s[36:39], s97 offen offset:1024
  s_mov_b32 s8, 0
  s_waitcnt vmcnt(2)
  s_branch pchk_80
pl_78:
  buffer_load_dword v224, v227, s[36:39], s13 offen sc0 sc1
  s_add_u32 s8, s8, 1
  s_cmp_gt_u32 s8, 0x80000
  s_cbranch_scc1 L_abort
  s_waitcnt vmcnt(0)
pchk_80:
  v_cmp_ne_u32 vcc, 1, v224
  s_nop 3
  s_cbranch_vccnz pl_78
  s_add_u32 s87, s47, 2048
  buffer_load_dwordx4 a[0:3], v2, s[36:39], s87 offen offset:0 sc1
  buffer_load_dwordx4 a[4:7], v2, s[36:39], s87 offen offset:1024 sc1
  s_add_u32 s87, s47, 8192
  buffer_load_dwordx4 a[8:11], v2, s[36:39], s87 offen offset:0 sc1
  buffer_load_dwordx4 a[12:15], v2, s[36:39], s87 offen offset:1024 sc1
  s_add_u32 s87, s47, 14336
  buffer_load_dwordx4 a[16:19], v2, s[36:39], s87 offen offset:0 sc1
  buffer_load_dwordx4 a[20:23], v2, s[36:39], s87 offen offset:1024 sc1
  s_add_u32 s87, s47, 20480
  buffer_load_dwordx4 a[24:27], v2, s[36:39], s87 offen offset:0 sc1
  buffer_load_dwordx4 a[28:31], v2, s[36:39], s87 offen offset:1024 sc1
  s_waitcnt vmcnt(8)
  s_mov_b64 exec, 1
  buffer_store_dword v229, off, s[36:39], s55
  s_mov_b64 exec, -1
  s_barrier
  s_cmp_eq_u32 s69, 1
  s_cbranch_scc1 L_dnf
  ds_read_b128 v[96:99], v210 offset:16384
  ds_read_b128 v[100:103], v211 offset:16384
  ds_read_b128 v[104:107], v210 offset:20480
  s_waitcnt lgkmcnt(2)
  s_add_u32 s87, s47, 26624
  v_mfma_f32_32x32x16_bf16 v[112:127], v[96:99], a[128:131], v[112:127]
  buffer_load_dwordx4 a[32:35], v2, s[36:39], s87 offen offset:0 sc1
  ds_read_b128 v[108:111], v211 offset:20480
  s_waitcnt lgkmcnt(2)
  v_mfma_f32_32x32x16_bf16 v[128:143], v[100:103], a[128:131], 0
  ds_read_b128 v[96:99], v210 offset:24576
  s_waitcnt lgkmcnt(2)
  v_mfma_f32_32x32x16_bf16 v[112:127], v[104:107], a[132:135], v[112:127]
  buffer_load_dwordx4 a[36:39], v2, s[36:39], s87 offen offset:1024 sc1
  ds_read_b128 v[100:103], v211 offset:24576
  s_waitcnt lgkmcnt(2)
  v_mfma_f32_32x32x16_bf16 v[128:143], v[108:111], a[132:135], v[128:143]
  ds_read_b128 v[104:107], v210 offset:28672
  s_waitcnt lgkmcnt(2)
  s_add_u32 s87, s47, 32768
  v_mfma_f32_32x32x16_bf16 v[112:127], v[96:99], a[136:139], v[112:127]
  buffer_load_dwordx4 a[40:43], v2, s[36:39], s87 offen offset:0 sc1
  ds_read_b128 v[108:111], v211 offset:28672
  s_waitcnt lgkmcnt(2)
  v_mfma_f32_32x32x16_bf16 v[128:143], v[100:103], a[136:139], v[128:143]
  ds_read_b128 v[96:99], v210 offset:32768
  s_waitcnt lgkmcnt(2)
  v_mfma_f32_32x32x16_bf16 v[112:127], v[104:107], a[140:143], v[112:127]
  buffer_load_dwordx4 a[44:47], v2, s[36:39], s87 offen offset:1024 sc1
  ds_read_b128 v[100:103], v211 offset:32768
  s_waitcnt lgkmcnt(2)
  v_mfma_f32_32x32x16_bf16 v[128:143], v[108:111], a[140:143], v[128:143]
  ds_read_b128 v[104:107], v210 offset:36864
  s_waitcnt lgkmcnt(2)
  s_add_u32 s87, s47, 38912
  v_mfma_f32_32x32x16_bf16 v[112:127], v[96:99], a[144:147], v[112:127]
  buffer_load_dwordx4 a[48:51], v2, s[36:39], s87 offen offset:0 sc1
  ds_read_b128 v[108:111], v211 offset:36864
  s_waitcnt lgkmcnt(2)
  v_mfma_f32_32x32x16_bf16 v[128:143], v[100:103], a[144:147], v[128:143]
  ds_read_b128 v[96:99], v210 offset:40960
  s_waitcnt lgkmcnt(2)
  v_mfma_f32_32x32x16_bf16 v[112:127], v[104:107], a[148:151], v[112:127]
  buffer_load_dwordx4 a[52:55], v2, s[36:39], s87 offen offset:1024 sc1
  ds_read_b128 v[100:103], v211 offset:40960
  s_waitcnt lgkmcnt(2)
  v_mfma_f32_32x32x16_bf16 v[128:143], v[108:111], a[148:151], v[128:143]
  ds_read_b128 v[104:107], v210 offset:45056
  s_waitcnt lgkmcnt(2)
  v_mfma_f32_32x32x16_bf16 v[112:127], v[96:99], a[152:155], v[112:127]
  ds_read_b128 v[108:111], v211 offset:45056
  s_waitcnt lgkmcnt(2)
  s_add_u32 m0, s89, 45056
  s_add_u32 s88, s90, 0x1808000
  v_mfma_f32_32x32x16_bf16 v[128:143], v[100:103], a[152:155], v[128:143]
  buffer_load_dwordx4 v2, s[36:39], s88 offen sc1 lds
  ds_read_b128 v[96:99], v210 offset:49152
  buffer_load_dword v224, v227, s[36:39], s14 offen sc0 sc1
  s_waitcnt lgkmcnt(2)
  v_mfma_f32_32x32x16_bf16 v[112:127], v[104:107], a[156:159], v[112:127]
  ds_read_b128 v[100:103], v211 offset:49152
  s_waitcnt lgkmcnt(2)
  s_add_u32 m0, s89, 49152
  s_add_u32 s88, s90, 0x1808800
  v_mfma_f32_32x32x16_bf16 v[128:143], v[108:111], a[156:159], v[128:143]
  buffer_load_dwordx4 v2, s[36:39], s88 offen sc1 lds
  ds_read_b128 v[104:107], v210 offset:53248
  s_waitcnt lgkmcnt(2)
  v_mfma_f32_32x32x16_bf16 v[112:127], v[96:99], a[160:163], v[112:127]
  ds_read_b128 v[108:111], v211 offset:53248
  s_waitcnt lgkmcnt(2)
  s_add_u32 m0, s89, 53248
  s_add_u32 s88, s90, 0x180b000
  v_mfma_f32_32x32x16_bf16 v[128:143], v[100:103], a[160:163], v[128:143]
  buffer_load_dwordx4 v2, s[36:39], s88 offen sc1 lds
  ds_read_b128 v[96:99], v212 offset:12288
  s_waitcnt lgkmcnt(2)
  v_mfma_f32_32x32x16_bf16 v[112:127], v[104:107], a[164:167], v[112:127]
  ds_read_b128 v[100:103], v213 offset:12288
  s_waitcnt lgkmcnt(2)
  s_add_u32 m0, s89, 57344
  s_add_u32 s88, s90, 0x180b800
  v_mfma_f32_32x32x16_bf16 v[128:143], v[108:111], a[164:167], v[128:143]
  buffer_load_dwordx4 v2, s[36:39], s88 offen sc1 lds
  ds_read_b128 v[104:107], v212 offset:16384
  s_mov_b32 s8, 0
  s_waitcnt vmcnt(3)
  s_branch pchk_83
pl_81:
  buffer_load_dword v224, v227, s[36:39], s14 offen sc0 sc1
  s_add_u32 s8, s8, 1
  s_cmp_gt_u32 s8, 0x80000
  s_cbranch_scc1 L_abort
  s_waitcnt vmcnt(0)
pchk_83:
  v_cmp_ne_u32 vcc, 1, v224
  s_nop 3
  s_cbranch_vccnz pl_81
  s_waitcnt lgkmcnt(2)
  s_add_u32 s87, s47, 4096
  v_mfma_f32_32x32x16_bf16 v[112:127], v[96:99], a[168:171], v[112:127]
  buffer_load_dwordx4 a[56:59], v2, s[36:39], s87 offen offset:0 sc1
  ds_read_b128 v[108:111], v213 offset:16384
  s_waitcnt lgkmcnt(2)
  s_add_u32 m0, s89, 61440
  s_add_u32 s88, s90, 0x180e000
  v_mfma_f32_32x32x16_bf16 v[128:143], v[100:103], a[168:171], v[128:143]
  buffer_load_dwordx4 v2, s[36:39], s88 offen sc1 lds
  ds_read_b128 v[96:99], v212 offset:20480
  s_waitcnt lgkmcnt(2)
  v_mfma_f32_32x32x16_bf16 v[112:127], v[104:107], a[172:175], v[112:127]
  buffer_load_dwordx4 a[60:63], v2, s[36:39], s87 offen offset:1024 sc1
  ds_read_b128 v[100:103], v213 offset:20480
  s_waitcnt lgkmcnt(2)
  s_add_u32 m0, s89, 65536
  s_add_u32 s88, s90, 0x180e800
  v_mfma_f32_32x32x16_bf16 v[128:143], v[108:111], a[172:175], v[128:143]
  buffer_load_dwordx4 v2, s[36:39], s88 offen sc1 lds
  ds_read_b128 v[104:107], v212 offset:24576
  s_barrier
  s_waitcnt lgkmcnt(2)
  s_add_u32 s87, s47, 10240
  v_mfma_f32_32x32x16_bf16 v[112:127], v[96:99], a[176:179], v[112:127]
  buffer_load_dwordx4 a[64:67], v2, s[36:39], s87 offen offset:0 sc1
  ds_read_b128 v[108:111], v213 offset:24576
  s_waitcnt lgkmcnt(2)
  s_add_u32 m0, s89, 69632
  s_add_u32 s88, s90, 0x1811000
  v_mfma_f32_32x32x16_bf16 v[128:143], v[100:103], a[176:179], v[128:143]
  buffer_load_dwordx4 v2, s[36:39], s88 offen sc1 lds
  ds_read_b128 v[96:99], v212 offset:28672
  s_waitcnt lgkmcnt(2)
  v_mfma_f32_32x32x16_bf16 v[112:127], v[104:107], a[180:183], v[112:127]
  buffer_load_dwordx4 a[68:71], v2, s[36:39], s87 offen offset:1024 sc1
  ds_read_b128 v[100:103], v213 offset:28672
  s_waitcnt lgkmcnt(2)
  s_add_u32 m0, s89, 73728
  s_add_u32 s88, s90, 0x1811800
  v_mfma_f32_32x32x16_bf16 v[128:143], v[108:111], a[180:183], v[128:143]
  buffer_load_dwordx4 v2, s[36:39], s88 offen sc1 lds
  ds_read_b128 v[104:107], v212 offset:32768
  s_waitcnt lgkmcnt(2)
  s_add_u32 s87, s47, 16384
  v_mfma_f32_32x32x16_bf16 v[112:127], v[96:99], a[0:3], v[112:127]
  buffer_load_dwordx4 a[72:75], v2, s[36:39], s87 offen offset:0 sc1
  ds_read_b128 v[108:111], v213 offset:32768
  s_waitcnt lgkmcnt(2)
  s_add_u32 m0, s89, 77824
  s_add_u32 s88, s90, 0x1814000
  v_mfma_f32_32x32x16_bf16 v[128:143], v[100:103], a[0:3], v[128:143]
  buffer_load_dwordx4 v2, s[36:39], s88 offen sc1 lds
  ds_read_b128 v[96:99], v212 offset:36864
  s_waitcnt lgkmcnt(2)
  v_mfma_f32_32x32x16_bf16 v[112:127], v[104:107], a[4:7], v[112:127]
  buffer_load_dwordx4 a[76:79], v2, s[36:39], s87 offen offset:1024 sc1
  ds_read_b128 v[100:103], v213 offset:36864
  s_waitcnt lgkmcnt(2)
  s_add_u32 m0, s89, 81920
  s_add_u32 s88, s90, 0x1814800
  v_mfma_f32_32x32x16_bf16 v[128:143], v[108:111], a[4:7], v[128:143]
  buffer_load_dwordx4 v2, s[36:39], s88 offen sc1 lds
  ds_read_b128 v[104:107], v208 offset:0
  s_waitcnt lgkmcnt(2)
  s_add_u32 s87, s47, 22528
  v_mfma_f32_32x32x16_bf16 v[112:127], v[96:99], a[8:11], v[112:127]
  buffer_load_dwordx4 a[80:83], v2, s[36:39], s87 offen offset:0 sc1
  ds_read_b128 v[108:111], v209 offset:0
  s_waitcnt lgkmcnt(2)
  s_lshr_b32 s88, s3, 1
  s_mul_i32 s88, s88, 83968
  s_sub_u32 s90, s90, s88
  s_add_u32 m0, s89, 86016
  s_add_u32 s88, s90, 0x182a000
  v_mfma_f32_32x32x16_bf16 v[128:143], v[100:103], a[8:11], v[128:143]
  buffer_load_dwordx4 v2, s[36:39], s88 offen sc1 lds
  ds_read_b128 v[96:99], v208 offset:4096
  s_waitcnt lgkmcnt(2)
  v_mfma_f32_32x32x16_bf16 v[112:127], v[104:107], a[12:15], v[112:127]
  buffer_load_dwordx4 a[84:87], v2, s[36:39], s87 offen offset:1024 sc1
  ds_read_b128 v[100:103], v209 offset:4096
  s_waitcnt lgkmcnt(2)
  s_lshr_b32 s92, s10, 1
  s_mul_i32 s92, s92, 98304
  s_mul_i32 s93, s3, 3072
  s_add_u32 s92, s92, s93
  s_add_u32 m0, s93, 90112
  v_mfma_f32_32x32x16_bf16 v[128:143], v[108:111], a[12:15], v[128:143]
  buffer_load_dwordx4 v2, s[36:39], s92 offen offset:0 sc1 lds
  ds_read_b128 v[104:107], v208 offset:8192
  s_waitcnt lgkmcnt(2)
  s_add_u32 s87, s47, 28672
  v_mfma_f32_32x32x16_bf16 v[112:127], v[96:99], a[16:19], v[112:127]
  buffer_load_dwordx4 a[88:91], v2, s[36:39], s87 offen offset:0 sc1
  ds_read_b128 v[108:111], v209 offset:8192
  s_waitcnt lgkmcnt(2)
  s_add_u32 m0, s93, 90112
  v_mfma_f32_32x32x16_bf16 v[128:143], v[100:103], a[16:19], v[128:143]
  buffer_load_dwordx4 v2, s[36:39], s92 offen offset:1024 sc1 lds
  ds_read_b128 v[96:99], v208 offset:12288
  s_waitcnt lgkmcnt(2)
  v_mfma_f32_32x32x16_bf16 v[112:127], v[104:107], a[20:23], v[112:127]
  buffer_load_dwordx4 a[92:95], v2, s[36:39], s87 offen offset:1024 sc1
  ds_read_b128 v[100:103], v209 offset:12288
  s_waitcnt lgkmcnt(2)
  s_add_u32 m0, s93, 90112
  v_mfma_f32_32x32x16_bf16 v[128:143], v[108:111], a[20:23], v[128:143]
  buffer_load_dwordx4 v2, s[36:39], s92 offen offset:2048 sc1 lds
  ds_read_b128 v[104:107], v208 offset:16384
  s_add_u32 s92, s92, 12288
  s_barrier
  s_waitcnt lgkmcnt(2)
  s_add_u32 s87, s47, 34816
  v_mfma_f32_32x32x16_bf16 v[112:127], v[96:99], a[24:27], v[112:127]
  buffer_load_dwordx4 a[96:99], v2, s[36:39], s87 offen offset:0 sc1
  ds_read_b128 v[108:111], v209 offset:16384
  s_waitcnt lgkmcnt(2)
  s_add_u32 m0, s93, 135168
  v_mfma_f32_32x32x16_bf16 v[128:143], v[100:103], a[24:27], v[128:143]
  buffer_load_dwordx4 v2, s[36:39], s92 offen offset:0 sc1 lds
  ds_read_b128 v[96:99], v208 offset:20480
  s_waitcnt lgkmcnt(2)
  v_mfma_f32_32x32x16_bf16 v[112:127], v[104:107], a[28:31], v[112:127]
  buffer_load_dwordx4 a[100:103], v2, s[36:39], s87 offen offset:1024 sc1
  ds_read_b128 v[100:103], v209 offset:20480
  s_waitcnt lgkmcnt(2)
  s_add_u32 m0, s93, 135168
  v_mfma_f32_32x32x16_bf16 v[128:143], v[108:111], a[28:31], v[128:143]
  buffer_load_dwordx4 v2, s[36:39], s92 offen offset:1024 sc1 lds
  ds_read_b128 v[104:107], v208 offset:32768
  s_waitcnt lgkmcnt(2)
  s_add_u32 s87, s47, 40960
  v_mfma_f32_32x32x16_bf16 v[112:127], v[96:99], a[32:35], v[112:127]
  buffer_load_dwordx4 a[104:107], v2, s[36:39], s87 offen offset:0 sc1
  ds_read_b128 v[108:111], v209 offset:32768
  s_waitcnt lgkmcnt(2)
  s_add_u32 m0, s93, 135168
  v_mfma_f32_32x32x16_bf16 v[128:143], v[100:103], a[32:35], v[128:143]
  buffer_load_dwordx4 v2, s[36:39], s92 offen offset:2048 sc1 lds
  ds_read_b128 v[96:99], v208 offset:24576
  s_add_u32 s92, s92, 12288
  s_waitcnt lgkmcnt(2)
  v_mfma_f32_32x32x16_bf16 v[112:127], v[104:107], a[36:39], v[112:127]
  buffer_load_dwordx4 a[108:111], v2, s[36:39], s87 offen offset:1024 sc1
  ds_read_b128 v[100:103], v209 offset:24576
  s_waitcnt lgkmcnt(2)
  s_add_u32 m0, s93, 147456
  v_mfma_f32_32x32x16_bf16 v[128:143], v[108:111], a[36:39], v[128:143]
  buffer_load_dwordx4 v2, s[36:39], s92 offen offset:0 sc1 lds
  ds_read_b128 v[104:107], v208 offset:28672
  s_waitcnt lgkmcnt(2)
  s_lshr_b32 s87, s3, 1
  s_mul_i32 s87, s87, 41984
  s_sub_u32 s87, s47, s87
  s_add_u32 s87, s87, 86016
  v_mfma_f32_32x32x16_bf16 v[112:127], v[96:99], a[40:43], v[112:127]
  buffer_load_dwordx4 a[112:115], v2, s[36:39], s87 offen offset:0 sc1
  ds_read_b128 v[108:111], v209 offset:28672
  s_waitcnt lgkmcnt(2)
  s_add_u32 m0, s93, 147456
  v_mfma_f32_32x32x16_bf16 v[128:143], v[100:103], a[40:43], v[128:143]
  buffer_load_dwordx4 v2, s[36:39], s92 offen offset:1024 sc1 lds
  ds_read_b128 v[96:99], v210 offset:57344
  s_waitcnt lgkmcnt(2)
  v_mfma_f32_32x32x16_bf16 v[112:127], v[104:107], a[44:47], v[112:127]
  ds_read_b128 v[100:103], v211 offset:57344
  s_waitcnt lgkmcnt(2)
  s_add_u32 m0, s93, 147456
  v_mfma_f32_32x32x16_bf16 v[128:143], v[108:111], a[44:47], v[128:143]
  buffer_load_dwordx4 v2, s[36:39], s92 offen offset:2048 sc1 lds
  ds_read_b128 v[104:107], v212 offset:0
  s_add_u32 s92, s92, 12288
  s_waitcnt lgkmcnt(2)
  v_mfma_f32_32x32x16_bf16 v[112:127], v[96:99], a[48:51], v[112:127]
  ds_read_b128 v[108:111], v213 offset:0
  s_waitcnt lgkmcnt(2)
  v_mfma_f32_32x32x16_bf16 v[128:143], v[100:103], a[48:51], v[128:143]
  ds_read_b128 v[96:99], v212 offset:4096
  s_waitcnt lgkmcnt(2)
  v_mfma_f32_32x32x16_bf16 v[112:127], v[104:107], a[52:55], v[112:127]
  ds_read_b128 v[100:103], v213 offset:4096
  s_waitcnt lgkmcnt(2)
  v_mfma_f32_32x32x16_bf16 v[128:143], v[108:111], a[52:55], v[128:143]
  ds_read_b128 v[104:107], v212 offset:8192
  s_waitcnt vmcnt(17)
  s_barrier
  s_waitcnt lgkmcnt(2)
  v_mfma_f32_32x32x16_bf16 v[112:127], v[96:99], a[56:59], v[112:127]
  ds_read_b128 v[108:111], v213 offset:8192
  s_waitcnt lgkmcnt(2)
  s_add_u32 m0, s93, 0
  v_mfma_f32_32x32x16_bf16 v[128:143], v[100:103], a[56:59], v[128:143]
  buffer_load_dwordx4 v2, s[36:39], s92 offen offset:0 sc1 lds
  ds_read_b128 v[96:99], v208 offset:36864
  s_waitcnt lgkmcnt(2)
  v_mfma_f32_32x32x16_bf16 v[112:127], v[104:107], a[60:63], v[112:127]
  ds_read_b128 v[100:103], v209 offset:36864
  s_waitcnt lgkmcnt(2)
  s_add_u32 m0, s93, 0
  v_mfma_f32_32x32x16_bf16 v[128:143], v[108:111], a[60:63], v[128:143]
  buffer_load_dwordx4 v2, s[36:39], s92 offen offset:1024 sc1 lds
  ds_read_b128 v[104:107], v208 offset:40960
  s_waitcnt lgkmcnt(2)
  v_mfma_f32_32x32x16_bf16 v[112:127], v[96:99], a[64:67], v[112:127]
  ds_read_b128 v[108:111], v209 offset:40960
  s_waitcnt lgkmcnt(2)
  s_add_u32 m0, s93, 0
  v_mfma_f32_32x32x16_bf16 v[128:143], v[100:103], a[64:67], v[128:143]
  buffer_load_dwordx4 v2, s[36:39], s92 offen offset:2048 sc1 lds
  ds_read_b128 v[96:99], v208 offset:45056
  s_add_u32 s92, s92, 12288
  s_waitcnt lgkmcnt(2)
  v_mfma_f32_32x32x16_bf16 v[112:127], v[104:107], a[68:71], v[112:127]
  ds_read_b128 v[100:103], v209 offset:45056
  s_waitcnt lgkmcnt(2)
  s_add_u32 m0, s93, 12288
  v_mfma_f32_32x32x16_bf16 v[128:143], v[108:111], a[68:71], v[128:143]
  buffer_load_dwordx4 v2, s[36:39], s92 offen offset:0 sc1 lds
  ds_read_b128 v[104:107], v208 offset:49152
  s_waitcnt lgkmcnt(2)
  v_mfma_f32_32x32x16_bf16 v[112:127], v[96:99], a[72:75], v[112:127]
  ds_read_b128 v[108:111], v209 offset:49152
  s_waitcnt lgkmcnt(2)
  s_add_u32 m0, s93, 12288
  v_mfma_f32_32x32x16_bf16 v[128:143], v[100:103], a[72:75], v[128:143]
  buffer_load_dwordx4 v2, s[36:39], s92 offen offset:1024 sc1 lds
  ds_read_b128 v[96:99], v208 offset:53248
  s_waitcnt lgkmcnt(2)
  v_mfma_f32_32x32x16_bf16 v[112:127], v[104:107], a[76:79], v[112:127]
  ds_read_b128 v[100:103], v209 offset:53248
  s_waitcnt lgkmcnt(2)
  s_add_u32 m0, s93, 12288
  v_mfma_f32_32x32x16_bf16 v[128:143], v[108:111], a[76:79], v[128:143]
  buffer_load_dwordx4 v2, s[36:39], s92 offen offset:2048 sc1 lds
  ds_read_b128 v[104:107], v208 offset:57344
  s_add_u32 s92, s92, 12288
  s_waitcnt lgkmcnt(2)
  v_mfma_f32_32x32x16_bf16 v[112:127], v[96:99], a[80:83], v[112:127]
  ds_read_b128 v[108:111], v209 offset:57344
  s_waitcnt lgkmcnt(2)
  s_add_u32 m0, s93, 24576
  v_mfma_f32_32x32x16_bf16 v[128:143], v[100:103], a[80:83], v[128:143]
  buffer_load_dwordx4 v2, s[36:39], s92 offen offset:0 sc1 lds
  ds_read_b128 v[96:99], v210 offset:0
  s_waitcnt vmcnt(23)
  s_waitcnt lgkmcnt(2)
  v_mfma_f32_32x32x16_bf16 v[112:127], v[104:107], a[84:87], v[112:127]
  ds_read_b128 v[100:103], v211 offset:0
  s_waitcnt lgkmcnt(2)
  s_add_u32 m0, s93, 24576
  v_mfma_f32_32x32x16_bf16 v[128:143], v[108:111], a[84:87], v[128:143]
  buffer_load_dwordx4 v2, s[36:39], s92 offen offset:1024 sc1 lds
  ds_read_b128 v[104:107], v210 offset:4096
  s_waitcnt vmcnt(22)
  s_waitcnt lgkmcnt(2)
  v_mfma_f32_32x32x16_bf16 v[112:127], v[96:99], a[88:91], v[112:127]
  ds_read_b128 v[108:111], v211 offset:4096
  s_waitcnt lgkmcnt(2)
  s_add_u32 m0, s93, 24576
  v_mfma_f32_32x32x16_bf16 v[128:143], v[100:103], a[88:91], v[128:143]
  buffer_load_dwordx4 v2, s[36:39], s92 offen offset:2048 sc1 lds
  ds_read_b128 v[96:99], v210 offset:8192
  s_add_u32 s92, s92, 12288
  s_waitcnt vmcnt(21)
  s_waitcnt lgkmcnt(2)
  v_mfma_f32_32x32x16_bf16 v[112:127], v[104:107], a[92:95], v[112:127]
  ds_read_b128 v[100:103], v211 offset:8192
  s_waitcnt lgkmcnt(2)
  v_mfma_f32_32x32x16_bf16 v[128:143], v[108:111], a[92:95], v[128:143]
  ds_read_b128 v[104:107], v210 offset:12288
  s_waitcnt vmcnt(19)
  s_waitcnt lgkmcnt(2)
  v_mfma_f32_32x32x16_bf16 v[112:127], v[96:99], a[96:99], v[112:127]
  ds_read_b128 v[108:111], v211 offset:12288
  s_waitcnt lgkmcnt(2)
  v_mfma_f32_32x32x16_bf16 v[128:143], v[100:103], a[96:99], v[128:143]
  ds_read_b128 v[96:99], v210 offset:16384
  s_waitcnt vmcnt(17)
  s_waitcnt lgkmcnt(2)
  v_mfma_f32_32x32x16_bf16 v[112:127], v[104:107], a[100:103], v[112:127]
  ds_read_b128 v[100:103], v211 offset:16384
  s_waitcnt lgkmcnt(2)
  v_mfma_f32_32x32x16_bf16 v[128:143], v[108:111], a[100:103], v[128:143]
  ds_read_b128 v[104:107], v210 offset:20480
  s_waitcnt vmcnt(15)
  s_waitcnt lgkmcnt(2)
  v_mfma_f32_32x32x16_bf16 v[112:127], v[96:99], a[104:107], v[112:127]
  ds_read_b128 v[108:111], v211 offset:20480
  s_waitcnt lgkmcnt(2)
  v_mfma_f32_32x32x16_bf16 v[128:143], v[100:103], a[104:107], v[128:143]
  ds_read_b128 v[96:99], v210 offset:24576
  s_waitcnt vmcnt(13)
  s_waitcnt lgkmcnt(2)
  v_mfma_f32_32x32x16_bf16 v[112:127], v[104:107], a[108:111], v[112:127]
  ds_read_b128 v[100:103], v211 offset:24576
  s_waitcnt lgkmcnt(2)
  v_mfma_f32_32x32x16_bf16 v[128:143], v[108:111], a[108:111], v[128:143]
  s_waitcnt vmcnt(11)
  s_waitcnt lgkmcnt(1)
  v_mfma_f32_32x32x16_bf16 v[112:127], v[96:99], a[112:115], v[112:127]
  s_waitcnt lgkmcnt(0)
  v_mfma_f32_32x32x16_bf16 v[128:143], v[100:103], a[112:115], v[128:143]
  s_nop 11
  ds_write_b128 v214, v[128:131] offset:0
  ds_write_b128 v214, v[132:135] offset:1024
  ds_write_b128 v214, v[136:139] offset:2048
  ds_write_b128 v214, v[140:143] offset:3072
  s_waitcnt lgkmcnt(0)
  s_barrier
  ds_read_b128 v[128:131], v215 offset:0
  ds_read_b128 v[132:135], v215 offset:1024
  ds_read_b128 v[136:139], v215 offset:2048
  ds_read_b128 v[140:143], v215 offset:3072
  s_add_u32 m0, s93, 36864
  s_nop 0
  buffer_load_dwordx4 v2, s[36:39], s92 offen offset:0 sc1 lds
  s_add_u32 m0, s93, 36864
  s_nop 0
  buffer_load_dwordx4 v2, s[36:39], s92 offen offset:1024 sc1 lds
  s_waitcnt lgkmcnt(3)
  v_pk_add_f32 v[112:113], v[112:113], v[128:129]
  v_pk_add_f32 v[114:115], v[114:115], v[130:131]
  v_cvt_pk_bf16_f32 v248, v112, v113
  v_cvt_pk_bf16_f32 v249, v114, v115
  v_pk_add_f32 v[90:91], v[112:113], v[114:115]
  v_pk_mul_f32 v[92:93], v[112:113], v[112:113]
  v_pk_fma_f32 v[92:93], v[114:115], v[114:115], v[92:93]
  s_waitcnt lgkmcnt(2)
  v_pk_add_f32 v[116:117], v[116:117], v[132:133]
  v_pk_add_f32 v[118:119], v[118:119], v[134:135]
  v_cvt_pk_bf16_f32 v250, v116, v117
  v_cvt_pk_bf16_f32 v251, v118, v119
  buffer_store_dwordx4 v[248:251], v2, s[36:39], s44 offen offset:0
  v_pk_add_f32 v[90:91], v[90:91], v[116:117]
  v_pk_fma_f32 v[92:93], v[116:117], v[116:117], v[92:93]
  v_pk_add_f32 v[90:91], v[90:91], v[118:119]
  v_pk_fma_f32 v[92:93], v[118:119], v[118:119], v[92:93]
  s_waitcnt lgkmcnt(1)
  v_pk_add_f32 v[120:121], v[120:121], v[136:137]
  v_pk_add_f32 v[122:123], v[122:123], v[138:139]
  v_cvt_pk_bf16_f32 v252, v120, v121
  v_cvt_pk_bf16_f32 v253, v122, v123
  v_pk_add_f32 v[90:91], v[90:91], v[120:121]
  v_pk_fma_f32 v[92:93], v[120:121], v[120:121], v[92:93]
  v_pk_add_f32 v[90:91], v[90:91], v[122:123]
  v_pk_fma_f32 v[92:93], v[122:123], v[122:123], v[92:93]
  s_waitcnt lgkmcnt(0)
  v_pk_add_f32 v[124:125], v[124:125], v[140:141]
  v_pk_add_f32 v[126:127], v[126:127], v[142:143]
  v_cvt_pk_bf16_f32 v254, v124, v125
  v_cvt_pk_bf16_f32 v255, v126, v127
  buffer_store_dwordx4 v[252:255], v2, s[36:39], s44 offen offset:1024
  v_pk_add_f32 v[90:91], v[90:91], v[124:125]
  v_pk_fma_f32 v[92:93], v[124:125], v[124:125], v[92:93]
  v_pk_add_f32 v[90:91], v[90:91], v[126:127]
  v_pk_fma_f32 v[92:93], v[126:127], v[126:127], v[92:93]
  v_add_f32 v90, v90, v91
  v_add_f32 v91, v92, v93
  v_mov_b32 v92, v90
  v_mov_b32 v93, v91
  s_nop 0
  v_permlane32_swap_b32 v90, v92
  v_permlane32_swap_b32 v91, v93
  s_mov_b32 exec_hi, 0
  v_pk_add_f32 v[90:91], v[90:91], v[92:93]
  buffer_store_dwordx2 v[90:91], v2, s[36:39], s45 offen
  s_mov_b32 exec_hi, -1
  s_add_u32 m0, s93, 36864
  s_nop 0
  buffer_load_dwordx4 v2, s[36:39], s92 offen offset:2048 sc1 lds
  s_add_u32 s92, s92, 12288
  s_add_u32 m0, s93, 49152
  s_nop 0
  buffer_load_dwordx4 v2, s[36:39], s92 offen offset:0 sc1 lds
  s_add_u32 m0, s93, 49152
  s_nop 0
  buffer_load_dwordx4 v2, s[36:39], s92 offen offset:1024 sc1 lds
  s_add_u32 m0, s93, 49152
  s_nop 0
  buffer_load_dwordx4 v2, s[36:39], s92 offen offset:2048 sc1 lds
  s_waitcnt vmcnt(4)
  s_mov_b64 exec, 1
  buffer_store_dword v229, off, s[36:39], s12
  s_mov_b64 exec, -1
  s_add_u32 s68, s68, 0x8000
  s_add_u32 s69, s69, 1
  s_add_u32 s96, s57, 0x2000
  s_add_u32 s48, s48, 0x8000
  s_add_u32 s49, s49, 0x8000
  s_add_u32 s50, s50, 0x8000
  s_add_u32 s55, s55, 0x8000
  s_add_u32 s57, s57, 0x8000
  s_branch L_layer
L_dnf:
  ds_read_b128 v[96:99], v210 offset:16384
  ds_read_b128 v[100:103], v211 offset:16384
  ds_read_b128 v[104:107], v210 offset:20480
  s_waitcnt lgkmcnt(2)
  s_add_u32 s87, s47, 26624
  v_mfma_f32_32x32x16_bf16 v[112:127], v[96:99], a[128:131], v[112:127]
  buffer_load_dwordx4 a[32:35], v2, s[36:39], s87 offen offset:0 sc1
  ds_read_b128 v[108:111], v211 offset:20480
  s_waitcnt lgkmcnt(2)
  v_mfma_f32_32x32x16_bf16 v[128:143], v[100:103], a[128:131], 0
  ds_read_b128 v[96:99], v210 offset:24576
  s_waitcnt lgkmcnt(2)
  v_mfma_f32_32x32x16_bf16 v[112:127], v[104:107], a[132:135], v[112:127]
  buffer_load_dwordx4 a[36:39], v2, s[36:39], s87 offen offset:1024 sc1
  ds_read_b128 v[100:103], v211 offset:24576
  s_waitcnt lgkmcnt(2)
  v_mfma_f32_32x32x16_bf16 v[128:143], v[108:111], a[132:135], v[128:143]
  ds_read_b128 v[104:107], v210 offset:28672
  s_waitcnt lgkmcnt(2)
  s_add_u32 s87, s47, 32768
  v_mfma_f32_32x32x16_bf16 v[112:127], v[96:99], a[136:139], v[112:127]
  buffer_load_dwordx4 a[40:43], v2, s[36:39], s87 offen offset:0 sc1
  ds_read_b128 v[108:111], v211 offset:28672
  s_waitcnt lgkmcnt(2)
  v_mfma_f32_32x32x16_bf16 v[128:143], v[100:103], a[136:139], v[128:143]
  ds_read_b128 v[96:99], v210 offset:32768
  s_waitcnt lgkmcnt(2)
  v_mfma_f32_32x32x16_bf16 v[112:127], v[104:107], a[140:143], v[112:127]
  buffer_load_dwordx4 a[44:47], v2, s[36:39], s87 offen offset:1024 sc1
  ds_read_b128 v[100:103], v211 offset:32768
  s_waitcnt lgkmcnt(2)
  v_mfma_f32_32x32x16_bf16 v[128:143], v[108:111], a[140:143], v[128:143]
  ds_read_b128 v[104:107], v210 offset:36864
  s_waitcnt lgkmcnt(2)
  s_add_u32 s87, s47, 38912
  v_mfma_f32_32x32x16_bf16 v[112:127], v[96:99], a[144:147], v[112:127]
  buffer_load_dwordx4 a[48:51], v2, s[36:39], s87 offen offset:0 sc1
  ds_read_b128 v[108:111], v211 offset:36864
  s_waitcnt lgkmcnt(2)
  v_mfma_f32_32x32x16_bf16 v[128:143], v[100:103], a[144:147], v[128:143]
  ds_read_b128 v[96:99], v210 offset:40960
  s_waitcnt lgkmcnt(2)
  v_mfma_f32_32x32x16_bf16 v[112:127], v[104:107], a[148:151], v[112:127]
  buffer_load_dwordx4 a[52:55], v2, s[36:39], s87 offen offset:1024 sc1
  ds_read_b128 v[100:103], v211 offset:40960
  s_waitcnt lgkmcnt(2)
  v_mfma_f32_32x32x16_bf16 v[128:143], v[108:111], a[148:151], v[128:143]
  ds_read_b128 v[104:107], v210 offset:45056
  s_waitcnt lgkmcnt(2)
  v_mfma_f32_32x32x16_bf16 v[112:127], v[96:99], a[152:155], v[112:127]
  ds_read_b128 v[108:111], v211 offset:45056
  s_waitcnt lgkmcnt(2)
  s_add_u32 m0, s89, 45056
  s_add_u32 s88, s90, 0x1808000
  v_mfma_f32_32x32x16_bf16 v[128:143], v[100:103], a[152:155], v[128:143]
  buffer_load_dwordx4 v2, s[36:39], s88 offen sc1 lds
  ds_read_b128 v[96:99], v210 offset:49152
  buffer_load_dword v224, v227, s[36:39], s14 offen sc0 sc1
  s_waitcnt lgkmcnt(2)
  v_mfma_f32_32x32x16_bf16 v[112:127], v[104:107], a[156:159], v[112:127]
  ds_read_b128 v[100:103], v211 offset:49152
  s_waitcnt lgkmcnt(2)
  s_add_u32 m0, s89, 49152
  s_add_u32 s88, s90, 0x1808800
  v_mfma_f32_32x32x16_bf16 v[128:143], v[108:111], a[156:159], v[128:143]
  buffer_load_dwordx4 v2, s[36:39], s88 offen sc1 lds
  ds_read_b128 v[104:107], v210 offset:53248
  s_waitcnt lgkmcnt(2)
  v_mfma_f32_32x32x16_bf16 v[112:127], v[96:99], a[160:163], v[112:127]
  ds_read_b128 v[108:111], v211 offset:53248
  s_waitcnt lgkmcnt(2)
  s_add_u32 m0, s89, 53248
  s_add_u32 s88, s90, 0x180b000
  v_mfma_f32_32x32x16_bf16 v[128:143], v[100:103], a[160:163], v[128:143]
  buffer_load_dwordx4 v2, s[36:39], s88 offen sc1 lds
  ds_read_b128 v[96:99], v212 offset:12288
  s_waitcnt lgkmcnt(2)
  v_mfma_f32_32x32x16_bf16 v[112:127], v[104:107], a[164:167], v[112:127]
  ds_read_b128 v[100:103], v213 offset:12288
  s_waitcnt lgkmcnt(2)
  s_add_u32 m0, s89, 57344
  s_add_u32 s88, s90, 0x180b800
  v_mfma_f32_32x32x16_bf16 v[128:143], v[108:111], a[164:167], v[128:143]
  buffer_load_dwordx4 v2, s[36:39], s88 offen sc1 lds
  ds_read_b128 v[104:107], v212 offset:16384
  s_mov_b32 s8, 0
  s_waitcnt vmcnt(3)
  s_branch pchk_86
pl_84:
  buffer_load_dword v224, v227, s[36:39], s14 offen sc0 sc1
  s_add_u32 s8, s8, 1
  s_cmp_gt_u32 s8, 0x80000
  s_cbranch_scc1 L_abort
  s_waitcnt vmcnt(0)
pchk_86:
  v_cmp_ne_u32 vcc, 1, v224
  s_nop 3
  s_cbranch_vccnz pl_84
  s_waitcnt lgkmcnt(2)
  s_add_u32 s87, s47, 4096
  v_mfma_f32_32x32x16_bf16 v[112:127], v[96:99], a[168:171], v[112:127]
  buffer_load_dwordx4 a[56:59], v2, s[36:39], s87 offen offset:0 sc1
  ds_read_b128 v[108:111], v213 offset:16384
  s_waitcnt lgkmcnt(2)
  s_add_u32 m0, s89, 61440
  s_add_u32 s88, s90, 0x180e000
  v_mfma_f32_32x32x16_bf16 v[128:143], v[100:103], a[168:171], v[128:143]
  buffer_load_dwordx4 v2, s[36:39], s88 offen sc1 lds
  ds_read_b128 v[96:99], v212 offset:20480
  s_waitcnt lgkmcnt(2)
  v_mfma_f32_32x32x16_bf16 v[112:127], v[104:107], a[172:175], v[112:127]
  buffer_load_dwordx4 a[60:63], v2, s[36:39], s87 offen offset:1024 sc1
  ds_read_b128 v[100:103], v213 offset:20480
  s_waitcnt lgkmcnt(2)
  s_add_u32 m0, s89, 65536
  s_add_u32 s88, s90, 0x180e800
  v_mfma_f32_32x32x16_bf16 v[128:143], v[108:111], a[172:175], v[128:143]
  buffer_load_dwordx4 v2, s[36:39], s88 offen sc1 lds
  ds_read_b128 v[104:107], v212 offset:24576
  s_barrier
  s_waitcnt lgkmcnt(2)
  s_add_u32 s87, s47, 10240
  v_mfma_f32_32x32x16_bf16 v[112:127], v[96:99], a[176:179], v[112:127]
  buffer_load_dwordx4 a[64:67], v2, s[36:39], s87 offen offset:0 sc1
  ds_read_b128 v[108:111], v213 offset:24576
  s_waitcnt lgkmcnt(2)
  s_add_u32 m0, s89, 69632
  s_add_u32 s88, s90, 0x1811000
  v_mfma_f32_32x32x16_bf16 v[128:143], v[100:103], a[176:179], v[128:143]
  buffer_load_dwordx4 v2, s[36:39], s88 offen sc1 lds
  ds_read_b128 v[96:99], v212 offset:28672
  s_waitcnt lgkmcnt(2)
  v_mfma_f32_32x32x16_bf16 v[112:127], v[104:107], a[180:183], v[112:127]
  buffer_load_dwordx4 a[68:71], v2, s[36:39], s87 offen offset:1024 sc1
  ds_read_b128 v[100:103], v213 offset:28672
  s_waitcnt lgkmcnt(2)
  s_add_u32 m0, s89, 73728
  s_add_u32 s88, s90, 0x1811800
  v_mfma_f32_32x32x16_bf16 v[128:143], v[108:111], a[180:183], v[128:143]
  buffer_load_dwordx4 v2, s[36:39], s88 offen sc1 lds
  ds_read_b128 v[104:107], v212 offset:32768
  s_waitcnt lgkmcnt(2)
  s_add_u32 s87, s47, 16384
  v_mfma_f32_32x32x16_bf16 v[112:127], v[96:99], a[0:3], v[112:127]
  buffer_load_dwordx4 a[72:75], v2, s[36:39], s87 offen offset:0 sc1
  ds_read_b128 v[108:111], v213 offset:32768
  s_waitcnt lgkmcnt(2)
  s_add_u32 m0, s89, 77824
  s_add_u32 s88, s90, 0x1814000
  v_mfma_f32_32x32x16_bf16 v[128:143], v[100:103], a[0:3], v[128:143]
  buffer_load_dwordx4 v2, s[36:39], s88 offen sc1 lds
  ds_read_b128 v[96:99], v212 offset:36864
  s_waitcnt lgkmcnt(2)
  v_mfma_f32_32x32x16_bf16 v[112:127], v[104:107], a[4:7], v[112:127]
  buffer_load_dwordx4 a[76:79], v2, s[36:39], s87 offen offset:1024 sc1
  ds_read_b128 v[100:103], v213 offset:36864
  s_waitcnt lgkmcnt(2)
  s_add_u32 m0, s89, 81920
  s_add_u32 s88, s90, 0x1814800
  v_mfma_f32_32x32x16_bf16 v[128:143], v[108:111], a[4:7], v[128:143]
  buffer_load_dwordx4 v2, s[36:39], s88 offen sc1 lds
  ds_read_b128 v[104:107], v208 offset:0
  s_waitcnt lgkmcnt(2)
  s_add_u32 s87, s47, 22528
  v_mfma_f32_32x32x16_bf16 v[112:127], v[96:99], a[8:11], v[112:127]
  buffer_load_dwordx4 a[80:83], v2, s[36:39], s87 offen offset:0 sc1
  ds_read_b128 v[108:111], v209 offset:0
  s_waitcnt lgkmcnt(2)
  s_lshr_b32 s88, s3, 1
  s_mul_i32 s88, s88, 83968
  s_sub_u32 s90, s90, s88
  s_add_u32 m0, s89, 86016
  s_add_u32 s88, s90, 0x182a000
  v_mfma_f32_32x32x16_bf16 v[128:143], v[100:103], a[8:11], v[128:143]
  buffer_load_dwordx4 v2, s[36:39], s88 offen sc1 lds
  ds_read_b128 v[96:99], v208 offset:4096
  s_waitcnt lgkmcnt(2)
  v_mfma_f32_32x32x16_bf16 v[112:127], v[104:107], a[12:15], v[112:127]
  buffer_load_dwordx4 a[84:87], v2, s[36:39], s87 offen offset:1024 sc1
  ds_read_b128 v[100:103], v209 offset:4096
  s_waitcnt lgkmcnt(2)
  v_mfma_f32_32x32x16_bf16 v[128:143], v[108:111], a[12:15], v[128:143]
  ds_read_b128 v[104:107], v208 offset:8192
  s_waitcnt lgkmcnt(2)
  s_add_u32 s87, s47, 28672
  v_mfma_f32_32x32x16_bf16 v[112:127], v[96:99], a[16:19], v[112:127]
  buffer_load_dwordx4 a[88:91], v2, s[36:39], s87 offen offset:0 sc1
  ds_read_b128 v[108:111], v209 offset:8192
  s_waitcnt lgkmcnt(2)
  v_mfma_f32_32x32x16_bf16 v[128:143], v[100:103], a[16:19], v[128:143]
  ds_read_b128 v[96:99], v208 offset:12288
  s_waitcnt lgkmcnt(2)
  v_mfma_f32_32x32x16_bf16 v[112:127], v[104:107], a[20:23], v[112:127]
  buffer_load_dwordx4 a[92:95], v2, s[36:39], s87 offen offset:1024 sc1
  ds_read_b128 v[100:103], v209 offset:12288
  s_waitcnt lgkmcnt(2)
  v_mfma_f32_32x32x16_bf16 v[128:143], v[108:111], a[20:23], v[128:143]
  ds_read_b128 v[104:107], v208 offset:16384
  s_waitcnt lgkmcnt(2)
  s_add_u32 s87, s47, 34816
  v_mfma_f32_32x32x16_bf16 v[112:127], v[96:99], a[24:27], v[112:127]
  buffer_load_dwordx4 a[96:99], v2, s[36:39], s87 offen offset:0 sc1
  ds_read_b128 v[108:111], v209 offset:16384
  s_waitcnt lgkmcnt(2)
  v_mfma_f32_32x32x16_bf16 v[128:143], v[100:103], a[24:27], v[128:143]
  ds_read_b128 v[96:99], v208 offset:20480
  s_waitcnt lgkmcnt(2)
  v_mfma_f32_32x32x16_bf16 v[112:127], v[104:107], a[28:31], v[112:127]
  buffer_load_dwordx4 a[100:103], v2, s[36:39], s87 offen offset:1024 sc1
  ds_read_b128 v[100:103], v209 offset:20480
  s_waitcnt lgkmcnt(2)
  v_mfma_f32_32x32x16_bf16 v[128:143], v[108:111], a[28:31], v[128:143]
  ds_read_b128 v[104:107], v208 offset:32768
  s_waitcnt lgkmcnt(2)
  s_add_u32 s87, s47, 40960
  v_mfma_f32_32x32x16_bf16 v[112:127], v[96:99], a[32:35], v[112:127]
  buffer_load_dwordx4 a[104:107], v2, s[36:39], s87 offen offset:0 sc1
  ds_read_b128 v[108:111], v209 offset:32768
  s_waitcnt lgkmcnt(2)
  v_mfma_f32_32x32x16_bf16 v[128:143], v[100:103], a[32:35], v[128:143]
  ds_read_b128 v[96:99], v208 offset:24576
  s_waitcnt lgkmcnt(2)
  v_mfma_f32_32x32x16_bf16 v[112:127], v[104:107], a[36:39], v[112:127]
  buffer_load_dwordx4 a[108:111], v2, s[36:39], s87 offen offset:1024 sc1
  ds_read_b128 v[100:103], v209 offset:24576
  s_waitcnt lgkmcnt(2)
  v_mfma_f32_32x32x16_bf16 v[128:143], v[108:111], a[36:39], v[128:143]
  ds_read_b128 v[104:107], v208 offset:28672
  s_waitcnt lgkmcnt(2)
  s_lshr_b32 s87, s3, 1
  s_mul_i32 s87, s87, 41984
  s_sub_u32 s87, s47, s87
  s_add_u32 s87, s87, 86016
  v_mfma_f32_32x32x16_bf16 v[112:127], v[96:99], a[40:43], v[112:127]
  buffer_load_dwordx4 a[112:115], v2, s[36:39], s87 offen offset:0 sc1
  ds_read_b128 v[108:111], v209 offset:28672
  s_waitcnt lgkmcnt(2)
  v_mfma_f32_32x32x16_bf16 v[128:143], v[100:103], a[40:43], v[128:143]
  ds_read_b128 v[96:99], v210 offset:57344
  s_waitcnt lgkmcnt(2)
  v_mfma_f32_32x32x16_bf16 v[112:127], v[104:107], a[44:47], v[112:127]
  ds_read_b128 v[100:103], v211 offset:57344
  s_waitcnt lgkmcnt(2)
  v_mfma_f32_32x32x16_bf16 v[128:143], v[108:111], a[44:47], v[128:143]
  ds_read_b128 v[104:107], v212 offset:0
  s_waitcnt lgkmcnt(2)
  v_mfma_f32_32x32x16_bf16 v[112:127], v[96:99], a[48:51], v[112:127]
  ds_read_b128 v[108:111], v213 offset:0
  s_waitcnt lgkmcnt(2)
  v_mfma_f32_32x32x16_bf16 v[128:143], v[100:103], a[48:51], v[128:143]
  ds_read_b128 v[96:99], v212 offset:4096
  s_waitcnt lgkmcnt(2)
  v_mfma_f32_32x32x16_bf16 v[112:127], v[104:107], a[52:55], v[112:127]
  ds_read_b128 v[100:103], v213 offset:4096
  s_waitcnt lgkmcnt(2)
  v_mfma_f32_32x32x16_bf16 v[128:143], v[108:111], a[52:55], v[128:143]
  ds_read_b128 v[104:107], v212 offset:8192
  s_waitcnt vmcnt(8)
  s_barrier
  s_waitcnt lgkmcnt(2)
  v_mfma_f32_32x32x16_bf16 v[112:127], v[96:99], a[56:59], v[112:127]
  ds_read_b128 v[108:111], v213 offset:8192
  s_waitcnt lgkmcnt(2)
  v_mfma_f32_32x32x16_bf16 v[128:143], v[100:103], a[56:59], v[128:143]
  ds_read_b128 v[96:99], v208 offset:36864
  s_waitcnt lgkmcnt(2)
  v_mfma_f32_32x32x16_bf16 v[112:127], v[104:107], a[60:63], v[112:127]
  ds_read_b128 v[100:103], v209 offset:36864
  s_waitcnt lgkmcnt(2)
  v_mfma_f32_32x32x16_bf16 v[128:143], v[108:111], a[60:63], v[128:143]
  ds_read_b128 v[104:107], v208 offset:40960
  s_waitcnt lgkmcnt(2)
  v_mfma_f32_32x32x16_bf16 v[112:127], v[96:99], a[64:67], v[112:127]
  ds_read_b128 v[108:111], v209 offset:40960
  s_waitcnt lgkmcnt(2)
  v_mfma_f32_32x32x16_bf16 v[128:143], v[100:103], a[64:67], v[128:143]
  ds_read_b128 v[96:99], v208 offset:45056
  s_waitcnt lgkmcnt(2)
  v_mfma_f32_32x32x16_bf16 v[112:127], v[104:107], a[68:71], v[112:127]
  ds_read_b128 v[100:103], v209 offset:45056
  s_waitcnt lgkmcnt(2)
  v_mfma_f32_32x32x16_bf16 v[128:143], v[108:111], a[68:71], v[128:143]
  ds_read_b128 v[104:107], v208 offset:49152
  s_waitcnt lgkmcnt(2)
  v_mfma_f32_32x32x16_bf16 v[112:127], v[96:99], a[72:75], v[112:127]
  ds_read_b128 v[108:111], v209 offset:49152
  s_waitcnt lgkmcnt(2)
  v_mfma_f32_32x32x16_bf16 v[128:143], v[100:103], a[72:75], v[128:143]
  ds_read_b128 v[96:99], v208 offset:53248
  s_waitcnt lgkmcnt(2)
  v_mfma_f32_32x32x16_bf16 v[112:127], v[104:107], a[76:79], v[112:127]
  ds_read_b128 v[100:103], v209 offset:53248
  s_waitcnt lgkmcnt(2)
  v_mfma_f32_32x32x16_bf16 v[128:143], v[108:111], a[76:79], v[128:143]
  ds_read_b128 v[104:107], v208 offset:57344
  s_waitcnt lgkmcnt(2)
  v_mfma_f32_32x32x16_bf16 v[112:127], v[96:99], a[80:83], v[112:127]
  ds_read_b128 v[108:111], v209 offset:57344
  s_waitcnt lgkmcnt(2)
  v_mfma_f32_32x32x16_bf16 v[128:143], v[100:103], a[80:83], v[128:143]
  ds_read_b128 v[96:99], v210 offset:0
  s_waitcnt vmcnt(7)
  s_waitcnt lgkmcnt(2)
  v_mfma_f32_32x32x16_bf16 v[112:127], v[104:107], a[84:87], v[112:127]
  ds_read_b128 v[100:103], v211 offset:0
  s_waitcnt lgkmcnt(2)
  v_mfma_f32_32x32x16_bf16 v[128:143], v[108:111], a[84:87], v[128:143]
  ds_read_b128 v[104:107], v210 offset:4096
  s_waitcnt vmcnt(6)
  s_waitcnt lgkmcnt(2)
  v_mfma_f32_32x32x16_bf16 v[112:127], v[96:99], a[88:91], v[112:127]
  ds_read_b128 v[108:111], v211 offset:4096
  s_waitcnt lgkmcnt(2)
  v_mfma_f32_32x32x16_bf16 v[128:143], v[100:103], a[88:91], v[128:143]
  ds_read_b128 v[96:99], v210 offset:8192
  s_waitcnt vmcnt(5)
  s_waitcnt lgkmcnt(2)
  v_mfma_f32_32x32x16_bf16 v[112:127], v[104:107], a[92:95], v[112:127]
  ds_read_b128 v[100:103], v211 offset:8192
  s_waitcnt lgkmcnt(2)
  v_mfma_f32_32x32x16_bf16 v[128:143], v[108:111], a[92:95], v[128:143]
  ds_read_b128 v[104:107], v210 offset:12288
  s_waitcnt vmcnt(4)
  s_waitcnt lgkmcnt(2)
  v_mfma_f32_32x32x16_bf16 v[112:127], v[96:99], a[96:99], v[112:127]
  ds_read_b128 v[108:111], v211 offset:12288
  s_waitcnt lgkmcnt(2)
  v_mfma_f32_32x32x16_bf16 v[128:143], v[100:103], a[96:99], v[128:143]
  ds_read_b128 v[96:99], v210 offset:16384
  s_waitcnt vmcnt(3)
  s_waitcnt lgkmcnt(2)
  v_mfma_f32_32x32x16_bf16 v[112:127], v[104:107], a[100:103], v[112:127]
  ds_read_b128 v[100:103], v211 offset:16384
  s_waitcnt lgkmcnt(2)
  v_mfma_f32_32x32x16_bf16 v[128:143], v[108:111], a[100:103], v[128:143]
  ds_read_b128 v[104:107], v210 offset:20480
  s_waitcnt vmcnt(2)
  s_waitcnt lgkmcnt(2)
  v_mfma_f32_32x32x16_bf16 v[112:127], v[96:99], a[104:107], v[112:127]
  ds_read_b128 v[108:111], v211 offset:20480
  s_waitcnt lgkmcnt(2)
  v_mfma_f32_32x32x16_bf16 v[128:143], v[100:103], a[104:107], v[128:143]
  ds_read_b128 v[96:99], v210 offset:24576
  s_waitcnt vmcnt(1)
  s_waitcnt lgkmcnt(2)
  v_mfma_f32_32x32x16_bf16 v[112:127], v[104:107], a[108:111], v[112:127]
  ds_read_b128 v[100:103], v211 offset:24576
  s_waitcnt lgkmcnt(2)
  v_mfma_f32_32x32x16_bf16 v[128:143], v[108:111], a[108:111], v[128:143]
  s_waitcnt vmcnt(0)
  s_waitcnt lgkmcnt(1)
  v_mfma_f32_32x32x16_bf16 v[112:127], v[96:99], a[112:115], v[112:127]
  s_waitcnt lgkmcnt(0)
  v_mfma_f32_32x32x16_bf16 v[128:143], v[100:103], a[112:115], v[128:143]
  s_nop 11
  ds_write_b128 v214, v[128:131] offset:0
  ds_write_b128 v214, v[132:135] offset:1024
  ds_write_b128 v214, v[136:139] offset:2048
  ds_write_b128 v214, v[140:143] offset:3072
  s_waitcnt lgkmcnt(0)
  s_barrier
  ds_read_b128 v[128:131], v215 offset:0
  ds_read_b128 v[132:135], v215 offset:1024
  ds_read_b128 v[136:139], v215 offset:2048
  ds_read_b128 v[140:143], v215 offset:3072
  s_waitcnt lgkmcnt(3)
  v_pk_add_f32 v[112:113], v[112:113], v[128:129]
  v_pk_add_f32 v[114:115], v[114:115], v[130:131]
  v_cvt_pk_bf16_f32 v248, v112, v113
  v_cvt_pk_bf16_f32 v249, v114, v115
  s_waitcnt lgkmcnt(2)
  v_pk_add_f32 v[116:117], v[116:117], v[132:133]
  v_pk_add_f32 v[118:119], v[118:119], v[134:135]
  v_cvt_pk_bf16_f32 v250, v116, v117
  v_cvt_pk_bf16_f32 v251, v118, v119
L_final:
  s_waitcnt lgkmcnt(1)
  v_pk_add_f32 v[120:121], v[120:121], v[136:137]
  v_pk_add_f32 v[122:123], v[122:123], v[138:139]
  v_cvt_pk_bf16_f32 v252, v120, v121
  v_cvt_pk_bf16_f32 v253, v122, v123
  s_waitcnt lgkmcnt(0)
  v_pk_add_f32 v[124:125], v[124:125], v[140:141]
  v_pk_add_f32 v[126:127], v[126:127], v[142:143]
  v_cvt_pk_bf16_f32 v254, v124, v125
  v_cvt_pk_bf16_f32 v255, v126, v127
  s_sub_u32 s86, s44, 0x800000
  s_and_b32 s87, s86, 0xffff8000
  s_bfe_u32 s86, s86, 0x4000b
  s_lshl_b32 s86, s86, 6
  s_add_u32 s87, s87, s86
  v_permlane32_swap_b32 v248, v250
  v_permlane32_swap_b32 v249, v251
  ds_write_b128 v90, v[248:251] offset:0
  v_permlane32_swap_b32 v252, v254
  v_permlane32_swap_b32 v253, v255
  ds_write_b128 v90, v[252:255] offset:32
  ds_read_b128 v[128:131], v91 offset:0
  ds_read_b128 v[132:135], v91 offset:1280
  s_add_u32 s86, s87, 16384
  s_waitcnt lgkmcnt(1)
  buffer_store_dwordx4 v[128:131], v92, s[64:67], s87 offen
  s_waitcnt lgkmcnt(0)
  buffer_store_dwordx4 v[132:135], v92, s[64:67], s86 offen
  s_endpgm
L_aslow:
  v_mov_b32 v136, 0xff800000
  v_mov_b32 v137, 0xff800000
  s_mov_b32 s78, 0
  s_mov_b32 s74, 0
L_aslow_mx:
  buffer_load_dwordx4 v[12:15], v2, s[12:15], s74 offen sc1
  s_add_u32 s74, s74, 2048
  s_waitcnt vmcnt(0)
  v_mfma_f32_32x32x16_bf16 v[40:55], v[12:15], v[4:7], 0
  v_mfma_f32_32x32x16_bf16 v[56:71], v[12:15], v[8:11], 0
  s_nop 15
  v_max3_f32 v136, v40, v41, v136
  v_max3_f32 v136, v42, v43, v136
  v_max3_f32 v136, v44, v45, v136
  v_max3_f32 v136, v46, v47, v136
  v_max3_f32 v136, v48, v49, v136
  v_max3_f32 v136, v50, v51, v136
  v_max3_f32 v136, v52, v53, v136
  v_max3_f32 v136, v54, v55, v136
  v_max3_f32 v137, v56, v57, v137
  v_max3_f32 v137, v58, v59, v137
  v_max3_f32 v137, v60, v61, v137
  v_max3_f32 v137, v62, v63, v137
  v_max3_f32 v137, v64, v65, v137
  v_max3_f32 v137, v66, v67, v137
  v_max3_f32 v137, v68, v69, v137
  v_max3_f32 v137, v70, v71, v137
  s_add_u32 s78, s78, 1
  s_cmp_lt_u32 s78, 64
  s_cbranch_scc1 L_aslow_mx
  v_mov_b32 v138, v136
  s_nop 1
  v_permlane32_swap_b32 v136, v138
  s_nop 0
  v_max_f32 v136, v136, v138
  v_sub_f32 v104, 0, v136
  v_sub_f32 v105, 0, v136
  v_sub_f32 v106, 0, v136
  v_sub_f32 v107, 0, v136
  v_sub_f32 v108, 0, v136
  v_sub_f32 v109, 0, v136
  v_sub_f32 v110, 0, v136
  v_sub_f32 v111, 0, v136
  v_sub_f32 v112, 0, v136
  v_sub_f32 v113, 0, v136
  v_sub_f32 v114, 0, v136
  v_sub_f32 v115, 0, v136
  v_sub_f32 v116, 0, v136
  v_sub_f32 v117, 0, v136
  v_sub_f32 v118, 0, v136
  v_sub_f32 v119, 0, v136
  v_mov_b32 v138, v137
  s_nop 1
  v_permlane32_swap_b32 v137, v138
  s_nop 0
  v_max_f32 v137, v137, v138
  v_sub_f32 v120, 0, v137
  v_sub_f32 v121, 0, v137
  v_sub_f32 v122, 0, v137
  v_sub_f32 v123, 0, v137
  v_sub_f32 v124, 0, v137
  v_sub_f32 v125, 0, v137
  v_sub_f32 v126, 0, v137
  v_sub_f32 v127, 0, v137
  v_sub_f32 v128, 0, v137
  v_sub_f32 v129, 0, v137
  v_sub_f32 v130, 0, v137
  v_sub_f32 v131, 0, v137
  v_sub_f32 v132, 0, v137
  v_sub_f32 v133, 0, v137
  v_sub_f32 v134, 0, v137
  v_sub_f32 v135, 0, v137
  v_mov_b32 v72, 0
  v_mov_b32 v73, 0
  v_mov_b32 v74, 0
  v_mov_b32 v75, 0
  v_mov_b32 v76, 0
  v_mov_b32 v77, 0
  v_mov_b32 v78, 0
  v_mov_b32 v79, 0
  v_mov_b32 v80, 0
  v_mov_b32 v81, 0
  v_mov_b32 v82, 0
  v_mov_b32 v83, 0
  v_mov_b32 v84, 0
  v_mov_b32 v85, 0
  v_mov_b32 v86, 0
  v_mov_b32 v87, 0
  v_mov_b32 v88, 0
  v_mov_b32 v89, 0
  v_mov_b32 v90, 0
  v_mov_b32 v91, 0
  v_mov_b32 v92, 0
  v_mov_b32 v93, 0
  v_mov_b32 v94, 0
  v_mov_b32 v95, 0
  v_mov_b32 v96, 0
  v_mov_b32 v97, 0
  v_mov_b32 v98, 0
  v_mov_b32 v99, 0
  v_mov_b32 v100, 0
  v_mov_b32 v101, 0
  v_mov_b32 v102, 0
  v_mov_b32 v103, 0
  v_mov_b32 v20, 0x3f803f80
  v_mov_b32 v21, 0x3f803f80
  v_mov_b32 v22, 0x3f803f80
  v_mov_b32 v23, 0x3f803f80
  v_mov_b32 v24, 0x3f803f80
  v_mov_b32 v25, 0x3f803f80
  v_mov_b32 v26, 0x3f803f80
  v_mov_b32 v27, 0x3f803f80
  v_and_b32 v138, 0xffff, v239
  s_mov_b32 s78, 0
  s_mov_b32 s74, 0
L_aslow_pv:
  buffer_load_dwordx4 v[12:15], v2, s[12:15], s74 offen sc1
  s_mov_b32 exec_lo, 0xffff
  s_mov_b32 exec_hi, 0xffff
  buffer_load_dwordx4 v[20:23], v138, s[12:15], s74 offen sc1
  buffer_load_dwordx4 v[24:27], v138, s[12:15], s74 offen offset:512 sc1
  s_mov_b64 exec, -1
  s_add_u32 s74, s74, 2048
  s_waitcnt vmcnt(0)
  v_mfma_f32_32x32x16_bf16 v[40:55], v[12:15], v[4:7], v[104:119]
  v_mfma_f32_32x32x16_bf16 v[56:71], v[12:15], v[8:11], v[120:135]
  s_nop 15
  v_exp_f32 v40, v40
  v_exp_f32 v41, v41
  v_exp_f32 v42, v42
  v_exp_f32 v43, v43
  v_exp_f32 v44, v44
  v_exp_f32 v45, v45
  v_exp_f32 v46, v46
  v_exp_f32 v47, v47
  v_exp_f32 v48, v48
  v_exp_f32 v49, v49
  v_exp_f32 v50, v50
  v_exp_f32 v51, v51
  v_exp_f32 v52, v52
  v_exp_f32 v53, v53
  v_exp_f32 v54, v54
  v_exp_f32 v55, v55
  v_exp_f32 v56, v56
  v_exp_f32 v57, v57
  v_exp_f32 v58, v58
  v_exp_f32 v59, v59
  v_exp_f32 v60, v60
  v_exp_f32 v61, v61
  v_exp_f32 v62, v62
  v_exp_f32 v63, v63
  v_exp_f32 v64, v64
  v_exp_f32 v65, v65
  v_exp_f32 v66, v66
  v_exp_f32 v67, v67
  v_exp_f32 v68, v68
  v_exp_f32 v69, v69
  v_exp_f32 v70, v70
  v_exp_f32 v71, v71
  s_nop 1
  v_smfmac_f32_32x32x32_bf16 v[72:87], v[20:23], v[40:47], v36
  v_smfmac_f32_32x32x32_bf16 v[72:87], v[24:27], v[48:55], v36
  v_smfmac_f32_32x32x32_bf16 v[88:103], v[20:23], v[56:63], v36
  v_smfmac_f32_32x32x32_bf16 v[88:103], v[24:27], v[64:71], v36
  s_nop 7
  s_add_u32 s78, s78, 1
  s_cmp_lt_u32 s78, 64
  s_cbranch_scc1 L_aslow_pv
  s_nop 15
  v_rcp_f32 v136, v80
  v_rcp_f32 v137, v96
  s_nop 0
  s_branch L_afin
G_layer:
  s_lshr_b32 s74, s10, 1
  s_lshl_b32 s74, s74, 10
  s_add_u32 s74, s74, 0x4c0000
  buffer_load_dwordx4 v[24:27], v2, s[36:39], s74 offen sc1
  s_add_u32 s74, s74, 16384
  buffer_load_dwordx4 v[28:31], v2, s[36:39], s74 offen sc1
  s_add_u32 s74, s74, 16384
  buffer_load_dwordx4 v[32:35], v2, s[36:39], s74 offen sc1
  s_add_u32 s74, s74, 16384
  s_mov_b32 s73, s51
  s_mov_b32 s75, s58
  s_mov_b32 s76, s59
  s_add_u32 s77, s59, 131072
  s_sub_u32 s78, s51, 0x800000
  s_lshr_b32 s78, s78, 15
  s_mul_i32 s78, s78, 88064
  s_lshr_b32 s79, s10, 1
  s_lshl_b32 s79, s79, 12
  s_add_u32 s78, s78, s79
  s_add_u32 s78, s78, 0xa00000
  s_add_u32 s79, s56, 0x4000
  v_bfe_u32 v6, v1, 4, 1
  v_and_b32 v7, 0xffff, v239
  v_lshl_add_u32 v7, v6, 11, v7
  s_waitcnt vmcnt(0) lgkmcnt(0)
  buffer_load_dword v224, v225, s[36:39], s96 offen sc0 sc1
  s_barrier
  s_mov_b32 s8, 0
  s_waitcnt vmcnt(0)
  s_branch pchk_89
pl_87:
  buffer_load_dword v224, v225, s[36:39], s96 offen sc0 sc1
  s_add_u32 s8, s8, 1
  s_cmp_gt_u32 s8, 0x80000
  s_cbranch_scc1 L_abort
  s_waitcnt vmcnt(0)
pchk_89:
  v_cmp_ne_u32 vcc, 1, v224
  s_nop 3
  s_cbranch_vccnz pl_87
  buffer_load_dwordx4 a[0:3], v2, s[36:39], s73 offen offset:0 sc1
  buffer_load_dwordx4 a[4:7], v2, s[36:39], s73 offen offset:1024 sc1
  buffer_load_dwordx4 a[8:11], v2, s[36:39], s73 offen offset:2048 sc1
  buffer_load_dwordx4 a[12:15], v2, s[36:39], s73 offen offset:3072 sc1
  s_add_u32 s73, s73, 4096
  buffer_load_dwordx4 a[16:19], v2, s[36:39], s73 offen offset:0 sc1
  buffer_load_dwordx4 a[20:23], v2, s[36:39], s73 offen offset:1024 sc1
  buffer_load_dwordx4 v[8:11], v2, s[36:39], s52 offen offset:0 sc1
  buffer_load_dwordx4 v[12:15], v2, s[36:39], s52 offen offset:1024 sc1
  buffer_load_dwordx4 v[16:19], v2, s[36:39], s52 offen offset:2048 sc1
  buffer_load_dwordx4 v[20:23], v2, s[36:39], s52 offen offset:3072 sc1
  buffer_load_dwordx4 a[24:27], v2, s[36:39], s73 offen offset:2048 sc1
  buffer_load_dwordx4 a[28:31], v2, s[36:39], s73 offen offset:3072 sc1
  s_add_u32 s73, s73, 4096
  ds_read_b128 v[48:51], v222 offset:29696
  ds_read_b128 v[52:55], v222 offset:30720
  ds_read_b128 v[56:59], v222 offset:32768
  s_waitcnt vmcnt(11)
  s_waitcnt lgkmcnt(2)
  v_mfma_f32_32x32x16_bf16 v[88:103], v[48:51], a[0:3], 0
  buffer_load_dwordx4 a[32:35], v2, s[36:39], s73 offen offset:0 sc1
  ds_read_b128 v[60:63], v222 offset:33792
  s_waitcnt lgkmcnt(2)
  v_mfma_f32_32x32x16_bf16 v[104:119], a[0:3], v[52:55], 0
  ds_read_b128 v[48:51], v222 offset:35840
  s_waitcnt vmcnt(11)
  s_waitcnt lgkmcnt(2)
  v_mfma_f32_32x32x16_bf16 v[88:103], v[56:59], a[4:7], v[88:103]
  buffer_load_dwordx4 a[36:39], v2, s[36:39], s73 offen offset:1024 sc1
  ds_read_b128 v[52:55], v222 offset:36864
  s_waitcnt lgkmcnt(2)
  v_mfma_f32_32x32x16_bf16 v[104:119], a[4:7], v[60:63], v[104:119]
  ds_read_b128 v[56:59], v222 offset:38912
  s_waitcnt vmcnt(11)
  s_waitcnt lgkmcnt(2)
  v_mfma_f32_32x32x16_bf16 v[88:103], v[48:51], a[8:11], v[88:103]
  buffer_load_dwordx4 a[40:43], v2, s[36:39], s73 offen offset:2048 sc1
  ds_read_b128 v[60:63], v222 offset:39936
  s_waitcnt lgkmcnt(2)
  v_mfma_f32_32x32x16_bf16 v[104:119], a[8:11], v[52:55], v[104:119]
  ds_read_b128 v[48:51], v223 offset:13312
  s_waitcnt vmcnt(11)
  s_waitcnt lgkmcnt(2)
  v_mfma_f32_32x32x16_bf16 v[88:103], v[56:59], a[12:15], v[88:103]
  buffer_load_dwordx4 a[44:47], v2, s[36:39], s73 offen offset:3072 sc1
  ds_read_b128 v[52:55], v223 offset:14336
  s_add_u32 s73, s73, 4096
  s_waitcnt lgkmcnt(2)
  v_mfma_f32_32x32x16_bf16 v[104:119], a[12:15], v[60:63], v[104:119]
  ds_read_b128 v[56:59], v223 offset:16384
  s_waitcnt vmcnt(11)
  s_waitcnt lgkmcnt(2)
  v_mfma_f32_32x32x16_bf16 v[88:103], v[48:51], a[16:19], v[88:103]
  buffer_load_dwordx4 a[48:51], v2, s[36:39], s73 offen offset:0 sc1
  ds_read_b128 v[60:63], v223 offset:17408
  s_waitcnt lgkmcnt(2)
  v_mfma_f32_32x32x16_bf16 v[104:119], a[16:19], v[52:55], v[104:119]
  ds_read_b128 v[48:51], v223 offset:19456
  s_waitcnt vmcnt(11)
  s_waitcnt lgkmcnt(2)
  v_mfma_f32_32x32x16_bf16 v[88:103], v[56:59], a[20:23], v[88:103]
  buffer_load_dwordx4 a[52:55], v2, s[36:39], s73 offen offset:1024 sc1
  ds_read_b128 v[52:55], v223 offset:20480
  s_waitcnt lgkmcnt(2)
  v_mfma_f32_32x32x16_bf16 v[104:119], a[20:23], v[60:63], v[104:119]
  ds_read_b128 v[56:59], v223 offset:22528
  s_waitcnt vmcnt(7)
  s_waitcnt lgkmcnt(2)
  v_mfma_f32_32x32x16_bf16 v[88:103], v[48:51], a[24:27], v[88:103]
  buffer_load_dwordx4 a[56:59], v2, s[36:39], s73 offen offset:2048 sc1
  ds_read_b128 v[60:63], v223 offset:23552
  s_waitcnt lgkmcnt(2)
  v_mfma_f32_32x32x16_bf16 v[104:119], a[24:27], v[52:55], v[104:119]
  ds_read_b128 v[48:51], v223 offset:25600
  s_waitcnt vmcnt(7)
  s_waitcnt lgkmcnt(2)
  v_mfma_f32_32x32x16_bf16 v[88:103], v[56:59], a[28:31], v[88:103]
  buffer_load_dwordx4 a[60:63], v2, s[36:39], s73 offen offset:3072 sc1
  ds_read_b128 v[52:55], v223 offset:26624
  s_add_u32 s73, s73, 4096
  s_waitcnt lgkmcnt(2)
  v_mfma_f32_32x32x16_bf16 v[104:119], a[28:31], v[60:63], v[104:119]
  ds_read_b128 v[56:59], v223 offset:28672
  s_waitcnt vmcnt(7)
  s_waitcnt lgkmcnt(2)
  v_mfma_f32_32x32x16_bf16 v[88:103], v[48:51], a[32:35], v[88:103]
  buffer_load_dwordx4 a[64:67], v2, s[36:39], s73 offen offset:0 sc1
  ds_read_b128 v[60:63], v223 offset:29696
  v_add_f32 v8, v8, v16
  v_add_f32 v9, v9, v17
  s_waitcnt lgkmcnt(2)
  v_mfma_f32_32x32x16_bf16 v[104:119], a[32:35], v[52:55], v[104:119]
  ds_read_b128 v[48:51], v223 offset:31744
  v_add_f32 v10, v10, v18
  v_add_f32 v11, v11, v19
  s_waitcnt vmcnt(7)
  s_waitcnt lgkmcnt(2)
  v_mfma_f32_32x32x16_bf16 v[88:103], v[56:59], a[36:39], v[88:103]
  buffer_load_dwordx4 a[68:71], v2, s[36:39], s73 offen offset:1024 sc1
  ds_read_b128 v[52:55], v223 offset:32768
  v_add_f32 v12, v12, v20
  v_add_f32 v13, v13, v21
  s_waitcnt lgkmcnt(2)
  v_mfma_f32_32x32x16_bf16 v[104:119], a[36:39], v[60:63], v[104:119]
  ds_read_b128 v[56:59], v223 offset:34816
  v_add_f32 v14, v14, v22
  v_add_f32 v15, v15, v23
  s_waitcnt vmcnt(7)
  s_waitcnt lgkmcnt(2)
  v_mfma_f32_32x32x16_bf16 v[88:103], v[48:51], a[40:43], v[88:103]
  buffer_load_dwordx4 a[72:75], v2, s[36:39], s73 offen offset:2048 sc1
  ds_read_b128 v[60:63], v223 offset:35840
  v_add_f32 v8, v8, v12
  v_add_f32 v9, v9, v13
  s_waitcnt lgkmcnt(2)
  v_mfma_f32_32x32x16_bf16 v[104:119], a[40:43], v[52:55], v[104:119]
  ds_read_b128 v[48:51], v2 offset:1024
  v_add_f32 v10, v10, v14
  v_add_f32 v11, v11, v15
  s_waitcnt vmcnt(7)
  s_waitcnt lgkmcnt(2)
  v_mfma_f32_32x32x16_bf16 v[88:103], v[56:59], a[44:47], v[88:103]
  buffer_load_dwordx4 a[76:79], v2, s[36:39], s73 offen offset:3072 sc1
  ds_read_b128 v[52:55], v2 offset:2048
  s_add_u32 s73, s73, 4096
  v_add_f32 v8, v8, v10
  v_add_f32 v9, v9, v11
  s_waitcnt lgkmcnt(2)
  v_mfma_f32_32x32x16_bf16 v[104:119], a[44:47], v[60:63], v[104:119]
  ds_read_b128 v[56:59], v2 offset:4096
  v_mov_b32 v42, v8
  v_mov_b32 v43, v9
  s_waitcnt vmcnt(7)
  s_waitcnt lgkmcnt(2)
  v_mfma_f32_32x32x16_bf16 v[88:103], v[48:51], a[48:51], v[88:103]
  buffer_load_dwordx4 a[80:83], v2, s[36:39], s73 offen offset:0 sc1
  ds_read_b128 v[60:63], v2 offset:5120
  s_nop 0
  v_permlane32_swap_b32 v8, v42
  s_waitcnt lgkmcnt(2)
  v_mfma_f32_32x32x16_bf16 v[104:119], a[48:51], v[52:55], v[104:119]
  ds_read_b128 v[48:51], v2 offset:7168
  v_permlane32_swap_b32 v9, v43
  v_add_f32 v8, v8, v42
  s_waitcnt vmcnt(7)
  s_waitcnt lgkmcnt(2)
  v_mfma_f32_32x32x16_bf16 v[88:103], v[56:59], a[52:55], v[88:103]
  buffer_load_dwordx4 a[84:87], v2, s[36:39], s73 offen offset:1024 sc1
  ds_read_b128 v[52:55], v2 offset:8192
  v_add_f32 v9, v9, v43
  v_mul_f32 v40, 0.001953125, v8
  s_waitcnt lgkmcnt(2)
  v_mfma_f32_32x32x16_bf16 v[104:119], a[52:55], v[60:63], v[104:119]
  ds_read_b128 v[56:59], v2 offset:10240
  v_mul_f32 v9, 0.001953125, v9
  v_fma_f32 v9, -v40, v40, v9
  s_waitcnt vmcnt(7)
  s_waitcnt lgkmcnt(2)
  v_mfma_f32_32x32x16_bf16 v[88:103], v[48:51], a[56:59], v[88:103]
  buffer_load_dwordx4 a[88:91], v2, s[36:39], s73 offen offset:2048 sc1
  ds_read_b128 v[60:63], v2 offset:11264
  v_max_f32 v9, 0, v9
  v_cvt_pk_bf16_f32 v9, v9, v9
  s_waitcnt lgkmcnt(2)
  v_mfma_f32_32x32x16_bf16 v[104:119], a[56:59], v[52:55], v[104:119]
  ds_read_b128 v[48:51], v2 offset:13312
  v_and_b32 v9, 0xffff0000, v9
  v_add_f32 v9, 0x3727c5ac, v9
  s_waitcnt vmcnt(7)
  s_waitcnt lgkmcnt(2)
  v_mfma_f32_32x32x16_bf16 v[88:103], v[56:59], a[60:63], v[88:103]
  buffer_load_dwordx4 a[92:95], v2, s[36:39], s73 offen offset:3072 sc1
  ds_read_b128 v[52:55], v2 offset:14336
  s_add_u32 s73, s73, 4096
  v_cvt_pk_bf16_f32 v9, v9, v9
  v_and_b32 v9, 0xffff0000, v9
  s_waitcnt lgkmcnt(2)
  v_mfma_f32_32x32x16_bf16 v[104:119], a[60:63], v[60:63], v[104:119]
  ds_read_b128 v[56:59], v2 offset:16384
  v_sqrt_f32 v9, v9
  v_sub_f32 v42, 0, v40
  s_waitcnt vmcnt(7)
  s_waitcnt lgkmcnt(2)
  v_mfma_f32_32x32x16_bf16 v[88:103], v[48:51], a[64:67], v[88:103]
  buffer_load_dwordx4 a[96:99], v2, s[36:39], s73 offen offset:0 sc1
  ds_read_b128 v[60:63], v2 offset:17408
  v_cvt_pk_bf16_f32 v9, v9, v9
  v_and_b32 v9, 0xffff0000, v9
  s_waitcnt lgkmcnt(2)
  v_mfma_f32_32x32x16_bf16 v[104:119], a[64:67], v[52:55], v[104:119]
  ds_read_b128 v[48:51], v2 offset:19456
  v_rcp_f32 v41, v9
  v_cvt_pk_bf16_f32 v36, v42, v42
  s_waitcnt vmcnt(7)
  s_waitcnt lgkmcnt(2)
  v_mfma_f32_32x32x16_bf16 v[88:103], v[56:59], a[68:71], v[88:103]
  buffer_load_dwordx4 a[100:103], v2, s[36:39], s73 offen offset:1024 sc1
  ds_read_b128 v[52:55], v2 offset:20480
  v_mov_b32 v37, v36
  v_mov_b32 v38, v36
  s_waitcnt lgkmcnt(2)
  v_mfma_f32_32x32x16_bf16 v[104:119], a[68:71], v[60:63], v[104:119]
  ds_read_b128 v[56:59], v2 offset:22528
  v_mov_b32 v39, v36
  s_lshl_b32 s74, s3, 7
  s_waitcnt vmcnt(7)
  s_waitcnt lgkmcnt(2)
  v_mfma_f32_32x32x16_bf16 v[88:103], v[48:51], a[72:75], v[88:103]
  buffer_load_dwordx4 a[104:107], v2, s[36:39], s73 offen offset:2048 sc1
  ds_read_b128 v[60:63], v2 offset:23552
  s_add_u32 s74, s74, 159744
  v_and_b32 v42, 31, v1
  s_waitcnt lgkmcnt(2)
  v_mfma_f32_32x32x16_bf16 v[104:119], a[72:75], v[52:55], v[104:119]
  ds_read_b128 v[48:51], v2 offset:25600
  v_lshlrev_b32 v42, 2, v42
  v_add_u32 v42, s74, v42
  s_waitcnt vmcnt(7)
  s_waitcnt lgkmcnt(2)
  v_mfma_f32_32x32x16_bf16 v[88:103], v[56:59], a[76:79], v[88:103]
  buffer_load_dwordx4 a[108:111], v2, s[36:39], s73 offen offset:3072 sc1
  ds_read_b128 v[52:55], v2 offset:26624
  s_add_u32 s73, s73, 4096
  ds_write_b32 v42, v41
  v_lshrrev_b32 v43, 5, v1
  s_waitcnt lgkmcnt(3)
  v_mfma_f32_32x32x16_bf16 v[104:119], a[76:79], v[60:63], v[104:119]
  ds_read_b128 v[56:59], v2 offset:28672
  v_lshlrev_b32 v43, 4, v43
  v_add_u32 v43, s74, v43
  s_waitcnt vmcnt(7)
  s_waitcnt lgkmcnt(3)
  v_mfma_f32_32x32x16_bf16 v[88:103], v[48:51], a[80:83], v[88:103]
  buffer_load_dwordx4 a[112:115], v2, s[36:39], s73 offen offset:0 sc1
  ds_read_b128 v[60:63], v2 offset:29696
  ds_read_b128 v[120:123], v43 offset:0
  ds_read_b128 v[124:127], v43 offset:32
  s_waitcnt lgkmcnt(5)
  v_mfma_f32_32x32x16_bf16 v[104:119], a[80:83], v[52:55], v[104:119]
  ds_read_b128 v[48:51], v2 offset:31744
  ds_read_b128 v[128:131], v43 offset:64
  ds_read_b128 v[132:135], v43 offset:96
  s_waitcnt vmcnt(7)
  s_waitcnt lgkmcnt(6)
  v_mfma_f32_32x32x16_bf16 v[88:103], v[56:59], a[84:87], v[88:103]
  buffer_load_dwordx4 a[116:119], v2, s[36:39], s73 offen offset:1024 sc1
  ds_read_b128 v[52:55], v2 offset:32768
  v_mul_f32 v42, 0x3eb8aa3b, v41
  s_waitcnt lgkmcnt(6)
  v_mfma_f32_32x32x16_bf16 v[104:119], a[84:87], v[60:63], v[104:119]
  ds_read_b128 v[56:59], v2 offset:34816
  s_waitcnt vmcnt(7)
  s_waitcnt lgkmcnt(4)
  v_mfma_f32_32x32x16_bf16 v[88:103], v[48:51], a[88:91], v[88:103]
  buffer_load_dwordx4 a[120:123], v2, s[36:39], s73 offen offset:2048 sc1
  ds_read_b128 v[60:63], v2 offset:35840
  s_waitcnt lgkmcnt(2)
  v_mfma_f32_32x32x16_bf16 v[104:119], a[88:91], v[52:55], v[104:119]
  ds_read_b128 v[48:51], v2 offset:37888
  s_waitcnt vmcnt(7)
  s_waitcnt lgkmcnt(2)
  v_mfma_f32_32x32x16_bf16 v[88:103], v[56:59], a[92:95], v[88:103]
  buffer_load_dwordx4 a[124:127], v2, s[36:39], s73 offen offset:3072 sc1
  ds_read_b128 v[52:55], v2 offset:38912
  s_add_u32 s73, s73, 4096
  s_waitcnt lgkmcnt(2)
  v_mfma_f32_32x32x16_bf16 v[104:119], a[92:95], v[60:63], v[104:119]
  ds_read_b128 v[56:59], v2 offset:40960
  s_waitcnt vmcnt(7)
  s_waitcnt lgkmcnt(2)
  v_mfma_f32_32x32x16_bf16 v[88:103], v[48:51], a[96:99], v[88:103]
  ds_read_b128 v[60:63], v2 offset:41984
  s_waitcnt lgkmcnt(2)
  v_mfma_f32_32x32x16_bf16 v[104:119], a[96:99], v[52:55], v[104:119]
  ds_read_b128 v[48:51], v2 offset:44032
  s_waitcnt vmcnt(6)
  s_waitcnt lgkmcnt(2)
  v_mfma_f32_32x32x16_bf16 v[88:103], v[56:59], a[100:103], v[88:103]
  ds_read_b128 v[52:55], v2 offset:45056
  s_waitcnt lgkmcnt(2)
  v_mfma_f32_32x32x16_bf16 v[104:119], a[100:103], v[60:63], v[104:119]
  ds_read_b128 v[56:59], v2 offset:47104
  s_waitcnt vmcnt(5)
  s_waitcnt lgkmcnt(2)
  v_mfma_f32_32x32x16_bf16 v[88:103], v[48:51], a[104:107], v[88:103]
  ds_read_b128 v[60:63], v2 offset:48128
  s_waitcnt lgkmcnt(2)
  v_mfma_f32_32x32x16_bf16 v[104:119], a[104:107], v[52:55], v[104:119]
  ds_read_b128 v[48:51], v2 offset:50176
  s_waitcnt vmcnt(4)
  s_waitcnt lgkmcnt(2)
  v_mfma_f32_32x32x16_bf16 v[88:103], v[56:59], a[108:111], v[88:103]
  ds_read_b128 v[52:55], v2 offset:51200
  s_waitcnt lgkmcnt(2)
  v_mfma_f32_32x32x16_bf16 v[104:119], a[108:111], v[60:63], v[104:119]
  ds_read_b128 v[56:59], v2 offset:53248
  s_waitcnt vmcnt(3)
  s_waitcnt lgkmcnt(2)
  v_mfma_f32_32x32x16_bf16 v[88:103], v[48:51], a[112:115], v[88:103]
  ds_read_b128 v[60:63], v2 offset:54272
  s_waitcnt lgkmcnt(2)
  v_mfma_f32_32x32x16_bf16 v[104:119], a[112:115], v[52:55], v[104:119]
  ds_read_b128 v[48:51], v2 offset:56320
  s_waitcnt vmcnt(2)
  s_waitcnt lgkmcnt(2)
  v_mfma_f32_32x32x16_bf16 v[88:103], v[56:59], a[116:119], v[88:103]
  ds_read_b128 v[52:55], v2 offset:57344
  s_waitcnt lgkmcnt(2)
  v_mfma_f32_32x32x16_bf16 v[104:119], a[116:119], v[60:63], v[104:119]
  ds_read_b128 v[56:59], v2 offset:59392
  s_waitcnt vmcnt(1)
  s_waitcnt lgkmcnt(2)
  v_mfma_f32_32x32x16_bf16 v[88:103], v[48:51], a[120:123], v[88:103]
  ds_read_b128 v[60:63], v2 offset:60416
  s_waitcnt lgkmcnt(2)
  v_mfma_f32_32x32x16_bf16 v[104:119], a[120:123], v[52:55], v[104:119]
  ds_read_b128 v[48:51], v222 offset:28672
  s_waitcnt vmcnt(0)
  s_waitcnt lgkmcnt(2)
  v_mfma_f32_32x32x16_bf16 v[88:103], v[56:59], a[124:127], v[88:103]
  ds_read_b128 v[52:55], v222 offset:31744
  s_waitcnt lgkmcnt(2)
  v_mfma_f32_32x32x16_bf16 v[104:119], a[124:127], v[60:63], v[104:119]
  ds_read_b128 v[56:59], v222 offset:34816
  v_mfma_f32_32x32x16_bf16 v[88:103], v[28:31], v[36:39], v[88:103]
  v_mfma_f32_32x32x16_bf16 v[104:119], v[36:39], v[32:35], v[104:119]
  s_waitcnt lgkmcnt(2)
  v_mfma_f32_32x32x16_bf16 v[72:87], v[48:51], a[0:3], 0
  ds_read_b128 v[60:63], v222 offset:37888
  s_waitcnt lgkmcnt(2)
  v_mfma_f32_32x32x16_bf16 v[72:87], v[52:55], a[4:7], v[72:87]
  ds_read_b128 v[48:51], v223 offset:12288
  s_waitcnt lgkmcnt(2)
  v_mfma_f32_32x32x16_bf16 v[72:87], v[56:59], a[8:11], v[72:87]
  ds_read_b128 v[52:55], v223 offset:15360
  s_waitcnt lgkmcnt(2)
  v_mfma_f32_32x32x16_bf16 v[72:87], v[60:63], a[12:15], v[72:87]
  ds_read_b128 v[56:59], v223 offset:18432
  s_waitcnt lgkmcnt(2)
  v_mfma_f32_32x32x16_bf16 v[72:87], v[48:51], a[16:19], v[72:87]
  ds_read_b128 v[60:63], v223 offset:21504
  v_mul_f32 v88, v88, v41
  v_mul_f32 v89, v89, v41
  v_mul_f32 v90, v90, v41
  s_waitcnt lgkmcnt(2)
  v_mfma_f32_32x32x16_bf16 v[72:87], v[52:55], a[20:23], v[72:87]
  ds_read_b128 v[48:51], v223 offset:24576
  v_mul_f32 v91, v91, v41
  v_mul_f32 v92, v92, v41
  v_mul_f32 v93, v93, v41
  s_waitcnt lgkmcnt(2)
  v_mfma_f32_32x32x16_bf16 v[72:87], v[56:59], a[24:27], v[72:87]
  ds_read_b128 v[52:55], v223 offset:27648
  v_mul_f32 v94, v94, v41
  v_mul_f32 v95, v95, v41
  v_cvt_pk_bf16_f32 v136, v88, v89
  s_waitcnt lgkmcnt(2)
  v_mfma_f32_32x32x16_bf16 v[72:87], v[60:63], a[28:31], v[72:87]
  ds_read_b128 v[56:59], v223 offset:30720
  v_cvt_pk_bf16_f32 v137, v90, v91
  v_cvt_pk_bf16_f32 v138, v92, v93
  v_cvt_pk_bf16_f32 v139, v94, v95
  s_waitcnt lgkmcnt(2)
  v_mfma_f32_32x32x16_bf16 v[72:87], v[48:51], a[32:35], v[72:87]
  ds_read_b128 v[60:63], v223 offset:33792
  buffer_store_dwordx4 v[136:139], v240, s[36:39], s76 offen sc1
  v_mul_f32 v96, v96, v41
  v_mul_f32 v97, v97, v41
  s_waitcnt lgkmcnt(2)
  v_mfma_f32_32x32x16_bf16 v[72:87], v[52:55], a[36:39], v[72:87]
  ds_read_b128 v[48:51], v2 offset:0
  v_mul_f32 v98, v98, v41
  v_mul_f32 v99, v99, v41
  s_waitcnt lgkmcnt(2)
  v_mfma_f32_32x32x16_bf16 v[72:87], v[56:59], a[40:43], v[72:87]
  ds_read_b128 v[52:55], v2 offset:3072
  v_mul_f32 v100, v100, v41
  v_mul_f32 v101, v101, v41
  s_waitcnt lgkmcnt(2)
  v_mfma_f32_32x32x16_bf16 v[72:87], v[60:63], a[44:47], v[72:87]
  ds_read_b128 v[56:59], v2 offset:6144
  v_mul_f32 v102, v102, v41
  v_mul_f32 v103, v103, v41
  s_waitcnt lgkmcnt(2)
  v_mfma_f32_32x32x16_bf16 v[72:87], v[48:51], a[48:51], v[72:87]
  ds_read_b128 v[60:63], v2 offset:9216
  v_cvt_pk_bf16_f32 v140, v96, v97
  v_cvt_pk_bf16_f32 v141, v98, v99
  s_waitcnt lgkmcnt(2)
  v_mfma_f32_32x32x16_bf16 v[72:87], v[52:55], a[52:55], v[72:87]
  ds_read_b128 v[48:51], v2 offset:12288
  v_cvt_pk_bf16_f32 v142, v100, v101
  v_cvt_pk_bf16_f32 v143, v102, v103
  s_waitcnt lgkmcnt(2)
  v_mfma_f32_32x32x16_bf16 v[72:87], v[56:59], a[56:59], v[72:87]
  ds_read_b128 v[52:55], v2 offset:15360
  buffer_store_dwordx4 v[140:143], v240, s[36:39], s77 offen sc1
  v_mul_f32 v104, v104, v120
  s_waitcnt lgkmcnt(2)
  v_mfma_f32_32x32x16_bf16 v[72:87], v[60:63], a[60:63], v[72:87]
  ds_read_b128 v[56:59], v2 offset:18432
  v_mul_f32 v105, v105, v121
  v_mul_f32 v106, v106, v122
  s_waitcnt lgkmcnt(2)
  v_mfma_f32_32x32x16_bf16 v[72:87], v[48:51], a[64:67], v[72:87]
  ds_read_b128 v[60:63], v2 offset:21504
  v_mul_f32 v107, v107, v123
  v_mul_f32 v108, v108, v124
  s_waitcnt lgkmcnt(2)
  v_mfma_f32_32x32x16_bf16 v[72:87], v[52:55], a[68:71], v[72:87]
  ds_read_b128 v[48:51], v2 offset:24576
  v_mul_f32 v109, v109, v125
  v_mul_f32 v110, v110, v126
  s_waitcnt lgkmcnt(2)
  v_mfma_f32_32x32x16_bf16 v[72:87], v[56:59], a[72:75], v[72:87]
  ds_read_b128 v[52:55], v2 offset:27648
  v_mul_f32 v111, v111, v127
  v_cvt_pk_bf16_f32 v144, v104, v105
  s_waitcnt lgkmcnt(2)
  v_mfma_f32_32x32x16_bf16 v[72:87], v[60:63], a[76:79], v[72:87]
  ds_read_b128 v[56:59], v2 offset:30720
  v_cvt_pk_bf16_f32 v145, v106, v107
  v_cvt_pk_bf16_f32 v146, v108, v109
  s_waitcnt lgkmcnt(2)
  v_mfma_f32_32x32x16_bf16 v[72:87], v[48:51], a[80:83], v[72:87]
  ds_read_b128 v[60:63], v2 offset:33792
  v_cvt_pk_bf16_f32 v147, v110, v111
  buffer_store_dwordx4 v[144:147], v239, s[36:39], s76 offen offset:0 sc1
  s_waitcnt lgkmcnt(2)
  v_mfma_f32_32x32x16_bf16 v[72:87], v[52:55], a[84:87], v[72:87]
  ds_read_b128 v[48:51], v2 offset:36864
  v_mul_f32 v112, v112, v128
  v_mul_f32 v113, v113, v129
  s_waitcnt lgkmcnt(2)
  v_mfma_f32_32x32x16_bf16 v[72:87], v[56:59], a[88:91], v[72:87]
  ds_read_b128 v[52:55], v2 offset:39936
  v_mul_f32 v114, v114, v130
  v_mul_f32 v115, v115, v131
  s_waitcnt lgkmcnt(2)
  v_mfma_f32_32x32x16_bf16 v[72:87], v[60:63], a[92:95], v[72:87]
  ds_read_b128 v[56:59], v2 offset:43008
  v_mul_f32 v116, v116, v132
  v_mul_f32 v117, v117, v133
  s_waitcnt lgkmcnt(2)
  v_mfma_f32_32x32x16_bf16 v[72:87], v[48:51], a[96:99], v[72:87]
  ds_read_b128 v[60:63], v2 offset:46080
  v_mul_f32 v118, v118, v134
  v_mul_f32 v119, v119, v135
  s_waitcnt lgkmcnt(2)
  v_mfma_f32_32x32x16_bf16 v[72:87], v[52:55], a[100:103], v[72:87]
  ds_read_b128 v[48:51], v2 offset:49152
  v_cvt_pk_bf16_f32 v148, v112, v113
  v_cvt_pk_bf16_f32 v149, v114, v115
  s_waitcnt lgkmcnt(2)
  v_mfma_f32_32x32x16_bf16 v[72:87], v[56:59], a[104:107], v[72:87]
  ds_read_b128 v[52:55], v2 offset:52224
  v_cvt_pk_bf16_f32 v150, v116, v117
  v_cvt_pk_bf16_f32 v151, v118, v119
  s_waitcnt lgkmcnt(2)
  v_mfma_f32_32x32x16_bf16 v[72:87], v[60:63], a[108:111], v[72:87]
  ds_read_b128 v[56:59], v2 offset:55296
  buffer_store_dwordx4 v[148:151], v239, s[36:39], s76 offen offset:512 sc1
  s_waitcnt lgkmcnt(2)
  v_mfma_f32_32x32x16_bf16 v[72:87], v[48:51], a[112:115], v[72:87]
  ds_read_b128 v[60:63], v2 offset:58368
  s_waitcnt lgkmcnt(2)
  v_mfma_f32_32x32x16_bf16 v[72:87], v[52:55], a[116:119], v[72:87]
  s_waitcnt lgkmcnt(1)
  v_mfma_f32_32x32x16_bf16 v[72:87], v[56:59], a[120:123], v[72:87]
  s_waitcnt lgkmcnt(0)
  v_mfma_f32_32x32x16_bf16 v[72:87], v[60:63], a[124:127], v[72:87]
  v_mfma_f32_32x32x16_bf16 v[72:87], v[24:27], v[36:39], v[72:87]
  s_nop 11
  v_mul_f32 v72, v72, v42
  v_mul_f32 v73, v73, v42
  v_mul_f32 v74, v74, v42
  v_mul_f32 v75, v75, v42
  v_mul_f32 v76, v76, v42
  v_mul_f32 v77, v77, v42
  v_mul_f32 v78, v78, v42
  v_mul_f32 v79, v79, v42
  v_cvt_pk_bf16_f32 v152, v72, v73
  v_cvt_pk_bf16_f32 v153, v74, v75
  v_cvt_pk_bf16_f32 v154, v76, v77
  v_cvt_pk_bf16_f32 v155, v78, v79
  buffer_store_dwordx4 v[152:155], v2, s[36:39], s75 offen offset:0 sc1
  v_mul_f32 v80, v80, v42
  v_mul_f32 v81, v81, v42
  v_mul_f32 v82, v82, v42
  v_mul_f32 v83, v83, v42
  v_mul_f32 v84, v84, v42
  v_mul_f32 v85, v85, v42
  v_mul_f32 v86, v86, v42
  v_mul_f32 v87, v87, v42
  v_cvt_pk_bf16_f32 v156, v80, v81
  v_cvt_pk_bf16_f32 v157, v82, v83
  v_cvt_pk_bf16_f32 v158, v84, v85
  v_cvt_pk_bf16_f32 v159, v86, v87
  buffer_store_dwordx4 v[156:159], v2, s[36:39], s75 offen offset:1024 sc1
  s_waitcnt vmcnt(0)
  s_mov_b64 exec, 1
  buffer_store_dword v229, off, s[36:39], s56 sc0 sc1
  s_mov_b64 exec, -1
  s_barrier
G_att:
  s_mov_b32 s70, s10
  s_mov_b32 s71, s9
  v_mov_b32 v136, 0x3f803f80
  v_mov_b32 v137, 0x3f803f80
  v_mov_b32 v138, 0x3f803f80
  v_mov_b32 v139, 0x3f803f80
  v_mul_u32_u24 v140, 2080, v1
  ds_write_b128 v140, v[136:139] offset:2048
  v_mov_b32 v40, 0
  v_mov_b32 v41, 0
  v_mov_b32 v42, 0
  v_mov_b32 v43, 0
  ds_write_b128 v140, v[40:43] offset:2064
  v_mov_b32 v36, 0xdddddddd
  v_mov_b32 v144, v2
  v_and_b32 v145, 0xffff, v239
  v_add_u32 v146, 512, v145
  v_and_b32 v141, 27, v1
  v_cmp_ne_u32 vcc, 16, v141
  v_mov_b32 v142, 2048
  v_mov_b32 v143, 2064
  v_and_b32 v141, 16, v1
  v_cndmask_b32 v142, v142, v143, vcc
  v_cmp_ne_u32 vcc, 0, v141
  s_nop 1
  v_cndmask_b32 v145, v145, v142, vcc
  v_cndmask_b32 v146, v146, v142, vcc
  s_lshl_b32 s73, s70, 17
  s_lshl_b32 s72, s69, 22
  s_add_u32 s73, s73, s72
  s_add_u32 s73, s73, 0x1000000
  s_add_u32 s12, s36, s73
  s_addc_u32 s13, s37, 0
  s_mov_b32 s14, 131072
  s_mov_b32 s15, 0x20000
  s_lshl_b32 s79, s71, 18
  s_lshl_b32 s72, s3, 16
  s_add_u32 s79, s79, s72
  s_lshl_b32 s72, s70, 10
  s_add_u32 s79, s79, s72
  s_add_u32 s76, s79, 0x600000
  s_add_u32 s77, s76, 32768
  s_lshl_b32 s78, s71, 3
  s_add_u32 s78, s78, s3
  s_lshl_b32 s78, s78, 11
  s_mul_i32 s74, s3, 2080
  s_mul_i32 s83, s10, 44032
  s_mul_i32 s72, s3, 11264
  s_add_u32 s83, s83, s72
  v_mov_b32 v37, v144
  v_mov_b32 v38, v145
  v_mov_b32 v39, v146
  v_mov_b32 v72, 0
  v_mov_b32 v73, 0
  v_mov_b32 v74, 0
  v_mov_b32 v75, 0
  v_mov_b32 v76, 0
  v_mov_b32 v77, 0
  v_mov_b32 v78, 0
  v_mov_b32 v79, 0
  v_mov_b32 v80, 0
  v_mov_b32 v81, 0
  v_mov_b32 v82, 0
  v_mov_b32 v83, 0
  v_mov_b32 v84, 0
  v_mov_b32 v85, 0
  v_mov_b32 v86, 0
  v_mov_b32 v87, 0
  v_mov_b32 v88, 0
  v_mov_b32 v89, 0
  v_mov_b32 v90, 0
  v_mov_b32 v91, 0
  v_mov_b32 v92, 0
  v_mov_b32 v93, 0
  v_mov_b32 v94, 0
  v_mov_b32 v95, 0
  v_mov_b32 v96, 0
  v_mov_b32 v97, 0
  v_mov_b32 v98, 0
  v_mov_b32 v99, 0
  v_mov_b32 v100, 0
  v_mov_b32 v101, 0
  v_mov_b32 v102, 0
  v_mov_b32 v103, 0
  v_mov_b32 v64, 0
  v_mov_b32 v65, 0
  v_mov_b32 v66, 0
  v_mov_b32 v67, 0
  v_mov_b32 v68, 0
  v_mov_b32 v69, 0
  v_mov_b32 v70, 0
  v_mov_b32 v71, 0
  v_mov_b32 v32, 0
  v_mov_b32 v33, 0
  v_mov_b32 v34, 0
  v_mov_b32 v35, 0
  s_lshr_b32 s72, s70, 1
  s_lshl_b32 s72, s72, 4
  s_lshl_b32 s82, s72, 4
  s_add_u32 s82, s82, s68
  s_add_u32 s82, s82, 0x4f0000
  s_lshl_b32 s75, s9, 1
  s_add_u32 s72, s72, s75
  s_waitcnt lgkmcnt(0)
  s_add_u32 s94, s73, s78
  s_add_u32 s95, s94, 8192
  s_lshl_b32 s96, s72, 4
  s_add_u32 s96, s96, s68
  s_add_u32 s96, s96, 0x4f0000
  s_mov_b32 s8, 0
pl_90:
  buffer_load_dword v224, v226, s[36:39], s96 offen sc0 sc1
  s_add_u32 s8, s8, 1
  s_cmp_gt_u32 s8, 0x80000
  s_cbranch_scc1 L_abort
  s_waitcnt vmcnt(0)
pchk_92:
  v_cmp_ne_u32 vcc, 1, v224
  s_nop 3
  s_cbranch_vccnz pl_90
  buffer_load_dwordx4 v[4:7], v2, s[36:39], s76 offen sc1
  s_mov_b32 m0, s74
  s_add_u32 s74, s74, 8320
  buffer_load_dwordx4 v2, s[36:39], s94 offen sc1 lds
  buffer_load_dwordx4 v2, s[36:39], s94 offen offset:1024 sc1 lds
  s_add_u32 s78, s78, 8192
  s_and_b32 s78, s78, 0x1ffff
  buffer_load_dwordx4 v[8:11], v2, s[36:39], s77 offen sc1
  s_mov_b32 m0, s74
  s_add_u32 s74, s74, 8320
  buffer_load_dwordx4 v2, s[36:39], s95 offen sc1 lds
  buffer_load_dwordx4 v2, s[36:39], s95 offen offset:1024 sc1 lds
  s_add_u32 s78, s78, 8192
  s_and_b32 s78, s78, 0x1ffff
  buffer_load_dword v104, v247, s[36:39], s82 offen sc0 sc1
  s_cmp_lg_u32 s69, 0
  s_cbranch_scc1 norf_93
  s_lshl_b32 s92, s9, 1
  s_and_b32 s93, s10, 1
  s_add_u32 s92, s92, s93
  s_lshl_b32 s92, s92, 1
  s_bfe_u32 s93, s10, 0x10001
  s_add_u32 s92, s92, s93
  s_lshr_b32 s93, s10, 2
  s_lshl_b32 s92, s92, 1
  s_and_b32 s94, s3, 1
  s_add_u32 s92, s92, s94
  s_lshl_b32 s94, s92, 12
  s_lshl_b32 s95, s93, 9
  s_add_u32 s94, s94, s95
  s_lshl_b32 s92, s92, 15
  s_lshl_b32 s93, s93, 12
  s_add_u32 s92, s92, s93
  s_lshr_b32 s93, s3, 1
  s_lshl_b32 s93, s93, 11
  s_add_u32 s92, s92, s93
  v_and_b32 v148, 15, v1
  v_lshlrev_b32 v148, 7, v148
  s_lshl_b32 s93, s9, 18
  s_lshl_b32 s95, s3, 16
  s_add_u32 s93, s93, s95
  s_lshl_b32 s95, s10, 10
  s_add_u32 s93, s93, s95
  s_add_u32 s97, s93, 0x600000
  v_mov_b32 v233, s97
  s_add_u32 s97, s93, 0x600000
  s_mov_b32 exec_lo, 0xff
  s_mov_b32 exec_hi, 0x0
  v_add_u32 v233, s97, v234
  s_mov_b64 exec, -1
  s_add_u32 s97, s93, 0x607c00
  s_mov_b32 exec_lo, 0xff00
  s_mov_b32 exec_hi, 0x0
  v_add_u32 v233, s97, v234
  s_mov_b64 exec, -1
  s_add_u32 s97, s92, 0x7ff800
  s_mov_b32 exec_lo, 0xffff0000
  s_mov_b32 exec_hi, 0x0
  v_add_u32 v233, s97, v234
  s_mov_b64 exec, -1
  s_add_u32 s97, s94, 0x4ff000
  s_mov_b32 exec_lo, 0x0
  s_mov_b32 exec_hi, 0xf
  v_add_u32 v233, s97, v234
  s_mov_b64 exec, -1
  s_lshl_b32 s92, s9, 1
  s_and_b32 s93, s10, 1
  s_add_u32 s92, s92, s93
  s_lshr_b32 s93, s10, 1
  s_lshl_b32 s92, s92, 2
  s_add_u32 s92, s92, s3
  s_lshl_b32 s93, s93, 11
  s_lshl_b32 s94, s92, 15
  s_add_u32 s93, s93, s94
  s_add_u32 s97, s93, 0x600000
  v_mov_b32 v231, s97
  s_add_u32 s97, s93, 0x600000
  s_mov_b32 exec_lo, 0xffff
  s_mov_b32 exec_hi, 0x0
  v_add_u32 v231, s97, v234
  s_mov_b64 exec, -1
  s_mov_b32 exec_lo, 0x00ff0000
  s_mov_b32 exec_hi, 0
  v_lshlrev_b32 v231, 19, v1
  v_add_u32 v231, 0xc00000, v231
  s_mov_b64 exec, -1
  s_lshr_b32 s93, s10, 1
  s_mul_i32 s93, s93, 6
  s_min_u32 s93, s93, 80
  s_mul_i32 s92, s92, 86
  s_add_u32 s92, s92, s93
  s_lshl_b32 s92, s92, 10
  s_add_u32 s97, s92, 0xa00000
  v_mov_b32 v232, s97
  s_add_u32 s97, s92, 0xa00000
  s_mov_b32 exec_lo, 0xffffffff
  s_mov_b32 exec_hi, 0xffff
  v_add_u32 v232, s97, v234
  s_mov_b64 exec, -1
  s_lshl_b32 s86, s9, 1
  s_and_b32 s87, s10, 1
  s_add_u32 s86, s86, s87
  s_lshl_b32 s86, s86, 1
  s_bfe_u32 s87, s10, 0x10001
  s_add_u32 s86, s86, s87
  s_lshr_b32 s87, s10, 2
  s_lshr_b32 s88, s3, 1
  s_lshl_b32 s89, s86, 1
  s_and_b32 s90, s3, 1
  s_add_u32 s89, s89, s90
  s_lshl_b32 s46, s89, 15
  s_lshl_b32 s90, s88, 14
  s_add_u32 s46, s46, s90
  s_add_u32 s46, s46, 0x600000
  s_mul_i32 s47, s89, 88064
  s_mul_i32 s90, s88, 43008
  s_add_u32 s47, s47, s90
  s_add_u32 s47, s47, 0xa00000
  s_lshl_b32 s45, s89, 12
  s_lshl_b32 s90, s87, 9
  s_add_u32 s45, s45, s90
  s_lshl_b32 s90, s88, 3
  s_add_u32 s45, s45, s90
  s_add_u32 s45, s45, 0x500000
  s_lshl_b32 s44, s89, 15
  s_lshl_b32 s90, s87, 12
  s_add_u32 s44, s44, s90
  s_lshl_b32 s90, s88, 11
  s_add_u32 s44, s44, s90
  s_add_u32 s44, s44, 0x800000
  s_lshl_b32 s48, s86, 3
  s_add_u32 s48, s48, s87
  s_lshl_b32 s48, s48, 2
  s_add_u32 s48, s48, s3
  s_lshl_b32 s48, s48, 2
  s_add_u32 s48, s48, 0x4f2000
  s_lshl_b32 s49, s9, 9
  s_and_b32 s90, s86, 3
  s_lshl_b32 s90, s90, 2
  s_add_u32 s49, s49, s90
  s_add_u32 s49, s49, 0x4f1000
  s_lshr_b32 s50, s86, 1
  s_lshl_b32 s50, s50, 8
  s_and_b32 s90, s89, 3
  s_lshl_b32 s90, s90, 2
  s_add_u32 s50, s50, s90
  s_add_u32 s50, s50, 0x4f3000
  s_mul_i32 s90, s88, 3072
  v_add_u32 v208, s90, v2
  v_xor_b32 v209, 1024, v208
  v_add_u32 v210, 61440, v208
  v_add_u32 v212, 122880, v208
  v_add_u32 v211, 61440, v209
  v_add_u32 v213, 122880, v209
  s_lshl_b32 s90, s3, 12
  s_add_u32 s90, s90, 102400
  v_add_u32 v214, s90, v2
  s_xor_b32 s90, s3, 2
  s_lshl_b32 s90, s90, 12
  s_add_u32 s90, s90, 102400
  v_add_u32 v215, s90, v2
  s_lshl_b32 s86, s9, 1
  s_and_b32 s87, s10, 1
  s_add_u32 s86, s86, s87
  s_lshr_b32 s87, s10, 1
  s_lshr_b32 s88, s10, 1
  s_mul_i32 s88, s88, 6
  s_min_u32 s88, s88, 80
  s_lshl_b32 s89, s86, 2
  s_add_u32 s89, s89, s3
  s_lshl_b32 s51, s89, 15
  s_lshl_b32 s90, s87, 11
  s_add_u32 s58, s51, s90
  s_add_u32 s58, s58, 0x600000
  s_add_u32 s51, s51, 0x800000
  s_lshl_b32 s52, s89, 12
  s_add_u32 s52, s52, 0x500000
  s_mul_i32 s53, s89, 86
  s_add_u32 s53, s53, s88
  s_lshl_b32 s53, s53, 10
  s_add_u32 s53, s53, 0xa00000
  s_mul_i32 s54, s87, 6
  s_sub_u32 s54, s54, s88
  s_lshl_b32 s55, s86, 4
  s_add_u32 s55, s55, s87
  s_lshl_b32 s55, s55, 2
  s_add_u32 s55, s55, s3
  s_lshl_b32 s55, s55, 2
  s_add_u32 s55, s55, 0x4f3000
  s_lshl_b32 s56, s87, 4
  s_add_u32 s56, s56, s86
  s_lshl_b32 s56, s56, 2
  s_add_u32 s56, s56, s3
  s_lshl_b32 s56, s56, 2
  s_add_u32 s56, s56, 0x4f8000
  s_lshr_b32 s57, s89, 1
  s_lshl_b32 s57, s57, 7
  s_and_b32 s90, s3, 1
  s_lshl_b32 s90, s90, 2
  s_add_u32 s57, s57, s90
  s_add_u32 s57, s57, 0x4f2000
  s_lshl_b32 s59, s87, 18
  s_lshl_b32 s90, s89, 11
  s_add_u32 s59, s59, s90
  s_add_u32 s59, s59, 0x1400000
  v_add_u32 v222, 61440, v2
  v_add_u32 v223, 122880, v2
norf_93:
  s_waitcnt vmcnt(3)
  s_barrier
  ds_read_b128 v[12:15], v37
  ds_read_b128 v[20:23], v38
  ds_read_b128 v[24:27], v39
  s_waitcnt lgkmcnt(0)
  v_mfma_f32_32x32x16_bf16 v[40:55], v[12:15], v[4:7], 0
  s_nop 11
  v_exp_f32 v40, v40
  v_exp_f32 v41, v41
  v_smfmac_f32_32x32x32_bf16 v[88:103], v[32:35], v[64:71], v36
  ds_read_b128 v[16:19], v37 offset:2080
  v_exp_f32 v42, v42
  v_exp_f32 v43, v43
  v_exp_f32 v44, v44
  v_mfma_f32_32x32x16_bf16 v[56:71], v[12:15], v[8:11], 0
  ds_read_b128 v[28:31], v38 offset:2080
  v_exp_f32 v45, v45
  v_exp_f32 v46, v46
  v_exp_f32 v47, v47
  v_exp_f32 v48, v48
  v_exp_f32 v49, v49
  v_smfmac_f32_32x32x32_bf16 v[72:87], v[20:23], v[40:47], v36
  ds_read_b128 v[32:35], v39 offset:2080
  v_exp_f32 v50, v50
  v_exp_f32 v51, v51
  v_exp_f32 v52, v52
  v_exp_f32 v53, v53
  v_exp_f32 v54, v54
  v_exp_f32 v55, v55
  v_exp_f32 v56, v56
  v_exp_f32 v57, v57
  v_smfmac_f32_32x32x32_bf16 v[72:87], v[24:27], v[48:55], v36
  s_waitcnt lgkmcnt(0)
  v_exp_f32 v58, v58
  v_exp_f32 v59, v59
  v_exp_f32 v60, v60
  v_mfma_f32_32x32x16_bf16 v[40:55], v[16:19], v[4:7], 0
  v_exp_f32 v61, v61
  v_exp_f32 v62, v62
  v_exp_f32 v63, v63
  v_exp_f32 v64, v64
  v_exp_f32 v65, v65
  v_smfmac_f32_32x32x32_bf16 v[88:103], v[20:23], v[56:63], v36
  v_exp_f32 v66, v66
  v_exp_f32 v67, v67
  v_exp_f32 v68, v68
  v_exp_f32 v69, v69
  v_exp_f32 v70, v70
  v_exp_f32 v71, v71
  s_mov_b32 s8, 0
  s_waitcnt vmcnt(0)
  s_branch pchk_96
pl_94:
  buffer_load_dword v104, v247, s[36:39], s82 offen sc0 sc1
  s_add_u32 s8, s8, 1
  s_cmp_gt_u32 s8, 0x80000
  s_cbranch_scc1 L_abort
  s_waitcnt vmcnt(0)
pchk_96:
  v_cmp_ne_u32 vcc, 1, v104
  s_nop 3
  s_cbranch_vccnz pl_94
  s_barrier
  v_exp_f32 v40, v40
  v_exp_f32 v41, v41
  v_smfmac_f32_32x32x32_bf16 v[88:103], v[24:27], v[64:71], v36
  ds_read_b128 v[12:15], v37 offset:4160
  v_exp_f32 v42, v42
  v_exp_f32 v43, v43
  v_exp_f32 v44, v44
  v_mfma_f32_32x32x16_bf16 v[56:71], v[16:19], v[8:11], 0
  ds_read_b128 v[20:23], v38 offset:4160
  v_exp_f32 v45, v45
  v_exp_f32 v46, v46
  v_exp_f32 v47, v47
  v_exp_f32 v48, v48
  v_exp_f32 v49, v49
  v_smfmac_f32_32x32x32_bf16 v[72:87], v[28:31], v[40:47], v36
  ds_read_b128 v[24:27], v39 offset:4160
  v_exp_f32 v50, v50
  v_exp_f32 v51, v51
  v_exp_f32 v52, v52
  v_exp_f32 v53, v53
  v_exp_f32 v54, v54
  v_exp_f32 v55, v55
  v_exp_f32 v56, v56
  v_exp_f32 v57, v57
  s_mov_b32 m0, s74
  s_add_u32 s74, s74, 8320
  v_smfmac_f32_32x32x32_bf16 v[72:87], v[32:35], v[48:55], v36
  buffer_load_dwordx4 v2, s[12:15], s78 offen sc1 lds
  s_waitcnt lgkmcnt(0)
  v_exp_f32 v58, v58
  v_exp_f32 v59, v59
  v_exp_f32 v60, v60
  v_mfma_f32_32x32x16_bf16 v[40:55], v[12:15], v[4:7], 0
  v_exp_f32 v61, v61
  v_exp_f32 v62, v62
  v_exp_f32 v63, v63
  v_exp_f32 v64, v64
  v_exp_f32 v65, v65
  v_smfmac_f32_32x32x32_bf16 v[88:103], v[28:31], v[56:63], v36
  buffer_load_dwordx4 v2, s[12:15], s78 offen offset:1024 sc1 lds
  s_add_u32 s78, s78, 8192
  s_and_b32 s78, s78, 0x1ffff
  v_exp_f32 v66, v66
  v_exp_f32 v67, v67
  v_exp_f32 v68, v68
  v_exp_f32 v69, v69
  v_exp_f32 v70, v70
  v_exp_f32 v71, v71
  v_exp_f32 v40, v40
  v_exp_f32 v41, v41
  v_smfmac_f32_32x32x32_bf16 v[88:103], v[32:35], v[64:71], v36
  ds_read_b128 v[16:19], v37 offset:6240
  v_exp_f32 v42, v42
  v_exp_f32 v43, v43
  v_exp_f32 v44, v44
  v_mfma_f32_32x32x16_bf16 v[56:71], v[12:15], v[8:11], 0
  ds_read_b128 v[28:31], v38 offset:6240
  v_exp_f32 v45, v45
  v_exp_f32 v46, v46
  v_exp_f32 v47, v47
  v_exp_f32 v48, v48
  v_exp_f32 v49, v49
  v_smfmac_f32_32x32x32_bf16 v[72:87], v[20:23], v[40:47], v36
  ds_read_b128 v[32:35], v39 offset:6240
  v_exp_f32 v50, v50
  v_exp_f32 v51, v51
  v_exp_f32 v52, v52
  v_exp_f32 v53, v53
  v_exp_f32 v54, v54
  v_exp_f32 v55, v55
  v_exp_f32 v56, v56
  v_exp_f32 v57, v57
  s_mov_b32 m0, s74
  s_add_u32 s74, s74, 8320
  v_smfmac_f32_32x32x32_bf16 v[72:87], v[24:27], v[48:55], v36
  buffer_load_dwordx4 v2, s[12:15], s78 offen sc1 lds
  s_waitcnt lgkmcnt(0)
  v_exp_f32 v58, v58
  v_exp_f32 v59, v59
  v_exp_f32 v60, v60
  v_mfma_f32_32x32x16_bf16 v[40:55], v[16:19], v[4:7], 0
  v_exp_f32 v61, v61
  v_exp_f32 v62, v62
  v_exp_f32 v63, v63
  v_exp_f32 v64, v64
  v_exp_f32 v65, v65
  v_smfmac_f32_32x32x32_bf16 v[88:103], v[20:23], v[56:63], v36
  buffer_load_dwordx4 v2, s[12:15], s78 offen offset:1024 sc1 lds
  s_add_u32 s78, s78, 8192
  s_and_b32 s78, s78, 0x1ffff
  v_exp_f32 v66, v66
  v_exp_f32 v67, v67
  v_exp_f32 v68, v68
  v_exp_f32 v69, v69
  v_exp_f32 v70, v70
  v_exp_f32 v71, v71
  v_exp_f32 v40, v40
  v_exp_f32 v41, v41
  v_smfmac_f32_32x32x32_bf16 v[88:103], v[24:27], v[64:71], v36
  ds_read_b128 v[12:15], v37 offset:8320
  v_exp_f32 v42, v42
  v_exp_f32 v43, v43
  v_exp_f32 v44, v44
  v_mfma_f32_32x32x16_bf16 v[56:71], v[16:19], v[8:11], 0
  ds_read_b128 v[20:23], v38 offset:8320
  v_exp_f32 v45, v45
  v_exp_f32 v46, v46
  v_exp_f32 v47, v47
  v_exp_f32 v48, v48
  v_exp_f32 v49, v49
  v_smfmac_f32_32x32x32_bf16 v[72:87], v[28:31], v[40:47], v36
  ds_read_b128 v[24:27], v39 offset:8320
  v_exp_f32 v50, v50
  v_exp_f32 v51, v51
  v_exp_f32 v52, v52
  v_exp_f32 v53, v53
  v_exp_f32 v54, v54
  v_exp_f32 v55, v55
  v_exp_f32 v56, v56
  v_exp_f32 v57, v57
  v_smfmac_f32_32x32x32_bf16 v[72:87], v[32:35], v[48:55], v36
  s_waitcnt lgkmcnt(0)
  v_exp_f32 v58, v58
  v_exp_f32 v59, v59
  v_exp_f32 v60, v60
  v_mfma_f32_32x32x16_bf16 v[40:55], v[12:15], v[4:7], 0
  v_exp_f32 v61, v61
  v_exp_f32 v62, v62
  v_exp_f32 v63, v63
  v_exp_f32 v64, v64
  v_exp_f32 v65, v65
  v_smfmac_f32_32x32x32_bf16 v[88:103], v[28:31], v[56:63], v36
  v_exp_f32 v66, v66
  v_exp_f32 v67, v67
  v_exp_f32 v68, v68
  v_exp_f32 v69, v69
  v_exp_f32 v70, v70
  v_exp_f32 v71, v71
  v_exp_f32 v40, v40
  v_exp_f32 v41, v41
  v_smfmac_f32_32x32x32_bf16 v[88:103], v[32:35], v[64:71], v36
  ds_read_b128 v[16:19], v37 offset:10400
  v_exp_f32 v42, v42
  v_exp_f32 v43, v43
  v_exp_f32 v44, v44
  v_mfma_f32_32x32x16_bf16 v[56:71], v[12:15], v[8:11], 0
  ds_read_b128 v[28:31], v38 offset:10400
  v_exp_f32 v45, v45
  v_exp_f32 v46, v46
  v_exp_f32 v47, v47
  v_exp_f32 v48, v48
  v_exp_f32 v49, v49
  v_smfmac_f32_32x32x32_bf16 v[72:87], v[20:23], v[40:47], v36
  ds_read_b128 v[32:35], v39 offset:10400
  v_exp_f32 v50, v50
  v_exp_f32 v51, v51
  v_exp_f32 v52, v52
  v_exp_f32 v53, v53
  v_exp_f32 v54, v54
  v_exp_f32 v55, v55
  v_exp_f32 v56, v56
  v_exp_f32 v57, v57
  s_mov_b32 m0, s74
  s_add_u32 s74, s74, 8320
  v_smfmac_f32_32x32x32_bf16 v[72:87], v[24:27], v[48:55], v36
  buffer_load_dwordx4 v2, s[12:15], s78 offen sc1 lds
  s_waitcnt lgkmcnt(0)
  v_exp_f32 v58, v58
  v_exp_f32 v59, v59
  v_exp_f32 v60, v60
  v_mfma_f32_32x32x16_bf16 v[40:55], v[16:19], v[4:7], 0
  v_exp_f32 v61, v61
  v_exp_f32 v62, v62
  v_exp_f32 v63, v63
  v_exp_f32 v64, v64
  v_exp_f32 v65, v65
  v_smfmac_f32_32x32x32_bf16 v[88:103], v[20:23], v[56:63], v36
  buffer_load_dwordx4 v2, s[12:15], s78 offen offset:1024 sc1 lds
  s_add_u32 s78, s78, 8192
  s_and_b32 s78, s78, 0x1ffff
  v_exp_f32 v66, v66
  v_exp_f32 v67, v67
  v_exp_f32 v68, v68
  v_exp_f32 v69, v69
  v_exp_f32 v70, v70
  v_exp_f32 v71, v71
  v_exp_f32 v40, v40
  v_exp_f32 v41, v41
  v_smfmac_f32_32x32x32_bf16 v[88:103], v[24:27], v[64:71], v36
  ds_read_b128 v[12:15], v37 offset:12480
  v_exp_f32 v42, v42
  v_exp_f32 v43, v43
  v_exp_f32 v44, v44
  v_mfma_f32_32x32x16_bf16 v[56:71], v[16:19], v[8:11], 0
  ds_read_b128 v[20:23], v38 offset:12480
  v_exp_f32 v45, v45
  v_exp_f32 v46, v46
  v_exp_f32 v47, v47
  v_exp_f32 v48, v48
  v_exp_f32 v49, v49
  v_smfmac_f32_32x32x32_bf16 v[72:87], v[28:31], v[40:47], v36
  ds_read_b128 v[24:27], v39 offset:12480
  v_exp_f32 v50, v50
  v_exp_f32 v51, v51
  v_exp_f32 v52, v52
  v_exp_f32 v53, v53
  v_exp_f32 v54, v54
  v_exp_f32 v55, v55
  v_exp_f32 v56, v56
  v_exp_f32 v57, v57
  s_mov_b32 m0, s74
  s_add_u32 s74, s74, 8320
  v_smfmac_f32_32x32x32_bf16 v[72:87], v[32:35], v[48:55], v36
  buffer_load_dwordx4 v2, s[12:15], s78 offen sc1 lds
  s_waitcnt lgkmcnt(0)
  v_exp_f32 v58, v58
  v_exp_f32 v59, v59
  v_exp_f32 v60, v60
  v_mfma_f32_32x32x16_bf16 v[40:55], v[12:15], v[4:7], 0
  v_exp_f32 v61, v61
  v_exp_f32 v62, v62
  v_exp_f32 v63, v63
  v_exp_f32 v64, v64
  v_exp_f32 v65, v65
  v_smfmac_f32_32x32x32_bf16 v[88:103], v[28:31], v[56:63], v36
  buffer_load_dwordx4 v2, s[12:15], s78 offen offset:1024 sc1 lds
  s_add_u32 s78, s78, 8192
  s_and_b32 s78, s78, 0x1ffff
  v_exp_f32 v66, v66
  v_exp_f32 v67, v67
  v_exp_f32 v68, v68
  v_exp_f32 v69, v69
  v_exp_f32 v70, v70
  v_exp_f32 v71, v71
  v_exp_f32 v40, v40
  v_exp_f32 v41, v41
  v_smfmac_f32_32x32x32_bf16 v[88:103], v[32:35], v[64:71], v36
  ds_read_b128 v[16:19], v37 offset:14560
  v_exp_f32 v42, v42
  v_exp_f32 v43, v43
  v_exp_f32 v44, v44
  v_mfma_f32_32x32x16_bf16 v[56:71], v[12:15], v[8:11], 0
  ds_read_b128 v[28:31], v38 offset:14560
  v_exp_f32 v45, v45
  v_exp_f32 v46, v46
  v_exp_f32 v47, v47
  v_exp_f32 v48, v48
  v_exp_f32 v49, v49
  v_smfmac_f32_32x32x32_bf16 v[72:87], v[20:23], v[40:47], v36
  ds_read_b128 v[32:35], v39 offset:14560
  v_exp_f32 v50, v50
  v_exp_f32 v51, v51
  v_exp_f32 v52, v52
  v_exp_f32 v53, v53
  v_exp_f32 v54, v54
  v_exp_f32 v55, v55
  v_exp_f32 v56, v56
  v_exp_f32 v57, v57
  s_mov_b32 m0, s74
  s_add_u32 s74, s74, 8320
  v_smfmac_f32_32x32x32_bf16 v[72:87], v[24:27], v[48:55], v36
  buffer_load_dwordx4 v2, s[12:15], s78 offen sc1 lds
  s_waitcnt lgkmcnt(0)
  v_exp_f32 v58, v58
  v_exp_f32 v59, v59
  v_exp_f32 v60, v60
  v_mfma_f32_32x32x16_bf16 v[40:55], v[16:19], v[4:7], 0
  v_exp_f32 v61, v61
  v_exp_f32 v62, v62
  v_exp_f32 v63, v63
  v_exp_f32 v64, v64
  v_exp_f32 v65, v65
  v_smfmac_f32_32x32x32_bf16 v[88:103], v[20:23], v[56:63], v36
  buffer_load_dwordx4 v2, s[12:15], s78 offen offset:1024 sc1 lds
  s_add_u32 s78, s78, 8192
  s_and_b32 s78, s78, 0x1ffff
  v_exp_f32 v66, v66
  v_exp_f32 v67, v67
  v_exp_f32 v68, v68
  v_exp_f32 v69, v69
  v_exp_f32 v70, v70
  v_exp_f32 v71, v71
  s_waitcnt vmcnt(6)
  s_barrier
  v_exp_f32 v40, v40
  v_exp_f32 v41, v41
  v_smfmac_f32_32x32x32_bf16 v[88:103], v[24:27], v[64:71], v36
  ds_read_b128 v[12:15], v37 offset:16640
  v_exp_f32 v42, v42
  v_exp_f32 v43, v43
  v_exp_f32 v44, v44
  v_mfma_f32_32x32x16_bf16 v[56:71], v[16:19], v[8:11], 0
  ds_read_b128 v[20:23], v38 offset:16640
  v_exp_f32 v45, v45
  v_exp_f32 v46, v46
  v_exp_f32 v47, v47
  v_exp_f32 v48, v48
  v_exp_f32 v49, v49
  v_smfmac_f32_32x32x32_bf16 v[72:87], v[28:31], v[40:47], v36
  ds_read_b128 v[24:27], v39 offset:16640
  v_exp_f32 v50, v50
  v_exp_f32 v51, v51
  v_exp_f32 v52, v52
  v_exp_f32 v53, v53
  v_exp_f32 v54, v54
  v_exp_f32 v55, v55
  v_exp_f32 v56, v56
  v_exp_f32 v57, v57
  s_mov_b32 m0, s74
  s_add_u32 s74, s74, 8320
  v_smfmac_f32_32x32x32_bf16 v[72:87], v[32:35], v[48:55], v36
  buffer_load_dwordx4 v2, s[12:15], s78 offen sc1 lds
  s_waitcnt lgkmcnt(0)
  v_exp_f32 v58, v58
  v_exp_f32 v59, v59
  v_exp_f32 v60, v60
  v_mfma_f32_32x32x16_bf16 v[40:55], v[12:15], v[4:7], 0
  v_exp_f32 v61, v61
  v_exp_f32 v62, v62
  v_exp_f32 v63, v63
  v_exp_f32 v64, v64
  v_exp_f32 v65, v65
  v_smfmac_f32_32x32x32_bf16 v[88:103], v[28:31], v[56:63], v36
  buffer_load_dwordx4 v2, s[12:15], s78 offen offset:1024 sc1 lds
  s_add_u32 s78, s78, 8192
  s_and_b32 s78, s78, 0x1ffff
  v_exp_f32 v66, v66
  v_exp_f32 v67, v67
  v_exp_f32 v68, v68
  v_exp_f32 v69, v69
  v_exp_f32 v70, v70
  v_exp_f32 v71, v71
  s_cmp_lg_u32 s69, 0
  s_cbranch_scc1 l0_97
  s_cmp_lg_u32 s33, 0
  s_cbranch_scc1 rlgu_98
  s_add_u32 m0, s34, 0
  s_nop 0
  buffer_load_dwordx4 v244, s[40:43], s16 offen lds
  s_add_u32 m0, s34, 1024
  s_nop 0
  buffer_load_dwordx4 v244, s[40:43], s17 offen lds
  s_bitcmp1_b32 s35, 1
  s_cbranch_scc1 rl1_100
  s_add_u32 m0, s34, 2048
  s_nop 0
  buffer_load_dwordx4 v244, s[40:43], s18 offen lds
  s_add_u32 m0, s34, 3072
  s_nop 0
  buffer_load_dwordx4 v244, s[40:43], s19 offen lds
  s_branch rl2_101
rl1_100:
  s_mov_b32 s92, s28
  s_and_b32 s93, s29, 0xffff
  s_mov_b32 s94, 0x158000
  s_mov_b32 s95, 0x20000
  s_add_u32 m0, s34, 2048
  s_nop 0
  buffer_load_dwordx4 v243, s[92:95], s18 offen lds
  s_add_u32 m0, s34, 3072
  s_nop 0
  buffer_load_dwordx4 v243, s[92:95], s19 offen lds
rl2_101:
  s_branch rldone_99
rlgu_98:
  s_mov_b32 s92, s24
  s_and_b32 s93, s25, 0xffff
  s_mov_b32 s94, 0x158000
  s_mov_b32 s95, 0x20000
  s_add_u32 m0, s34, 0
  s_add_u32 s84, s16, 0
  buffer_load_dwordx4 v242, s[92:95], s84 offen lds
  s_add_u32 m0, s34, 2048
  s_add_u32 s84, s16, 44032
  buffer_load_dwordx4 v242, s[92:95], s84 offen lds
  s_add_u32 m0, s34, 4096
  s_add_u32 s84, s16, 88064
  buffer_load_dwordx4 v242, s[92:95], s84 offen lds
  s_add_u32 m0, s34, 6144
  s_add_u32 s84, s16, 132096
  buffer_load_dwordx4 v242, s[92:95], s84 offen lds
rldone_99:
l0_97:
  v_exp_f32 v40, v40
  v_exp_f32 v41, v41
  v_smfmac_f32_32x32x32_bf16 v[88:103], v[32:35], v[64:71], v36
  ds_read_b128 v[16:19], v37 offset:18720
  v_exp_f32 v42, v42
  v_exp_f32 v43, v43
  v_exp_f32 v44, v44
  v_mfma_f32_32x32x16_bf16 v[56:71], v[12:15], v[8:11], 0
  ds_read_b128 v[28:31], v38 offset:18720
  v_exp_f32 v45, v45
  v_exp_f32 v46, v46
  v_exp_f32 v47, v47
  v_exp_f32 v48, v48
  v_exp_f32 v49, v49
  v_smfmac_f32_32x32x32_bf16 v[72:87], v[20:23], v[40:47], v36
  ds_read_b128 v[32:35], v39 offset:18720
  v_exp_f32 v50, v50
  v_exp_f32 v51, v51
  v_exp_f32 v52, v52
  v_exp_f32 v53, v53
  v_exp_f32 v54, v54
  v_exp_f32 v55, v55
  v_exp_f32 v56, v56
  v_exp_f32 v57, v57
  v_smfmac_f32_32x32x32_bf16 v[72:87], v[24:27], v[48:55], v36
  s_waitcnt lgkmcnt(0)
  v_exp_f32 v58, v58
  v_exp_f32 v59, v59
  v_exp_f32 v60, v60
  v_mfma_f32_32x32x16_bf16 v[40:55], v[16:19], v[4:7], 0
  v_exp_f32 v61, v61
  v_exp_f32 v62, v62
  v_exp_f32 v63, v63
  v_exp_f32 v64, v64
  v_exp_f32 v65, v65
  s_mov_b32 m0, s74
  s_add_u32 s74, s74, 8320
  v_smfmac_f32_32x32x32_bf16 v[88:103], v[20:23], v[56:63], v36
  buffer_load_dwordx4 v2, s[12:15], s78 offen sc1 lds
  v_exp_f32 v66, v66
  v_exp_f32 v67, v67
  v_exp_f32 v68, v68
  v_exp_f32 v69, v69
  v_exp_f32 v70, v70
  v_exp_f32 v71, v71
  v_exp_f32 v40, v40
  v_exp_f32 v41, v41
  v_smfmac_f32_32x32x32_bf16 v[88:103], v[24:27], v[64:71], v36
  ds_read_b128 v[12:15], v37 offset:20800
  v_exp_f32 v42, v42
  v_exp_f32 v43, v43
  v_exp_f32 v44, v44
  v_mfma_f32_32x32x16_bf16 v[56:71], v[16:19], v[8:11], 0
  ds_read_b128 v[20:23], v38 offset:20800
  v_exp_f32 v45, v45
  v_exp_f32 v46, v46
  v_exp_f32 v47, v47
  v_exp_f32 v48, v48
  v_exp_f32 v49, v49
  v_smfmac_f32_32x32x32_bf16 v[72:87], v[28:31], v[40:47], v36
  ds_read_b128 v[24:27], v39 offset:20800
  v_exp_f32 v50, v50
  v_exp_f32 v51, v51
  v_exp_f32 v52, v52
  v_exp_f32 v53, v53
  v_exp_f32 v54, v54
  v_exp_f32 v55, v55
  v_exp_f32 v56, v56
  v_exp_f32 v57, v57
  v_smfmac_f32_32x32x32_bf16 v[72:87], v[32:35], v[48:55], v36
  s_waitcnt lgkmcnt(0)
  v_exp_f32 v58, v58
  v_exp_f32 v59, v59
  v_exp_f32 v60, v60
  v_mfma_f32_32x32x16_bf16 v[40:55], v[12:15], v[4:7], 0
  v_exp_f32 v61, v61
  v_exp_f32 v62, v62
  v_exp_f32 v63, v63
  v_exp_f32 v64, v64
  v_exp_f32 v65, v65
  v_smfmac_f32_32x32x32_bf16 v[88:103], v[28:31], v[56:63], v36
  buffer_load_dwordx4 v2, s[12:15], s78 offen offset:1024 sc1 lds
  s_add_u32 s78, s78, 8192
  s_and_b32 s78, s78, 0x1ffff
  v_exp_f32 v66, v66
  v_exp_f32 v67, v67
  v_exp_f32 v68, v68
  v_exp_f32 v69, v69
  v_exp_f32 v70, v70
  v_exp_f32 v71, v71
  v_exp_f32 v40, v40
  v_exp_f32 v41, v41
  v_smfmac_f32_32x32x32_bf16 v[88:103], v[32:35], v[64:71], v36
  ds_read_b128 v[16:19], v37 offset:22880
  v_exp_f32 v42, v42
  v_exp_f32 v43, v43
  v_exp_f32 v44, v44
  v_mfma_f32_32x32x16_bf16 v[56:71], v[12:15], v[8:11], 0
  ds_read_b128 v[28:31], v38 offset:22880
  v_exp_f32 v45, v45
  v_exp_f32 v46, v46
  v_exp_f32 v47, v47
  v_exp_f32 v48, v48
  v_exp_f32 v49, v49
  v_smfmac_f32_32x32x32_bf16 v[72:87], v[20:23], v[40:47], v36
  ds_read_b128 v[32:35], v39 offset:22880
  v_exp_f32 v50, v50
  v_exp_f32 v51, v51
  v_exp_f32 v52, v52
  v_exp_f32 v53, v53
  v_exp_f32 v54, v54
  v_exp_f32 v55, v55
  v_exp_f32 v56, v56
  v_exp_f32 v57, v57
  v_smfmac_f32_32x32x32_bf16 v[72:87], v[24:27], v[48:55], v36
  s_waitcnt lgkmcnt(0)
  v_exp_f32 v58, v58
  v_exp_f32 v59, v59
  v_exp_f32 v60, v60
  v_mfma_f32_32x32x16_bf16 v[40:55], v[16:19], v[4:7], 0
  v_exp_f32 v61, v61
  v_exp_f32 v62, v62
  v_exp_f32 v63, v63
  v_exp_f32 v64, v64
  v_exp_f32 v65, v65
  s_mov_b32 m0, s74
  s_add_u32 s74, s74, 8320
  v_smfmac_f32_32x32x32_bf16 v[88:103], v[20:23], v[56:63], v36
  buffer_load_dwordx4 v2, s[12:15], s78 offen sc1 lds
  v_exp_f32 v66, v66
  v_exp_f32 v67, v67
  v_exp_f32 v68, v68
  v_exp_f32 v69, v69
  v_exp_f32 v70, v70
  v_exp_f32 v71, v71
  v_exp_f32 v40, v40
  v_exp_f32 v41, v41
  v_smfmac_f32_32x32x32_bf16 v[88:103], v[24:27], v[64:71], v36
  ds_read_b128 v[12:15], v37 offset:24960
  v_exp_f32 v42, v42
  v_exp_f32 v43, v43
  v_exp_f32 v44, v44
  v_mfma_f32_32x32x16_bf16 v[56:71], v[16:19], v[8:11], 0
  ds_read_b128 v[20:23], v38 offset:24960
  v_exp_f32 v45, v45
  v_exp_f32 v46, v46
  v_exp_f32 v47, v47
  v_exp_f32 v48, v48
  v_exp_f32 v49, v49
  v_smfmac_f32_32x32x32_bf16 v[72:87], v[28:31], v[40:47], v36
  ds_read_b128 v[24:27], v39 offset:24960
  v_exp_f32 v50, v50
  v_exp_f32 v51, v51
  v_exp_f32 v52, v52
  v_exp_f32 v53, v53
  v_exp_f32 v54, v54
  v_exp_f32 v55, v55
  v_exp_f32 v56, v56
  v_exp_f32 v57, v57
  v_smfmac_f32_32x32x32_bf16 v[72:87], v[32:35], v[48:55], v36
  s_waitcnt lgkmcnt(0)
  v_exp_f32 v58, v58
  v_exp_f32 v59, v59
  v_exp_f32 v60, v60
  v_mfma_f32_32x32x16_bf16 v[40:55], v[12:15], v[4:7], 0
  v_exp_f32 v61, v61
  v_exp_f32 v62, v62
  v_exp_f32 v63, v63
  v_exp_f32 v64, v64
  v_exp_f32 v65, v65
  v_smfmac_f32_32x32x32_bf16 v[88:103], v[28:31], v[56:63], v36
  buffer_load_dwordx4 v2, s[12:15], s78 offen offset:1024 sc1 lds
  s_add_u32 s78, s78, 8192
  s_and_b32 s78, s78, 0x1ffff
  v_exp_f32 v66, v66
  v_exp_f32 v67, v67
  v_exp_f32 v68, v68
  v_exp_f32 v69, v69
  v_exp_f32 v70, v70
  v_exp_f32 v71, v71
  s_waitcnt vmcnt(4)
  s_barrier
  s_cmp_lg_u32 s69, 0
  s_cbranch_scc1 l0_102
  s_cmp_lg_u32 s33, 0
  s_cbranch_scc1 rlgu_103
  s_bitcmp1_b32 s35, 2
  s_cselect_b32 s92, s20, s28
  s_cselect_b32 s93, s21, s29
  s_mov_b32 s94, 0x158000
  s_cselect_b32 s94, 0x80000, s94
  s_and_b32 s93, s93, 0xffff
  s_mov_b32 s95, 0x20000
  s_add_u32 m0, s34, 4096
  s_nop 0
  buffer_load_dwordx4 v243, s[92:95], s22 offen lds
  s_add_u32 m0, s34, 5120
  s_nop 0
  buffer_load_dwordx4 v243, s[92:95], s23 offen lds
  s_branch rldone_104
rlgu_103:
  s_mov_b32 s92, s26
  s_and_b32 s93, s27, 0xffff
  s_mov_b32 s94, 0x158000
  s_mov_b32 s95, 0x20000
  s_add_u32 m0, s34, 1024
  s_add_u32 s84, s16, 0
  buffer_load_dwordx4 v241, s[92:95], s84 offen lds
  s_add_u32 m0, s34, 3072
  s_add_u32 s84, s16, 44032
  buffer_load_dwordx4 v241, s[92:95], s84 offen lds
  s_add_u32 m0, s34, 5120
  s_add_u32 s84, s16, 88064
  buffer_load_dwordx4 v241, s[92:95], s84 offen lds
  s_add_u32 m0, s34, 7168
  s_add_u32 s84, s16, 132096
  buffer_load_dwordx4 v241, s[92:95], s84 offen lds
rldone_104:
l0_102:
  v_exp_f32 v40, v40
  v_exp_f32 v41, v41
  v_smfmac_f32_32x32x32_bf16 v[88:103], v[32:35], v[64:71], v36
  ds_read_b128 v[16:19], v37 offset:27040
  v_exp_f32 v42, v42
  v_exp_f32 v43, v43
  v_exp_f32 v44, v44
  v_mfma_f32_32x32x16_bf16 v[56:71], v[12:15], v[8:11], 0
  ds_read_b128 v[28:31], v38 offset:27040
  v_exp_f32 v45, v45
  v_exp_f32 v46, v46
  v_exp_f32 v47, v47
  v_exp_f32 v48, v48
  v_exp_f32 v49, v49
  v_smfmac_f32_32x32x32_bf16 v[72:87], v[20:23], v[40:47], v36
  ds_read_b128 v[32:35], v39 offset:27040
  v_exp_f32 v50, v50
  v_exp_f32 v51, v51
  v_exp_f32 v52, v52
  v_exp_f32 v53, v53
  v_exp_f32 v54, v54
  v_exp_f32 v55, v55
  v_exp_f32 v56, v56
  v_exp_f32 v57, v57
  v_smfmac_f32_32x32x32_bf16 v[72:87], v[24:27], v[48:55], v36
  s_waitcnt lgkmcnt(0)
  v_exp_f32 v58, v58
  v_exp_f32 v59, v59
  v_exp_f32 v60, v60
  v_mfma_f32_32x32x16_bf16 v[40:55], v[16:19], v[4:7], 0
  v_exp_f32 v61, v61
  v_exp_f32 v62, v62
  v_exp_f32 v63, v63
  v_exp_f32 v64, v64
  v_exp_f32 v65, v65
  s_mov_b32 m0, s74
  s_add_u32 s74, s74, 8320
  v_smfmac_f32_32x32x32_bf16 v[88:103], v[20:23], v[56:63], v36
  buffer_load_dwordx4 v2, s[12:15], s78 offen sc1 lds
  v_exp_f32 v66, v66
  v_exp_f32 v67, v67
  v_exp_f32 v68, v68
  v_exp_f32 v69, v69
  v_exp_f32 v70, v70
  v_exp_f32 v71, v71
  v_exp_f32 v40, v40
  v_exp_f32 v41, v41
  v_smfmac_f32_32x32x32_bf16 v[88:103], v[24:27], v[64:71], v36
  ds_read_b128 v[12:15], v37 offset:29120
  v_exp_f32 v42, v42
  v_exp_f32 v43, v43
  v_exp_f32 v44, v44
  v_mfma_f32_32x32x16_bf16 v[56:71], v[16:19], v[8:11], 0
  ds_read_b128 v[20:23], v38 offset:29120
  v_exp_f32 v45, v45
  v_exp_f32 v46, v46
  v_exp_f32 v47, v47
  v_exp_f32 v48, v48
  v_exp_f32 v49, v49
  v_smfmac_f32_32x32x32_bf16 v[72:87], v[28:31], v[40:47], v36
  ds_read_b128 v[24:27], v39 offset:29120
  v_exp_f32 v50, v50
  v_exp_f32 v51, v51
  v_exp_f32 v52, v52
  v_exp_f32 v53, v53
  v_exp_f32 v54, v54
  v_exp_f32 v55, v55
  v_exp_f32 v56, v56
  v_exp_f32 v57, v57
  v_smfmac_f32_32x32x32_bf16 v[72:87], v[32:35], v[48:55], v36
  s_waitcnt lgkmcnt(0)
  v_exp_f32 v58, v58
  v_exp_f32 v59, v59
  v_exp_f32 v60, v60
  v_mfma_f32_32x32x16_bf16 v[40:55], v[12:15], v[4:7], 0
  v_exp_f32 v61, v61
  v_exp_f32 v62, v62
  v_exp_f32 v63, v63
  v_exp_f32 v64, v64
  v_exp_f32 v65, v65
  v_smfmac_f32_32x32x32_bf16 v[88:103], v[28:31], v[56:63], v36
  buffer_load_dwordx4 v2, s[12:15], s78 offen offset:1024 sc1 lds
  s_add_u32 s78, s78, 8192
  s_and_b32 s78, s78, 0x1ffff
  v_exp_f32 v66, v66
  v_exp_f32 v67, v67
  v_exp_f32 v68, v68
  v_exp_f32 v69, v69
  v_exp_f32 v70, v70
  v_exp_f32 v71, v71
  v_exp_f32 v40, v40
  v_exp_f32 v41, v41
  v_smfmac_f32_32x32x32_bf16 v[88:103], v[32:35], v[64:71], v36
  ds_read_b128 v[16:19], v37 offset:31200
  v_exp_f32 v42, v42
  v_exp_f32 v43, v43
  v_exp_f32 v44, v44
  v_mfma_f32_32x32x16_bf16 v[56:71], v[12:15], v[8:11], 0
  ds_read_b128 v[28:31], v38 offset:31200
  v_exp_f32 v45, v45
  v_exp_f32 v46, v46
  v_exp_f32 v47, v47
  v_exp_f32 v48, v48
  v_exp_f32 v49, v49
  v_smfmac_f32_32x32x32_bf16 v[72:87], v[20:23], v[40:47], v36
  ds_read_b128 v[32:35], v39 offset:31200
  v_exp_f32 v50, v50
  v_exp_f32 v51, v51
  v_exp_f32 v52, v52
  v_exp_f32 v53, v53
  v_exp_f32 v54, v54
  v_exp_f32 v55, v55
  v_exp_f32 v56, v56
  v_exp_f32 v57, v57
  v_smfmac_f32_32x32x32_bf16 v[72:87], v[24:27], v[48:55], v36
  s_waitcnt lgkmcnt(0)
  v_exp_f32 v58, v58
  v_exp_f32 v59, v59
  v_exp_f32 v60, v60
  v_mfma_f32_32x32x16_bf16 v[40:55], v[16:19], v[4:7], 0
  v_exp_f32 v61, v61
  v_exp_f32 v62, v62
  v_exp_f32 v63, v63
  v_exp_f32 v64, v64
  v_exp_f32 v65, v65
  s_mov_b32 m0, s74
  s_add_u32 s74, s74, 8320
  v_smfmac_f32_32x32x32_bf16 v[88:103], v[20:23], v[56:63], v36
  buffer_load_dwordx4 v2, s[12:15], s78 offen sc1 lds
  v_exp_f32 v66, v66
  v_exp_f32 v67, v67
  v_exp_f32 v68, v68
  v_exp_f32 v69, v69
  v_exp_f32 v70, v70
  v_exp_f32 v71, v71
  v_exp_f32 v40, v40
  v_exp_f32 v41, v41
  v_smfmac_f32_32x32x32_bf16 v[88:103], v[24:27], v[64:71], v36
  ds_read_b128 v[12:15], v37 offset:33280
  v_exp_f32 v42, v42
  v_exp_f32 v43, v43
  v_exp_f32 v44, v44
  v_mfma_f32_32x32x16_bf16 v[56:71], v[16:19], v[8:11], 0
  ds_read_b128 v[20:23], v38 offset:33280
  v_exp_f32 v45, v45
  v_exp_f32 v46, v46
  v_exp_f32 v47, v47
  v_exp_f32 v48, v48
  v_exp_f32 v49, v49
  v_smfmac_f32_32x32x32_bf16 v[72:87], v[28:31], v[40:47], v36
  ds_read_b128 v[24:27], v39 offset:33280
  v_exp_f32 v50, v50
  v_exp_f32 v51, v51
  v_exp_f32 v52, v52
  v_exp_f32 v53, v53
  v_exp_f32 v54, v54
  v_exp_f32 v55, v55
  v_exp_f32 v56, v56
  v_exp_f32 v57, v57
  v_smfmac_f32_32x32x32_bf16 v[72:87], v[32:35], v[48:55], v36
  s_waitcnt lgkmcnt(0)
  v_exp_f32 v58, v58
  v_exp_f32 v59, v59
  v_exp_f32 v60, v60
  v_mfma_f32_32x32x16_bf16 v[40:55], v[12:15], v[4:7], 0
  v_exp_f32 v61, v61
  v_exp_f32 v62, v62
  v_exp_f32 v63, v63
  v_exp_f32 v64, v64
  v_exp_f32 v65, v65
  v_smfmac_f32_32x32x32_bf16 v[88:103], v[28:31], v[56:63], v36
  buffer_load_dwordx4 v2, s[12:15], s78 offen offset:1024 sc1 lds
  s_add_u32 s78, s78, 8192
  s_and_b32 s78, s78, 0x1ffff
  v_exp_f32 v66, v66
  v_exp_f32 v67, v67
  v_exp_f32 v68, v68
  v_exp_f32 v69, v69
  v_exp_f32 v70, v70
  v_exp_f32 v71, v71
  v_exp_f32 v40, v40
  v_exp_f32 v41, v41
  v_smfmac_f32_32x32x32_bf16 v[88:103], v[32:35], v[64:71], v36
  ds_read_b128 v[16:19], v37 offset:35360
  v_exp_f32 v42, v42
  v_exp_f32 v43, v43
  v_exp_f32 v44, v44
  v_mfma_f32_32x32x16_bf16 v[56:71], v[12:15], v[8:11], 0
  ds_read_b128 v[28:31], v38 offset:35360
  v_exp_f32 v45, v45
  v_exp_f32 v46, v46
  v_exp_f32 v47, v47
  v_exp_f32 v48, v48
  v_exp_f32 v49, v49
  v_smfmac_f32_32x32x32_bf16 v[72:87], v[20:23], v[40:47], v36
  ds_read_b128 v[32:35], v39 offset:35360
  v_exp_f32 v50, v50
  v_exp_f32 v51, v51
  v_exp_f32 v52, v52
  v_exp_f32 v53, v53
  v_exp_f32 v54, v54
  v_exp_f32 v55, v55
  v_exp_f32 v56, v56
  v_exp_f32 v57, v57
  v_smfmac_f32_32x32x32_bf16 v[72:87], v[24:27], v[48:55], v36
  s_waitcnt lgkmcnt(0)
  v_exp_f32 v58, v58
  v_exp_f32 v59, v59
  v_exp_f32 v60, v60
  v_mfma_f32_32x32x16_bf16 v[40:55], v[16:19], v[4:7], 0
  v_exp_f32 v61, v61
  v_exp_f32 v62, v62
  v_exp_f32 v63, v63
  v_exp_f32 v64, v64
  v_exp_f32 v65, v65
  s_mov_b32 m0, s74
  s_add_u32 s74, s74, 8320
  v_smfmac_f32_32x32x32_bf16 v[88:103], v[20:23], v[56:63], v36
  buffer_load_dwordx4 v2, s[12:15], s78 offen sc1 lds
  v_exp_f32 v66, v66
  v_exp_f32 v67, v67
  v_exp_f32 v68, v68
  v_exp_f32 v69, v69
  v_exp_f32 v70, v70
  v_exp_f32 v71, v71
  v_exp_f32 v40, v40
  v_exp_f32 v41, v41
  v_smfmac_f32_32x32x32_bf16 v[88:103], v[24:27], v[64:71], v36
  ds_read_b128 v[12:15], v37 offset:37440
  v_exp_f32 v42, v42
  v_exp_f32 v43, v43
  v_exp_f32 v44, v44
  v_mfma_f32_32x32x16_bf16 v[56:71], v[16:19], v[8:11], 0
  ds_read_b128 v[20:23], v38 offset:37440
  v_exp_f32 v45, v45
  v_exp_f32 v46, v46
  v_exp_f32 v47, v47
  v_exp_f32 v48, v48
  v_exp_f32 v49, v49
  v_smfmac_f32_32x32x32_bf16 v[72:87], v[28:31], v[40:47], v36
  ds_read_b128 v[24:27], v39 offset:37440
  v_exp_f32 v50, v50
  v_exp_f32 v51, v51
  v_exp_f32 v52, v52
  v_exp_f32 v53, v53
  v_exp_f32 v54, v54
  v_exp_f32 v55, v55
  v_exp_f32 v56, v56
  v_exp_f32 v57, v57
  v_smfmac_f32_32x32x32_bf16 v[72:87], v[32:35], v[48:55], v36
  s_waitcnt lgkmcnt(0)
  v_exp_f32 v58, v58
  v_exp_f32 v59, v59
  v_exp_f32 v60, v60
  v_mfma_f32_32x32x16_bf16 v[40:55], v[12:15], v[4:7], 0
  v_exp_f32 v61, v61
  v_exp_f32 v62, v62
  v_exp_f32 v63, v63
  v_exp_f32 v64, v64
  v_exp_f32 v65, v65
  v_smfmac_f32_32x32x32_bf16 v[88:103], v[28:31], v[56:63], v36
  buffer_load_dwordx4 v2, s[12:15], s78 offen offset:1024 sc1 lds
  s_add_u32 s78, s78, 8192
  s_and_b32 s78, s78, 0x1ffff
  v_exp_f32 v66, v66
  v_exp_f32 v67, v67
  v_exp_f32 v68, v68
  v_exp_f32 v69, v69
  v_exp_f32 v70, v70
  v_exp_f32 v71, v71
  v_exp_f32 v40, v40
  v_exp_f32 v41, v41
  v_smfmac_f32_32x32x32_bf16 v[88:103], v[32:35], v[64:71], v36
  ds_read_b128 v[16:19], v37 offset:39520
  v_exp_f32 v42, v42
  v_exp_f32 v43, v43
  v_exp_f32 v44, v44
  v_mfma_f32_32x32x16_bf16 v[56:71], v[12:15], v[8:11], 0
  ds_read_b128 v[28:31], v38 offset:39520
  v_exp_f32 v45, v45
  v_exp_f32 v46, v46
  v_exp_f32 v47, v47
  v_exp_f32 v48, v48
  v_exp_f32 v49, v49
  v_smfmac_f32_32x32x32_bf16 v[72:87], v[20:23], v[40:47], v36
  ds_read_b128 v[32:35], v39 offset:39520
  v_exp_f32 v50, v50
  v_exp_f32 v51, v51
  v_exp_f32 v52, v52
  v_exp_f32 v53, v53
  v_exp_f32 v54, v54
  v_exp_f32 v55, v55
  v_exp_f32 v56, v56
  v_exp_f32 v57, v57
  v_smfmac_f32_32x32x32_bf16 v[72:87], v[24:27], v[48:55], v36
  s_waitcnt lgkmcnt(0)
  v_exp_f32 v58, v58
  v_exp_f32 v59, v59
  v_exp_f32 v60, v60
  v_mfma_f32_32x32x16_bf16 v[40:55], v[16:19], v[4:7], 0
  v_exp_f32 v61, v61
  v_exp_f32 v62, v62
  v_exp_f32 v63, v63
  v_exp_f32 v64, v64
  v_exp_f32 v65, v65
  s_mov_b32 m0, s74
  s_add_u32 s74, s74, 8320
  v_smfmac_f32_32x32x32_bf16 v[88:103], v[20:23], v[56:63], v36
  buffer_load_dwordx4 v2, s[12:15], s78 offen sc1 lds
  v_exp_f32 v66, v66
  v_exp_f32 v67, v67
  v_exp_f32 v68, v68
  v_exp_f32 v69, v69
  v_exp_f32 v70, v70
  v_exp_f32 v71, v71
  v_exp_f32 v40, v40
  v_exp_f32 v41, v41
  v_smfmac_f32_32x32x32_bf16 v[88:103], v[24:27], v[64:71], v36
  ds_read_b128 v[12:15], v37 offset:41600
  v_exp_f32 v42, v42
  v_exp_f32 v43, v43
  v_exp_f32 v44, v44
  v_mfma_f32_32x32x16_bf16 v[56:71], v[16:19], v[8:11], 0
  ds_read_b128 v[20:23], v38 offset:41600
  v_exp_f32 v45, v45
  v_exp_f32 v46, v46
  v_exp_f32 v47, v47
  v_exp_f32 v48, v48
  v_exp_f32 v49, v49
  v_smfmac_f32_32x32x32_bf16 v[72:87], v[28:31], v[40:47], v36
  ds_read_b128 v[24:27], v39 offset:41600
  v_exp_f32 v50, v50
  v_exp_f32 v51, v51
  v_exp_f32 v52, v52
  v_exp_f32 v53, v53
  v_exp_f32 v54, v54
  v_exp_f32 v55, v55
  v_exp_f32 v56, v56
  v_exp_f32 v57, v57
  v_smfmac_f32_32x32x32_bf16 v[72:87], v[32:35], v[48:55], v36
  s_waitcnt lgkmcnt(0)
  v_exp_f32 v58, v58
  v_exp_f32 v59, v59
  v_exp_f32 v60, v60
  v_mfma_f32_32x32x16_bf16 v[40:55], v[12:15], v[4:7], 0
  v_exp_f32 v61, v61
  v_exp_f32 v62, v62
  v_exp_f32 v63, v63
  v_exp_f32 v64, v64
  v_exp_f32 v65, v65
  v_smfmac_f32_32x32x32_bf16 v[88:103], v[28:31], v[56:63], v36
  buffer_load_dwordx4 v2, s[12:15], s78 offen offset:1024 sc1 lds
  s_add_u32 s78, s78, 8192
  s_and_b32 s78, s78, 0x1ffff
  v_exp_f32 v66, v66
  v_exp_f32 v67, v67
  v_exp_f32 v68, v68
  v_exp_f32 v69, v69
  v_exp_f32 v70, v70
  v_exp_f32 v71, v71
  v_exp_f32 v40, v40
  v_exp_f32 v41, v41
  v_smfmac_f32_32x32x32_bf16 v[88:103], v[32:35], v[64:71], v36
  ds_read_b128 v[16:19], v37 offset:43680
  v_exp_f32 v42, v42
  v_exp_f32 v43, v43
  v_exp_f32 v44, v44
  v_mfma_f32_32x32x16_bf16 v[56:71], v[12:15], v[8:11], 0
  ds_read_b128 v[28:31], v38 offset:43680
  v_exp_f32 v45, v45
  v_exp_f32 v46, v46
  v_exp_f32 v47, v47
  v_exp_f32 v48, v48
  v_exp_f32 v49, v49
  v_smfmac_f32_32x32x32_bf16 v[72:87], v[20:23], v[40:47], v36
  ds_read_b128 v[32:35], v39 offset:43680
  v_exp_f32 v50, v50
  v_exp_f32 v51, v51
  v_exp_f32 v52, v52
  v_exp_f32 v53, v53
  v_exp_f32 v54, v54
  v_exp_f32 v55, v55
  v_exp_f32 v56, v56
  v_exp_f32 v57, v57
  v_smfmac_f32_32x32x32_bf16 v[72:87], v[24:27], v[48:55], v36
  s_waitcnt lgkmcnt(0)
  v_exp_f32 v58, v58
  v_exp_f32 v59, v59
  v_exp_f32 v60, v60
  v_mfma_f32_32x32x16_bf16 v[40:55], v[16:19], v[4:7], 0
  v_exp_f32 v61, v61
  v_exp_f32 v62, v62
  v_exp_f32 v63, v63
  v_exp_f32 v64, v64
  v_exp_f32 v65, v65
  s_mov_b32 m0, s74
  s_add_u32 s74, s74, 8320
  v_smfmac_f32_32x32x32_bf16 v[88:103], v[20:23], v[56:63], v36
  buffer_load_dwordx4 v2, s[12:15], s78 offen sc1 lds
  v_exp_f32 v66, v66
  v_exp_f32 v67, v67
  v_exp_f32 v68, v68
  v_exp_f32 v69, v69
  v_exp_f32 v70, v70
  v_exp_f32 v71, v71
  v_exp_f32 v40, v40
  v_exp_f32 v41, v41
  v_smfmac_f32_32x32x32_bf16 v[88:103], v[24:27], v[64:71], v36
  ds_read_b128 v[12:15], v37 offset:45760
  v_exp_f32 v42, v42
  v_exp_f32 v43, v43
  v_exp_f32 v44, v44
  v_mfma_f32_32x32x16_bf16 v[56:71], v[16:19], v[8:11], 0
  ds_read_b128 v[20:23], v38 offset:45760
  v_exp_f32 v45, v45
  v_exp_f32 v46, v46
  v_exp_f32 v47, v47
  v_exp_f32 v48, v48
  v_exp_f32 v49, v49
  v_smfmac_f32_32x32x32_bf16 v[72:87], v[28:31], v[40:47], v36
  ds_read_b128 v[24:27], v39 offset:45760
  v_exp_f32 v50, v50
  v_exp_f32 v51, v51
  v_exp_f32 v52, v52
  v_exp_f32 v53, v53
  v_exp_f32 v54, v54
  v_exp_f32 v55, v55
  v_exp_f32 v56, v56
  v_exp_f32 v57, v57
  v_smfmac_f32_32x32x32_bf16 v[72:87], v[32:35], v[48:55], v36
  s_waitcnt lgkmcnt(0)
  v_exp_f32 v58, v58
  v_exp_f32 v59, v59
  v_exp_f32 v60, v60
  v_mfma_f32_32x32x16_bf16 v[40:55], v[12:15], v[4:7], 0
  v_exp_f32 v61, v61
  v_exp_f32 v62, v62
  v_exp_f32 v63, v63
  v_exp_f32 v64, v64
  v_exp_f32 v65, v65
  v_smfmac_f32_32x32x32_bf16 v[88:103], v[28:31], v[56:63], v36
  buffer_load_dwordx4 v2, s[12:15], s78 offen offset:1024 sc1 lds
  s_add_u32 s78, s78, 8192
  s_and_b32 s78, s78, 0x1ffff
  v_exp_f32 v66, v66
  v_exp_f32 v67, v67
  v_exp_f32 v68, v68
  v_exp_f32 v69, v69
  v_exp_f32 v70, v70
  v_exp_f32 v71, v71
  v_exp_f32 v40, v40
  v_exp_f32 v41, v41
  v_smfmac_f32_32x32x32_bf16 v[88:103], v[32:35], v[64:71], v36
  ds_read_b128 v[16:19], v37 offset:47840
  v_exp_f32 v42, v42
  v_exp_f32 v43, v43
  v_exp_f32 v44, v44
  v_mfma_f32_32x32x16_bf16 v[56:71], v[12:15], v[8:11], 0
  ds_read_b128 v[28:31], v38 offset:47840
  v_exp_f32 v45, v45
  v_exp_f32 v46, v46
  v_exp_f32 v47, v47
  v_exp_f32 v48, v48
  v_exp_f32 v49, v49
  v_smfmac_f32_32x32x32_bf16 v[72:87], v[20:23], v[40:47], v36
  ds_read_b128 v[32:35], v39 offset:47840
  v_exp_f32 v50, v50
  v_exp_f32 v51, v51
  v_exp_f32 v52, v52
  v_exp_f32 v53, v53
  v_exp_f32 v54, v54
  v_exp_f32 v55, v55
  v_exp_f32 v56, v56
  v_exp_f32 v57, v57
  v_smfmac_f32_32x32x32_bf16 v[72:87], v[24:27], v[48:55], v36
  s_waitcnt lgkmcnt(0)
  v_exp_f32 v58, v58
  v_exp_f32 v59, v59
  v_exp_f32 v60, v60
  v_mfma_f32_32x32x16_bf16 v[40:55], v[16:19], v[4:7], 0
  v_exp_f32 v61, v61
  v_exp_f32 v62, v62
  v_exp_f32 v63, v63
  v_exp_f32 v64, v64
  v_exp_f32 v65, v65
  s_mov_b32 m0, s74
  s_add_u32 s74, s74, 8320
  v_smfmac_f32_32x32x32_bf16 v[88:103], v[20:23], v[56:63], v36
  buffer_load_dwordx4 v2, s[12:15], s78 offen sc1 lds
  v_exp_f32 v66, v66
  v_exp_f32 v67, v67
  v_exp_f32 v68, v68
  v_exp_f32 v69, v69
  v_exp_f32 v70, v70
  v_exp_f32 v71, v71
  v_exp_f32 v40, v40
  v_exp_f32 v41, v41
  v_smfmac_f32_32x32x32_bf16 v[88:103], v[24:27], v[64:71], v36
  ds_read_b128 v[12:15], v37 offset:49920
  v_exp_f32 v42, v42
  v_exp_f32 v43, v43
  v_exp_f32 v44, v44
  v_mfma_f32_32x32x16_bf16 v[56:71], v[16:19], v[8:11], 0
  ds_read_b128 v[20:23], v38 offset:49920
  v_exp_f32 v45, v45
  v_exp_f32 v46, v46
  v_exp_f32 v47, v47
  v_exp_f32 v48, v48
  v_exp_f32 v49, v49
  v_smfmac_f32_32x32x32_bf16 v[72:87], v[28:31], v[40:47], v36
  ds_read_b128 v[24:27], v39 offset:49920
  v_exp_f32 v50, v50
  v_exp_f32 v51, v51
  v_exp_f32 v52, v52
  v_exp_f32 v53, v53
  v_exp_f32 v54, v54
  v_exp_f32 v55, v55
  v_exp_f32 v56, v56
  v_exp_f32 v57, v57
  v_smfmac_f32_32x32x32_bf16 v[72:87], v[32:35], v[48:55], v36
  s_waitcnt lgkmcnt(0)
  v_exp_f32 v58, v58
  v_exp_f32 v59, v59
  v_exp_f32 v60, v60
  v_mfma_f32_32x32x16_bf16 v[40:55], v[12:15], v[4:7], 0
  v_exp_f32 v61, v61
  v_exp_f32 v62, v62
  v_exp_f32 v63, v63
  v_exp_f32 v64, v64
  v_exp_f32 v65, v65
  v_smfmac_f32_32x32x32_bf16 v[88:103], v[28:31], v[56:63], v36
  buffer_load_dwordx4 v2, s[12:15], s78 offen offset:1024 sc1 lds
  s_add_u32 s78, s78, 8192
  s_and_b32 s78, s78, 0x1ffff
  v_exp_f32 v66, v66
  v_exp_f32 v67, v67
  v_exp_f32 v68, v68
  v_exp_f32 v69, v69
  v_exp_f32 v70, v70
  v_exp_f32 v71, v71
  s_cmp_lg_u32 s69, 0
  s_cbranch_scc1 l0_105
  s_waitcnt vmcnt(12)
  s_cmp_lg_u32 s33, 0
  s_cbranch_scc1 rfg_106
  v_add_u32 v152, s34, v246
  v_add_u32 v153, s34, v245
  v_xor_b32 v154, 64, v245
  v_add_u32 v154, s34, v154
  ds_read_b64_tr_b16 v[160:161], v152 offset:0
  ds_read_b64_tr_b16 v[162:163], v152 offset:512
  ds_read_b64_tr_b16 v[164:165], v152 offset:1024
  ds_read_b64_tr_b16 v[166:167], v152 offset:1536
  s_bitcmp1_b32 s35, 1
  s_cbranch_scc1 rf1_108
  ds_read_b64_tr_b16 v[168:169], v152 offset:2048
  ds_read_b64_tr_b16 v[170:171], v152 offset:2560
  ds_read_b64_tr_b16 v[172:173], v152 offset:3072
  ds_read_b64_tr_b16 v[174:175], v152 offset:3584
  s_branch rf2_109
rf1_108:
  ds_read_b64_tr_b16 v[168:169], v153 offset:2048
  ds_read_b64_tr_b16 v[170:171], v153 offset:3072
  ds_read_b64_tr_b16 v[172:173], v154 offset:2048
  ds_read_b64_tr_b16 v[174:175], v154 offset:3072
rf2_109:
  ds_read_b64_tr_b16 v[176:177], v153 offset:4096
  ds_read_b64_tr_b16 v[178:179], v153 offset:5120
  ds_read_b64_tr_b16 v[180:181], v154 offset:4096
  ds_read_b64_tr_b16 v[182:183], v154 offset:5120
  s_waitcnt lgkmcnt(0)
  buffer_store_dwordx4 v[160:163], v2, s[36:39], s30 offen offset:0 sc1
  buffer_store_dwordx4 v[164:167], v2, s[36:39], s30 offen offset:1024 sc1
  buffer_store_dwordx4 v[168:171], v2, s[36:39], s31 offen offset:0 sc1
  buffer_store_dwordx4 v[172:175], v2, s[36:39], s31 offen offset:1024 sc1
  buffer_store_dwordx4 v[176:179], v2, s[36:39], s32 offen offset:0 sc1
  buffer_store_dwordx4 v[180:183], v2, s[36:39], s32 offen offset:1024 sc1
  s_branch rfd_107
rfg_106:
  v_bfe_u32 v153, v1, 4, 1
  v_lshl_add_u32 v152, v153, 10, v246
  v_xor_b32 v153, 32, v152
  v_add_u32 v152, s34, v152
  v_add_u32 v153, s34, v153
  ds_read_b64_tr_b16 v[160:161], v152 offset:0
  ds_read_b64_tr_b16 v[162:163], v152 offset:512
  ds_read_b64_tr_b16 v[164:165], v153 offset:0
  ds_read_b64_tr_b16 v[166:167], v153 offset:512
  ds_read_b64_tr_b16 v[168:169], v152 offset:2048
  ds_read_b64_tr_b16 v[170:171], v152 offset:2560
  ds_read_b64_tr_b16 v[172:173], v153 offset:2048
  ds_read_b64_tr_b16 v[174:175], v153 offset:2560
  s_waitcnt lgkmcnt(0)
  ds_read_b64_tr_b16 v[176:177], v152 offset:4096
  ds_read_b64_tr_b16 v[178:179], v152 offset:4608
  ds_read_b64_tr_b16 v[180:181], v153 offset:4096
  ds_read_b64_tr_b16 v[182:183], v153 offset:4608
  ds_read_b64_tr_b16 v[184:185], v152 offset:6144
  ds_read_b64_tr_b16 v[186:187], v152 offset:6656
  ds_read_b64_tr_b16 v[188:189], v153 offset:6144
  ds_read_b64_tr_b16 v[190:191], v153 offset:6656
  s_add_u32 s84, s30, 4096
  s_waitcnt lgkmcnt(0)
  v_mfma_f32_32x32x16_bf16 v[104:119], v[136:139], v[160:163], 0
  buffer_store_dwordx4 v[160:163], v2, s[36:39], s30 offen offset:0 sc1
  v_mfma_f32_32x32x16_bf16 v[120:135], v[136:139], v[164:167], 0
  buffer_store_dwordx4 v[164:167], v2, s[36:39], s30 offen offset:1024 sc1
  v_mfma_f32_32x32x16_bf16 v[104:119], v[136:139], v[168:171], v[104:119]
  buffer_store_dwordx4 v[168:171], v2, s[36:39], s30 offen offset:2048 sc1
  v_mfma_f32_32x32x16_bf16 v[120:135], v[136:139], v[172:175], v[120:135]
  buffer_store_dwordx4 v[172:175], v2, s[36:39], s30 offen offset:3072 sc1
  v_mfma_f32_32x32x16_bf16 v[104:119], v[136:139], v[176:179], v[104:119]
  buffer_store_dwordx4 v[176:179], v2, s[36:39], s84 offen offset:0 sc1
  v_mfma_f32_32x32x16_bf16 v[120:135], v[136:139], v[180:183], v[120:135]
  buffer_store_dwordx4 v[180:183], v2, s[36:39], s84 offen offset:1024 sc1
  v_mfma_f32_32x32x16_bf16 v[104:119], v[136:139], v[184:187], v[104:119]
  buffer_store_dwordx4 v[184:187], v2, s[36:39], s84 offen offset:2048 sc1
  v_mfma_f32_32x32x16_bf16 v[120:135], v[136:139], v[188:191], v[120:135]
  buffer_store_dwordx4 v[188:191], v2, s[36:39], s84 offen offset:3072 sc1
  s_nop 11
  s_mov_b32 exec_hi, 0
  v_cvt_pk_bf16_f32 v154, v104, v104
  v_and_b32 v154, 0xffff0000, v154
  v_sub_f32 v154, v104, v154
  v_cvt_pk_bf16_f32 v155, v104, v154
  buffer_store_dword v155, v2, s[36:39], s33 offen offset:0 sc1
  v_cvt_pk_bf16_f32 v154, v120, v120
  v_and_b32 v154, 0xffff0000, v154
  v_sub_f32 v154, v120, v154
  v_cvt_pk_bf16_f32 v156, v120, v154
  buffer_store_dword v156, v2, s[36:39], s33 offen offset:1024 sc1
  s_mov_b32 exec_hi, -1
rfd_107:
l0_105:
  v_exp_f32 v40, v40
  v_exp_f32 v41, v41
  v_smfmac_f32_32x32x32_bf16 v[88:103], v[32:35], v[64:71], v36
  ds_read_b128 v[16:19], v37 offset:52000
  v_exp_f32 v42, v42
  v_exp_f32 v43, v43
  v_exp_f32 v44, v44
  v_mfma_f32_32x32x16_bf16 v[56:71], v[12:15], v[8:11], 0
  ds_read_b128 v[28:31], v38 offset:52000
  v_exp_f32 v45, v45
  v_exp_f32 v46, v46
  v_exp_f32 v47, v47
  v_exp_f32 v48, v48
  v_exp_f32 v49, v49
  v_smfmac_f32_32x32x32_bf16 v[72:87], v[20:23], v[40:47], v36
  ds_read_b128 v[32:35], v39 offset:52000
  v_exp_f32 v50, v50
  v_exp_f32 v51, v51
  v_exp_f32 v52, v52
  v_exp_f32 v53, v53
  v_exp_f32 v54, v54
  v_exp_f32 v55, v55
  v_exp_f32 v56, v56
  v_exp_f32 v57, v57
  v_smfmac_f32_32x32x32_bf16 v[72:87], v[24:27], v[48:55], v36
  s_waitcnt lgkmcnt(0)
  v_exp_f32 v58, v58
  v_exp_f32 v59, v59
  v_exp_f32 v60, v60
  v_mfma_f32_32x32x16_bf16 v[40:55], v[16:19], v[4:7], 0
  v_exp_f32 v61, v61
  v_exp_f32 v62, v62
  v_exp_f32 v63, v63
  v_exp_f32 v64, v64
  v_exp_f32 v65, v65
  v_smfmac_f32_32x32x32_bf16 v[88:103], v[20:23], v[56:63], v36
  v_exp_f32 v66, v66
  v_exp_f32 v67, v67
  v_exp_f32 v68, v68
  v_exp_f32 v69, v69
  v_exp_f32 v70, v70
  v_exp_f32 v71, v71
  v_exp_f32 v40, v40
  v_exp_f32 v41, v41
  v_smfmac_f32_32x32x32_bf16 v[88:103], v[24:27], v[64:71], v36
  ds_read_b128 v[12:15], v37 offset:54080
  v_exp_f32 v42, v42
  v_exp_f32 v43, v43
  v_exp_f32 v44, v44
  v_mfma_f32_32x32x16_bf16 v[56:71], v[16:19], v[8:11], 0
  ds_read_b128 v[20:23], v38 offset:54080
  v_exp_f32 v45, v45
  v_exp_f32 v46, v46
  v_exp_f32 v47, v47
  v_exp_f32 v48, v48
  v_exp_f32 v49, v49
  v_smfmac_f32_32x32x32_bf16 v[72:87], v[28:31], v[40:47], v36
  ds_read_b128 v[24:27], v39 offset:54080
  v_exp_f32 v50, v50
  v_exp_f32 v51, v51
  v_exp_f32 v52, v52
  v_exp_f32 v53, v53
  v_exp_f32 v54, v54
  v_exp_f32 v55, v55
  v_exp_f32 v56, v56
  v_exp_f32 v57, v57
  v_smfmac_f32_32x32x32_bf16 v[72:87], v[32:35], v[48:55], v36
  s_waitcnt lgkmcnt(0)
  v_exp_f32 v58, v58
  v_exp_f32 v59, v59
  v_exp_f32 v60, v60
  v_mfma_f32_32x32x16_bf16 v[40:55], v[12:15], v[4:7], 0
  v_exp_f32 v61, v61
  v_exp_f32 v62, v62
  v_exp_f32 v63, v63
  v_exp_f32 v64, v64
  v_exp_f32 v65, v65
  v_smfmac_f32_32x32x32_bf16 v[88:103], v[28:31], v[56:63], v36
  v_exp_f32 v66, v66
  v_exp_f32 v67, v67
  v_exp_f32 v68, v68
  v_exp_f32 v69, v69
  v_exp_f32 v70, v70
  v_exp_f32 v71, v71
  v_exp_f32 v40, v40
  v_exp_f32 v41, v41
  v_smfmac_f32_32x32x32_bf16 v[88:103], v[32:35], v[64:71], v36
  ds_read_b128 v[16:19], v37 offset:56160
  v_exp_f32 v42, v42
  v_exp_f32 v43, v43
  v_exp_f32 v44, v44
  v_mfma_f32_32x32x16_bf16 v[56:71], v[12:15], v[8:11], 0
  ds_read_b128 v[28:31], v38 offset:56160
  v_exp_f32 v45, v45
  v_exp_f32 v46, v46
  v_exp_f32 v47, v47
  v_exp_f32 v48, v48
  v_exp_f32 v49, v49
  v_smfmac_f32_32x32x32_bf16 v[72:87], v[20:23], v[40:47], v36
  ds_read_b128 v[32:35], v39 offset:56160
  v_exp_f32 v50, v50
  v_exp_f32 v51, v51
  v_exp_f32 v52, v52
  v_exp_f32 v53, v53
  v_exp_f32 v54, v54
  v_exp_f32 v55, v55
  v_exp_f32 v56, v56
  v_exp_f32 v57, v57
  v_smfmac_f32_32x32x32_bf16 v[72:87], v[24:27], v[48:55], v36
  s_waitcnt lgkmcnt(0)
  v_exp_f32 v58, v58
  v_exp_f32 v59, v59
  v_exp_f32 v60, v60
  v_mfma_f32_32x32x16_bf16 v[40:55], v[16:19], v[4:7], 0
  v_exp_f32 v61, v61
  v_exp_f32 v62, v62
  v_exp_f32 v63, v63
  v_exp_f32 v64, v64
  v_exp_f32 v65, v65
  v_smfmac_f32_32x32x32_bf16 v[88:103], v[20:23], v[56:63], v36
  v_exp_f32 v66, v66
  v_exp_f32 v67, v67
  v_exp_f32 v68, v68
  v_exp_f32 v69, v69
  v_exp_f32 v70, v70
  v_exp_f32 v71, v71
  v_exp_f32 v40, v40
  v_exp_f32 v41, v41
  v_smfmac_f32_32x32x32_bf16 v[88:103], v[24:27], v[64:71], v36
  ds_read_b128 v[12:15], v37 offset:58240
  v_exp_f32 v42, v42
  v_exp_f32 v43, v43
  v_exp_f32 v44, v44
  v_mfma_f32_32x32x16_bf16 v[56:71], v[16:19], v[8:11], 0
  ds_read_b128 v[20:23], v38 offset:58240
  v_exp_f32 v45, v45
  v_exp_f32 v46, v46
  v_exp_f32 v47, v47
  v_exp_f32 v48, v48
  v_exp_f32 v49, v49
  v_smfmac_f32_32x32x32_bf16 v[72:87], v[28:31], v[40:47], v36
  ds_read_b128 v[24:27], v39 offset:58240
  v_exp_f32 v50, v50
  v_exp_f32 v51, v51
  v_exp_f32 v52, v52
  v_exp_f32 v53, v53
  v_exp_f32 v54, v54
  v_exp_f32 v55, v55
  v_exp_f32 v56, v56
  v_exp_f32 v57, v57
  v_smfmac_f32_32x32x32_bf16 v[72:87], v[32:35], v[48:55], v36
  s_waitcnt lgkmcnt(0)
  v_exp_f32 v58, v58
  v_exp_f32 v59, v59
  v_exp_f32 v60, v60
  v_mfma_f32_32x32x16_bf16 v[40:55], v[12:15], v[4:7], 0
  v_exp_f32 v61, v61
  v_exp_f32 v62, v62
  v_exp_f32 v63, v63
  v_exp_f32 v64, v64
  v_exp_f32 v65, v65
  v_smfmac_f32_32x32x32_bf16 v[88:103], v[28:31], v[56:63], v36
  v_add_u32 v37, 58240, v37
  v_add_u32 v38, 58240, v38
  v_add_u32 v39, 58240, v39
  v_exp_f32 v66, v66
  v_exp_f32 v67, v67
  v_exp_f32 v68, v68
  v_exp_f32 v69, v69
  v_exp_f32 v70, v70
  v_exp_f32 v71, v71
  s_waitcnt vmcnt(6)
  s_cmp_eq_u32 s69, 0
  s_cbranch_scc1 kvw_110
  s_waitcnt vmcnt(0)
kvw_110:
  s_barrier
  s_cmp_lg_u32 s69, 0
  s_cbranch_scc1 nores_111
  s_lshl_b32 s72, s9, 1
  s_and_b32 s79, s10, 1
  s_add_u32 s72, s72, s79
  s_lshl_b32 s72, s72, 1
  s_bfe_u32 s79, s10, 0x10001
  s_add_u32 s72, s72, s79
  s_lshr_b32 s79, s10, 2
  s_lshl_b32 s72, s72, 1
  s_and_b32 s74, s3, 1
  s_add_u32 s72, s72, s74
  s_lshl_b32 s72, s72, 15
  s_lshl_b32 s79, s79, 1
  s_lshr_b32 s74, s3, 1
  s_add_u32 s79, s79, s74
  s_lshl_b32 s79, s79, 6
  s_add_u32 s72, s72, s79
  buffer_load_dwordx2 v[248:249], v237, s[60:63], s72 offen offset:0
  buffer_load_dwordx2 v[250:251], v237, s[60:63], s72 offen offset:16
  buffer_load_dwordx2 v[252:253], v237, s[60:63], s72 offen offset:32
  buffer_load_dwordx2 v[254:255], v237, s[60:63], s72 offen offset:48
  s_lshl_b32 s75, s10, 3
  s_add_u32 s75, s75, s9
  s_lshl_b32 s75, s75, 2
  s_add_u32 s75, s75, s3
  s_mul_i32 s74, s75, 1376
  s_mul_i32 s75, s75, 1536
  s_mov_b64 exec, 0xfff
  s_mov_b64 exec, -1
nores_111:
  v_exp_f32 v40, v40
  v_exp_f32 v41, v41
  v_smfmac_f32_32x32x32_bf16 v[88:103], v[32:35], v[64:71], v36
  ds_read_b128 v[16:19], v37 offset:2080
  v_exp_f32 v42, v42
  v_exp_f32 v43, v43
  v_exp_f32 v44, v44
  v_mfma_f32_32x32x16_bf16 v[56:71], v[12:15], v[8:11], 0
  ds_read_b128 v[28:31], v38 offset:2080
  v_exp_f32 v45, v45
  v_exp_f32 v46, v46
  v_exp_f32 v47, v47
  v_exp_f32 v48, v48
  v_exp_f32 v49, v49
  v_smfmac_f32_32x32x32_bf16 v[72:87], v[20:23], v[40:47], v36
  ds_read_b128 v[32:35], v39 offset:2080
  v_exp_f32 v50, v50
  v_exp_f32 v51, v51
  v_exp_f32 v52, v52
  v_exp_f32 v53, v53
  v_exp_f32 v54, v54
  v_exp_f32 v55, v55
  v_exp_f32 v56, v56
  v_exp_f32 v57, v57
  v_smfmac_f32_32x32x32_bf16 v[72:87], v[24:27], v[48:55], v36
  s_waitcnt lgkmcnt(0)
  v_exp_f32 v58, v58
  v_exp_f32 v59, v59
  v_exp_f32 v60, v60
  v_mfma_f32_32x32x16_bf16 v[40:55], v[16:19], v[4:7], 0
  buffer_load_dword a6, v233, s[36:39], 0 offen sc1
  v_exp_f32 v61, v61
  v_exp_f32 v62, v62
  v_exp_f32 v63, v63
  v_exp_f32 v64, v64
  v_exp_f32 v65, v65
  v_smfmac_f32_32x32x32_bf16 v[88:103], v[20:23], v[56:63], v36
  v_exp_f32 v66, v66
  v_exp_f32 v67, v67
  v_exp_f32 v68, v68
  v_exp_f32 v69, v69
  v_exp_f32 v70, v70
  v_exp_f32 v71, v71
  v_exp_f32 v40, v40
  v_exp_f32 v41, v41
  v_smfmac_f32_32x32x32_bf16 v[88:103], v[24:27], v[64:71], v36
  ds_read_b128 v[12:15], v37 offset:4160
  v_exp_f32 v42, v42
  v_exp_f32 v43, v43
  v_exp_f32 v44, v44
  v_mfma_f32_32x32x16_bf16 v[56:71], v[16:19], v[8:11], 0
  ds_read_b128 v[20:23], v38 offset:4160
  v_exp_f32 v45, v45
  v_exp_f32 v46, v46
  v_exp_f32 v47, v47
  v_exp_f32 v48, v48
  v_exp_f32 v49, v49
  v_smfmac_f32_32x32x32_bf16 v[72:87], v[28:31], v[40:47], v36
  ds_read_b128 v[24:27], v39 offset:4160
  v_exp_f32 v50, v50
  v_exp_f32 v51, v51
  v_exp_f32 v52, v52
  v_exp_f32 v53, v53
  v_exp_f32 v54, v54
  v_exp_f32 v55, v55
  v_exp_f32 v56, v56
  v_exp_f32 v57, v57
  v_smfmac_f32_32x32x32_bf16 v[72:87], v[32:35], v[48:55], v36
  s_waitcnt lgkmcnt(0)
  v_exp_f32 v58, v58
  v_exp_f32 v59, v59
  v_exp_f32 v60, v60
  v_mfma_f32_32x32x16_bf16 v[40:55], v[12:15], v[4:7], 0
  v_exp_f32 v61, v61
  v_exp_f32 v62, v62
  v_exp_f32 v63, v63
  v_exp_f32 v64, v64
  v_exp_f32 v65, v65
  v_smfmac_f32_32x32x32_bf16 v[88:103], v[28:31], v[56:63], v36
  v_exp_f32 v66, v66
  v_exp_f32 v67, v67
  v_exp_f32 v68, v68
  v_exp_f32 v69, v69
  v_exp_f32 v70, v70
  v_exp_f32 v71, v71
  v_exp_f32 v40, v40
  v_exp_f32 v41, v41
  v_smfmac_f32_32x32x32_bf16 v[88:103], v[32:35], v[64:71], v36
  ds_read_b128 v[16:19], v37 offset:6240
  v_exp_f32 v42, v42
  v_exp_f32 v43, v43
  v_exp_f32 v44, v44
  v_mfma_f32_32x32x16_bf16 v[56:71], v[12:15], v[8:11], 0
  ds_read_b128 v[28:31], v38 offset:6240
  v_exp_f32 v45, v45
  v_exp_f32 v46, v46
  v_exp_f32 v47, v47
  v_exp_f32 v48, v48
  v_exp_f32 v49, v49
  v_smfmac_f32_32x32x32_bf16 v[72:87], v[20:23], v[40:47], v36
  ds_read_b128 v[32:35], v39 offset:6240
  v_exp_f32 v50, v50
  v_exp_f32 v51, v51
  v_exp_f32 v52, v52
  v_exp_f32 v53, v53
  v_exp_f32 v54, v54
  v_exp_f32 v55, v55
  v_exp_f32 v56, v56
  v_exp_f32 v57, v57
  v_smfmac_f32_32x32x32_bf16 v[72:87], v[24:27], v[48:55], v36
  s_waitcnt lgkmcnt(0)
  v_exp_f32 v58, v58
  v_exp_f32 v59, v59
  v_exp_f32 v60, v60
  v_mfma_f32_32x32x16_bf16 v[40:55], v[16:19], v[4:7], 0
  buffer_load_dword a7, v232, s[36:39], 0 offen sc1
  v_exp_f32 v61, v61
  v_exp_f32 v62, v62
  v_exp_f32 v63, v63
  v_exp_f32 v64, v64
  v_exp_f32 v65, v65
  v_smfmac_f32_32x32x32_bf16 v[88:103], v[20:23], v[56:63], v36
  v_exp_f32 v66, v66
  v_exp_f32 v67, v67
  v_exp_f32 v68, v68
  v_exp_f32 v69, v69
  v_exp_f32 v70, v70
  v_exp_f32 v71, v71
  v_exp_f32 v40, v40
  v_exp_f32 v41, v41
  v_smfmac_f32_32x32x32_bf16 v[88:103], v[24:27], v[64:71], v36
  ds_read_b128 v[12:15], v37 offset:8320
  v_exp_f32 v42, v42
  v_exp_f32 v43, v43
  v_exp_f32 v44, v44
  v_mfma_f32_32x32x16_bf16 v[56:71], v[16:19], v[8:11], 0
  ds_read_b128 v[20:23], v38 offset:8320
  v_exp_f32 v45, v45
  v_exp_f32 v46, v46
  v_exp_f32 v47, v47
  v_exp_f32 v48, v48
  v_exp_f32 v49, v49
  v_smfmac_f32_32x32x32_bf16 v[72:87], v[28:31], v[40:47], v36
  ds_read_b128 v[24:27], v39 offset:8320
  v_exp_f32 v50, v50
  v_exp_f32 v51, v51
  v_exp_f32 v52, v52
  v_exp_f32 v53, v53
  v_exp_f32 v54, v54
  v_exp_f32 v55, v55
  v_exp_f32 v56, v56
  v_exp_f32 v57, v57
  v_smfmac_f32_32x32x32_bf16 v[72:87], v[32:35], v[48:55], v36
  s_waitcnt lgkmcnt(0)
  v_exp_f32 v58, v58
  v_exp_f32 v59, v59
  v_exp_f32 v60, v60
  v_mfma_f32_32x32x16_bf16 v[40:55], v[12:15], v[4:7], 0
  v_exp_f32 v61, v61
  v_exp_f32 v62, v62
  v_exp_f32 v63, v63
  v_exp_f32 v64, v64
  v_exp_f32 v65, v65
  v_smfmac_f32_32x32x32_bf16 v[88:103], v[28:31], v[56:63], v36
  v_exp_f32 v66, v66
  v_exp_f32 v67, v67
  v_exp_f32 v68, v68
  v_exp_f32 v69, v69
  v_exp_f32 v70, v70
  v_exp_f32 v71, v71
  s_cmp_lg_u32 s69, 0
  s_cbranch_scc1 l0_112
  s_lshl_b32 s96, s2, 2
  s_add_u32 s96, s96, s3
  s_lshl_b32 s96, s96, 2
  s_add_u32 s96, s96, 0x4f5000
  s_waitcnt vmcnt(6)
  s_mov_b64 exec, 1
  buffer_store_dword v229, off, s[36:39], s96 sc0 sc1
  s_mov_b64 exec, -1
l0_112:
  v_exp_f32 v40, v40
  v_exp_f32 v41, v41
  v_smfmac_f32_32x32x32_bf16 v[88:103], v[32:35], v[64:71], v36
  ds_read_b128 v[16:19], v37 offset:10400
  v_exp_f32 v42, v42
  v_exp_f32 v43, v43
  v_exp_f32 v44, v44
  v_mfma_f32_32x32x16_bf16 v[56:71], v[12:15], v[8:11], 0
  ds_read_b128 v[28:31], v38 offset:10400
  v_exp_f32 v45, v45
  v_exp_f32 v46, v46
  v_exp_f32 v47, v47
  v_exp_f32 v48, v48
  v_exp_f32 v49, v49
  v_smfmac_f32_32x32x32_bf16 v[72:87], v[20:23], v[40:47], v36
  ds_read_b128 v[32:35], v39 offset:10400
  v_exp_f32 v50, v50
  v_exp_f32 v51, v51
  v_exp_f32 v52, v52
  v_exp_f32 v53, v53
  v_exp_f32 v54, v54
  v_exp_f32 v55, v55
  v_exp_f32 v56, v56
  v_exp_f32 v57, v57
  v_smfmac_f32_32x32x32_bf16 v[72:87], v[24:27], v[48:55], v36
  s_waitcnt lgkmcnt(0)
  v_exp_f32 v58, v58
  v_exp_f32 v59, v59
  v_exp_f32 v60, v60
  v_mfma_f32_32x32x16_bf16 v[40:55], v[16:19], v[4:7], 0
  v_exp_f32 v61, v61
  v_exp_f32 v62, v62
  v_exp_f32 v63, v63
  v_exp_f32 v64, v64
  v_exp_f32 v65, v65
  v_smfmac_f32_32x32x32_bf16 v[88:103], v[20:23], v[56:63], v36
  v_exp_f32 v66, v66
  v_exp_f32 v67, v67
  v_exp_f32 v68, v68
  v_exp_f32 v69, v69
  v_exp_f32 v70, v70
  v_exp_f32 v71, v71
  v_exp_f32 v40, v40
  v_exp_f32 v41, v41
  v_smfmac_f32_32x32x32_bf16 v[88:103], v[24:27], v[64:71], v36
  ds_read_b128 v[12:15], v37 offset:12480
  v_exp_f32 v42, v42
  v_exp_f32 v43, v43
  v_exp_f32 v44, v44
  v_mfma_f32_32x32x16_bf16 v[56:71], v[16:19], v[8:11], 0
  ds_read_b128 v[20:23], v38 offset:12480
  v_exp_f32 v45, v45
  v_exp_f32 v46, v46
  v_exp_f32 v47, v47
  v_exp_f32 v48, v48
  v_exp_f32 v49, v49
  v_smfmac_f32_32x32x32_bf16 v[72:87], v[28:31], v[40:47], v36
  ds_read_b128 v[24:27], v39 offset:12480
  v_exp_f32 v50, v50
  v_exp_f32 v51, v51
  v_exp_f32 v52, v52
  v_exp_f32 v53, v53
  v_exp_f32 v54, v54
  v_exp_f32 v55, v55
  v_exp_f32 v56, v56
  v_exp_f32 v57, v57
  v_smfmac_f32_32x32x32_bf16 v[72:87], v[32:35], v[48:55], v36
  s_waitcnt lgkmcnt(0)
  v_exp_f32 v58, v58
  v_exp_f32 v59, v59
  v_exp_f32 v60, v60
  v_mfma_f32_32x32x16_bf16 v[40:55], v[12:15], v[4:7], 0
  v_exp_f32 v61, v61
  v_exp_f32 v62, v62
  v_exp_f32 v63, v63
  v_exp_f32 v64, v64
  v_exp_f32 v65, v65
  v_smfmac_f32_32x32x32_bf16 v[88:103], v[28:31], v[56:63], v36
  v_exp_f32 v66, v66
  v_exp_f32 v67, v67
  v_exp_f32 v68, v68
  v_exp_f32 v69, v69
  v_exp_f32 v70, v70
  v_exp_f32 v71, v71
  v_exp_f32 v40, v40
  v_exp_f32 v41, v41
  v_smfmac_f32_32x32x32_bf16 v[88:103], v[32:35], v[64:71], v36
  ds_read_b128 v[16:19], v37 offset:14560
  v_exp_f32 v42, v42
  v_exp_f32 v43, v43
  v_exp_f32 v44, v44
  v_mfma_f32_32x32x16_bf16 v[56:71], v[12:15], v[8:11], 0
  ds_read_b128 v[28:31], v38 offset:14560
  v_exp_f32 v45, v45
  v_exp_f32 v46, v46
  v_exp_f32 v47, v47
  v_exp_f32 v48, v48
  v_exp_f32 v49, v49
  v_smfmac_f32_32x32x32_bf16 v[72:87], v[20:23], v[40:47], v36
  ds_read_b128 v[32:35], v39 offset:14560
  v_exp_f32 v50, v50
  v_exp_f32 v51, v51
  v_exp_f32 v52, v52
  v_exp_f32 v53, v53
  v_exp_f32 v54, v54
  v_exp_f32 v55, v55
  v_exp_f32 v56, v56
  v_exp_f32 v57, v57
  v_smfmac_f32_32x32x32_bf16 v[72:87], v[24:27], v[48:55], v36
  s_waitcnt lgkmcnt(0)
  v_exp_f32 v58, v58
  v_exp_f32 v59, v59
  v_exp_f32 v60, v60
  v_mfma_f32_32x32x16_bf16 v[40:55], v[16:19], v[4:7], 0
  v_exp_f32 v61, v61
  v_exp_f32 v62, v62
  v_exp_f32 v63, v63
  v_exp_f32 v64, v64
  v_exp_f32 v65, v65
  v_smfmac_f32_32x32x32_bf16 v[88:103], v[20:23], v[56:63], v36
  v_exp_f32 v66, v66
  v_exp_f32 v67, v67
  v_exp_f32 v68, v68
  v_exp_f32 v69, v69
  v_exp_f32 v70, v70
  v_exp_f32 v71, v71
  v_exp_f32 v40, v40
  v_exp_f32 v41, v41
  v_smfmac_f32_32x32x32_bf16 v[88:103], v[24:27], v[64:71], v36
  ds_read_b128 v[12:15], v37 offset:16640
  v_exp_f32 v42, v42
  v_exp_f32 v43, v43
  v_exp_f32 v44, v44
  v_mfma_f32_32x32x16_bf16 v[56:71], v[16:19], v[8:11], 0
  ds_read_b128 v[20:23], v38 offset:16640
  v_exp_f32 v45, v45
  v_exp_f32 v46, v46
  v_exp_f32 v47, v47
  v_exp_f32 v48, v48
  v_exp_f32 v49, v49
  v_smfmac_f32_32x32x32_bf16 v[72:87], v[28:31], v[40:47], v36
  ds_read_b128 v[24:27], v39 offset:16640
  v_exp_f32 v50, v50
  v_exp_f32 v51, v51
  v_exp_f32 v52, v52
  v_exp_f32 v53, v53
  v_exp_f32 v54, v54
  v_exp_f32 v55, v55
  v_exp_f32 v56, v56
  v_exp_f32 v57, v57
  v_smfmac_f32_32x32x32_bf16 v[72:87], v[32:35], v[48:55], v36
  s_waitcnt lgkmcnt(0)
  v_exp_f32 v58, v58
  v_exp_f32 v59, v59
  v_exp_f32 v60, v60
  v_mfma_f32_32x32x16_bf16 v[40:55], v[12:15], v[4:7], 0
  v_exp_f32 v61, v61
  v_exp_f32 v62, v62
  v_exp_f32 v63, v63
  v_exp_f32 v64, v64
  v_exp_f32 v65, v65
  v_smfmac_f32_32x32x32_bf16 v[88:103], v[28:31], v[56:63], v36
  v_exp_f32 v66, v66
  v_exp_f32 v67, v67
  v_exp_f32 v68, v68
  v_exp_f32 v69, v69
  v_exp_f32 v70, v70
  v_exp_f32 v71, v71
  v_exp_f32 v40, v40
  v_exp_f32 v41, v41
  v_smfmac_f32_32x32x32_bf16 v[88:103], v[32:35], v[64:71], v36
  ds_read_b128 v[16:19], v37 offset:18720
  v_exp_f32 v42, v42
  v_exp_f32 v43, v43
  v_exp_f32 v44, v44
  v_mfma_f32_32x32x16_bf16 v[56:71], v[12:15], v[8:11], 0
  ds_read_b128 v[28:31], v38 offset:18720
  v_exp_f32 v45, v45
  v_exp_f32 v46, v46
  v_exp_f32 v47, v47
  v_exp_f32 v48, v48
  v_exp_f32 v49, v49
  v_smfmac_f32_32x32x32_bf16 v[72:87], v[20:23], v[40:47], v36
  ds_read_b128 v[32:35], v39 offset:18720
  v_exp_f32 v50, v50
  v_exp_f32 v51, v51
  v_exp_f32 v52, v52
  v_exp_f32 v53, v53
  v_exp_f32 v54, v54
  v_exp_f32 v55, v55
  v_exp_f32 v56, v56
  v_exp_f32 v57, v57
  v_smfmac_f32_32x32x32_bf16 v[72:87], v[24:27], v[48:55], v36
  s_waitcnt lgkmcnt(0)
  v_exp_f32 v58, v58
  v_exp_f32 v59, v59
  v_exp_f32 v60, v60
  v_mfma_f32_32x32x16_bf16 v[40:55], v[16:19], v[4:7], 0
  v_exp_f32 v61, v61
  v_exp_f32 v62, v62
  v_exp_f32 v63, v63
  v_exp_f32 v64, v64
  v_exp_f32 v65, v65
  v_smfmac_f32_32x32x32_bf16 v[88:103], v[20:23], v[56:63], v36
  v_exp_f32 v66, v66
  v_exp_f32 v67, v67
  v_exp_f32 v68, v68
  v_exp_f32 v69, v69
  v_exp_f32 v70, v70
  v_exp_f32 v71, v71
  v_exp_f32 v40, v40
  v_exp_f32 v41, v41
  v_smfmac_f32_32x32x32_bf16 v[88:103], v[24:27], v[64:71], v36
  ds_read_b128 v[12:15], v37 offset:20800
  v_exp_f32 v42, v42
  v_exp_f32 v43, v43
  v_exp_f32 v44, v44
  v_mfma_f32_32x32x16_bf16 v[56:71], v[16:19], v[8:11], 0
  ds_read_b128 v[20:23], v38 offset:20800
  v_exp_f32 v45, v45
  v_exp_f32 v46, v46
  v_exp_f32 v47, v47
  v_exp_f32 v48, v48
  v_exp_f32 v49, v49
  v_smfmac_f32_32x32x32_bf16 v[72:87], v[28:31], v[40:47], v36
  ds_read_b128 v[24:27], v39 offset:20800
  v_exp_f32 v50, v50
  v_exp_f32 v51, v51
  v_exp_f32 v52, v52
  v_exp_f32 v53, v53
  v_exp_f32 v54, v54
  v_exp_f32 v55, v55
  v_exp_f32 v56, v56
  v_exp_f32 v57, v57
  v_smfmac_f32_32x32x32_bf16 v[72:87], v[32:35], v[48:55], v36
  s_waitcnt lgkmcnt(0)
  v_exp_f32 v58, v58
  v_exp_f32 v59, v59
  v_exp_f32 v60, v60
  v_mfma_f32_32x32x16_bf16 v[40:55], v[12:15], v[4:7], 0
  v_exp_f32 v61, v61
  v_exp_f32 v62, v62
  v_exp_f32 v63, v63
  v_exp_f32 v64, v64
  v_exp_f32 v65, v65
  v_smfmac_f32_32x32x32_bf16 v[88:103], v[28:31], v[56:63], v36
  v_exp_f32 v66, v66
  v_exp_f32 v67, v67
  v_exp_f32 v68, v68
  v_exp_f32 v69, v69
  v_exp_f32 v70, v70
  v_exp_f32 v71, v71
  v_exp_f32 v40, v40
  v_exp_f32 v41, v41
  v_smfmac_f32_32x32x32_bf16 v[88:103], v[32:35], v[64:71], v36
  ds_read_b128 v[16:19], v37 offset:22880
  v_exp_f32 v42, v42
  v_exp_f32 v43, v43
  v_exp_f32 v44, v44
  v_mfma_f32_32x32x16_bf16 v[56:71], v[12:15], v[8:11], 0
  ds_read_b128 v[28:31], v38 offset:22880
  v_exp_f32 v45, v45
  v_exp_f32 v46, v46
  v_exp_f32 v47, v47
  v_exp_f32 v48, v48
  v_exp_f32 v49, v49
  v_smfmac_f32_32x32x32_bf16 v[72:87], v[20:23], v[40:47], v36
  ds_read_b128 v[32:35], v39 offset:22880
  v_exp_f32 v50, v50
  v_exp_f32 v51, v51
  v_exp_f32 v52, v52
  v_exp_f32 v53, v53
  v_exp_f32 v54, v54
  v_exp_f32 v55, v55
  v_exp_f32 v56, v56
  v_exp_f32 v57, v57
  v_smfmac_f32_32x32x32_bf16 v[72:87], v[24:27], v[48:55], v36
  s_waitcnt lgkmcnt(0)
  v_exp_f32 v58, v58
  v_exp_f32 v59, v59
  v_exp_f32 v60, v60
  v_mfma_f32_32x32x16_bf16 v[40:55], v[16:19], v[4:7], 0
  v_exp_f32 v61, v61
  v_exp_f32 v62, v62
  v_exp_f32 v63, v63
  v_exp_f32 v64, v64
  v_exp_f32 v65, v65
  v_smfmac_f32_32x32x32_bf16 v[88:103], v[20:23], v[56:63], v36
  v_exp_f32 v66, v66
  v_exp_f32 v67, v67
  v_exp_f32 v68, v68
  v_exp_f32 v69, v69
  v_exp_f32 v70, v70
  v_exp_f32 v71, v71
  v_exp_f32 v40, v40
  v_exp_f32 v41, v41
  v_smfmac_f32_32x32x32_bf16 v[88:103], v[24:27], v[64:71], v36
  ds_read_b128 v[12:15], v37 offset:24960
  v_exp_f32 v42, v42
  v_exp_f32 v43, v43
  v_exp_f32 v44, v44
  v_mfma_f32_32x32x16_bf16 v[56:71], v[16:19], v[8:11], 0
  ds_read_b128 v[20:23], v38 offset:24960
  v_exp_f32 v45, v45
  v_exp_f32 v46, v46
  v_exp_f32 v47, v47
  v_exp_f32 v48, v48
  v_exp_f32 v49, v49
  v_smfmac_f32_32x32x32_bf16 v[72:87], v[28:31], v[40:47], v36
  ds_read_b128 v[24:27], v39 offset:24960
  v_exp_f32 v50, v50
  v_exp_f32 v51, v51
  v_exp_f32 v52, v52
  v_exp_f32 v53, v53
  v_exp_f32 v54, v54
  v_exp_f32 v55, v55
  v_exp_f32 v56, v56
  v_exp_f32 v57, v57
  v_smfmac_f32_32x32x32_bf16 v[72:87], v[32:35], v[48:55], v36
  s_waitcnt lgkmcnt(0)
  v_exp_f32 v58, v58
  v_exp_f32 v59, v59
  v_exp_f32 v60, v60
  v_mfma_f32_32x32x16_bf16 v[40:55], v[12:15], v[4:7], 0
  v_exp_f32 v61, v61
  v_exp_f32 v62, v62
  v_exp_f32 v63, v63
  v_exp_f32 v64, v64
  v_exp_f32 v65, v65
  v_smfmac_f32_32x32x32_bf16 v[88:103], v[28:31], v[56:63], v36
  v_exp_f32 v66, v66
  v_exp_f32 v67, v67
  v_exp_f32 v68, v68
  v_exp_f32 v69, v69
  v_exp_f32 v70, v70
  v_exp_f32 v71, v71
  v_exp_f32 v40, v40
  v_exp_f32 v41, v41
  v_smfmac_f32_32x32x32_bf16 v[88:103], v[32:35], v[64:71], v36
  ds_read_b128 v[16:19], v37 offset:27040
  v_exp_f32 v42, v42
  v_exp_f32 v43, v43
  v_exp_f32 v44, v44
  v_mfma_f32_32x32x16_bf16 v[56:71], v[12:15], v[8:11], 0
  ds_read_b128 v[28:31], v38 offset:27040
  v_exp_f32 v45, v45
  v_exp_f32 v46, v46
  v_exp_f32 v47, v47
  v_exp_f32 v48, v48
  v_exp_f32 v49, v49
  v_smfmac_f32_32x32x32_bf16 v[72:87], v[20:23], v[40:47], v36
  ds_read_b128 v[32:35], v39 offset:27040
  v_exp_f32 v50, v50
  v_exp_f32 v51, v51
  v_exp_f32 v52, v52
  v_exp_f32 v53, v53
  v_exp_f32 v54, v54
  v_exp_f32 v55, v55
  v_exp_f32 v56, v56
  v_exp_f32 v57, v57
  v_smfmac_f32_32x32x32_bf16 v[72:87], v[24:27], v[48:55], v36
  s_waitcnt lgkmcnt(0)
  v_exp_f32 v58, v58
  v_exp_f32 v59, v59
  v_exp_f32 v60, v60
  v_mfma_f32_32x32x16_bf16 v[40:55], v[16:19], v[4:7], 0
  v_exp_f32 v61, v61
  v_exp_f32 v62, v62
  v_exp_f32 v63, v63
  v_exp_f32 v64, v64
  v_exp_f32 v65, v65
  v_smfmac_f32_32x32x32_bf16 v[88:103], v[20:23], v[56:63], v36
  v_exp_f32 v66, v66
  v_exp_f32 v67, v67
  v_exp_f32 v68, v68
  v_exp_f32 v69, v69
  v_exp_f32 v70, v70
  v_exp_f32 v71, v71
  v_exp_f32 v40, v40
  v_exp_f32 v41, v41
  v_smfmac_f32_32x32x32_bf16 v[88:103], v[24:27], v[64:71], v36
  ds_read_b128 v[12:15], v37 offset:29120
  v_exp_f32 v42, v42
  v_exp_f32 v43, v43
  v_exp_f32 v44, v44
  v_mfma_f32_32x32x16_bf16 v[56:71], v[16:19], v[8:11], 0
  ds_read_b128 v[20:23], v38 offset:29120
  v_exp_f32 v45, v45
  v_exp_f32 v46, v46
  v_exp_f32 v47, v47
  v_exp_f32 v48, v48
  v_exp_f32 v49, v49
  v_smfmac_f32_32x32x32_bf16 v[72:87], v[28:31], v[40:47], v36
  ds_read_b128 v[24:27], v39 offset:29120
  v_exp_f32 v50, v50
  v_exp_f32 v51, v51
  v_exp_f32 v52, v52
  v_exp_f32 v53, v53
  v_exp_f32 v54, v54
  v_exp_f32 v55, v55
  v_exp_f32 v56, v56
  v_exp_f32 v57, v57
  v_smfmac_f32_32x32x32_bf16 v[72:87], v[32:35], v[48:55], v36
  s_waitcnt lgkmcnt(0)
  v_exp_f32 v58, v58
  v_exp_f32 v59, v59
  v_exp_f32 v60, v60
  v_mfma_f32_32x32x16_bf16 v[40:55], v[12:15], v[4:7], 0
  v_exp_f32 v61, v61
  v_exp_f32 v62, v62
  v_exp_f32 v63, v63
  v_exp_f32 v64, v64
  v_exp_f32 v65, v65
  v_smfmac_f32_32x32x32_bf16 v[88:103], v[28:31], v[56:63], v36
  v_exp_f32 v66, v66
  v_exp_f32 v67, v67
  v_exp_f32 v68, v68
  v_exp_f32 v69, v69
  v_exp_f32 v70, v70
  v_exp_f32 v71, v71
  v_exp_f32 v40, v40
  v_exp_f32 v41, v41
  v_smfmac_f32_32x32x32_bf16 v[88:103], v[32:35], v[64:71], v36
  ds_read_b128 v[16:19], v37 offset:31200
  v_exp_f32 v42, v42
  v_exp_f32 v43, v43
  v_exp_f32 v44, v44
  v_mfma_f32_32x32x16_bf16 v[56:71], v[12:15], v[8:11], 0
  ds_read_b128 v[28:31], v38 offset:31200
  v_exp_f32 v45, v45
  v_exp_f32 v46, v46
  v_exp_f32 v47, v47
  v_exp_f32 v48, v48
  v_exp_f32 v49, v49
  v_smfmac_f32_32x32x32_bf16 v[72:87], v[20:23], v[40:47], v36
  ds_read_b128 v[32:35], v39 offset:31200
  v_exp_f32 v50, v50
  v_exp_f32 v51, v51
  v_exp_f32 v52, v52
  v_exp_f32 v53, v53
  v_exp_f32 v54, v54
  v_exp_f32 v55, v55
  v_exp_f32 v56, v56
  v_exp_f32 v57, v57
  v_smfmac_f32_32x32x32_bf16 v[72:87], v[24:27], v[48:55], v36
  s_waitcnt lgkmcnt(0)
  v_exp_f32 v58, v58
  v_exp_f32 v59, v59
  v_exp_f32 v60, v60
  v_mfma_f32_32x32x16_bf16 v[40:55], v[16:19], v[4:7], 0
  v_exp_f32 v61, v61
  v_exp_f32 v62, v62
  v_exp_f32 v63, v63
  v_exp_f32 v64, v64
  v_exp_f32 v65, v65
  v_smfmac_f32_32x32x32_bf16 v[88:103], v[20:23], v[56:63], v36
  v_exp_f32 v66, v66
  v_exp_f32 v67, v67
  v_exp_f32 v68, v68
  v_exp_f32 v69, v69
  v_exp_f32 v70, v70
  v_exp_f32 v71, v71
  v_exp_f32 v40, v40
  v_exp_f32 v41, v41
  v_smfmac_f32_32x32x32_bf16 v[88:103], v[24:27], v[64:71], v36
  ds_read_b128 v[12:15], v37 offset:33280
  v_exp_f32 v42, v42
  v_exp_f32 v43, v43
  v_exp_f32 v44, v44
  v_mfma_f32_32x32x16_bf16 v[56:71], v[16:19], v[8:11], 0
  ds_read_b128 v[20:23], v38 offset:33280
  v_exp_f32 v45, v45
  v_exp_f32 v46, v46
  v_exp_f32 v47, v47
  v_exp_f32 v48, v48
  v_exp_f32 v49, v49
  v_smfmac_f32_32x32x32_bf16 v[72:87], v[28:31], v[40:47], v36
  ds_read_b128 v[24:27], v39 offset:33280
  v_exp_f32 v50, v50
  v_exp_f32 v51, v51
  v_exp_f32 v52, v52
  v_exp_f32 v53, v53
  v_exp_f32 v54, v54
  v_exp_f32 v55, v55
  v_exp_f32 v56, v56
  v_exp_f32 v57, v57
  v_smfmac_f32_32x32x32_bf16 v[72:87], v[32:35], v[48:55], v36
  s_waitcnt lgkmcnt(0)
  v_exp_f32 v58, v58
  v_exp_f32 v59, v59
  v_exp_f32 v60, v60
  v_mfma_f32_32x32x16_bf16 v[40:55], v[12:15], v[4:7], 0
  v_exp_f32 v61, v61
  v_exp_f32 v62, v62
  v_exp_f32 v63, v63
  v_exp_f32 v64, v64
  v_exp_f32 v65, v65
  v_smfmac_f32_32x32x32_bf16 v[88:103], v[28:31], v[56:63], v36
  v_exp_f32 v66, v66
  v_exp_f32 v67, v67
  v_exp_f32 v68, v68
  v_exp_f32 v69, v69
  v_exp_f32 v70, v70
  v_exp_f32 v71, v71
  s_mov_b32 s79, 0x4f5000
  s_cmp_lg_u32 s69, 0
  s_cbranch_scc1 l0_113
  buffer_load_dwordx4 v[104:107], v2, s[36:39], s79 offen offset:0 sc0 sc1
  buffer_load_dwordx4 v[108:111], v2, s[36:39], s79 offen offset:1024 sc0 sc1
  buffer_load_dwordx4 v[112:115], v2, s[36:39], s79 offen offset:2048 sc0 sc1
  buffer_load_dwordx4 v[116:119], v2, s[36:39], s79 offen offset:3072 sc0 sc1
l0_113:
  v_exp_f32 v40, v40
  v_exp_f32 v41, v41
  v_smfmac_f32_32x32x32_bf16 v[88:103], v[32:35], v[64:71], v36
  ds_read_b128 v[16:19], v37 offset:35360
  v_exp_f32 v42, v42
  v_exp_f32 v43, v43
  v_exp_f32 v44, v44
  v_mfma_f32_32x32x16_bf16 v[56:71], v[12:15], v[8:11], 0
  ds_read_b128 v[28:31], v38 offset:35360
  v_exp_f32 v45, v45
  v_exp_f32 v46, v46
  v_exp_f32 v47, v47
  v_exp_f32 v48, v48
  v_exp_f32 v49, v49
  v_smfmac_f32_32x32x32_bf16 v[72:87], v[20:23], v[40:47], v36
  ds_read_b128 v[32:35], v39 offset:35360
  v_exp_f32 v50, v50
  v_exp_f32 v51, v51
  v_exp_f32 v52, v52
  v_exp_f32 v53, v53
  v_exp_f32 v54, v54
  v_exp_f32 v55, v55
  v_exp_f32 v56, v56
  v_exp_f32 v57, v57
  v_smfmac_f32_32x32x32_bf16 v[72:87], v[24:27], v[48:55], v36
  s_waitcnt lgkmcnt(0)
  v_exp_f32 v58, v58
  v_exp_f32 v59, v59
  v_exp_f32 v60, v60
  v_mfma_f32_32x32x16_bf16 v[40:55], v[16:19], v[4:7], 0
  v_exp_f32 v61, v61
  v_exp_f32 v62, v62
  v_exp_f32 v63, v63
  v_exp_f32 v64, v64
  v_exp_f32 v65, v65
  v_smfmac_f32_32x32x32_bf16 v[88:103], v[20:23], v[56:63], v36
  v_exp_f32 v66, v66
  v_exp_f32 v67, v67
  v_exp_f32 v68, v68
  v_exp_f32 v69, v69
  v_exp_f32 v70, v70
  v_exp_f32 v71, v71
  v_exp_f32 v40, v40
  v_exp_f32 v41, v41
  v_smfmac_f32_32x32x32_bf16 v[88:103], v[24:27], v[64:71], v36
  ds_read_b128 v[12:15], v37 offset:37440
  v_exp_f32 v42, v42
  v_exp_f32 v43, v43
  v_exp_f32 v44, v44
  v_mfma_f32_32x32x16_bf16 v[56:71], v[16:19], v[8:11], 0
  ds_read_b128 v[20:23], v38 offset:37440
  v_exp_f32 v45, v45
  v_exp_f32 v46, v46
  v_exp_f32 v47, v47
  v_exp_f32 v48, v48
  v_exp_f32 v49, v49
  v_smfmac_f32_32x32x32_bf16 v[72:87], v[28:31], v[40:47], v36
  ds_read_b128 v[24:27], v39 offset:37440
  v_exp_f32 v50, v50
  v_exp_f32 v51, v51
  v_exp_f32 v52, v52
  v_exp_f32 v53, v53
  v_exp_f32 v54, v54
  v_exp_f32 v55, v55
  v_exp_f32 v56, v56
  v_exp_f32 v57, v57
  v_smfmac_f32_32x32x32_bf16 v[72:87], v[32:35], v[48:55], v36
  s_waitcnt lgkmcnt(0)
  v_exp_f32 v58, v58
  v_exp_f32 v59, v59
  v_exp_f32 v60, v60
  v_mfma_f32_32x32x16_bf16 v[40:55], v[12:15], v[4:7], 0
  v_exp_f32 v61, v61
  v_exp_f32 v62, v62
  v_exp_f32 v63, v63
  v_exp_f32 v64, v64
  v_exp_f32 v65, v65
  v_smfmac_f32_32x32x32_bf16 v[88:103], v[28:31], v[56:63], v36
  v_exp_f32 v66, v66
  v_exp_f32 v67, v67
  v_exp_f32 v68, v68
  v_exp_f32 v69, v69
  v_exp_f32 v70, v70
  v_exp_f32 v71, v71
  v_exp_f32 v40, v40
  v_exp_f32 v41, v41
  v_smfmac_f32_32x32x32_bf16 v[88:103], v[32:35], v[64:71], v36
  ds_read_b128 v[16:19], v37 offset:39520
  v_exp_f32 v42, v42
  v_exp_f32 v43, v43
  v_exp_f32 v44, v44
  v_mfma_f32_32x32x16_bf16 v[56:71], v[12:15], v[8:11], 0
  ds_read_b128 v[28:31], v38 offset:39520
  v_exp_f32 v45, v45
  v_exp_f32 v46, v46
  v_exp_f32 v47, v47
  v_exp_f32 v48, v48
  v_exp_f32 v49, v49
  v_smfmac_f32_32x32x32_bf16 v[72:87], v[20:23], v[40:47], v36
  ds_read_b128 v[32:35], v39 offset:39520
  v_exp_f32 v50, v50
  v_exp_f32 v51, v51
  v_exp_f32 v52, v52
  v_exp_f32 v53, v53
  v_exp_f32 v54, v54
  v_exp_f32 v55, v55
  v_exp_f32 v56, v56
  v_exp_f32 v57, v57
  v_smfmac_f32_32x32x32_bf16 v[72:87], v[24:27], v[48:55], v36
  s_waitcnt lgkmcnt(0)
  v_exp_f32 v58, v58
  v_exp_f32 v59, v59
  v_exp_f32 v60, v60
  v_mfma_f32_32x32x16_bf16 v[40:55], v[16:19], v[4:7], 0
  v_exp_f32 v61, v61
  v_exp_f32 v62, v62
  v_exp_f32 v63, v63
  v_exp_f32 v64, v64
  v_exp_f32 v65, v65
  v_smfmac_f32_32x32x32_bf16 v[88:103], v[20:23], v[56:63], v36
  v_exp_f32 v66, v66
  v_exp_f32 v67, v67
  v_exp_f32 v68, v68
  v_exp_f32 v69, v69
  v_exp_f32 v70, v70
  v_exp_f32 v71, v71
  v_exp_f32 v40, v40
  v_exp_f32 v41, v41
  v_smfmac_f32_32x32x32_bf16 v[88:103], v[24:27], v[64:71], v36
  ds_read_b128 v[12:15], v37 offset:41600
  v_exp_f32 v42, v42
  v_exp_f32 v43, v43
  v_exp_f32 v44, v44
  v_mfma_f32_32x32x16_bf16 v[56:71], v[16:19], v[8:11], 0
  ds_read_b128 v[20:23], v38 offset:41600
  v_exp_f32 v45, v45
  v_exp_f32 v46, v46
  v_exp_f32 v47, v47
  v_exp_f32 v48, v48
  v_exp_f32 v49, v49
  v_smfmac_f32_32x32x32_bf16 v[72:87], v[28:31], v[40:47], v36
  ds_read_b128 v[24:27], v39 offset:41600
  v_exp_f32 v50, v50
  v_exp_f32 v51, v51
  v_exp_f32 v52, v52
  v_exp_f32 v53, v53
  v_exp_f32 v54, v54
  v_exp_f32 v55, v55
  v_exp_f32 v56, v56
  v_exp_f32 v57, v57
  v_smfmac_f32_32x32x32_bf16 v[72:87], v[32:35], v[48:55], v36
  s_waitcnt lgkmcnt(0)
  v_exp_f32 v58, v58
  v_exp_f32 v59, v59
  v_exp_f32 v60, v60
  v_mfma_f32_32x32x16_bf16 v[40:55], v[12:15], v[4:7], 0
  v_exp_f32 v61, v61
  v_exp_f32 v62, v62
  v_exp_f32 v63, v63
  v_exp_f32 v64, v64
  v_exp_f32 v65, v65
  v_smfmac_f32_32x32x32_bf16 v[88:103], v[28:31], v[56:63], v36
  v_exp_f32 v66, v66
  v_exp_f32 v67, v67
  v_exp_f32 v68, v68
  v_exp_f32 v69, v69
  v_exp_f32 v70, v70
  v_exp_f32 v71, v71
  s_cmp_lg_u32 s69, 0
  s_cbranch_scc1 l0_114
  s_mov_b32 s8, 0
  s_branch rf2c_116
rf2p_115:
  buffer_load_dwordx4 v[104:107], v2, s[36:39], s79 offen offset:0 sc0 sc1
  buffer_load_dwordx4 v[108:111], v2, s[36:39], s79 offen offset:1024 sc0 sc1
  buffer_load_dwordx4 v[112:115], v2, s[36:39], s79 offen offset:2048 sc0 sc1
  buffer_load_dwordx4 v[116:119], v2, s[36:39], s79 offen offset:3072 sc0 sc1
  s_add_u32 s8, s8, 1
  s_cmp_gt_u32 s8, 0x80000
  s_cbranch_scc1 L_abort
rf2c_116:
  s_waitcnt vmcnt(0)
  v_and_b32 v104, v104, v112
  v_and_b32 v105, v105, v113
  v_and_b32 v106, v106, v114
  v_and_b32 v107, v107, v115
  v_and_b32 v108, v108, v116
  v_and_b32 v109, v109, v117
  v_and_b32 v110, v110, v118
  v_and_b32 v111, v111, v119
  v_and_b32 v104, v104, v108
  v_and_b32 v105, v105, v109
  v_and_b32 v106, v106, v110
  v_and_b32 v107, v107, v111
  v_and_b32 v104, v104, v106
  v_and_b32 v105, v105, v107
  v_and_b32 v104, v104, v105
  v_cmp_ne_u32 vcc, 1, v104
  s_nop 3
  s_cbranch_vccnz rf2p_115
l0_114:
  s_barrier
  v_exp_f32 v40, v40
  v_exp_f32 v41, v41
  v_smfmac_f32_32x32x32_bf16 v[88:103], v[32:35], v[64:71], v36
  ds_read_b128 v[16:19], v37 offset:43680
  v_exp_f32 v42, v42
  v_exp_f32 v43, v43
  v_exp_f32 v44, v44
  v_mfma_f32_32x32x16_bf16 v[56:71], v[12:15], v[8:11], 0
  ds_read_b128 v[28:31], v38 offset:43680
  v_exp_f32 v45, v45
  v_exp_f32 v46, v46
  v_exp_f32 v47, v47
  v_exp_f32 v48, v48
  v_exp_f32 v49, v49
  v_smfmac_f32_32x32x32_bf16 v[72:87], v[20:23], v[40:47], v36
  ds_read_b128 v[32:35], v39 offset:43680
  v_exp_f32 v50, v50
  v_exp_f32 v51, v51
  v_exp_f32 v52, v52
  v_exp_f32 v53, v53
  v_exp_f32 v54, v54
  v_exp_f32 v55, v55
  v_exp_f32 v56, v56
  v_exp_f32 v57, v57
  s_lshr_b32 s82, s3, 1
  s_mul_i32 s82, s82, 32768
  s_and_b32 s81, s3, 1
  s_lshl_b32 s81, s81, 10
  s_add_u32 s82, s82, s81
  s_lshr_b32 s81, s10, 2
  s_mul_i32 s81, s81, 65536
  s_add_u32 s82, s82, s81
  s_lshl_b32 s81, s3, 10
  s_add_u32 m0, s81, 135168
  s_add_u32 s80, s82, 0x1980000
  v_smfmac_f32_32x32x32_bf16 v[72:87], v[24:27], v[48:55], v36
  buffer_load_dwordx4 v2, s[36:39], s80 offen sc1 lds
  s_waitcnt lgkmcnt(0)
  v_exp_f32 v58, v58
  v_exp_f32 v59, v59
  v_exp_f32 v60, v60
  v_mfma_f32_32x32x16_bf16 v[40:55], v[16:19], v[4:7], 0
  v_exp_f32 v61, v61
  v_exp_f32 v62, v62
  v_exp_f32 v63, v63
  v_exp_f32 v64, v64
  v_exp_f32 v65, v65
  s_add_u32 m0, s81, 139264
  s_add_u32 s80, s82, 0x1980800
  v_smfmac_f32_32x32x32_bf16 v[88:103], v[20:23], v[56:63], v36
  buffer_load_dwordx4 v2, s[36:39], s80 offen sc1 lds
  v_exp_f32 v66, v66
  v_exp_f32 v67, v67
  v_exp_f32 v68, v68
  v_exp_f32 v69, v69
  v_exp_f32 v70, v70
  v_exp_f32 v71, v71
  v_exp_f32 v40, v40
  v_exp_f32 v41, v41
  v_smfmac_f32_32x32x32_bf16 v[88:103], v[24:27], v[64:71], v36
  ds_read_b128 v[12:15], v37 offset:45760
  v_exp_f32 v42, v42
  v_exp_f32 v43, v43
  v_exp_f32 v44, v44
  v_mfma_f32_32x32x16_bf16 v[56:71], v[16:19], v[8:11], 0
  ds_read_b128 v[20:23], v38 offset:45760
  v_exp_f32 v45, v45
  v_exp_f32 v46, v46
  v_exp_f32 v47, v47
  v_exp_f32 v48, v48
  v_exp_f32 v49, v49
  v_smfmac_f32_32x32x32_bf16 v[72:87], v[28:31], v[40:47], v36
  ds_read_b128 v[24:27], v39 offset:45760
  v_exp_f32 v50, v50
  v_exp_f32 v51, v51
  v_exp_f32 v52, v52
  v_exp_f32 v53, v53
  v_exp_f32 v54, v54
  v_exp_f32 v55, v55
  v_exp_f32 v56, v56
  v_exp_f32 v57, v57
  s_add_u32 m0, s81, 143360
  s_add_u32 s80, s82, 0x1981000
  v_smfmac_f32_32x32x32_bf16 v[72:87], v[32:35], v[48:55], v36
  buffer_load_dwordx4 v2, s[36:39], s80 offen sc1 lds
  s_waitcnt lgkmcnt(0)
  v_exp_f32 v58, v58
  v_exp_f32 v59, v59
  v_exp_f32 v60, v60
  s_add_u32 m0, s81, 147456
  s_add_u32 s80, s82, 0x1981800
  v_mfma_f32_32x32x16_bf16 v[40:55], v[12:15], v[4:7], 0
  buffer_load_dwordx4 v2, s[36:39], s80 offen sc1 lds
  v_exp_f32 v61, v61
  v_exp_f32 v62, v62
  v_exp_f32 v63, v63
  v_exp_f32 v64, v64
  v_exp_f32 v65, v65
  s_add_u32 m0, s81, 151552
  s_add_u32 s80, s82, 0x1982000
  v_smfmac_f32_32x32x32_bf16 v[88:103], v[28:31], v[56:63], v36
  buffer_load_dwordx4 v2, s[36:39], s80 offen sc1 lds
  v_exp_f32 v66, v66
  v_exp_f32 v67, v67
  v_exp_f32 v68, v68
  v_exp_f32 v69, v69
  v_exp_f32 v70, v70
  v_exp_f32 v71, v71
  v_exp_f32 v40, v40
  v_exp_f32 v41, v41
  v_smfmac_f32_32x32x32_bf16 v[88:103], v[32:35], v[64:71], v36
  ds_read_b128 v[16:19], v37 offset:47840
  v_exp_f32 v42, v42
  v_exp_f32 v43, v43
  v_exp_f32 v44, v44
  v_mfma_f32_32x32x16_bf16 v[56:71], v[12:15], v[8:11], 0
  ds_read_b128 v[28:31], v38 offset:47840
  v_exp_f32 v45, v45
  v_exp_f32 v46, v46
  v_exp_f32 v47, v47
  v_exp_f32 v48, v48
  v_exp_f32 v49, v49
  v_smfmac_f32_32x32x32_bf16 v[72:87], v[20:23], v[40:47], v36
  ds_read_b128 v[32:35], v39 offset:47840
  v_exp_f32 v50, v50
  v_exp_f32 v51, v51
  v_exp_f32 v52, v52
  v_exp_f32 v53, v53
  v_exp_f32 v54, v54
  v_exp_f32 v55, v55
  v_exp_f32 v56, v56
  v_exp_f32 v57, v57
  s_add_u32 m0, s81, 155648
  s_add_u32 s80, s82, 0x1982800
  v_smfmac_f32_32x32x32_bf16 v[72:87], v[24:27], v[48:55], v36
  buffer_load_dwordx4 v2, s[36:39], s80 offen sc1 lds
  s_waitcnt lgkmcnt(0)
  v_exp_f32 v58, v58
  v_exp_f32 v59, v59
  v_exp_f32 v60, v60
  v_mfma_f32_32x32x16_bf16 v[40:55], v[16:19], v[4:7], 0
  v_exp_f32 v61, v61
  v_exp_f32 v62, v62
  v_exp_f32 v63, v63
  v_exp_f32 v64, v64
  v_exp_f32 v65, v65
  s_add_u32 m0, s81, 159744
  s_add_u32 s80, s82, 0x1983000
  v_smfmac_f32_32x32x32_bf16 v[88:103], v[20:23], v[56:63], v36
  buffer_load_dwordx4 v2, s[36:39], s80 offen sc1 lds
  v_exp_f32 v66, v66
  v_exp_f32 v67, v67
  v_exp_f32 v68, v68
  v_exp_f32 v69, v69
  v_exp_f32 v70, v70
  v_exp_f32 v71, v71
  v_exp_f32 v40, v40
  v_exp_f32 v41, v41
  v_smfmac_f32_32x32x32_bf16 v[88:103], v[24:27], v[64:71], v36
  ds_read_b128 v[12:15], v37 offset:49920
  v_exp_f32 v42, v42
  v_exp_f32 v43, v43
  v_exp_f32 v44, v44
  v_mfma_f32_32x32x16_bf16 v[56:71], v[16:19], v[8:11], 0
  ds_read_b128 v[20:23], v38 offset:49920
  v_exp_f32 v45, v45
  v_exp_f32 v46, v46
  v_exp_f32 v47, v47
  v_exp_f32 v48, v48
  v_exp_f32 v49, v49
  v_smfmac_f32_32x32x32_bf16 v[72:87], v[28:31], v[40:47], v36
  ds_read_b128 v[24:27], v39 offset:49920
  v_exp_f32 v50, v50
  v_exp_f32 v51, v51
  v_exp_f32 v52, v52
  v_exp_f32 v53, v53
  v_exp_f32 v54, v54
  v_exp_f32 v55, v55
  v_exp_f32 v56, v56
  v_exp_f32 v57, v57
  s_add_u32 m0, s81, 0
  s_add_u32 s80, s82, 0x1983800
  v_smfmac_f32_32x32x32_bf16 v[72:87], v[32:35], v[48:55], v36
  buffer_load_dwordx4 v2, s[36:39], s80 offen sc1 lds
  s_waitcnt lgkmcnt(0)
  v_exp_f32 v58, v58
  v_exp_f32 v59, v59
  v_exp_f32 v60, v60
  s_add_u32 m0, s81, 4096
  s_add_u32 s80, s82, 0x1984000
  v_mfma_f32_32x32x16_bf16 v[40:55], v[12:15], v[4:7], 0
  buffer_load_dwordx4 v2, s[36:39], s80 offen sc1 lds
  v_exp_f32 v61, v61
  v_exp_f32 v62, v62
  v_exp_f32 v63, v63
  v_exp_f32 v64, v64
  v_exp_f32 v65, v65
  s_add_u32 m0, s81, 8192
  s_add_u32 s80, s82, 0x1984800
  v_smfmac_f32_32x32x32_bf16 v[88:103], v[28:31], v[56:63], v36
  buffer_load_dwordx4 v2, s[36:39], s80 offen sc1 lds
  v_exp_f32 v66, v66
  v_exp_f32 v67, v67
  v_exp_f32 v68, v68
  v_exp_f32 v69, v69
  v_exp_f32 v70, v70
  v_exp_f32 v71, v71
  v_exp_f32 v40, v40
  v_exp_f32 v41, v41
  v_smfmac_f32_32x32x32_bf16 v[88:103], v[32:35], v[64:71], v36
  ds_read_b128 v[16:19], v37 offset:52000
  v_exp_f32 v42, v42
  v_exp_f32 v43, v43
  v_exp_f32 v44, v44
  v_mfma_f32_32x32x16_bf16 v[56:71], v[12:15], v[8:11], 0
  ds_read_b128 v[28:31], v38 offset:52000
  v_exp_f32 v45, v45
  v_exp_f32 v46, v46
  v_exp_f32 v47, v47
  v_exp_f32 v48, v48
  v_exp_f32 v49, v49
  v_smfmac_f32_32x32x32_bf16 v[72:87], v[20:23], v[40:47], v36
  ds_read_b128 v[32:35], v39 offset:52000
  v_exp_f32 v50, v50
  v_exp_f32 v51, v51
  v_exp_f32 v52, v52
  v_exp_f32 v53, v53
  v_exp_f32 v54, v54
  v_exp_f32 v55, v55
  v_exp_f32 v56, v56
  v_exp_f32 v57, v57
  s_add_u32 m0, s81, 12288
  s_add_u32 s80, s82, 0x1985000
  v_smfmac_f32_32x32x32_bf16 v[72:87], v[24:27], v[48:55], v36
  buffer_load_dwordx4 v2, s[36:39], s80 offen sc1 lds
  s_waitcnt lgkmcnt(0)
  v_exp_f32 v58, v58
  v_exp_f32 v59, v59
  v_exp_f32 v60, v60
  v_mfma_f32_32x32x16_bf16 v[40:55], v[16:19], v[4:7], 0
  v_exp_f32 v61, v61
  v_exp_f32 v62, v62
  v_exp_f32 v63, v63
  v_exp_f32 v64, v64
  v_exp_f32 v65, v65
  s_add_u32 m0, s81, 16384
  s_add_u32 s80, s82, 0x1985800
  v_smfmac_f32_32x32x32_bf16 v[88:103], v[20:23], v[56:63], v36
  buffer_load_dwordx4 v2, s[36:39], s80 offen sc1 lds
  v_exp_f32 v66, v66
  v_exp_f32 v67, v67
  v_exp_f32 v68, v68
  v_exp_f32 v69, v69
  v_exp_f32 v70, v70
  v_exp_f32 v71, v71
  v_exp_f32 v40, v40
  v_exp_f32 v41, v41
  v_smfmac_f32_32x32x32_bf16 v[88:103], v[24:27], v[64:71], v36
  ds_read_b128 v[12:15], v37 offset:54080
  v_exp_f32 v42, v42
  v_exp_f32 v43, v43
  v_exp_f32 v44, v44
  v_mfma_f32_32x32x16_bf16 v[56:71], v[16:19], v[8:11], 0
  ds_read_b128 v[20:23], v38 offset:54080
  v_exp_f32 v45, v45
  v_exp_f32 v46, v46
  v_exp_f32 v47, v47
  v_exp_f32 v48, v48
  v_exp_f32 v49, v49
  v_smfmac_f32_32x32x32_bf16 v[72:87], v[28:31], v[40:47], v36
  ds_read_b128 v[24:27], v39 offset:54080
  v_exp_f32 v50, v50
  v_exp_f32 v51, v51
  v_exp_f32 v52, v52
  v_exp_f32 v53, v53
  v_exp_f32 v54, v54
  v_exp_f32 v55, v55
  v_exp_f32 v56, v56
  v_exp_f32 v57, v57
  s_add_u32 m0, s81, 20480
  s_add_u32 s80, s82, 0x1986000
  v_smfmac_f32_32x32x32_bf16 v[72:87], v[32:35], v[48:55], v36
  buffer_load_dwordx4 v2, s[36:39], s80 offen sc1 lds
  s_waitcnt lgkmcnt(0)
  v_exp_f32 v58, v58
  v_exp_f32 v59, v59
  v_exp_f32 v60, v60
  s_lshr_b32 s84, s10, 1
  s_mul_i32 s84, s84, 6
  s_min_u32 s84, s84, 80
  s_lshl_b32 s84, s84, 15
  s_lshl_b32 s85, s3, 11
  s_add_u32 s84, s84, s85
  s_add_u32 s84, s84, 0x200000
  s_cmp_gt_u32 s54, 0
  s_cselect_b32 s84, 0xf0000000, s84
  s_add_u32 m0, s85, 36864
  v_mfma_f32_32x32x16_bf16 v[40:55], v[12:15], v[4:7], 0
  buffer_load_dwordx4 v2, s[36:39], s84 offen offset:0 sc1 lds
  v_exp_f32 v61, v61
  v_exp_f32 v62, v62
  v_exp_f32 v63, v63
  v_exp_f32 v64, v64
  v_exp_f32 v65, v65
  s_add_u32 m0, s81, 24576
  s_add_u32 s80, s82, 0x1986800
  v_smfmac_f32_32x32x32_bf16 v[88:103], v[28:31], v[56:63], v36
  buffer_load_dwordx4 v2, s[36:39], s80 offen sc1 lds
  v_exp_f32 v66, v66
  v_exp_f32 v67, v67
  v_exp_f32 v68, v68
  v_exp_f32 v69, v69
  v_exp_f32 v70, v70
  v_exp_f32 v71, v71
  v_exp_f32 v40, v40
  v_exp_f32 v41, v41
  v_smfmac_f32_32x32x32_bf16 v[88:103], v[32:35], v[64:71], v36
  ds_read_b128 v[16:19], v37 offset:56160
  v_exp_f32 v42, v42
  v_exp_f32 v43, v43
  v_exp_f32 v44, v44
  v_mfma_f32_32x32x16_bf16 v[56:71], v[12:15], v[8:11], 0
  ds_read_b128 v[28:31], v38 offset:56160
  v_exp_f32 v45, v45
  v_exp_f32 v46, v46
  v_exp_f32 v47, v47
  v_exp_f32 v48, v48
  v_exp_f32 v49, v49
  v_smfmac_f32_32x32x32_bf16 v[72:87], v[20:23], v[40:47], v36
  ds_read_b128 v[32:35], v39 offset:56160
  v_exp_f32 v50, v50
  v_exp_f32 v51, v51
  v_exp_f32 v52, v52
  v_exp_f32 v53, v53
  v_exp_f32 v54, v54
  v_exp_f32 v55, v55
  v_exp_f32 v56, v56
  v_exp_f32 v57, v57
  s_add_u32 m0, s81, 28672
  s_add_u32 s80, s82, 0x1987000
  v_smfmac_f32_32x32x32_bf16 v[72:87], v[24:27], v[48:55], v36
  buffer_load_dwordx4 v2, s[36:39], s80 offen sc1 lds
  s_waitcnt lgkmcnt(0)
  v_exp_f32 v58, v58
  v_exp_f32 v59, v59
  v_exp_f32 v60, v60
  v_mfma_f32_32x32x16_bf16 v[40:55], v[16:19], v[4:7], 0
  v_exp_f32 v61, v61
  v_exp_f32 v62, v62
  v_exp_f32 v63, v63
  v_exp_f32 v64, v64
  v_exp_f32 v65, v65
  s_add_u32 m0, s81, 32768
  s_add_u32 s80, s82, 0x1987800
  v_smfmac_f32_32x32x32_bf16 v[88:103], v[20:23], v[56:63], v36
  buffer_load_dwordx4 v2, s[36:39], s80 offen sc1 lds
  v_exp_f32 v66, v66
  v_exp_f32 v67, v67
  v_exp_f32 v68, v68
  v_exp_f32 v69, v69
  v_exp_f32 v70, v70
  v_exp_f32 v71, v71
  v_exp_f32 v40, v40
  v_exp_f32 v41, v41
  v_smfmac_f32_32x32x32_bf16 v[88:103], v[24:27], v[64:71], v36
  ds_read_b128 v[12:15], v37 offset:58240
  v_exp_f32 v42, v42
  v_exp_f32 v43, v43
  v_exp_f32 v44, v44
  v_mfma_f32_32x32x16_bf16 v[56:71], v[16:19], v[8:11], 0
  ds_read_b128 v[20:23], v38 offset:58240
  v_exp_f32 v45, v45
  v_exp_f32 v46, v46
  v_exp_f32 v47, v47
  v_exp_f32 v48, v48
  v_exp_f32 v49, v49
  v_smfmac_f32_32x32x32_bf16 v[72:87], v[28:31], v[40:47], v36
  ds_read_b128 v[24:27], v39 offset:58240
  v_exp_f32 v50, v50
  v_exp_f32 v51, v51
  v_exp_f32 v52, v52
  v_exp_f32 v53, v53
  v_exp_f32 v54, v54
  v_exp_f32 v55, v55
  v_exp_f32 v56, v56
  v_exp_f32 v57, v57
  s_add_u32 m0, s85, 36864
  v_smfmac_f32_32x32x32_bf16 v[72:87], v[32:35], v[48:55], v36
  buffer_load_dwordx4 v2, s[36:39], s84 offen offset:1024 sc1 lds
  s_add_u32 s84, s84, 8192
  s_waitcnt lgkmcnt(0)
  v_exp_f32 v58, v58
  v_exp_f32 v59, v59
  v_exp_f32 v60, v60
  s_add_u32 m0, s85, 45056
  v_mfma_f32_32x32x16_bf16 v[40:55], v[12:15], v[4:7], 0
  buffer_load_dwordx4 v2, s[36:39], s84 offen offset:0 sc1 lds
  v_exp_f32 v61, v61
  v_exp_f32 v62, v62
  v_exp_f32 v63, v63
  v_exp_f32 v64, v64
  v_exp_f32 v65, v65
  s_add_u32 m0, s85, 45056
  v_smfmac_f32_32x32x32_bf16 v[88:103], v[28:31], v[56:63], v36
  buffer_load_dwordx4 v2, s[36:39], s84 offen offset:1024 sc1 lds
  s_add_u32 s84, s84, 8192
  v_add_u32 v37, 58240, v37
  v_add_u32 v38, 58240, v38
  v_add_u32 v39, 58240, v39
  v_exp_f32 v66, v66
  v_exp_f32 v67, v67
  v_exp_f32 v68, v68
  v_exp_f32 v69, v69
  v_exp_f32 v70, v70
  v_exp_f32 v71, v71
  v_exp_f32 v40, v40
  v_exp_f32 v41, v41
  v_smfmac_f32_32x32x32_bf16 v[88:103], v[32:35], v[64:71], v36
  ds_read_b128 v[16:19], v37 offset:2080
  v_exp_f32 v42, v42
  v_exp_f32 v43, v43
  v_exp_f32 v44, v44
  v_mfma_f32_32x32x16_bf16 v[56:71], v[12:15], v[8:11], 0
  ds_read_b128 v[28:31], v38 offset:2080
  v_exp_f32 v45, v45
  v_exp_f32 v46, v46
  v_exp_f32 v47, v47
  v_exp_f32 v48, v48
  v_exp_f32 v49, v49
  v_smfmac_f32_32x32x32_bf16 v[72:87], v[20:23], v[40:47], v36
  ds_read_b128 v[32:35], v39 offset:2080
  v_exp_f32 v50, v50
  v_exp_f32 v51, v51
  v_exp_f32 v52, v52
  v_exp_f32 v53, v53
  v_exp_f32 v54, v54
  v_exp_f32 v55, v55
  v_exp_f32 v56, v56
  v_exp_f32 v57, v57
  s_add_u32 m0, s85, 53248
  v_smfmac_f32_32x32x32_bf16 v[72:87], v[24:27], v[48:55], v36
  buffer_load_dwordx4 v2, s[36:39], s84 offen offset:0 sc1 lds
  s_waitcnt lgkmcnt(0)
  v_exp_f32 v58, v58
  v_exp_f32 v59, v59
  v_exp_f32 v60, v60
  v_mfma_f32_32x32x16_bf16 v[40:55], v[16:19], v[4:7], 0
  v_exp_f32 v61, v61
  v_exp_f32 v62, v62
  v_exp_f32 v63, v63
  v_exp_f32 v64, v64
  v_exp_f32 v65, v65
  s_add_u32 m0, s85, 53248
  v_smfmac_f32_32x32x32_bf16 v[88:103], v[20:23], v[56:63], v36
  buffer_load_dwordx4 v2, s[36:39], s84 offen offset:1024 sc1 lds
  s_add_u32 s84, s84, 8192
  v_exp_f32 v66, v66
  v_exp_f32 v67, v67
  v_exp_f32 v68, v68
  v_exp_f32 v69, v69
  v_exp_f32 v70, v70
  v_exp_f32 v71, v71
  v_exp_f32 v40, v40
  v_exp_f32 v41, v41
  v_smfmac_f32_32x32x32_bf16 v[88:103], v[24:27], v[64:71], v36
  ds_read_b128 v[12:15], v37 offset:4160
  v_exp_f32 v42, v42
  v_exp_f32 v43, v43
  v_exp_f32 v44, v44
  v_mfma_f32_32x32x16_bf16 v[56:71], v[16:19], v[8:11], 0
  ds_read_b128 v[20:23], v38 offset:4160
  v_exp_f32 v45, v45
  v_exp_f32 v46, v46
  v_exp_f32 v47, v47
  v_exp_f32 v48, v48
  v_exp_f32 v49, v49
  v_smfmac_f32_32x32x32_bf16 v[72:87], v[28:31], v[40:47], v36
  ds_read_b128 v[24:27], v39 offset:4160
  v_exp_f32 v50, v50
  v_exp_f32 v51, v51
  v_exp_f32 v52, v52
  v_exp_f32 v53, v53
  v_exp_f32 v54, v54
  v_exp_f32 v55, v55
  v_exp_f32 v56, v56
  v_exp_f32 v57, v57
  s_add_u32 m0, s85, 61440
  v_smfmac_f32_32x32x32_bf16 v[72:87], v[32:35], v[48:55], v36
  buffer_load_dwordx4 v2, s[36:39], s84 offen offset:0 sc1 lds
  s_waitcnt lgkmcnt(0)
  v_exp_f32 v58, v58
  v_exp_f32 v59, v59
  v_exp_f32 v60, v60
  s_add_u32 m0, s85, 61440
  v_mfma_f32_32x32x16_bf16 v[40:55], v[12:15], v[4:7], 0
  buffer_load_dwordx4 v2, s[36:39], s84 offen offset:1024 sc1 lds
  s_add_u32 s84, s84, 8192
  v_exp_f32 v61, v61
  v_exp_f32 v62, v62
  v_exp_f32 v63, v63
  v_exp_f32 v64, v64
  v_exp_f32 v65, v65
  s_add_u32 m0, s85, 69632
  v_smfmac_f32_32x32x32_bf16 v[88:103], v[28:31], v[56:63], v36
  buffer_load_dwordx4 v2, s[36:39], s84 offen offset:0 sc1 lds
  v_exp_f32 v66, v66
  v_exp_f32 v67, v67
  v_exp_f32 v68, v68
  v_exp_f32 v69, v69
  v_exp_f32 v70, v70
  v_exp_f32 v71, v71
  v_exp_f32 v40, v40
  v_exp_f32 v41, v41
  v_smfmac_f32_32x32x32_bf16 v[88:103], v[32:35], v[64:71], v36
  ds_read_b128 v[16:19], v37 offset:6240
  v_exp_f32 v42, v42
  v_exp_f32 v43, v43
  v_exp_f32 v44, v44
  v_mfma_f32_32x32x16_bf16 v[56:71], v[12:15], v[8:11], 0
  ds_read_b128 v[28:31], v38 offset:6240
  v_exp_f32 v45, v45
  v_exp_f32 v46, v46
  v_exp_f32 v47, v47
  v_exp_f32 v48, v48
  v_exp_f32 v49, v49
  v_smfmac_f32_32x32x32_bf16 v[72:87], v[20:23], v[40:47], v36
  ds_read_b128 v[32:35], v39 offset:6240
  v_exp_f32 v50, v50
  v_exp_f32 v51, v51
  v_exp_f32 v52, v52
  v_exp_f32 v53, v53
  v_exp_f32 v54, v54
  v_exp_f32 v55, v55
  v_exp_f32 v56, v56
  v_exp_f32 v57, v57
  s_add_u32 m0, s85, 69632
  v_smfmac_f32_32x32x32_bf16 v[72:87], v[24:27], v[48:55], v36
  buffer_load_dwordx4 v2, s[36:39], s84 offen offset:1024 sc1 lds
  s_add_u32 s84, s84, 8192
  s_waitcnt lgkmcnt(0)
  v_exp_f32 v58, v58
  v_exp_f32 v59, v59
  v_exp_f32 v60, v60
  v_mfma_f32_32x32x16_bf16 v[40:55], v[16:19], v[4:7], 0
  v_exp_f32 v61, v61
  v_exp_f32 v62, v62
  v_exp_f32 v63, v63
  v_exp_f32 v64, v64
  v_exp_f32 v65, v65
  s_add_u32 m0, s85, 77824
  v_smfmac_f32_32x32x32_bf16 v[88:103], v[20:23], v[56:63], v36
  buffer_load_dwordx4 v2, s[36:39], s84 offen offset:0 sc1 lds
  v_exp_f32 v66, v66
  v_exp_f32 v67, v67
  v_exp_f32 v68, v68
  v_exp_f32 v69, v69
  v_exp_f32 v70, v70
  v_exp_f32 v71, v71
  v_exp_f32 v40, v40
  v_exp_f32 v41, v41
  v_smfmac_f32_32x32x32_bf16 v[88:103], v[24:27], v[64:71], v36
  ds_read_b128 v[12:15], v37 offset:8320
  v_exp_f32 v42, v42
  v_exp_f32 v43, v43
  v_exp_f32 v44, v44
  v_mfma_f32_32x32x16_bf16 v[56:71], v[16:19], v[8:11], 0
  ds_read_b128 v[20:23], v38 offset:8320
  v_exp_f32 v45, v45
  v_exp_f32 v46, v46
  v_exp_f32 v47, v47
  v_exp_f32 v48, v48
  v_exp_f32 v49, v49
  v_smfmac_f32_32x32x32_bf16 v[72:87], v[28:31], v[40:47], v36
  ds_read_b128 v[24:27], v39 offset:8320
  v_exp_f32 v50, v50
  v_exp_f32 v51, v51
  v_exp_f32 v52, v52
  v_exp_f32 v53, v53
  v_exp_f32 v54, v54
  v_exp_f32 v55, v55
  v_exp_f32 v56, v56
  v_exp_f32 v57, v57
  s_add_u32 m0, s85, 77824
  v_smfmac_f32_32x32x32_bf16 v[72:87], v[32:35], v[48:55], v36
  buffer_load_dwordx4 v2, s[36:39], s84 offen offset:1024 sc1 lds
  s_add_u32 s84, s84, 8192
  s_waitcnt lgkmcnt(0)
  v_exp_f32 v58, v58
  v_exp_f32 v59, v59
  v_exp_f32 v60, v60
  s_add_u32 m0, s85, 86016
  v_mfma_f32_32x32x16_bf16 v[40:55], v[12:15], v[4:7], 0
  buffer_load_dwordx4 v2, s[36:39], s84 offen offset:0 sc1 lds
  v_exp_f32 v61, v61
  v_exp_f32 v62, v62
  v_exp_f32 v63, v63
  v_exp_f32 v64, v64
  v_exp_f32 v65, v65
  s_add_u32 m0, s85, 86016
  v_smfmac_f32_32x32x32_bf16 v[88:103], v[28:31], v[56:63], v36
  buffer_load_dwordx4 v2, s[36:39], s84 offen offset:1024 sc1 lds
  s_add_u32 s84, s84, 8192
  v_exp_f32 v66, v66
  v_exp_f32 v67, v67
  v_exp_f32 v68, v68
  v_exp_f32 v69, v69
  v_exp_f32 v70, v70
  v_exp_f32 v71, v71
  s_waitcnt vmcnt(13)
  s_barrier
  s_mov_b32 s90, s46
  v_lshlrev_b32 v176, 16, v248
  v_and_b32 v177, 0xffff0000, v248
  v_lshlrev_b32 v178, 16, v249
  v_and_b32 v179, 0xffff0000, v249
  v_exp_f32 v40, v40
  v_exp_f32 v41, v41
  v_smfmac_f32_32x32x32_bf16 v[88:103], v[32:35], v[64:71], v36
  ds_read_b128 v[16:19], v37 offset:10400
  v_exp_f32 v42, v42
  v_exp_f32 v43, v43
  v_exp_f32 v44, v44
  v_mfma_f32_32x32x16_bf16 v[56:71], v[12:15], v[8:11], 0
  ds_read_b128 v[28:31], v38 offset:10400
  v_exp_f32 v45, v45
  v_exp_f32 v46, v46
  v_exp_f32 v47, v47
  v_exp_f32 v48, v48
  v_exp_f32 v49, v49
  v_smfmac_f32_32x32x32_bf16 v[72:87], v[20:23], v[40:47], v36
  ds_read_b128 v[32:35], v39 offset:10400
  v_exp_f32 v50, v50
  v_exp_f32 v51, v51
  v_exp_f32 v52, v52
  v_exp_f32 v53, v53
  v_exp_f32 v54, v54
  v_exp_f32 v55, v55
  v_exp_f32 v56, v56
  v_exp_f32 v57, v57
  s_add_u32 m0, s85, 94208
  v_smfmac_f32_32x32x32_bf16 v[72:87], v[24:27], v[48:55], v36
  buffer_load_dwordx4 v2, s[36:39], s84 offen offset:0 sc1 lds
  s_waitcnt lgkmcnt(0)
  v_exp_f32 v58, v58
  v_exp_f32 v59, v59
  v_exp_f32 v60, v60
  v_mfma_f32_32x32x16_bf16 v[40:55], v[16:19], v[4:7], 0
  v_exp_f32 v61, v61
  v_exp_f32 v62, v62
  v_exp_f32 v63, v63
  v_exp_f32 v64, v64
  v_exp_f32 v65, v65
  s_add_u32 m0, s85, 94208
  v_smfmac_f32_32x32x32_bf16 v[88:103], v[20:23], v[56:63], v36
  buffer_load_dwordx4 v2, s[36:39], s84 offen offset:1024 sc1 lds
  s_add_u32 s84, s84, 8192
  v_exp_f32 v66, v66
  v_exp_f32 v67, v67
  v_exp_f32 v68, v68
  v_exp_f32 v69, v69
  v_exp_f32 v70, v70
  v_exp_f32 v71, v71
  v_lshlrev_b32 v180, 16, v250
  v_and_b32 v181, 0xffff0000, v250
  v_lshlrev_b32 v182, 16, v251
  v_and_b32 v183, 0xffff0000, v251
  v_lshlrev_b32 v184, 16, v252
  v_exp_f32 v40, v40
  v_exp_f32 v41, v41
  v_smfmac_f32_32x32x32_bf16 v[88:103], v[24:27], v[64:71], v36
  ds_read_b128 v[12:15], v37 offset:12480
  v_exp_f32 v42, v42
  v_exp_f32 v43, v43
  v_exp_f32 v44, v44
  v_mfma_f32_32x32x16_bf16 v[56:71], v[16:19], v[8:11], 0
  ds_read_b128 v[20:23], v38 offset:12480
  v_exp_f32 v45, v45
  v_exp_f32 v46, v46
  v_exp_f32 v47, v47
  v_exp_f32 v48, v48
  v_exp_f32 v49, v49
  v_smfmac_f32_32x32x32_bf16 v[72:87], v[28:31], v[40:47], v36
  ds_read_b128 v[24:27], v39 offset:12480
  v_exp_f32 v50, v50
  v_exp_f32 v51, v51
  v_exp_f32 v52, v52
  v_exp_f32 v53, v53
  v_exp_f32 v54, v54
  v_exp_f32 v55, v55
  v_exp_f32 v56, v56
  v_exp_f32 v57, v57
  s_add_u32 m0, s85, 102400
  v_smfmac_f32_32x32x32_bf16 v[72:87], v[32:35], v[48:55], v36
  buffer_load_dwordx4 v2, s[36:39], s84 offen offset:0 sc1 lds
  s_waitcnt lgkmcnt(0)
  v_exp_f32 v58, v58
  v_exp_f32 v59, v59
  v_exp_f32 v60, v60
  v_mfma_f32_32x32x16_bf16 v[40:55], v[12:15], v[4:7], 0
  v_exp_f32 v61, v61
  v_exp_f32 v62, v62
  v_exp_f32 v63, v63
  v_exp_f32 v64, v64
  v_exp_f32 v65, v65
  s_add_u32 m0, s85, 102400
  v_smfmac_f32_32x32x32_bf16 v[88:103], v[28:31], v[56:63], v36
  buffer_load_dwordx4 v2, s[36:39], s84 offen offset:1024 sc1 lds
  s_add_u32 s84, s84, 8192
  v_exp_f32 v66, v66
  v_exp_f32 v67, v67
  v_exp_f32 v68, v68
  v_exp_f32 v69, v69
  v_exp_f32 v70, v70
  v_exp_f32 v71, v71
  v_and_b32 v185, 0xffff0000, v252
  v_lshlrev_b32 v186, 16, v253
  v_and_b32 v187, 0xffff0000, v253
  v_lshlrev_b32 v188, 16, v254
  v_and_b32 v189, 0xffff0000, v254
  v_exp_f32 v40, v40
  v_exp_f32 v41, v41
  v_smfmac_f32_32x32x32_bf16 v[88:103], v[32:35], v[64:71], v36
  ds_read_b128 v[16:19], v37 offset:14560
  v_exp_f32 v42, v42
  v_exp_f32 v43, v43
  v_exp_f32 v44, v44
  v_mfma_f32_32x32x16_bf16 v[56:71], v[12:15], v[8:11], 0
  ds_read_b128 v[28:31], v38 offset:14560
  v_exp_f32 v45, v45
  v_exp_f32 v46, v46
  v_exp_f32 v47, v47
  v_exp_f32 v48, v48
  v_exp_f32 v49, v49
  v_smfmac_f32_32x32x32_bf16 v[72:87], v[20:23], v[40:47], v36
  ds_read_b128 v[32:35], v39 offset:14560
  v_exp_f32 v50, v50
  v_exp_f32 v51, v51
  v_exp_f32 v52, v52
  v_exp_f32 v53, v53
  v_exp_f32 v54, v54
  v_exp_f32 v55, v55
  v_exp_f32 v56, v56
  v_exp_f32 v57, v57
  s_add_u32 m0, s85, 110592
  v_smfmac_f32_32x32x32_bf16 v[72:87], v[24:27], v[48:55], v36
  buffer_load_dwordx4 v2, s[36:39], s84 offen offset:0 sc1 lds
  s_waitcnt lgkmcnt(0)
  v_exp_f32 v58, v58
  v_exp_f32 v59, v59
  v_exp_f32 v60, v60
  v_mfma_f32_32x32x16_bf16 v[40:55], v[16:19], v[4:7], 0
  v_exp_f32 v61, v61
  v_exp_f32 v62, v62
  v_exp_f32 v63, v63
  v_exp_f32 v64, v64
  v_exp_f32 v65, v65
  s_add_u32 m0, s85, 110592
  v_smfmac_f32_32x32x32_bf16 v[88:103], v[20:23], v[56:63], v36
  buffer_load_dwordx4 v2, s[36:39], s84 offen offset:1024 sc1 lds
  s_add_u32 s84, s84, 8192
  v_exp_f32 v66, v66
  v_exp_f32 v67, v67
  v_exp_f32 v68, v68
  v_exp_f32 v69, v69
  v_exp_f32 v70, v70
  v_exp_f32 v71, v71
  v_lshlrev_b32 v190, 16, v255
  v_and_b32 v191, 0xffff0000, v255
  v_exp_f32 v40, v40
  v_exp_f32 v41, v41
  v_smfmac_f32_32x32x32_bf16 v[88:103], v[24:27], v[64:71], v36
  ds_read_b128 v[12:15], v37 offset:16640
  v_exp_f32 v42, v42
  v_exp_f32 v43, v43
  v_exp_f32 v44, v44
  v_mfma_f32_32x32x16_bf16 v[56:71], v[16:19], v[8:11], 0
  ds_read_b128 v[20:23], v38 offset:16640
  v_exp_f32 v45, v45
  v_exp_f32 v46, v46
  v_exp_f32 v47, v47
  v_exp_f32 v48, v48
  v_exp_f32 v49, v49
  v_smfmac_f32_32x32x32_bf16 v[72:87], v[28:31], v[40:47], v36
  ds_read_b128 v[24:27], v39 offset:16640
  v_exp_f32 v50, v50
  v_exp_f32 v51, v51
  v_exp_f32 v52, v52
  v_exp_f32 v53, v53
  v_exp_f32 v54, v54
  v_exp_f32 v55, v55
  v_exp_f32 v56, v56
  v_exp_f32 v57, v57
  v_smfmac_f32_32x32x32_bf16 v[72:87], v[32:35], v[48:55], v36
  s_waitcnt lgkmcnt(0)
  v_exp_f32 v58, v58
  v_exp_f32 v59, v59
  v_exp_f32 v60, v60
  v_mfma_f32_32x32x16_bf16 v[40:55], v[12:15], v[4:7], 0
  v_exp_f32 v61, v61
  v_exp_f32 v62, v62
  v_exp_f32 v63, v63
  v_exp_f32 v64, v64
  v_exp_f32 v65, v65
  v_smfmac_f32_32x32x32_bf16 v[88:103], v[28:31], v[56:63], v36
  v_exp_f32 v66, v66
  v_exp_f32 v67, v67
  v_exp_f32 v68, v68
  v_exp_f32 v69, v69
  v_exp_f32 v70, v70
  v_exp_f32 v71, v71
  s_nop 1
  v_smfmac_f32_32x32x32_bf16 v[88:103], v[32:35], v[64:71], v36
  s_mov_b32 s96, 0x33800000
  s_lshl_b32 s72, s71, 5
  s_add_u32 s72, s72, s70
  s_lshl_b32 s79, s72, 2
  s_add_u32 s79, s79, s3
  s_lshl_b32 s79, s79, 2
  s_add_u32 s79, s79, s68
  s_add_u32 s79, s79, 0x4f1000
  s_nop 4
  v_add_f32 v138, v80, v96
  v_min_f32 v139, v80, v96
  v_pk_mul_f32 v[40:41], v[72:73], 0 op_sel_hi:[1,0]
  v_pk_mul_f32 v[42:43], v[74:75], 0 op_sel_hi:[1,0]
  v_pk_mul_f32 v[44:45], v[76:77], 0 op_sel_hi:[1,0]
  v_pk_mul_f32 v[46:47], v[78:79], 0 op_sel_hi:[1,0]
  v_pk_fma_f32 v[40:41], v[88:89], 0, v[40:41] op_sel_hi:[1,0,1]
  v_pk_fma_f32 v[42:43], v[90:91], 0, v[42:43] op_sel_hi:[1,0,1]
  v_pk_fma_f32 v[44:45], v[92:93], 0, v[44:45] op_sel_hi:[1,0,1]
  v_pk_fma_f32 v[46:47], v[94:95], 0, v[46:47] op_sel_hi:[1,0,1]
  v_pk_add_f32 v[40:41], v[40:41], v[42:43]
  v_pk_add_f32 v[44:45], v[44:45], v[46:47]
  v_pk_add_f32 v[40:41], v[40:41], v[44:45]
  v_add_f32 v40, v40, v41
  v_add_f32 v138, v138, v40
  v_cmp_ge_f32 vcc, 0x5f800000, v138
  v_cmp_le_f32 s[94:95], s96, v139
  v_rcp_f32 v136, v80
  v_rcp_f32 v137, v96
  s_and_b64 vcc, vcc, s[94:95]
  s_cmp_eq_u64 vcc, exec
  s_cbranch_scc0 G_aslow
G_afin:
  v_mul_f32 v72, v72, v136
  v_mul_f32 v73, v73, v136
  v_mul_f32 v74, v74, v136
  v_mul_f32 v75, v75, v136
  v_mul_f32 v76, v76, v136
  v_mul_f32 v77, v77, v136
  v_mul_f32 v78, v78, v136
  v_mul_f32 v79, v79, v136
  v_cvt_pk_bf16_f32 v40, v72, v73
  v_cvt_pk_bf16_f32 v41, v74, v75
  v_cvt_pk_bf16_f32 v42, v76, v77
  v_cvt_pk_bf16_f32 v43, v78, v79
  buffer_store_dwordx4 v[40:43], v2, s[36:39], s76 offen sc1
  v_mul_f32 v88, v88, v137
  v_mul_f32 v89, v89, v137
  v_mul_f32 v90, v90, v137
  v_mul_f32 v91, v91, v137
  v_mul_f32 v92, v92, v137
  v_mul_f32 v93, v93, v137
  v_mul_f32 v94, v94, v137
  v_mul_f32 v95, v95, v137
  v_cvt_pk_bf16_f32 v44, v88, v89
  v_cvt_pk_bf16_f32 v45, v90, v91
  v_cvt_pk_bf16_f32 v46, v92, v93
  v_cvt_pk_bf16_f32 v47, v94, v95
  buffer_store_dwordx4 v[44:47], v2, s[36:39], s77 offen sc1
  s_waitcnt vmcnt(0)
  s_mov_b64 exec, 1
  buffer_store_dword v229, off, s[36:39], s79 sc0 sc1
  s_mov_b64 exec, -1
  s_mov_b32 s8, 0
pl_117:
  buffer_load_dword v224, v228, s[36:39], s49 offen sc0 sc1
  s_add_u32 s8, s8, 1
  s_cmp_gt_u32 s8, 0x80000
  s_cbranch_scc1 L_abort
  s_waitcnt vmcnt(0)
pchk_119:
  v_cmp_ne_u32 vcc, 1, v224
  s_nop 3
  s_cbranch_vccnz pl_117
  buffer_load_dwordx4 a[0:3], v2, s[36:39], s90 offen offset:0 sc1
  buffer_load_dwordx4 a[4:7], v2, s[36:39], s90 offen offset:1024 sc1
  buffer_load_dwordx4 a[8:11], v2, s[36:39], s90 offen offset:2048 sc1
  buffer_load_dwordx4 a[12:15], v2, s[36:39], s90 offen offset:3072 sc1
  s_add_u32 s90, s90, 4096
  buffer_load_dwordx4 a[16:19], v2, s[36:39], s90 offen offset:0 sc1
  buffer_load_dwordx4 a[20:23], v2, s[36:39], s90 offen offset:1024 sc1
  buffer_load_dwordx4 a[24:27], v2, s[36:39], s90 offen offset:2048 sc1
  buffer_load_dwordx4 a[28:31], v2, s[36:39], s90 offen offset:3072 sc1
  s_add_u32 s90, s90, 4096
  buffer_load_dwordx4 a[32:35], v2, s[36:39], s90 offen offset:0 sc1
  buffer_load_dwordx4 a[36:39], v2, s[36:39], s90 offen offset:1024 sc1
  buffer_load_dwordx4 a[40:43], v2, s[36:39], s90 offen offset:2048 sc1
  buffer_load_dwordx4 a[44:47], v2, s[36:39], s90 offen offset:3072 sc1
  s_add_u32 s90, s90, 4096
  s_barrier
  s_lshr_b32 s95, s10, 1
  s_mul_i32 s95, s95, 6
  s_min_u32 s95, s95, 80
  s_lshl_b32 s95, s95, 10
  s_add_u32 s95, s95, 0x4d0000
  s_mov_b32 s74, s51
  s_cmp_gt_u32 s54, 4
  s_cselect_b32 s74, 0xf0000000, s74
  s_mov_b32 s76, s53
  s_add_u32 s78, s55, 0x3000
  ds_read_b128 v[160:163], v212 offset:12288
  ds_read_b128 v[164:167], v213 offset:12288
  ds_read_b128 v[168:171], v212 offset:16384
  s_waitcnt vmcnt(11)
  s_waitcnt lgkmcnt(2)
  v_mfma_f32_32x32x16_bf16 v[176:191], v[160:163], a[0:3], v[176:191]
  buffer_load_dwordx4 a[48:51], v2, s[36:39], s90 offen offset:0 sc1
  ds_read_b128 v[172:175], v213 offset:16384
  s_waitcnt lgkmcnt(2)
  v_mfma_f32_32x32x16_bf16 v[192:207], v[164:167], a[0:3], 0
  ds_read_b128 v[160:163], v212 offset:20480
  s_waitcnt vmcnt(11)
  s_waitcnt lgkmcnt(2)
  v_mfma_f32_32x32x16_bf16 v[176:191], v[168:171], a[4:7], v[176:191]
  buffer_load_dwordx4 a[52:55], v2, s[36:39], s90 offen offset:1024 sc1
  ds_read_b128 v[164:167], v213 offset:20480
  s_waitcnt lgkmcnt(2)
  v_mfma_f32_32x32x16_bf16 v[192:207], v[172:175], a[4:7], v[192:207]
  ds_read_b128 v[168:171], v212 offset:24576
  s_waitcnt vmcnt(11)
  s_waitcnt lgkmcnt(2)
  v_mfma_f32_32x32x16_bf16 v[176:191], v[160:163], a[8:11], v[176:191]
  buffer_load_dwordx4 a[56:59], v2, s[36:39], s90 offen offset:2048 sc1
  ds_read_b128 v[172:175], v213 offset:24576
  s_waitcnt lgkmcnt(2)
  v_mfma_f32_32x32x16_bf16 v[192:207], v[164:167], a[8:11], v[192:207]
  ds_read_b128 v[160:163], v212 offset:28672
  s_waitcnt vmcnt(11)
  s_waitcnt lgkmcnt(2)
  v_mfma_f32_32x32x16_bf16 v[176:191], v[168:171], a[12:15], v[176:191]
  buffer_load_dwordx4 a[60:63], v2, s[36:39], s90 offen offset:3072 sc1
  ds_read_b128 v[164:167], v213 offset:28672
  s_add_u32 s90, s90, 4096
  s_waitcnt lgkmcnt(2)
  v_mfma_f32_32x32x16_bf16 v[192:207], v[172:175], a[12:15], v[192:207]
  ds_read_b128 v[168:171], v212 offset:32768
  s_waitcnt vmcnt(11)
  s_waitcnt lgkmcnt(2)
  v_mfma_f32_32x32x16_bf16 v[176:191], v[160:163], a[16:19], v[176:191]
  buffer_load_dwordx4 v[28:31], v2, s[36:39], s95 offen offset:0 sc1
  ds_read_b128 v[172:175], v213 offset:32768
  s_waitcnt lgkmcnt(2)
  v_mfma_f32_32x32x16_bf16 v[192:207], v[164:167], a[16:19], v[192:207]
  ds_read_b128 v[160:163], v212 offset:36864
  s_waitcnt vmcnt(11)
  s_waitcnt lgkmcnt(2)
  v_mfma_f32_32x32x16_bf16 v[176:191], v[168:171], a[20:23], v[176:191]
  buffer_load_dwordx4 v[32:35], v2, s[36:39], s95 offen offset:1024 sc1
  ds_read_b128 v[164:167], v213 offset:36864
  s_waitcnt lgkmcnt(2)
  v_mfma_f32_32x32x16_bf16 v[192:207], v[172:175], a[20:23], v[192:207]
  ds_read_b128 v[168:171], v208 offset:0
  s_waitcnt vmcnt(11)
  s_waitcnt lgkmcnt(2)
  v_mfma_f32_32x32x16_bf16 v[176:191], v[160:163], a[24:27], v[176:191]
  buffer_load_dwordx4 v[36:39], v2, s[36:39], s95 offen offset:2048 sc1
  ds_read_b128 v[172:175], v209 offset:0
  s_waitcnt lgkmcnt(2)
  v_mfma_f32_32x32x16_bf16 v[192:207], v[164:167], a[24:27], v[192:207]
  ds_read_b128 v[160:163], v208 offset:4096
  s_waitcnt vmcnt(11)
  s_waitcnt lgkmcnt(2)
  v_mfma_f32_32x32x16_bf16 v[176:191], v[168:171], a[28:31], v[176:191]
  buffer_load_dwordx4 v[40:43], v2, s[36:39], s95 offen offset:3072 sc1
  ds_read_b128 v[164:167], v209 offset:4096
  s_waitcnt lgkmcnt(2)
  v_mfma_f32_32x32x16_bf16 v[192:207], v[172:175], a[28:31], v[192:207]
  ds_read_b128 v[168:171], v208 offset:8192
  s_waitcnt vmcnt(11)
  s_waitcnt lgkmcnt(2)
  s_add_u32 s95, s95, 4096
  v_mfma_f32_32x32x16_bf16 v[176:191], v[160:163], a[32:35], v[176:191]
  buffer_load_dwordx4 v[44:47], v2, s[36:39], s95 offen offset:0 sc1
  ds_read_b128 v[172:175], v209 offset:8192
  s_waitcnt lgkmcnt(2)
  v_mfma_f32_32x32x16_bf16 v[192:207], v[164:167], a[32:35], v[192:207]
  ds_read_b128 v[160:163], v208 offset:12288
  s_waitcnt vmcnt(11)
  s_waitcnt lgkmcnt(2)
  v_mfma_f32_32x32x16_bf16 v[176:191], v[168:171], a[36:39], v[176:191]
  buffer_load_dwordx4 v[48:51], v2, s[36:39], s95 offen offset:1024 sc1
  ds_read_b128 v[164:167], v209 offset:12288
  s_waitcnt lgkmcnt(2)
  v_mfma_f32_32x32x16_bf16 v[192:207], v[172:175], a[36:39], v[192:207]
  ds_read_b128 v[168:171], v208 offset:16384
  s_waitcnt vmcnt(11)
  s_waitcnt lgkmcnt(2)
  v_mfma_f32_32x32x16_bf16 v[176:191], v[160:163], a[40:43], v[176:191]
  ds_read_b128 v[172:175], v209 offset:16384
  s_waitcnt lgkmcnt(2)
  v_mfma_f32_32x32x16_bf16 v[192:207], v[164:167], a[40:43], v[192:207]
  ds_read_b128 v[160:163], v208 offset:20480
  s_waitcnt vmcnt(10)
  s_waitcnt lgkmcnt(2)
  v_mfma_f32_32x32x16_bf16 v[176:191], v[168:171], a[44:47], v[176:191]
  ds_read_b128 v[164:167], v209 offset:20480
  s_waitcnt lgkmcnt(2)
  v_mfma_f32_32x32x16_bf16 v[192:207], v[172:175], a[44:47], v[192:207]
  ds_read_b128 v[168:171], v208 offset:24576
  s_waitcnt vmcnt(9)
  s_waitcnt lgkmcnt(2)
  v_mfma_f32_32x32x16_bf16 v[176:191], v[160:163], a[48:51], v[176:191]
  ds_read_b128 v[172:175], v209 offset:24576
  s_waitcnt lgkmcnt(2)
  v_mfma_f32_32x32x16_bf16 v[192:207], v[164:167], a[48:51], v[192:207]
  ds_read_b128 v[160:163], v208 offset:28672
  s_waitcnt vmcnt(8)
  s_waitcnt lgkmcnt(2)
  v_mfma_f32_32x32x16_bf16 v[176:191], v[168:171], a[52:55], v[176:191]
  ds_read_b128 v[164:167], v209 offset:28672
  s_waitcnt lgkmcnt(2)
  v_mfma_f32_32x32x16_bf16 v[192:207], v[172:175], a[52:55], v[192:207]
  ds_read_b128 v[168:171], v208 offset:32768
  s_waitcnt vmcnt(7)
  s_waitcnt lgkmcnt(2)
  v_mfma_f32_32x32x16_bf16 v[176:191], v[160:163], a[56:59], v[176:191]
  ds_read_b128 v[172:175], v209 offset:32768
  s_waitcnt lgkmcnt(2)
  v_mfma_f32_32x32x16_bf16 v[192:207], v[164:167], a[56:59], v[192:207]
  s_waitcnt vmcnt(6)
  s_waitcnt lgkmcnt(1)
  v_mfma_f32_32x32x16_bf16 v[176:191], v[168:171], a[60:63], v[176:191]
  s_waitcnt lgkmcnt(0)
  v_mfma_f32_32x32x16_bf16 v[192:207], v[172:175], a[60:63], v[192:207]
  s_nop 11
  ds_write_b128 v214, v[192:195] offset:16384
  ds_write_b128 v214, v[196:199] offset:17408
  ds_write_b128 v214, v[200:203] offset:18432
  ds_write_b128 v214, v[204:207] offset:19456
  s_waitcnt lgkmcnt(0)
  s_barrier
  ds_read_b128 v[192:195], v215 offset:16384
  ds_read_b128 v[196:199], v215 offset:17408
  ds_read_b128 v[200:203], v215 offset:18432
  ds_read_b128 v[204:207], v215 offset:19456
  s_add_u32 m0, s85, 135168
  s_nop 0
  buffer_load_dwordx4 v2, s[36:39], s84 offen offset:0 sc1 lds
  s_add_u32 m0, s85, 135168
  s_nop 0
  buffer_load_dwordx4 v2, s[36:39], s84 offen offset:1024 sc1 lds
  s_add_u32 s84, s84, 8192
  s_add_u32 m0, s85, 143360
  s_nop 0
  buffer_load_dwordx4 v2, s[36:39], s84 offen offset:0 sc1 lds
  s_add_u32 m0, s85, 143360
  s_nop 0
  buffer_load_dwordx4 v2, s[36:39], s84 offen offset:1024 sc1 lds
  s_add_u32 s84, s84, 8192
  s_waitcnt lgkmcnt(3)
  v_pk_add_f32 v[176:177], v[176:177], v[192:193]
  v_pk_add_f32 v[178:179], v[178:179], v[194:195]
  v_cvt_pk_bf16_f32 v248, v176, v177
  v_cvt_pk_bf16_f32 v249, v178, v179
  v_pk_add_f32 v[152:153], v[176:177], v[178:179]
  v_pk_mul_f32 v[154:155], v[176:177], v[176:177]
  v_pk_fma_f32 v[154:155], v[178:179], v[178:179], v[154:155]
  s_waitcnt lgkmcnt(2)
  v_pk_add_f32 v[180:181], v[180:181], v[196:197]
  v_pk_add_f32 v[182:183], v[182:183], v[198:199]
  v_cvt_pk_bf16_f32 v250, v180, v181
  v_cvt_pk_bf16_f32 v251, v182, v183
  buffer_store_dwordx4 v[248:251], v2, s[36:39], s44 offen offset:0 sc1
  v_pk_add_f32 v[152:153], v[152:153], v[180:181]
  v_pk_fma_f32 v[154:155], v[180:181], v[180:181], v[154:155]
  v_pk_add_f32 v[152:153], v[152:153], v[182:183]
  v_pk_fma_f32 v[154:155], v[182:183], v[182:183], v[154:155]
  s_waitcnt lgkmcnt(1)
  v_pk_add_f32 v[184:185], v[184:185], v[200:201]
  v_pk_add_f32 v[186:187], v[186:187], v[202:203]
  v_cvt_pk_bf16_f32 v252, v184, v185
  v_cvt_pk_bf16_f32 v253, v186, v187
  v_pk_add_f32 v[152:153], v[152:153], v[184:185]
  v_pk_fma_f32 v[154:155], v[184:185], v[184:185], v[154:155]
  v_pk_add_f32 v[152:153], v[152:153], v[186:187]
  v_pk_fma_f32 v[154:155], v[186:187], v[186:187], v[154:155]
  s_waitcnt lgkmcnt(0)
  v_pk_add_f32 v[188:189], v[188:189], v[204:205]
  v_pk_add_f32 v[190:191], v[190:191], v[206:207]
  v_cvt_pk_bf16_f32 v254, v188, v189
  v_cvt_pk_bf16_f32 v255, v190, v191
  buffer_store_dwordx4 v[252:255], v2, s[36:39], s44 offen offset:1024 sc1
  v_pk_add_f32 v[152:153], v[152:153], v[188:189]
  v_pk_fma_f32 v[154:155], v[188:189], v[188:189], v[154:155]
  v_pk_add_f32 v[152:153], v[152:153], v[190:191]
  v_pk_fma_f32 v[154:155], v[190:191], v[190:191], v[154:155]
  v_add_f32 v152, v152, v153
  v_add_f32 v153, v154, v155
  v_mov_b32 v154, v152
  v_mov_b32 v155, v153
  s_nop 0
  v_permlane32_swap_b32 v152, v154
  v_permlane32_swap_b32 v153, v155
  s_mov_b32 exec_hi, 0
  v_pk_add_f32 v[152:153], v[152:153], v[154:155]
  buffer_store_dwordx2 v[152:153], v2, s[36:39], s45 offen sc1
  s_mov_b32 exec_hi, -1
  s_add_u32 m0, s85, 151552
  s_nop 0
  buffer_load_dwordx4 v2, s[36:39], s84 offen offset:0 sc1 lds
  s_add_u32 m0, s85, 151552
  s_nop 0
  buffer_load_dwordx4 v2, s[36:39], s84 offen offset:1024 sc1 lds
  s_add_u32 s84, s84, 8192
  s_waitcnt vmcnt(2)
  s_mov_b64 exec, 1
  buffer_store_dword v229, off, s[36:39], s48 sc0 sc1
  s_mov_b64 exec, -1
  s_mov_b32 s8, 0
pl_120:
  buffer_load_dword v224, v225, s[36:39], s57 offen sc0 sc1
  s_add_u32 s8, s8, 1
  s_cmp_gt_u32 s8, 0x80000
  s_cbranch_scc1 L_abort
  s_waitcnt vmcnt(0)
pchk_122:
  v_cmp_ne_u32 vcc, 1, v224
  s_nop 3
  s_cbranch_vccnz pl_120
  buffer_load_dwordx4 a[0:3], v2, s[36:39], s74 offen offset:0 sc1
  buffer_load_dwordx4 a[4:7], v2, s[36:39], s74 offen offset:1024 sc1
  buffer_load_dwordx4 a[8:11], v2, s[36:39], s74 offen offset:2048 sc1
  buffer_load_dwordx4 a[12:15], v2, s[36:39], s74 offen offset:3072 sc1
  s_add_u32 s74, s74, 4096
  buffer_load_dwordx4 a[16:19], v2, s[36:39], s74 offen offset:0 sc1
  buffer_load_dwordx4 a[20:23], v2, s[36:39], s74 offen offset:1024 sc1
  buffer_load_dwordx4 v[12:15], v2, s[36:39], s52 offen offset:0 sc1
  buffer_load_dwordx4 v[16:19], v2, s[36:39], s52 offen offset:1024 sc1
  buffer_load_dwordx4 v[20:23], v2, s[36:39], s52 offen offset:2048 sc1
  buffer_load_dwordx4 v[24:27], v2, s[36:39], s52 offen offset:3072 sc1
  buffer_load_dwordx4 a[24:27], v2, s[36:39], s74 offen offset:2048 sc1
  buffer_load_dwordx4 a[28:31], v2, s[36:39], s74 offen offset:3072 sc1
  s_add_u32 s74, s74, 4096
  ds_read_b128 v[64:67], v2 offset:36864
  ds_read_b128 v[68:71], v2 offset:37888
  ds_read_b128 v[72:75], v2 offset:38912
  s_waitcnt vmcnt(11)
  s_waitcnt lgkmcnt(2)
  v_mfma_f32_32x32x16_bf16 v[112:127], v[64:67], a[0:3], 0
  buffer_load_dwordx4 a[32:35], v2, s[36:39], s74 offen offset:0 sc1
  ds_read_b128 v[76:79], v2 offset:39936
  s_waitcnt lgkmcnt(2)
  v_mfma_f32_32x32x16_bf16 v[128:143], v[68:71], a[0:3], 0
  ds_read_b128 v[64:67], v2 offset:40960
  s_waitcnt vmcnt(11)
  s_waitcnt lgkmcnt(2)
  v_mfma_f32_32x32x16_bf16 v[112:127], v[72:75], a[4:7], v[112:127]
  buffer_load_dwordx4 a[36:39], v2, s[36:39], s74 offen offset:1024 sc1
  ds_read_b128 v[68:71], v2 offset:41984
  s_waitcnt lgkmcnt(2)
  v_mfma_f32_32x32x16_bf16 v[128:143], v[76:79], a[4:7], v[128:143]
  ds_read_b128 v[72:75], v2 offset:43008
  s_waitcnt vmcnt(11)
  s_waitcnt lgkmcnt(2)
  v_mfma_f32_32x32x16_bf16 v[112:127], v[64:67], a[8:11], v[112:127]
  buffer_load_dwordx4 a[40:43], v2, s[36:39], s74 offen offset:2048 sc1
  ds_read_b128 v[76:79], v2 offset:44032
  s_waitcnt lgkmcnt(2)
  v_mfma_f32_32x32x16_bf16 v[128:143], v[68:71], a[8:11], v[128:143]
  ds_read_b128 v[64:67], v2 offset:45056
  s_waitcnt vmcnt(11)
  s_waitcnt lgkmcnt(2)
  v_mfma_f32_32x32x16_bf16 v[112:127], v[72:75], a[12:15], v[112:127]
  buffer_load_dwordx4 a[44:47], v2, s[36:39], s74 offen offset:3072 sc1
  ds_read_b128 v[68:71], v2 offset:46080
  s_add_u32 s74, s74, 4096
  s_waitcnt lgkmcnt(2)
  v_mfma_f32_32x32x16_bf16 v[128:143], v[76:79], a[12:15], v[128:143]
  ds_read_b128 v[72:75], v2 offset:47104
  s_waitcnt vmcnt(11)
  s_waitcnt lgkmcnt(2)
  v_mfma_f32_32x32x16_bf16 v[112:127], v[64:67], a[16:19], v[112:127]
  buffer_load_dwordx4 a[48:51], v2, s[36:39], s74 offen offset:0 sc1
  ds_read_b128 v[76:79], v2 offset:48128
  s_waitcnt lgkmcnt(2)
  v_mfma_f32_32x32x16_bf16 v[128:143], v[68:71], a[16:19], v[128:143]
  ds_read_b128 v[64:67], v2 offset:49152
  s_waitcnt vmcnt(11)
  s_waitcnt lgkmcnt(2)
  v_mfma_f32_32x32x16_bf16 v[112:127], v[72:75], a[20:23], v[112:127]
  buffer_load_dwordx4 a[52:55], v2, s[36:39], s74 offen offset:1024 sc1
  ds_read_b128 v[68:71], v2 offset:50176
  s_waitcnt lgkmcnt(2)
  v_mfma_f32_32x32x16_bf16 v[128:143], v[76:79], a[20:23], v[128:143]
  ds_read_b128 v[72:75], v2 offset:51200
  s_waitcnt vmcnt(7)
  s_waitcnt lgkmcnt(2)
  v_mfma_f32_32x32x16_bf16 v[112:127], v[64:67], a[24:27], v[112:127]
  buffer_load_dwordx4 a[56:59], v2, s[36:39], s74 offen offset:2048 sc1
  ds_read_b128 v[76:79], v2 offset:52224
  s_waitcnt lgkmcnt(2)
  v_mfma_f32_32x32x16_bf16 v[128:143], v[68:71], a[24:27], v[128:143]
  ds_read_b128 v[64:67], v2 offset:53248
  s_waitcnt vmcnt(7)
  s_waitcnt lgkmcnt(2)
  v_mfma_f32_32x32x16_bf16 v[112:127], v[72:75], a[28:31], v[112:127]
  buffer_load_dwordx4 a[60:63], v2, s[36:39], s74 offen offset:3072 sc1
  ds_read_b128 v[68:71], v2 offset:54272
  s_add_u32 s74, s74, 4096
  s_waitcnt lgkmcnt(2)
  v_mfma_f32_32x32x16_bf16 v[128:143], v[76:79], a[28:31], v[128:143]
  ds_read_b128 v[72:75], v2 offset:55296
  s_waitcnt vmcnt(7)
  s_waitcnt lgkmcnt(2)
  v_mfma_f32_32x32x16_bf16 v[112:127], v[64:67], a[32:35], v[112:127]
  buffer_load_dwordx4 a[64:67], v2, s[36:39], s74 offen offset:0 sc1
  ds_read_b128 v[76:79], v2 offset:56320
  v_add_f32 v12, v12, v20
  v_add_f32 v13, v13, v21
  s_waitcnt lgkmcnt(2)
  v_mfma_f32_32x32x16_bf16 v[128:143], v[68:71], a[32:35], v[128:143]
  ds_read_b128 v[64:67], v2 offset:57344
  v_add_f32 v14, v14, v22
  v_add_f32 v15, v15, v23
  s_waitcnt vmcnt(7)
  s_waitcnt lgkmcnt(2)
  v_mfma_f32_32x32x16_bf16 v[112:127], v[72:75], a[36:39], v[112:127]
  buffer_load_dwordx4 a[68:71], v2, s[36:39], s74 offen offset:1024 sc1
  ds_read_b128 v[68:71], v2 offset:58368
  v_add_f32 v16, v16, v24
  v_add_f32 v17, v17, v25
  s_waitcnt lgkmcnt(2)
  v_mfma_f32_32x32x16_bf16 v[128:143], v[76:79], a[36:39], v[128:143]
  ds_read_b128 v[72:75], v2 offset:59392
  v_add_f32 v18, v18, v26
  v_add_f32 v19, v19, v27
  s_waitcnt vmcnt(7)
  s_waitcnt lgkmcnt(2)
  v_mfma_f32_32x32x16_bf16 v[112:127], v[64:67], a[40:43], v[112:127]
  buffer_load_dwordx4 a[72:75], v2, s[36:39], s74 offen offset:2048 sc1
  ds_read_b128 v[76:79], v2 offset:60416
  v_add_f32 v12, v12, v16
  v_add_f32 v13, v13, v17
  s_waitcnt lgkmcnt(2)
  v_mfma_f32_32x32x16_bf16 v[128:143], v[68:71], a[40:43], v[128:143]
  ds_read_b128 v[64:67], v222 offset:0
  v_add_f32 v14, v14, v18
  v_add_f32 v15, v15, v19
  s_waitcnt vmcnt(7)
  s_waitcnt lgkmcnt(2)
  v_mfma_f32_32x32x16_bf16 v[112:127], v[72:75], a[44:47], v[112:127]
  buffer_load_dwordx4 a[76:79], v2, s[36:39], s74 offen offset:3072 sc1
  ds_read_b128 v[68:71], v222 offset:1024
  s_add_u32 s74, s74, 4096
  v_add_f32 v12, v12, v14
  v_add_f32 v13, v13, v15
  s_waitcnt lgkmcnt(2)
  v_mfma_f32_32x32x16_bf16 v[128:143], v[76:79], a[44:47], v[128:143]
  ds_read_b128 v[72:75], v222 offset:2048
  v_mov_b32 v58, v12
  v_mov_b32 v59, v13
  s_waitcnt vmcnt(7)
  s_waitcnt lgkmcnt(2)
  v_mfma_f32_32x32x16_bf16 v[112:127], v[64:67], a[48:51], v[112:127]
  buffer_load_dwordx4 a[80:83], v2, s[36:39], s74 offen offset:0 sc1
  ds_read_b128 v[76:79], v222 offset:3072
  s_nop 0
  v_permlane32_swap_b32 v12, v58
  s_waitcnt lgkmcnt(2)
  v_mfma_f32_32x32x16_bf16 v[128:143], v[68:71], a[48:51], v[128:143]
  ds_read_b128 v[64:67], v222 offset:4096
  v_permlane32_swap_b32 v13, v59
  v_add_f32 v12, v12, v58
  s_waitcnt vmcnt(7)
  s_waitcnt lgkmcnt(2)
  v_mfma_f32_32x32x16_bf16 v[112:127], v[72:75], a[52:55], v[112:127]
  buffer_load_dwordx4 a[84:87], v2, s[36:39], s74 offen offset:1024 sc1
  ds_read_b128 v[68:71], v222 offset:5120
  v_add_f32 v13, v13, v59
  v_mul_f32 v56, 0.001953125, v12
  s_waitcnt lgkmcnt(2)
  v_mfma_f32_32x32x16_bf16 v[128:143], v[76:79], a[52:55], v[128:143]
  ds_read_b128 v[72:75], v222 offset:6144
  v_mul_f32 v13, 0.001953125, v13
  v_fma_f32 v13, -v56, v56, v13
  s_waitcnt vmcnt(7)
  s_waitcnt lgkmcnt(2)
  v_mfma_f32_32x32x16_bf16 v[112:127], v[64:67], a[56:59], v[112:127]
  buffer_load_dwordx4 a[88:91], v2, s[36:39], s74 offen offset:2048 sc1
  ds_read_b128 v[76:79], v222 offset:7168
  v_max_f32 v13, 0, v13
  v_cvt_pk_bf16_f32 v13, v13, v13
  s_waitcnt lgkmcnt(2)
  v_mfma_f32_32x32x16_bf16 v[128:143], v[68:71], a[56:59], v[128:143]
  ds_read_b128 v[64:67], v222 offset:8192
  v_and_b32 v13, 0xffff0000, v13
  v_add_f32 v13, 0x3727c5ac, v13
  s_waitcnt vmcnt(7)
  s_waitcnt lgkmcnt(2)
  v_mfma_f32_32x32x16_bf16 v[112:127], v[72:75], a[60:63], v[112:127]
  buffer_load_dwordx4 a[92:95], v2, s[36:39], s74 offen offset:3072 sc1
  ds_read_b128 v[68:71], v222 offset:9216
  s_add_u32 s74, s74, 4096
  v_cvt_pk_bf16_f32 v13, v13, v13
  v_and_b32 v13, 0xffff0000, v13
  s_waitcnt lgkmcnt(2)
  v_mfma_f32_32x32x16_bf16 v[128:143], v[76:79], a[60:63], v[128:143]
  ds_read_b128 v[72:75], v222 offset:10240
  v_sqrt_f32 v13, v13
  v_sub_f32 v58, 0, v56
  s_waitcnt vmcnt(7)
  s_waitcnt lgkmcnt(2)
  v_mfma_f32_32x32x16_bf16 v[112:127], v[64:67], a[64:67], v[112:127]
  buffer_load_dwordx4 a[96:99], v2, s[36:39], s74 offen offset:0 sc1
  ds_read_b128 v[76:79], v222 offset:11264
  v_cvt_pk_bf16_f32 v13, v13, v13
  v_and_b32 v13, 0xffff0000, v13
  s_waitcnt lgkmcnt(2)
  v_mfma_f32_32x32x16_bf16 v[128:143], v[68:71], a[64:67], v[128:143]
  ds_read_b128 v[64:67], v222 offset:12288
  v_rcp_f32 v57, v13
  v_cvt_pk_bf16_f32 v52, v58, v58
  s_waitcnt vmcnt(7)
  s_waitcnt lgkmcnt(2)
  v_mfma_f32_32x32x16_bf16 v[112:127], v[72:75], a[68:71], v[112:127]
  buffer_load_dwordx4 a[100:103], v2, s[36:39], s74 offen offset:1024 sc1
  ds_read_b128 v[68:71], v222 offset:13312
  v_mov_b32 v53, v52
  v_mov_b32 v54, v52
  s_waitcnt lgkmcnt(2)
  v_mfma_f32_32x32x16_bf16 v[128:143], v[76:79], a[68:71], v[128:143]
  ds_read_b128 v[72:75], v222 offset:14336
  v_mov_b32 v55, v52
  s_nop 0
  s_waitcnt vmcnt(7)
  s_waitcnt lgkmcnt(2)
  v_mfma_f32_32x32x16_bf16 v[112:127], v[64:67], a[72:75], v[112:127]
  buffer_load_dwordx4 a[104:107], v2, s[36:39], s74 offen offset:2048 sc1
  ds_read_b128 v[76:79], v222 offset:15360
  v_mul_f32 v58, v57, v57
  s_waitcnt lgkmcnt(2)
  v_mfma_f32_32x32x16_bf16 v[128:143], v[68:71], a[72:75], v[128:143]
  ds_read_b128 v[64:67], v222 offset:16384
  s_waitcnt vmcnt(7)
  s_waitcnt lgkmcnt(2)
  v_mfma_f32_32x32x16_bf16 v[112:127], v[72:75], a[76:79], v[112:127]
  buffer_load_dwordx4 a[108:111], v2, s[36:39], s74 offen offset:3072 sc1
  ds_read_b128 v[68:71], v222 offset:17408
  s_add_u32 s74, s74, 4096
  s_waitcnt lgkmcnt(2)
  v_mfma_f32_32x32x16_bf16 v[128:143], v[76:79], a[76:79], v[128:143]
  ds_read_b128 v[72:75], v222 offset:18432
  s_waitcnt vmcnt(7)
  s_waitcnt lgkmcnt(2)
  v_mfma_f32_32x32x16_bf16 v[112:127], v[64:67], a[80:83], v[112:127]
  buffer_load_dwordx4 a[112:115], v2, s[36:39], s74 offen offset:0 sc1
  ds_read_b128 v[76:79], v222 offset:19456
  s_waitcnt lgkmcnt(2)
  v_mfma_f32_32x32x16_bf16 v[128:143], v[68:71], a[80:83], v[128:143]
  ds_read_b128 v[64:67], v222 offset:20480
  s_waitcnt vmcnt(7)
  s_waitcnt lgkmcnt(2)
  v_mfma_f32_32x32x16_bf16 v[112:127], v[72:75], a[84:87], v[112:127]
  buffer_load_dwordx4 a[116:119], v2, s[36:39], s74 offen offset:1024 sc1
  ds_read_b128 v[68:71], v222 offset:21504
  s_waitcnt lgkmcnt(2)
  v_mfma_f32_32x32x16_bf16 v[128:143], v[76:79], a[84:87], v[128:143]
  ds_read_b128 v[72:75], v222 offset:22528
  s_waitcnt vmcnt(7)
  s_waitcnt lgkmcnt(2)
  v_mfma_f32_32x32x16_bf16 v[112:127], v[64:67], a[88:91], v[112:127]
  buffer_load_dwordx4 a[120:123], v2, s[36:39], s74 offen offset:2048 sc1
  ds_read_b128 v[76:79], v222 offset:23552
  s_waitcnt lgkmcnt(2)
  v_mfma_f32_32x32x16_bf16 v[128:143], v[68:71], a[88:91], v[128:143]
  ds_read_b128 v[64:67], v222 offset:24576
  s_waitcnt vmcnt(7)
  s_waitcnt lgkmcnt(2)
  v_mfma_f32_32x32x16_bf16 v[112:127], v[72:75], a[92:95], v[112:127]
  buffer_load_dwordx4 a[124:127], v2, s[36:39], s74 offen offset:3072 sc1
  ds_read_b128 v[68:71], v222 offset:25600
  s_add_u32 s74, s74, 4096
  s_waitcnt lgkmcnt(2)
  v_mfma_f32_32x32x16_bf16 v[128:143], v[76:79], a[92:95], v[128:143]
  ds_read_b128 v[72:75], v222 offset:26624
  s_waitcnt vmcnt(7)
  s_waitcnt lgkmcnt(2)
  v_mfma_f32_32x32x16_bf16 v[112:127], v[64:67], a[96:99], v[112:127]
  ds_read_b128 v[76:79], v222 offset:27648
  s_waitcnt lgkmcnt(2)
  v_mfma_f32_32x32x16_bf16 v[128:143], v[68:71], a[96:99], v[128:143]
  ds_read_b128 v[64:67], v222 offset:28672
  s_waitcnt vmcnt(6)
  s_waitcnt lgkmcnt(2)
  s_add_u32 m0, s85, 0
  v_mfma_f32_32x32x16_bf16 v[112:127], v[72:75], a[100:103], v[112:127]
  buffer_load_dwordx4 v2, s[36:39], s84 offen offset:0 sc1 lds
  ds_read_b128 v[68:71], v222 offset:29696
  s_waitcnt lgkmcnt(2)
  s_add_u32 m0, s85, 0
  v_mfma_f32_32x32x16_bf16 v[128:143], v[76:79], a[100:103], v[128:143]
  buffer_load_dwordx4 v2, s[36:39], s84 offen offset:1024 sc1 lds
  ds_read_b128 v[72:75], v222 offset:30720
  s_add_u32 s84, s84, 8192
  s_waitcnt vmcnt(7)
  s_waitcnt lgkmcnt(2)
  s_add_u32 m0, s85, 8192
  v_mfma_f32_32x32x16_bf16 v[112:127], v[64:67], a[104:107], v[112:127]
  buffer_load_dwordx4 v2, s[36:39], s84 offen offset:0 sc1 lds
  ds_read_b128 v[76:79], v222 offset:31744
  s_waitcnt lgkmcnt(2)
  s_add_u32 m0, s85, 8192
  v_mfma_f32_32x32x16_bf16 v[128:143], v[68:71], a[104:107], v[128:143]
  buffer_load_dwordx4 v2, s[36:39], s84 offen offset:1024 sc1 lds
  ds_read_b128 v[64:67], v222 offset:32768
  s_add_u32 s84, s84, 8192
  s_waitcnt vmcnt(8)
  s_waitcnt lgkmcnt(2)
  s_add_u32 m0, s85, 16384
  v_mfma_f32_32x32x16_bf16 v[112:127], v[72:75], a[108:111], v[112:127]
  buffer_load_dwordx4 v2, s[36:39], s84 offen offset:0 sc1 lds
  ds_read_b128 v[68:71], v222 offset:33792
  s_waitcnt lgkmcnt(2)
  s_add_u32 m0, s85, 16384
  v_mfma_f32_32x32x16_bf16 v[128:143], v[76:79], a[108:111], v[128:143]
  buffer_load_dwordx4 v2, s[36:39], s84 offen offset:1024 sc1 lds
  ds_read_b128 v[72:75], v222 offset:34816
  s_add_u32 s84, s84, 8192
  s_waitcnt vmcnt(9)
  s_waitcnt lgkmcnt(2)
  s_lshr_b32 s84, s10, 1
  s_mul_i32 s84, s84, 6
  s_min_u32 s84, s84, 80
  s_lshl_b32 s84, s84, 15
  s_lshl_b32 s85, s3, 11
  s_add_u32 s84, s84, s85
  s_add_u32 s84, s84, 0x220000
  s_cmp_gt_u32 s54, 4
  s_cselect_b32 s84, 0xf0000000, s84
  s_add_u32 m0, s85, 24576
  v_mfma_f32_32x32x16_bf16 v[112:127], v[64:67], a[112:115], v[112:127]
  buffer_load_dwordx4 v2, s[36:39], s84 offen offset:0 sc1 lds
  ds_read_b128 v[76:79], v222 offset:35840
  s_waitcnt lgkmcnt(2)
  s_add_u32 m0, s85, 24576
  v_mfma_f32_32x32x16_bf16 v[128:143], v[68:71], a[112:115], v[128:143]
  buffer_load_dwordx4 v2, s[36:39], s84 offen offset:1024 sc1 lds
  ds_read_b128 v[64:67], v222 offset:36864
  s_add_u32 s84, s84, 8192
  s_waitcnt vmcnt(10)
  s_waitcnt lgkmcnt(2)
  v_mfma_f32_32x32x16_bf16 v[112:127], v[72:75], a[116:119], v[112:127]
  ds_read_b128 v[68:71], v222 offset:37888
  s_waitcnt lgkmcnt(2)
  v_mfma_f32_32x32x16_bf16 v[128:143], v[76:79], a[116:119], v[128:143]
  ds_read_b128 v[72:75], v222 offset:38912
  s_waitcnt vmcnt(9)
  s_waitcnt lgkmcnt(2)
  v_mfma_f32_32x32x16_bf16 v[112:127], v[64:67], a[120:123], v[112:127]
  ds_read_b128 v[76:79], v222 offset:39936
  s_waitcnt lgkmcnt(2)
  v_mfma_f32_32x32x16_bf16 v[128:143], v[68:71], a[120:123], v[128:143]
  ds_read_b128 v[64:67], v222 offset:40960
  s_waitcnt vmcnt(8)
  s_waitcnt lgkmcnt(2)
  v_mfma_f32_32x32x16_bf16 v[112:127], v[72:75], a[124:127], v[112:127]
  ds_read_b128 v[68:71], v222 offset:41984
  s_waitcnt lgkmcnt(2)
  v_mfma_f32_32x32x16_bf16 v[128:143], v[76:79], a[124:127], v[128:143]
  ds_read_b128 v[72:75], v222 offset:43008
  v_mfma_f32_32x32x16_bf16 v[112:127], v[28:31], v[52:55], v[112:127]
  v_mfma_f32_32x32x16_bf16 v[128:143], v[32:35], v[52:55], v[128:143]
  s_waitcnt lgkmcnt(2)
  v_mfma_f32_32x32x16_bf16 v[144:159], v[64:67], a[0:3], 0
  ds_read_b128 v[76:79], v222 offset:44032
  s_waitcnt lgkmcnt(2)
  v_mfma_f32_32x32x16_bf16 v[160:175], v[68:71], a[0:3], 0
  ds_read_b128 v[64:67], v222 offset:45056
  s_waitcnt lgkmcnt(2)
  v_mfma_f32_32x32x16_bf16 v[144:159], v[72:75], a[4:7], v[144:159]
  ds_read_b128 v[68:71], v222 offset:46080
  s_waitcnt lgkmcnt(2)
  v_mfma_f32_32x32x16_bf16 v[160:175], v[76:79], a[4:7], v[160:175]
  ds_read_b128 v[72:75], v222 offset:47104
  s_barrier
  s_waitcnt lgkmcnt(2)
  s_lshr_b32 s90, s3, 1
  s_mul_i32 s90, s90, 86016
  s_and_b32 s89, s3, 1
  s_lshl_b32 s89, s89, 10
  s_add_u32 s90, s90, s89
  s_lshr_b32 s89, s10, 2
  s_mul_i32 s89, s89, 176128
  s_add_u32 s90, s90, s89
  s_lshl_b32 s89, s3, 10
  s_add_u32 m0, s89, 77824
  s_add_u32 s88, s90, 0x1800000
  v_mfma_f32_32x32x16_bf16 v[144:159], v[64:67], a[8:11], v[144:159]
  buffer_load_dwordx4 v2, s[36:39], s88 offen sc1 lds
  ds_read_b128 v[76:79], v222 offset:48128
  s_waitcnt lgkmcnt(2)
  v_mfma_f32_32x32x16_bf16 v[160:175], v[68:71], a[8:11], v[160:175]
  ds_read_b128 v[64:67], v222 offset:49152
  s_waitcnt lgkmcnt(2)
  v_mfma_f32_32x32x16_bf16 v[144:159], v[72:75], a[12:15], v[144:159]
  ds_read_b128 v[68:71], v222 offset:50176
  v_mul_f32 v112, v112, v58
  v_mul_f32 v113, v113, v58
  s_add_u32 m0, s85, 118784
  s_nop 0
  buffer_load_dwordx4 v2, s[36:39], s84 offen offset:0 sc1 lds
  s_waitcnt lgkmcnt(2)
  v_mfma_f32_32x32x16_bf16 v[160:175], v[76:79], a[12:15], v[160:175]
  ds_read_b128 v[72:75], v222 offset:51200
  v_mul_f32 v114, v114, v58
  v_mul_f32 v115, v115, v58
  s_waitcnt lgkmcnt(2)
  v_mfma_f32_32x32x16_bf16 v[144:159], v[64:67], a[16:19], v[144:159]
  ds_read_b128 v[76:79], v222 offset:52224
  v_mul_f32 v116, v116, v58
  v_mul_f32 v117, v117, v58
  s_add_u32 m0, s89, 81920
  s_add_u32 s88, s90, 0x1800800
  buffer_load_dwordx4 v2, s[36:39], s88 offen sc1 lds
  s_waitcnt lgkmcnt(2)
  v_mfma_f32_32x32x16_bf16 v[160:175], v[68:71], a[16:19], v[160:175]
  ds_read_b128 v[64:67], v222 offset:53248
  v_mul_f32 v118, v118, v58
  v_mul_f32 v119, v119, v58
  s_waitcnt lgkmcnt(2)
  v_mfma_f32_32x32x16_bf16 v[144:159], v[72:75], a[20:23], v[144:159]
  ds_read_b128 v[68:71], v222 offset:54272
  v_mul_f32 v112, v112, v120
  v_mul_f32 v113, v113, v121
  s_add_u32 m0, s85, 118784
  s_nop 0
  buffer_load_dwordx4 v2, s[36:39], s84 offen offset:1024 sc1 lds
  s_add_u32 s84, s84, 8192
  s_waitcnt lgkmcnt(2)
  v_mfma_f32_32x32x16_bf16 v[160:175], v[76:79], a[20:23], v[160:175]
  ds_read_b128 v[72:75], v222 offset:55296
  v_mul_f32 v114, v114, v122
  v_mul_f32 v115, v115, v123
  s_waitcnt lgkmcnt(2)
  v_mfma_f32_32x32x16_bf16 v[144:159], v[64:67], a[24:27], v[144:159]
  ds_read_b128 v[76:79], v222 offset:56320
  v_mul_f32 v116, v116, v124
  v_mul_f32 v117, v117, v125
  s_add_u32 m0, s89, 86016
  s_add_u32 s88, s90, 0x1803000
  buffer_load_dwordx4 v2, s[36:39], s88 offen sc1 lds
  s_waitcnt lgkmcnt(2)
  v_mfma_f32_32x32x16_bf16 v[160:175], v[68:71], a[24:27], v[160:175]
  ds_read_b128 v[64:67], v223 offset:12288
  v_mul_f32 v118, v118, v126
  v_mul_f32 v119, v119, v127
  s_waitcnt lgkmcnt(2)
  v_mfma_f32_32x32x16_bf16 v[144:159], v[72:75], a[28:31], v[144:159]
  ds_read_b128 v[68:71], v223 offset:13312
  v_cvt_pk_bf16_f32 v80, v112, v113
  v_cvt_pk_bf16_f32 v81, v114, v115
  s_add_u32 m0, s85, 126976
  s_nop 0
  buffer_load_dwordx4 v2, s[36:39], s84 offen offset:0 sc1 lds
  s_waitcnt lgkmcnt(2)
  v_mfma_f32_32x32x16_bf16 v[160:175], v[76:79], a[28:31], v[160:175]
  ds_read_b128 v[72:75], v223 offset:14336
  v_cvt_pk_bf16_f32 v82, v116, v117
  v_cvt_pk_bf16_f32 v83, v118, v119
  s_waitcnt lgkmcnt(2)
  v_mfma_f32_32x32x16_bf16 v[144:159], v[64:67], a[32:35], v[144:159]
  ds_read_b128 v[76:79], v223 offset:15360
  s_cmp_gt_u32 s54, 0
  s_cselect_b32 s97, 0xf0000000, s76
  buffer_store_dwordx4 v[80:83], v2, s[36:39], s97 offen offset:0 sc1
  v_mul_f32 v128, v128, v58
  s_add_u32 m0, s89, 90112
  s_add_u32 s88, s90, 0x1803800
  buffer_load_dwordx4 v2, s[36:39], s88 offen sc1 lds
  s_waitcnt lgkmcnt(2)
  v_mfma_f32_32x32x16_bf16 v[160:175], v[68:71], a[32:35], v[160:175]
  ds_read_b128 v[64:67], v223 offset:16384
  v_mul_f32 v129, v129, v58
  v_mul_f32 v130, v130, v58
  s_waitcnt lgkmcnt(2)
  v_mfma_f32_32x32x16_bf16 v[144:159], v[72:75], a[36:39], v[144:159]
  ds_read_b128 v[68:71], v223 offset:17408
  v_mul_f32 v131, v131, v58
  v_mul_f32 v132, v132, v58
  s_add_u32 m0, s85, 126976
  s_nop 0
  buffer_load_dwordx4 v2, s[36:39], s84 offen offset:1024 sc1 lds
  s_add_u32 s84, s84, 8192
  s_waitcnt lgkmcnt(2)
  v_mfma_f32_32x32x16_bf16 v[160:175], v[76:79], a[36:39], v[160:175]
  ds_read_b128 v[72:75], v223 offset:18432
  v_mul_f32 v133, v133, v58
  v_mul_f32 v134, v134, v58
  s_waitcnt lgkmcnt(2)
  v_mfma_f32_32x32x16_bf16 v[144:159], v[64:67], a[40:43], v[144:159]
  ds_read_b128 v[76:79], v223 offset:19456
  v_mul_f32 v135, v135, v58
  v_mul_f32 v128, v128, v136
  s_add_u32 m0, s89, 94208
  s_add_u32 s88, s90, 0x1806000
  buffer_load_dwordx4 v2, s[36:39], s88 offen sc1 lds
  s_waitcnt lgkmcnt(2)
  v_mfma_f32_32x32x16_bf16 v[160:175], v[68:71], a[40:43], v[160:175]
  ds_read_b128 v[64:67], v223 offset:20480
  v_mul_f32 v129, v129, v137
  v_mul_f32 v130, v130, v138
  s_waitcnt lgkmcnt(2)
  v_mfma_f32_32x32x16_bf16 v[144:159], v[72:75], a[44:47], v[144:159]
  ds_read_b128 v[68:71], v223 offset:21504
  v_mul_f32 v131, v131, v139
  v_mul_f32 v132, v132, v140
  s_add_u32 m0, s85, 36864
  s_nop 0
  buffer_load_dwordx4 v2, s[36:39], s84 offen offset:0 sc1 lds
  s_waitcnt lgkmcnt(2)
  v_mfma_f32_32x32x16_bf16 v[160:175], v[76:79], a[44:47], v[160:175]
  ds_read_b128 v[72:75], v223 offset:22528
  v_mul_f32 v133, v133, v141
  v_mul_f32 v134, v134, v142
  s_waitcnt lgkmcnt(2)
  v_mfma_f32_32x32x16_bf16 v[144:159], v[64:67], a[48:51], v[144:159]
  ds_read_b128 v[76:79], v223 offset:23552
  v_mul_f32 v135, v135, v143
  v_cvt_pk_bf16_f32 v84, v128, v129
  s_add_u32 m0, s89, 98304
  s_add_u32 s88, s90, 0x1806800
  buffer_load_dwordx4 v2, s[36:39], s88 offen sc1 lds
  s_waitcnt lgkmcnt(2)
  v_mfma_f32_32x32x16_bf16 v[160:175], v[68:71], a[48:51], v[160:175]
  ds_read_b128 v[64:67], v223 offset:24576
  v_cvt_pk_bf16_f32 v85, v130, v131
  v_cvt_pk_bf16_f32 v86, v132, v133
  s_waitcnt lgkmcnt(2)
  v_mfma_f32_32x32x16_bf16 v[144:159], v[72:75], a[52:55], v[144:159]
  ds_read_b128 v[68:71], v223 offset:25600
  v_cvt_pk_bf16_f32 v87, v134, v135
  s_cmp_gt_u32 s54, 1
  s_cselect_b32 s97, 0xf0000000, s76
  buffer_store_dwordx4 v[84:87], v2, s[36:39], s97 offen offset:1024 sc1
  s_add_u32 m0, s85, 36864
  s_nop 0
  buffer_load_dwordx4 v2, s[36:39], s84 offen offset:1024 sc1 lds
  s_add_u32 s84, s84, 8192
  s_waitcnt lgkmcnt(2)
  v_mfma_f32_32x32x16_bf16 v[160:175], v[76:79], a[52:55], v[160:175]
  ds_read_b128 v[72:75], v223 offset:26624
  s_waitcnt lgkmcnt(2)
  s_add_u32 m0, s85, 45056
  v_mfma_f32_32x32x16_bf16 v[144:159], v[64:67], a[56:59], v[144:159]
  buffer_load_dwordx4 v2, s[36:39], s84 offen offset:0 sc1 lds
  ds_read_b128 v[76:79], v223 offset:27648
  s_waitcnt lgkmcnt(2)
  v_mfma_f32_32x32x16_bf16 v[160:175], v[68:71], a[56:59], v[160:175]
  ds_read_b128 v[64:67], v223 offset:28672
  s_waitcnt lgkmcnt(2)
  s_add_u32 s12, s48, 0x2000
  s_add_u32 m0, s85, 45056
  v_mfma_f32_32x32x16_bf16 v[144:159], v[72:75], a[60:63], v[144:159]
  buffer_load_dwordx4 v2, s[36:39], s84 offen offset:1024 sc1 lds
  ds_read_b128 v[68:71], v223 offset:29696
  s_add_u32 s84, s84, 8192
  s_waitcnt lgkmcnt(2)
  v_mfma_f32_32x32x16_bf16 v[160:175], v[76:79], a[60:63], v[160:175]
  ds_read_b128 v[72:75], v223 offset:30720
  s_add_u32 s13, s50, 0x3000
  s_waitcnt lgkmcnt(2)
  s_mov_b32 s14, s50
  s_add_u32 m0, s85, 53248
  v_mfma_f32_32x32x16_bf16 v[144:159], v[64:67], a[64:67], v[144:159]
  buffer_load_dwordx4 v2, s[36:39], s84 offen offset:0 sc1 lds
  ds_read_b128 v[76:79], v223 offset:31744
  s_waitcnt lgkmcnt(2)
  v_mfma_f32_32x32x16_bf16 v[160:175], v[68:71], a[64:67], v[160:175]
  ds_read_b128 v[64:67], v223 offset:32768
  s_add_u32 s15, s50, 0x4000
  s_waitcnt lgkmcnt(2)
  s_lshl_b32 s86, s3, 12
  s_add_u32 m0, s85, 53248
  v_mfma_f32_32x32x16_bf16 v[144:159], v[72:75], a[68:71], v[144:159]
  buffer_load_dwordx4 v2, s[36:39], s84 offen offset:1024 sc1 lds
  ds_read_b128 v[68:71], v223 offset:33792
  s_add_u32 s84, s84, 8192
  s_waitcnt lgkmcnt(2)
  v_mfma_f32_32x32x16_bf16 v[160:175], v[76:79], a[68:71], v[160:175]
  ds_read_b128 v[72:75], v223 offset:34816
  s_add_u32 s86, s86, 135168
  s_waitcnt lgkmcnt(2)
  v_mfma_f32_32x32x16_bf16 v[144:159], v[64:67], a[72:75], v[144:159]
  ds_read_b128 v[76:79], v223 offset:35840
  v_and_b32 v90, 31, v1
  s_add_u32 m0, s85, 61440
  s_nop 0
  buffer_load_dwordx4 v2, s[36:39], s84 offen offset:0 sc1 lds
  s_waitcnt lgkmcnt(2)
  v_mfma_f32_32x32x16_bf16 v[160:175], v[68:71], a[72:75], v[160:175]
  s_waitcnt vmcnt(10)
  s_barrier
  ds_read_b128 v[64:67], v2 offset:0
  v_mul_u32_u24 v90, 80, v90
  s_waitcnt lgkmcnt(2)
  v_mfma_f32_32x32x16_bf16 v[144:159], v[72:75], a[76:79], v[144:159]
  ds_read_b128 v[68:71], v2 offset:1024
  v_lshrrev_b32 v91, 5, v1
  s_add_u32 m0, s85, 61440
  s_nop 0
  buffer_load_dwordx4 v2, s[36:39], s84 offen offset:1024 sc1 lds
  s_add_u32 s84, s84, 8192
  s_waitcnt lgkmcnt(2)
  v_mfma_f32_32x32x16_bf16 v[160:175], v[76:79], a[76:79], v[160:175]
  ds_read_b128 v[72:75], v2 offset:2048
  v_lshl_add_u32 v90, v91, 4, v90
  s_waitcnt lgkmcnt(2)
  v_mfma_f32_32x32x16_bf16 v[144:159], v[64:67], a[80:83], v[144:159]
  ds_read_b128 v[76:79], v2 offset:3072
  v_add_u32 v90, s86, v90
  s_add_u32 m0, s89, 102400
  s_add_u32 s88, s90, 0x1809000
  buffer_load_dwordx4 v2, s[36:39], s88 offen sc1 lds
  s_waitcnt lgkmcnt(2)
  v_mfma_f32_32x32x16_bf16 v[160:175], v[68:71], a[80:83], v[160:175]
  ds_read_b128 v[64:67], v2 offset:4096
  v_lshrrev_b32 v92, 2, v1
  s_waitcnt lgkmcnt(2)
  v_mfma_f32_32x32x16_bf16 v[144:159], v[72:75], a[84:87], v[144:159]
  ds_read_b128 v[68:71], v2 offset:5120
  v_mul_u32_u24 v91, 80, v92
  s_add_u32 m0, s85, 69632
  s_nop 0
  buffer_load_dwordx4 v2, s[36:39], s84 offen offset:0 sc1 lds
  s_waitcnt lgkmcnt(2)
  v_mfma_f32_32x32x16_bf16 v[160:175], v[76:79], a[84:87], v[160:175]
  ds_read_b128 v[72:75], v2 offset:6144
  v_and_b32 v93, 3, v1
  s_waitcnt lgkmcnt(2)
  v_mfma_f32_32x32x16_bf16 v[144:159], v[64:67], a[88:91], v[144:159]
  ds_read_b128 v[76:79], v2 offset:7168
  v_lshl_add_u32 v91, v93, 4, v91
  s_add_u32 m0, s89, 106496
  s_add_u32 s88, s90, 0x1809800
  buffer_load_dwordx4 v2, s[36:39], s88 offen sc1 lds
  s_waitcnt lgkmcnt(2)
  v_mfma_f32_32x32x16_bf16 v[160:175], v[68:71], a[88:91], v[160:175]
  ds_read_b128 v[64:67], v2 offset:8192
  v_add_u32 v91, s86, v91
  s_waitcnt lgkmcnt(2)
  v_mfma_f32_32x32x16_bf16 v[144:159], v[72:75], a[92:95], v[144:159]
  ds_read_b128 v[68:71], v2 offset:9216
  v_lshlrev_b32 v92, 10, v92
  s_add_u32 m0, s89, 110592
  s_add_u32 s88, s90, 0x180c000
  buffer_load_dwordx4 v2, s[36:39], s88 offen sc1 lds
  s_waitcnt lgkmcnt(2)
  v_mfma_f32_32x32x16_bf16 v[160:175], v[76:79], a[92:95], v[160:175]
  ds_read_b128 v[72:75], v2 offset:10240
  v_lshl_add_u32 v92, v93, 4, v92
  s_waitcnt lgkmcnt(2)
  v_mfma_f32_32x32x16_bf16 v[144:159], v[64:67], a[96:99], v[144:159]
  ds_read_b128 v[76:79], v2 offset:11264
  v_lshlrev_b32 v112, 16, v248
  s_add_u32 m0, s85, 69632
  s_nop 0
  buffer_load_dwordx4 v2, s[36:39], s84 offen offset:1024 sc1 lds
  s_add_u32 s84, s84, 8192
  s_waitcnt lgkmcnt(2)
  v_mfma_f32_32x32x16_bf16 v[160:175], v[68:71], a[96:99], v[160:175]
  ds_read_b128 v[64:67], v2 offset:12288
  v_and_b32 v113, 0xffff0000, v248
  s_add_u32 s97, s55, 0x4000
  s_waitcnt vmcnt(12)
  s_mov_b64 exec, 1
  buffer_store_dword v229, off, s[36:39], s97 sc0 sc1
  s_mov_b64 exec, -1
  s_waitcnt lgkmcnt(2)
  v_mfma_f32_32x32x16_bf16 v[144:159], v[72:75], a[100:103], v[144:159]
  ds_read_b128 v[68:71], v2 offset:13312
  v_lshlrev_b32 v114, 16, v249
  s_add_u32 m0, s89, 114688
  s_add_u32 s88, s90, 0x180c800
  buffer_load_dwordx4 v2, s[36:39], s88 offen sc1 lds
  s_waitcnt lgkmcnt(2)
  v_mfma_f32_32x32x16_bf16 v[160:175], v[76:79], a[100:103], v[160:175]
  ds_read_b128 v[72:75], v2 offset:14336
  v_and_b32 v115, 0xffff0000, v249
  s_waitcnt lgkmcnt(2)
  v_mfma_f32_32x32x16_bf16 v[144:159], v[64:67], a[104:107], v[144:159]
  ds_read_b128 v[76:79], v2 offset:15360
  v_lshlrev_b32 v116, 16, v250
  s_add_u32 m0, s89, 135168
  s_add_u32 s88, s90, 0x180f000
  buffer_load_dwordx4 v2, s[36:39], s88 offen sc1 lds
  s_waitcnt lgkmcnt(2)
  v_mfma_f32_32x32x16_bf16 v[160:175], v[68:71], a[104:107], v[160:175]
  ds_read_b128 v[64:67], v2 offset:16384
  v_and_b32 v117, 0xffff0000, v250
  s_waitcnt lgkmcnt(2)
  v_mfma_f32_32x32x16_bf16 v[144:159], v[72:75], a[108:111], v[144:159]
  ds_read_b128 v[68:71], v2 offset:17408
  v_lshlrev_b32 v118, 16, v251
  s_waitcnt lgkmcnt(2)
  v_mfma_f32_32x32x16_bf16 v[160:175], v[76:79], a[108:111], v[160:175]
  ds_read_b128 v[72:75], v2 offset:18432
  v_and_b32 v119, 0xffff0000, v251
  s_waitcnt lgkmcnt(2)
  v_mfma_f32_32x32x16_bf16 v[144:159], v[64:67], a[112:115], v[144:159]
  ds_read_b128 v[76:79], v2 offset:19456
  v_lshlrev_b32 v120, 16, v252
  s_add_u32 m0, s89, 139264
  s_add_u32 s88, s90, 0x180f800
  buffer_load_dwordx4 v2, s[36:39], s88 offen sc1 lds
  s_waitcnt lgkmcnt(2)
  v_mfma_f32_32x32x16_bf16 v[160:175], v[68:71], a[112:115], v[160:175]
  ds_read_b128 v[64:67], v2 offset:20480
  v_and_b32 v121, 0xffff0000, v252
  s_waitcnt lgkmcnt(2)
  v_mfma_f32_32x32x16_bf16 v[144:159], v[72:75], a[116:119], v[144:159]
  ds_read_b128 v[68:71], v2 offset:21504
  v_lshlrev_b32 v122, 16, v253
  s_add_u32 m0, s89, 143360
  s_add_u32 s88, s90, 0x1812000
  buffer_load_dwordx4 v2, s[36:39], s88 offen sc1 lds
  s_waitcnt lgkmcnt(2)
  v_mfma_f32_32x32x16_bf16 v[160:175], v[76:79], a[116:119], v[160:175]
  ds_read_b128 v[72:75], v2 offset:22528
  v_and_b32 v123, 0xffff0000, v253
  s_waitcnt lgkmcnt(2)
  v_mfma_f32_32x32x16_bf16 v[144:159], v[64:67], a[120:123], v[144:159]
  ds_read_b128 v[76:79], v2 offset:23552
  v_lshlrev_b32 v124, 16, v254
  s_waitcnt lgkmcnt(2)
  v_mfma_f32_32x32x16_bf16 v[160:175], v[68:71], a[120:123], v[160:175]
  ds_read_b128 v[64:67], v2 offset:24576
  v_and_b32 v125, 0xffff0000, v254
  s_waitcnt lgkmcnt(2)
  v_mfma_f32_32x32x16_bf16 v[144:159], v[72:75], a[124:127], v[144:159]
  ds_read_b128 v[68:71], v2 offset:25600
  v_lshlrev_b32 v126, 16, v255
  s_add_u32 m0, s89, 147456
  s_add_u32 s88, s90, 0x1812800
  buffer_load_dwordx4 v2, s[36:39], s88 offen sc1 lds
  s_waitcnt lgkmcnt(2)
  v_mfma_f32_32x32x16_bf16 v[160:175], v[76:79], a[124:127], v[160:175]
  ds_read_b128 v[72:75], v2 offset:26624
  v_and_b32 v127, 0xffff0000, v255
  buffer_load_dword v224, v227, s[36:39], s15 offen sc0 sc1
  v_mfma_f32_32x32x16_bf16 v[144:159], v[36:39], v[52:55], v[144:159]
  v_mfma_f32_32x32x16_bf16 v[160:175], v[40:43], v[52:55], v[160:175]
  s_waitcnt lgkmcnt(2)
  v_mfma_f32_32x32x16_bf16 v[176:191], v[64:67], a[0:3], 0
  ds_read_b128 v[76:79], v2 offset:27648
  s_waitcnt lgkmcnt(2)
  v_mfma_f32_32x32x16_bf16 v[192:207], v[68:71], a[0:3], 0
  ds_read_b128 v[64:67], v2 offset:28672
  s_waitcnt lgkmcnt(2)
  v_mfma_f32_32x32x16_bf16 v[176:191], v[72:75], a[4:7], v[176:191]
  ds_read_b128 v[68:71], v2 offset:29696
  s_waitcnt lgkmcnt(2)
  v_mfma_f32_32x32x16_bf16 v[192:207], v[76:79], a[4:7], v[192:207]
  ds_read_b128 v[72:75], v2 offset:30720
  s_barrier
  s_waitcnt lgkmcnt(2)
  s_add_u32 m0, s89, 151552
  s_add_u32 s88, s90, 0x1801000
  v_mfma_f32_32x32x16_bf16 v[176:191], v[64:67], a[8:11], v[176:191]
  buffer_load_dwordx4 v2, s[36:39], s88 offen sc1 lds
  ds_read_b128 v[76:79], v2 offset:31744
  s_waitcnt lgkmcnt(2)
  v_mfma_f32_32x32x16_bf16 v[192:207], v[68:71], a[8:11], v[192:207]
  ds_read_b128 v[64:67], v222 offset:57344
  s_waitcnt lgkmcnt(2)
  v_mfma_f32_32x32x16_bf16 v[176:191], v[72:75], a[12:15], v[176:191]
  ds_read_b128 v[68:71], v222 offset:58368
  v_mul_f32 v144, v144, v58
  v_mul_f32 v145, v145, v58
  s_add_u32 m0, s89, 155648
  s_add_u32 s88, s90, 0x1801800
  buffer_load_dwordx4 v2, s[36:39], s88 offen sc1 lds
  s_waitcnt lgkmcnt(2)
  v_mfma_f32_32x32x16_bf16 v[192:207], v[76:79], a[12:15], v[192:207]
  ds_read_b128 v[72:75], v222 offset:59392
  v_mul_f32 v146, v146, v58
  v_mul_f32 v147, v147, v58
  s_waitcnt lgkmcnt(2)
  v_mfma_f32_32x32x16_bf16 v[176:191], v[64:67], a[16:19], v[176:191]
  ds_read_b128 v[76:79], v222 offset:60416
  v_mul_f32 v148, v148, v58
  v_mul_f32 v149, v149, v58
  s_waitcnt lgkmcnt(2)
  v_mfma_f32_32x32x16_bf16 v[192:207], v[68:71], a[16:19], v[192:207]
  ds_read_b128 v[64:67], v223 offset:0
  v_mul_f32 v150, v150, v58
  v_mul_f32 v151, v151, v58
  s_mov_b32 s8, 0
  s_waitcnt vmcnt(2)
  s_branch pchk_125
pl_123:
  buffer_load_dword v224, v227, s[36:39], s15 offen sc0 sc1
  s_add_u32 s8, s8, 1
  s_cmp_gt_u32 s8, 0x80000
  s_cbranch_scc1 L_abort
  s_waitcnt vmcnt(0)
pchk_125:
  v_cmp_ne_u32 vcc, 1, v224
  s_nop 3
  s_cbranch_vccnz pl_123
  s_waitcnt lgkmcnt(2)
  v_mfma_f32_32x32x16_bf16 v[176:191], v[72:75], a[20:23], v[176:191]
  ds_read_b128 v[68:71], v223 offset:1024
  v_mul_f32 v144, v144, v152
  v_mul_f32 v145, v145, v153
  s_add_u32 m0, s89, 159744
  s_add_u32 s88, s90, 0x1804000
  buffer_load_dwordx4 v2, s[36:39], s88 offen sc1 lds
  s_waitcnt lgkmcnt(2)
  v_mfma_f32_32x32x16_bf16 v[192:207], v[76:79], a[20:23], v[192:207]
  ds_read_b128 v[72:75], v223 offset:2048
  v_mul_f32 v146, v146, v154
  v_mul_f32 v147, v147, v155
  s_add_u32 s87, s47, 0
  buffer_load_dwordx4 a[128:131], v2, s[36:39], s87 offen offset:0 sc1
  s_waitcnt lgkmcnt(2)
  v_mfma_f32_32x32x16_bf16 v[176:191], v[64:67], a[24:27], v[176:191]
  ds_read_b128 v[76:79], v223 offset:3072
  v_mul_f32 v148, v148, v156
  v_mul_f32 v149, v149, v157
  s_add_u32 m0, s89, 0
  s_add_u32 s88, s90, 0x1804800
  buffer_load_dwordx4 v2, s[36:39], s88 offen sc1 lds
  s_waitcnt lgkmcnt(2)
  v_mfma_f32_32x32x16_bf16 v[192:207], v[68:71], a[24:27], v[192:207]
  ds_read_b128 v[64:67], v223 offset:4096
  v_mul_f32 v150, v150, v158
  v_mul_f32 v151, v151, v159
  buffer_load_dwordx4 a[132:135], v2, s[36:39], s87 offen offset:1024 sc1
  s_waitcnt lgkmcnt(2)
  v_mfma_f32_32x32x16_bf16 v[176:191], v[72:75], a[28:31], v[176:191]
  ds_read_b128 v[68:71], v223 offset:5120
  v_cvt_pk_bf16_f32 v80, v144, v145
  v_cvt_pk_bf16_f32 v81, v146, v147
  s_waitcnt lgkmcnt(2)
  v_mfma_f32_32x32x16_bf16 v[192:207], v[76:79], a[28:31], v[192:207]
  ds_read_b128 v[72:75], v223 offset:6144
  v_cvt_pk_bf16_f32 v82, v148, v149
  v_cvt_pk_bf16_f32 v83, v150, v151
  s_add_u32 s87, s47, 6144
  buffer_load_dwordx4 a[136:139], v2, s[36:39], s87 offen offset:0 sc1
  s_waitcnt lgkmcnt(2)
  v_mfma_f32_32x32x16_bf16 v[176:191], v[64:67], a[32:35], v[176:191]
  ds_read_b128 v[76:79], v223 offset:7168
  s_cmp_gt_u32 s54, 2
  s_cselect_b32 s97, 0xf0000000, s76
  buffer_store_dwordx4 v[80:83], v2, s[36:39], s97 offen offset:2048 sc1
  v_mul_f32 v160, v160, v58
  s_add_u32 m0, s89, 4096
  s_add_u32 s88, s90, 0x1807000
  buffer_load_dwordx4 v2, s[36:39], s88 offen sc1 lds
  s_waitcnt lgkmcnt(2)
  v_mfma_f32_32x32x16_bf16 v[192:207], v[68:71], a[32:35], v[192:207]
  ds_read_b128 v[64:67], v223 offset:8192
  v_mul_f32 v161, v161, v58
  v_mul_f32 v162, v162, v58
  s_waitcnt lgkmcnt(2)
  v_mfma_f32_32x32x16_bf16 v[176:191], v[72:75], a[36:39], v[176:191]
  ds_read_b128 v[68:71], v223 offset:9216
  v_mul_f32 v163, v163, v58
  v_mul_f32 v164, v164, v58
  s_add_u32 m0, s89, 8192
  s_add_u32 s88, s90, 0x1807800
  buffer_load_dwordx4 v2, s[36:39], s88 offen sc1 lds
  s_waitcnt lgkmcnt(2)
  v_mfma_f32_32x32x16_bf16 v[192:207], v[76:79], a[36:39], v[192:207]
  ds_read_b128 v[72:75], v223 offset:10240
  v_mul_f32 v165, v165, v58
  v_mul_f32 v166, v166, v58
  buffer_load_dwordx4 a[140:143], v2, s[36:39], s87 offen offset:1024 sc1
  s_waitcnt lgkmcnt(2)
  v_mfma_f32_32x32x16_bf16 v[176:191], v[64:67], a[40:43], v[176:191]
  ds_read_b128 v[76:79], v223 offset:11264
  v_mul_f32 v167, v167, v58
  v_mul_f32 v160, v160, v168
  s_waitcnt lgkmcnt(2)
  v_mfma_f32_32x32x16_bf16 v[192:207], v[68:71], a[40:43], v[192:207]
  s_barrier
  ds_read_b128 v[64:67], v2 offset:36864
  v_mul_f32 v161, v161, v169
  v_mul_f32 v162, v162, v170
  s_waitcnt lgkmcnt(2)
  v_mfma_f32_32x32x16_bf16 v[176:191], v[72:75], a[44:47], v[176:191]
  ds_read_b128 v[68:71], v2 offset:37888
  v_mul_f32 v163, v163, v171
  v_mul_f32 v164, v164, v172
  s_add_u32 m0, s89, 12288
  s_add_u32 s88, s90, 0x180a000
  buffer_load_dwordx4 v2, s[36:39], s88 offen sc1 lds
  s_waitcnt lgkmcnt(2)
  v_mfma_f32_32x32x16_bf16 v[192:207], v[76:79], a[44:47], v[192:207]
  ds_read_b128 v[72:75], v2 offset:38912
  v_mul_f32 v165, v165, v173
  v_mul_f32 v166, v166, v174
  s_add_u32 s87, s47, 12288
  buffer_load_dwordx4 a[144:147], v2, s[36:39], s87 offen offset:0 sc1
  s_waitcnt lgkmcnt(2)
  v_mfma_f32_32x32x16_bf16 v[176:191], v[64:67], a[48:51], v[176:191]
  ds_read_b128 v[76:79], v2 offset:39936
  v_mul_f32 v167, v167, v175
  v_cvt_pk_bf16_f32 v84, v160, v161
  s_add_u32 m0, s89, 16384
  s_add_u32 s88, s90, 0x180a800
  buffer_load_dwordx4 v2, s[36:39], s88 offen sc1 lds
  s_waitcnt lgkmcnt(2)
  v_mfma_f32_32x32x16_bf16 v[192:207], v[68:71], a[48:51], v[192:207]
  ds_read_b128 v[64:67], v2 offset:40960
  v_cvt_pk_bf16_f32 v85, v162, v163
  v_cvt_pk_bf16_f32 v86, v164, v165
  s_waitcnt lgkmcnt(2)
  v_mfma_f32_32x32x16_bf16 v[176:191], v[72:75], a[52:55], v[176:191]
  ds_read_b128 v[68:71], v2 offset:41984
  v_cvt_pk_bf16_f32 v87, v166, v167
  s_cmp_gt_u32 s54, 3
  s_cselect_b32 s97, 0xf0000000, s76
  buffer_store_dwordx4 v[84:87], v2, s[36:39], s97 offen offset:3072 sc1
  s_add_u32 s76, s76, 4096
  s_waitcnt lgkmcnt(2)
  v_mfma_f32_32x32x16_bf16 v[192:207], v[76:79], a[52:55], v[192:207]
  buffer_load_dwordx4 a[148:151], v2, s[36:39], s87 offen offset:1024 sc1
  ds_read_b128 v[72:75], v2 offset:43008
  s_waitcnt lgkmcnt(2)
  s_add_u32 m0, s89, 20480
  s_add_u32 s88, s90, 0x180d000
  v_mfma_f32_32x32x16_bf16 v[176:191], v[64:67], a[56:59], v[176:191]
  buffer_load_dwordx4 v2, s[36:39], s88 offen sc1 lds
  ds_read_b128 v[76:79], v2 offset:44032
  s_waitcnt lgkmcnt(2)
  v_mfma_f32_32x32x16_bf16 v[192:207], v[68:71], a[56:59], v[192:207]
  ds_read_b128 v[64:67], v2 offset:45056
  s_waitcnt lgkmcnt(2)
  s_add_u32 m0, s89, 32768
  s_add_u32 s88, s90, 0x180d800
  v_mfma_f32_32x32x16_bf16 v[176:191], v[72:75], a[60:63], v[176:191]
  buffer_load_dwordx4 v2, s[36:39], s88 offen sc1 lds
  ds_read_b128 v[68:71], v2 offset:46080
  s_waitcnt lgkmcnt(2)
  s_add_u32 s87, s47, 18432
  v_mfma_f32_32x32x16_bf16 v[192:207], v[76:79], a[60:63], v[192:207]
  buffer_load_dwordx4 a[152:155], v2, s[36:39], s87 offen offset:0 sc1
  ds_read_b128 v[72:75], v2 offset:47104
  s_waitcnt lgkmcnt(2)
  v_mfma_f32_32x32x16_bf16 v[176:191], v[64:67], a[64:67], v[176:191]
  ds_read_b128 v[76:79], v2 offset:48128
  s_waitcnt lgkmcnt(2)
  v_mfma_f32_32x32x16_bf16 v[192:207], v[68:71], a[64:67], v[192:207]
  ds_read_b128 v[64:67], v2 offset:49152
  s_waitcnt lgkmcnt(2)
  s_add_u32 m0, s89, 24576
  s_add_u32 s88, s90, 0x1810000
  v_mfma_f32_32x32x16_bf16 v[176:191], v[72:75], a[68:71], v[176:191]
  buffer_load_dwordx4 v2, s[36:39], s88 offen sc1 lds
  ds_read_b128 v[68:71], v2 offset:50176
  s_waitcnt lgkmcnt(2)
  v_mfma_f32_32x32x16_bf16 v[192:207], v[76:79], a[68:71], v[192:207]
  buffer_load_dwordx4 a[156:159], v2, s[36:39], s87 offen offset:1024 sc1
  ds_read_b128 v[72:75], v2 offset:51200
  s_waitcnt lgkmcnt(2)
  s_add_u32 m0, s89, 28672
  s_add_u32 s88, s90, 0x1810800
  v_mfma_f32_32x32x16_bf16 v[176:191], v[64:67], a[72:75], v[176:191]
  buffer_load_dwordx4 v2, s[36:39], s88 offen sc1 lds
  ds_read_b128 v[76:79], v2 offset:52224
  s_waitcnt lgkmcnt(2)
  v_mfma_f32_32x32x16_bf16 v[192:207], v[68:71], a[72:75], v[192:207]
  ds_read_b128 v[64:67], v2 offset:53248
  s_waitcnt lgkmcnt(2)
  v_mfma_f32_32x32x16_bf16 v[176:191], v[72:75], a[76:79], v[176:191]
  ds_read_b128 v[68:71], v2 offset:54272
  s_waitcnt lgkmcnt(2)
  s_add_u32 s87, s47, 24576
  v_mfma_f32_32x32x16_bf16 v[192:207], v[76:79], a[76:79], v[192:207]
  buffer_load_dwordx4 a[160:163], v2, s[36:39], s87 offen offset:0 sc1
  ds_read_b128 v[72:75], v2 offset:55296
  s_waitcnt lgkmcnt(2)
  s_add_u32 m0, s89, 118784
  s_add_u32 s88, s90, 0x1813000
  v_mfma_f32_32x32x16_bf16 v[176:191], v[64:67], a[80:83], v[176:191]
  buffer_load_dwordx4 v2, s[36:39], s88 offen sc1 lds
  ds_read_b128 v[76:79], v2 offset:56320
  s_waitcnt lgkmcnt(2)
  v_mfma_f32_32x32x16_bf16 v[192:207], v[68:71], a[80:83], v[192:207]
  ds_read_b128 v[64:67], v2 offset:57344
  s_waitcnt lgkmcnt(2)
  s_add_u32 m0, s89, 122880
  s_add_u32 s88, s90, 0x1813800
  v_mfma_f32_32x32x16_bf16 v[176:191], v[72:75], a[84:87], v[176:191]
  buffer_load_dwordx4 v2, s[36:39], s88 offen sc1 lds
  ds_read_b128 v[68:71], v2 offset:58368
  s_waitcnt lgkmcnt(2)
  v_mfma_f32_32x32x16_bf16 v[192:207], v[76:79], a[84:87], v[192:207]
  buffer_load_dwordx4 a[164:167], v2, s[36:39], s87 offen offset:1024 sc1
  ds_read_b128 v[72:75], v2 offset:59392
  s_waitcnt lgkmcnt(2)
  v_mfma_f32_32x32x16_bf16 v[176:191], v[64:67], a[88:91], v[176:191]
  ds_read_b128 v[76:79], v2 offset:60416
  s_waitcnt lgkmcnt(2)
  v_mfma_f32_32x32x16_bf16 v[192:207], v[68:71], a[88:91], v[192:207]
  ds_read_b128 v[64:67], v222 offset:0
  s_waitcnt vmcnt(11)
  s_mov_b64 exec, 1
  buffer_store_dword v229, off, s[36:39], s78 sc0 sc1
  s_mov_b64 exec, -1
  s_barrier
  s_waitcnt lgkmcnt(2)
  s_add_u32 m0, s89, 126976
  s_add_u32 s88, s90, 0x1802000
  v_mfma_f32_32x32x16_bf16 v[176:191], v[72:75], a[92:95], v[176:191]
  buffer_load_dwordx4 v2, s[36:39], s88 offen sc1 lds
  ds_read_b128 v[68:71], v222 offset:1024
  s_waitcnt lgkmcnt(2)
  s_add_u32 s87, s47, 30720
  v_mfma_f32_32x32x16_bf16 v[192:207], v[76:79], a[92:95], v[192:207]
  buffer_load_dwordx4 a[168:171], v2, s[36:39], s87 offen offset:0 sc1
  ds_read_b128 v[72:75], v222 offset:2048
  s_waitcnt lgkmcnt(2)
  s_add_u32 m0, s89, 131072
  s_add_u32 s88, s90, 0x1802800
  v_mfma_f32_32x32x16_bf16 v[176:191], v[64:67], a[96:99], v[176:191]
  buffer_load_dwordx4 v2, s[36:39], s88 offen sc1 lds
  ds_read_b128 v[76:79], v222 offset:3072
  s_waitcnt lgkmcnt(2)
  v_mfma_f32_32x32x16_bf16 v[192:207], v[68:71], a[96:99], v[192:207]
  ds_read_b128 v[64:67], v222 offset:4096
  s_waitcnt lgkmcnt(2)
  v_mfma_f32_32x32x16_bf16 v[176:191], v[72:75], a[100:103], v[176:191]
  ds_read_b128 v[68:71], v222 offset:5120
  s_waitcnt lgkmcnt(2)
  v_mfma_f32_32x32x16_bf16 v[192:207], v[76:79], a[100:103], v[192:207]
  buffer_load_dwordx4 a[172:175], v2, s[36:39], s87 offen offset:1024 sc1
  ds_read_b128 v[72:75], v222 offset:6144
  s_waitcnt lgkmcnt(2)
  s_add_u32 m0, s89, 36864
  s_add_u32 s88, s90, 0x1805000
  v_mfma_f32_32x32x16_bf16 v[176:191], v[64:67], a[104:107], v[176:191]
  buffer_load_dwordx4 v2, s[36:39], s88 offen sc1 lds
  ds_read_b128 v[76:79], v222 offset:7168
  s_waitcnt lgkmcnt(2)
  v_mfma_f32_32x32x16_bf16 v[192:207], v[68:71], a[104:107], v[192:207]
  ds_read_b128 v[64:67], v222 offset:8192
  s_waitcnt lgkmcnt(2)
  s_add_u32 m0, s89, 40960
  s_add_u32 s88, s90, 0x1805800
  v_mfma_f32_32x32x16_bf16 v[176:191], v[72:75], a[108:111], v[176:191]
  buffer_load_dwordx4 v2, s[36:39], s88 offen sc1 lds
  ds_read_b128 v[68:71], v222 offset:9216
  s_waitcnt lgkmcnt(2)
  s_add_u32 s87, s47, 36864
  v_mfma_f32_32x32x16_bf16 v[192:207], v[76:79], a[108:111], v[192:207]
  buffer_load_dwordx4 a[176:179], v2, s[36:39], s87 offen offset:0 sc1
  ds_read_b128 v[72:75], v222 offset:10240
  s_waitcnt lgkmcnt(2)
  v_mfma_f32_32x32x16_bf16 v[176:191], v[64:67], a[112:115], v[176:191]
  ds_read_b128 v[76:79], v222 offset:11264
  s_waitcnt lgkmcnt(2)
  v_mfma_f32_32x32x16_bf16 v[192:207], v[68:71], a[112:115], v[192:207]
  ds_read_b128 v[64:67], v222 offset:12288
  s_waitcnt lgkmcnt(2)
  v_mfma_f32_32x32x16_bf16 v[176:191], v[72:75], a[116:119], v[176:191]
  ds_read_b128 v[68:71], v222 offset:13312
  s_waitcnt lgkmcnt(2)
  v_mfma_f32_32x32x16_bf16 v[192:207], v[76:79], a[116:119], v[192:207]
  buffer_load_dwordx4 a[180:183], v2, s[36:39], s87 offen offset:1024 sc1
  ds_read_b128 v[72:75], v222 offset:14336
  s_waitcnt lgkmcnt(2)
  v_mfma_f32_32x32x16_bf16 v[176:191], v[64:67], a[120:123], v[176:191]
  ds_read_b128 v[76:79], v222 offset:15360
  s_waitcnt lgkmcnt(2)
  v_mfma_f32_32x32x16_bf16 v[192:207], v[68:71], a[120:123], v[192:207]
  buffer_load_dword v224, v227, s[36:39], s13 offen sc0 sc1
  s_waitcnt lgkmcnt(1)
  v_mfma_f32_32x32x16_bf16 v[176:191], v[72:75], a[124:127], v[176:191]
  s_waitcnt lgkmcnt(0)
  v_mfma_f32_32x32x16_bf16 v[192:207], v[76:79], a[124:127], v[192:207]
  v_mfma_f32_32x32x16_bf16 v[176:191], v[44:47], v[52:55], v[176:191]
  v_mfma_f32_32x32x16_bf16 v[192:207], v[48:51], v[52:55], v[192:207]
  s_nop 10
  v_mul_f32 v176, v176, v58
  v_mul_f32 v177, v177, v58
  v_mul_f32 v178, v178, v58
  v_mul_f32 v179, v179, v58
  v_mul_f32 v180, v180, v58
  v_mul_f32 v181, v181, v58
  v_mul_f32 v182, v182, v58
  v_mul_f32 v183, v183, v58
  v_mul_f32 v176, v176, v184
  v_mul_f32 v177, v177, v185
  v_mul_f32 v178, v178, v186
  v_mul_f32 v179, v179, v187
  v_mul_f32 v180, v180, v188
  v_mul_f32 v181, v181, v189
  v_mul_f32 v182, v182, v190
  v_mul_f32 v183, v183, v191
  v_cvt_pk_bf16_f32 v80, v176, v177
  v_cvt_pk_bf16_f32 v81, v178, v179
  v_cvt_pk_bf16_f32 v82, v180, v181
  v_cvt_pk_bf16_f32 v83, v182, v183
  s_cmp_gt_u32 s54, 4
  s_cselect_b32 s97, 0xf0000000, s76
  buffer_store_dwordx4 v[80:83], v2, s[36:39], s97 offen offset:0 sc1
  v_mul_f32 v192, v192, v58
  v_mul_f32 v193, v193, v58
  v_mul_f32 v194, v194, v58
  v_mul_f32 v195, v195, v58
  v_mul_f32 v196, v196, v58
  v_mul_f32 v197, v197, v58
  v_mul_f32 v198, v198, v58
  v_mul_f32 v199, v199, v58
  v_mul_f32 v192, v192, v200
  v_mul_f32 v193, v193, v201
  v_mul_f32 v194, v194, v202
  v_mul_f32 v195, v195, v203
  v_mul_f32 v196, v196, v204
  v_mul_f32 v197, v197, v205
  v_mul_f32 v198, v198, v206
  v_mul_f32 v199, v199, v207
  v_cvt_pk_bf16_f32 v84, v192, v193
  v_cvt_pk_bf16_f32 v85, v194, v195
  v_cvt_pk_bf16_f32 v86, v196, v197
  v_cvt_pk_bf16_f32 v87, v198, v199
  s_cmp_gt_u32 s54, 5
  s_cselect_b32 s97, 0xf0000000, s76
  buffer_store_dwordx4 v[84:87], v2, s[36:39], s97 offen offset:1024 sc1
  s_mov_b32 s8, 0
  s_waitcnt vmcnt(2)
  s_branch pchk_128
pl_126:
  buffer_load_dword v224, v227, s[36:39], s13 offen sc0 sc1
  s_add_u32 s8, s8, 1
  s_cmp_gt_u32 s8, 0x80000
  s_cbranch_scc1 L_abort
  s_waitcnt vmcnt(0)
pchk_128:
  v_cmp_ne_u32 vcc, 1, v224
  s_nop 3
  s_cbranch_vccnz pl_126
  s_add_u32 s87, s47, 2048
  buffer_load_dwordx4 a[0:3], v2, s[36:39], s87 offen offset:0 sc1
  buffer_load_dwordx4 a[4:7], v2, s[36:39], s87 offen offset:1024 sc1
  s_add_u32 s87, s47, 8192
  buffer_load_dwordx4 a[8:11], v2, s[36:39], s87 offen offset:0 sc1
  buffer_load_dwordx4 a[12:15], v2, s[36:39], s87 offen offset:1024 sc1
  s_add_u32 s87, s47, 14336
  buffer_load_dwordx4 a[16:19], v2, s[36:39], s87 offen offset:0 sc1
  buffer_load_dwordx4 a[20:23], v2, s[36:39], s87 offen offset:1024 sc1
  s_add_u32 s87, s47, 20480
  buffer_load_dwordx4 a[24:27], v2, s[36:39], s87 offen offset:0 sc1
  buffer_load_dwordx4 a[28:31], v2, s[36:39], s87 offen offset:1024 sc1
  s_waitcnt vmcnt(8)
  s_mov_b64 exec, 1
  buffer_store_dword v229, off, s[36:39], s55 sc0 sc1
  s_mov_b64 exec, -1
  s_barrier
  s_cmp_eq_u32 s69, 1
  s_cbranch_scc1 G_dnf
  ds_read_b128 v[96:99], v210 offset:16384
  ds_read_b128 v[100:103], v211 offset:16384
  ds_read_b128 v[104:107], v210 offset:20480
  s_waitcnt lgkmcnt(2)
  s_add_u32 s87, s47, 26624
  v_mfma_f32_32x32x16_bf16 v[112:127], v[96:99], a[128:131], v[112:127]
  buffer_load_dwordx4 a[32:35], v2, s[36:39], s87 offen offset:0 sc1
  ds_read_b128 v[108:111], v211 offset:20480
  s_waitcnt lgkmcnt(2)
  v_mfma_f32_32x32x16_bf16 v[128:143], v[100:103], a[128:131], 0
  ds_read_b128 v[96:99], v210 offset:24576
  s_waitcnt lgkmcnt(2)
  v_mfma_f32_32x32x16_bf16 v[112:127], v[104:107], a[132:135], v[112:127]
  buffer_load_dwordx4 a[36:39], v2, s[36:39], s87 offen offset:1024 sc1
  ds_read_b128 v[100:103], v211 offset:24576
  s_waitcnt lgkmcnt(2)
  v_mfma_f32_32x32x16_bf16 v[128:143], v[108:111], a[132:135], v[128:143]
  ds_read_b128 v[104:107], v210 offset:28672
  s_waitcnt lgkmcnt(2)
  s_add_u32 s87, s47, 32768
  v_mfma_f32_32x32x16_bf16 v[112:127], v[96:99], a[136:139], v[112:127]
  buffer_load_dwordx4 a[40:43], v2, s[36:39], s87 offen offset:0 sc1
  ds_read_b128 v[108:111], v211 offset:28672
  s_waitcnt lgkmcnt(2)
  v_mfma_f32_32x32x16_bf16 v[128:143], v[100:103], a[136:139], v[128:143]
  ds_read_b128 v[96:99], v210 offset:32768
  s_waitcnt lgkmcnt(2)
  v_mfma_f32_32x32x16_bf16 v[112:127], v[104:107], a[140:143], v[112:127]
  buffer_load_dwordx4 a[44:47], v2, s[36:39], s87 offen offset:1024 sc1
  ds_read_b128 v[100:103], v211 offset:32768
  s_waitcnt lgkmcnt(2)
  v_mfma_f32_32x32x16_bf16 v[128:143], v[108:111], a[140:143], v[128:143]
  ds_read_b128 v[104:107], v210 offset:36864
  s_waitcnt lgkmcnt(2)
  s_add_u32 s87, s47, 38912
  v_mfma_f32_32x32x16_bf16 v[112:127], v[96:99], a[144:147], v[112:127]
  buffer_load_dwordx4 a[48:51], v2, s[36:39], s87 offen offset:0 sc1
  ds_read_b128 v[108:111], v211 offset:36864
  s_waitcnt lgkmcnt(2)
  v_mfma_f32_32x32x16_bf16 v[128:143], v[100:103], a[144:147], v[128:143]
  ds_read_b128 v[96:99], v210 offset:40960
  s_waitcnt lgkmcnt(2)
  v_mfma_f32_32x32x16_bf16 v[112:127], v[104:107], a[148:151], v[112:127]
  buffer_load_dwordx4 a[52:55], v2, s[36:39], s87 offen offset:1024 sc1
  ds_read_b128 v[100:103], v211 offset:40960
  s_waitcnt lgkmcnt(2)
  v_mfma_f32_32x32x16_bf16 v[128:143], v[108:111], a[148:151], v[128:143]
  ds_read_b128 v[104:107], v210 offset:45056
  s_waitcnt lgkmcnt(2)
  v_mfma_f32_32x32x16_bf16 v[112:127], v[96:99], a[152:155], v[112:127]
  ds_read_b128 v[108:111], v211 offset:45056
  s_waitcnt lgkmcnt(2)
  s_add_u32 m0, s89, 45056
  s_add_u32 s88, s90, 0x1808000
  v_mfma_f32_32x32x16_bf16 v[128:143], v[100:103], a[152:155], v[128:143]
  buffer_load_dwordx4 v2, s[36:39], s88 offen sc1 lds
  ds_read_b128 v[96:99], v210 offset:49152
  buffer_load_dword v224, v227, s[36:39], s14 offen sc0 sc1
  s_waitcnt lgkmcnt(2)
  v_mfma_f32_32x32x16_bf16 v[112:127], v[104:107], a[156:159], v[112:127]
  ds_read_b128 v[100:103], v211 offset:49152
  s_waitcnt lgkmcnt(2)
  s_add_u32 m0, s89, 49152
  s_add_u32 s88, s90, 0x1808800
  v_mfma_f32_32x32x16_bf16 v[128:143], v[108:111], a[156:159], v[128:143]
  buffer_load_dwordx4 v2, s[36:39], s88 offen sc1 lds
  ds_read_b128 v[104:107], v210 offset:53248
  s_waitcnt lgkmcnt(2)
  v_mfma_f32_32x32x16_bf16 v[112:127], v[96:99], a[160:163], v[112:127]
  ds_read_b128 v[108:111], v211 offset:53248
  s_waitcnt lgkmcnt(2)
  s_add_u32 m0, s89, 53248
  s_add_u32 s88, s90, 0x180b000
  v_mfma_f32_32x32x16_bf16 v[128:143], v[100:103], a[160:163], v[128:143]
  buffer_load_dwordx4 v2, s[36:39], s88 offen sc1 lds
  ds_read_b128 v[96:99], v212 offset:12288
  s_waitcnt lgkmcnt(2)
  v_mfma_f32_32x32x16_bf16 v[112:127], v[104:107], a[164:167], v[112:127]
  ds_read_b128 v[100:103], v213 offset:12288
  s_waitcnt lgkmcnt(2)
  s_add_u32 m0, s89, 57344
  s_add_u32 s88, s90, 0x180b800
  v_mfma_f32_32x32x16_bf16 v[128:143], v[108:111], a[164:167], v[128:143]
  buffer_load_dwordx4 v2, s[36:39], s88 offen sc1 lds
  ds_read_b128 v[104:107], v212 offset:16384
  s_mov_b32 s8, 0
  s_waitcnt vmcnt(3)
  s_branch pchk_131
pl_129:
  buffer_load_dword v224, v227, s[36:39], s14 offen sc0 sc1
  s_add_u32 s8, s8, 1
  s_cmp_gt_u32 s8, 0x80000
  s_cbranch_scc1 L_abort
  s_waitcnt vmcnt(0)
pchk_131:
  v_cmp_ne_u32 vcc, 1, v224
  s_nop 3
  s_cbranch_vccnz pl_129
  s_waitcnt lgkmcnt(2)
  s_add_u32 s87, s47, 4096
  v_mfma_f32_32x32x16_bf16 v[112:127], v[96:99], a[168:171], v[112:127]
  buffer_load_dwordx4 a[56:59], v2, s[36:39], s87 offen offset:0 sc1
  ds_read_b128 v[108:111], v213 offset:16384
  s_waitcnt lgkmcnt(2)
  s_add_u32 m0, s89, 61440
  s_add_u32 s88, s90, 0x180e000
  v_mfma_f32_32x32x16_bf16 v[128:143], v[100:103], a[168:171], v[128:143]
  buffer_load_dwordx4 v2, s[36:39], s88 offen sc1 lds
  ds_read_b128 v[96:99], v212 offset:20480
  s_waitcnt lgkmcnt(2)
  v_mfma_f32_32x32x16_bf16 v[112:127], v[104:107], a[172:175], v[112:127]
  buffer_load_dwordx4 a[60:63], v2, s[36:39], s87 offen offset:1024 sc1
  ds_read_b128 v[100:103], v213 offset:20480
  s_waitcnt lgkmcnt(2)
  s_add_u32 m0, s89, 65536
  s_add_u32 s88, s90, 0x180e800
  v_mfma_f32_32x32x16_bf16 v[128:143], v[108:111], a[172:175], v[128:143]
  buffer_load_dwordx4 v2, s[36:39], s88 offen sc1 lds
  ds_read_b128 v[104:107], v212 offset:24576
  s_barrier
  s_waitcnt lgkmcnt(2)
  s_add_u32 s87, s47, 10240
  v_mfma_f32_32x32x16_bf16 v[112:127], v[96:99], a[176:179], v[112:127]
  buffer_load_dwordx4 a[64:67], v2, s[36:39], s87 offen offset:0 sc1
  ds_read_b128 v[108:111], v213 offset:24576
  s_waitcnt lgkmcnt(2)
  s_add_u32 m0, s89, 69632
  s_add_u32 s88, s90, 0x1811000
  v_mfma_f32_32x32x16_bf16 v[128:143], v[100:103], a[176:179], v[128:143]
  buffer_load_dwordx4 v2, s[36:39], s88 offen sc1 lds
  ds_read_b128 v[96:99], v212 offset:28672
  s_waitcnt lgkmcnt(2)
  v_mfma_f32_32x32x16_bf16 v[112:127], v[104:107], a[180:183], v[112:127]
  buffer_load_dwordx4 a[68:71], v2, s[36:39], s87 offen offset:1024 sc1
  ds_read_b128 v[100:103], v213 offset:28672
  s_waitcnt lgkmcnt(2)
  s_add_u32 m0, s89, 73728
  s_add_u32 s88, s90, 0x1811800
  v_mfma_f32_32x32x16_bf16 v[128:143], v[108:111], a[180:183], v[128:143]
  buffer_load_dwordx4 v2, s[36:39], s88 offen sc1 lds
  ds_read_b128 v[104:107], v212 offset:32768
  s_waitcnt lgkmcnt(2)
  s_add_u32 s87, s47, 16384
  v_mfma_f32_32x32x16_bf16 v[112:127], v[96:99], a[0:3], v[112:127]
  buffer_load_dwordx4 a[72:75], v2, s[36:39], s87 offen offset:0 sc1
  ds_read_b128 v[108:111], v213 offset:32768
  s_waitcnt lgkmcnt(2)
  s_add_u32 m0, s89, 77824
  s_add_u32 s88, s90, 0x1814000
  v_mfma_f32_32x32x16_bf16 v[128:143], v[100:103], a[0:3], v[128:143]
  buffer_load_dwordx4 v2, s[36:39], s88 offen sc1 lds
  ds_read_b128 v[96:99], v212 offset:36864
  s_waitcnt lgkmcnt(2)
  v_mfma_f32_32x32x16_bf16 v[112:127], v[104:107], a[4:7], v[112:127]
  buffer_load_dwordx4 a[76:79], v2, s[36:39], s87 offen offset:1024 sc1
  ds_read_b128 v[100:103], v213 offset:36864
  s_waitcnt lgkmcnt(2)
  s_add_u32 m0, s89, 81920
  s_add_u32 s88, s90, 0x1814800
  v_mfma_f32_32x32x16_bf16 v[128:143], v[108:111], a[4:7], v[128:143]
  buffer_load_dwordx4 v2, s[36:39], s88 offen sc1 lds
  ds_read_b128 v[104:107], v208 offset:0
  s_waitcnt lgkmcnt(2)
  s_add_u32 s87, s47, 22528
  v_mfma_f32_32x32x16_bf16 v[112:127], v[96:99], a[8:11], v[112:127]
  buffer_load_dwordx4 a[80:83], v2, s[36:39], s87 offen offset:0 sc1
  ds_read_b128 v[108:111], v209 offset:0
  s_waitcnt lgkmcnt(2)
  s_lshr_b32 s88, s3, 1
  s_mul_i32 s88, s88, 83968
  s_sub_u32 s90, s90, s88
  s_add_u32 m0, s89, 86016
  s_add_u32 s88, s90, 0x182a000
  v_mfma_f32_32x32x16_bf16 v[128:143], v[100:103], a[8:11], v[128:143]
  buffer_load_dwordx4 v2, s[36:39], s88 offen sc1 lds
  ds_read_b128 v[96:99], v208 offset:4096
  s_waitcnt lgkmcnt(2)
  v_mfma_f32_32x32x16_bf16 v[112:127], v[104:107], a[12:15], v[112:127]
  buffer_load_dwordx4 a[84:87], v2, s[36:39], s87 offen offset:1024 sc1
  ds_read_b128 v[100:103], v209 offset:4096
  s_waitcnt lgkmcnt(2)
  s_lshr_b32 s92, s10, 1
  s_mul_i32 s92, s92, 98304
  s_mul_i32 s93, s3, 3072
  s_add_u32 s92, s92, s93
  s_add_u32 m0, s93, 90112
  v_mfma_f32_32x32x16_bf16 v[128:143], v[108:111], a[12:15], v[128:143]
  buffer_load_dwordx4 v2, s[36:39], s92 offen offset:0 sc1 lds
  ds_read_b128 v[104:107], v208 offset:8192
  s_waitcnt lgkmcnt(2)
  s_add_u32 s87, s47, 28672
  v_mfma_f32_32x32x16_bf16 v[112:127], v[96:99], a[16:19], v[112:127]
  buffer_load_dwordx4 a[88:91], v2, s[36:39], s87 offen offset:0 sc1
  ds_read_b128 v[108:111], v209 offset:8192
  s_waitcnt lgkmcnt(2)
  s_add_u32 m0, s93, 90112
  v_mfma_f32_32x32x16_bf16 v[128:143], v[100:103], a[16:19], v[128:143]
  buffer_load_dwordx4 v2, s[36:39], s92 offen offset:1024 sc1 lds
  ds_read_b128 v[96:99], v208 offset:12288
  s_waitcnt lgkmcnt(2)
  v_mfma_f32_32x32x16_bf16 v[112:127], v[104:107], a[20:23], v[112:127]
  buffer_load_dwordx4 a[92:95], v2, s[36:39], s87 offen offset:1024 sc1
  ds_read_b128 v[100:103], v209 offset:12288
  s_waitcnt lgkmcnt(2)
  s_add_u32 m0, s93, 90112
  v_mfma_f32_32x32x16_bf16 v[128:143], v[108:111], a[20:23], v[128:143]
  buffer_load_dwordx4 v2, s[36:39], s92 offen offset:2048 sc1 lds
  ds_read_b128 v[104:107], v208 offset:16384
  s_add_u32 s92, s92, 12288
  s_barrier
  s_waitcnt lgkmcnt(2)
  s_add_u32 s87, s47, 34816
  v_mfma_f32_32x32x16_bf16 v[112:127], v[96:99], a[24:27], v[112:127]
  buffer_load_dwordx4 a[96:99], v2, s[36:39], s87 offen offset:0 sc1
  ds_read_b128 v[108:111], v209 offset:16384
  s_waitcnt lgkmcnt(2)
  s_add_u32 m0, s93, 135168
  v_mfma_f32_32x32x16_bf16 v[128:143], v[100:103], a[24:27], v[128:143]
  buffer_load_dwordx4 v2, s[36:39], s92 offen offset:0 sc1 lds
  ds_read_b128 v[96:99], v208 offset:20480
  s_waitcnt lgkmcnt(2)
  v_mfma_f32_32x32x16_bf16 v[112:127], v[104:107], a[28:31], v[112:127]
  buffer_load_dwordx4 a[100:103], v2, s[36:39], s87 offen offset:1024 sc1
  ds_read_b128 v[100:103], v209 offset:20480
  s_waitcnt lgkmcnt(2)
  s_add_u32 m0, s93, 135168
  v_mfma_f32_32x32x16_bf16 v[128:143], v[108:111], a[28:31], v[128:143]
  buffer_load_dwordx4 v2, s[36:39], s92 offen offset:1024 sc1 lds
  ds_read_b128 v[104:107], v208 offset:32768
  s_waitcnt lgkmcnt(2)
  s_add_u32 s87, s47, 40960
  v_mfma_f32_32x32x16_bf16 v[112:127], v[96:99], a[32:35], v[112:127]
  buffer_load_dwordx4 a[104:107], v2, s[36:39], s87 offen offset:0 sc1
  ds_read_b128 v[108:111], v209 offset:32768
  s_waitcnt lgkmcnt(2)
  s_add_u32 m0, s93, 135168
  v_mfma_f32_32x32x16_bf16 v[128:143], v[100:103], a[32:35], v[128:143]
  buffer_load_dwordx4 v2, s[36:39], s92 offen offset:2048 sc1 lds
  ds_read_b128 v[96:99], v208 offset:24576
  s_add_u32 s92, s92, 12288
  s_waitcnt lgkmcnt(2)
  v_mfma_f32_32x32x16_bf16 v[112:127], v[104:107], a[36:39], v[112:127]
  buffer_load_dwordx4 a[108:111], v2, s[36:39], s87 offen offset:1024 sc1
  ds_read_b128 v[100:103], v209 offset:24576
  s_waitcnt lgkmcnt(2)
  s_add_u32 m0, s93, 147456
  v_mfma_f32_32x32x16_bf16 v[128:143], v[108:111], a[36:39], v[128:143]
  buffer_load_dwordx4 v2, s[36:39], s92 offen offset:0 sc1 lds
  ds_read_b128 v[104:107], v208 offset:28672
  s_waitcnt lgkmcnt(2)
  s_lshr_b32 s87, s3, 1
  s_mul_i32 s87, s87, 41984
  s_sub_u32 s87, s47, s87
  s_add_u32 s87, s87, 86016
  v_mfma_f32_32x32x16_bf16 v[112:127], v[96:99], a[40:43], v[112:127]
  buffer_load_dwordx4 a[112:115], v2, s[36:39], s87 offen offset:0 sc1
  ds_read_b128 v[108:111], v209 offset:28672
  s_waitcnt lgkmcnt(2)
  s_add_u32 m0, s93, 147456
  v_mfma_f32_32x32x16_bf16 v[128:143], v[100:103], a[40:43], v[128:143]
  buffer_load_dwordx4 v2, s[36:39], s92 offen offset:1024 sc1 lds
  ds_read_b128 v[96:99], v210 offset:57344
  s_waitcnt lgkmcnt(2)
  v_mfma_f32_32x32x16_bf16 v[112:127], v[104:107], a[44:47], v[112:127]
  ds_read_b128 v[100:103], v211 offset:57344
  s_waitcnt lgkmcnt(2)
  s_add_u32 m0, s93, 147456
  v_mfma_f32_32x32x16_bf16 v[128:143], v[108:111], a[44:47], v[128:143]
  buffer_load_dwordx4 v2, s[36:39], s92 offen offset:2048 sc1 lds
  ds_read_b128 v[104:107], v212 offset:0
  s_add_u32 s92, s92, 12288
  s_waitcnt lgkmcnt(2)
  v_mfma_f32_32x32x16_bf16 v[112:127], v[96:99], a[48:51], v[112:127]
  ds_read_b128 v[108:111], v213 offset:0
  s_waitcnt lgkmcnt(2)
  v_mfma_f32_32x32x16_bf16 v[128:143], v[100:103], a[48:51], v[128:143]
  ds_read_b128 v[96:99], v212 offset:4096
  s_waitcnt lgkmcnt(2)
  v_mfma_f32_32x32x16_bf16 v[112:127], v[104:107], a[52:55], v[112:127]
  ds_read_b128 v[100:103], v213 offset:4096
  s_waitcnt lgkmcnt(2)
  v_mfma_f32_32x32x16_bf16 v[128:143], v[108:111], a[52:55], v[128:143]
  ds_read_b128 v[104:107], v212 offset:8192
  s_waitcnt vmcnt(17)
  s_barrier
  s_waitcnt lgkmcnt(2)
  v_mfma_f32_32x32x16_bf16 v[112:127], v[96:99], a[56:59], v[112:127]
  ds_read_b128 v[108:111], v213 offset:8192
  s_waitcnt lgkmcnt(2)
  s_add_u32 m0, s93, 0
  v_mfma_f32_32x32x16_bf16 v[128:143], v[100:103], a[56:59], v[128:143]
  buffer_load_dwordx4 v2, s[36:39], s92 offen offset:0 sc1 lds
  ds_read_b128 v[96:99], v208 offset:36864
  s_waitcnt lgkmcnt(2)
  v_mfma_f32_32x32x16_bf16 v[112:127], v[104:107], a[60:63], v[112:127]
  ds_read_b128 v[100:103], v209 offset:36864
  s_waitcnt lgkmcnt(2)
  s_add_u32 m0, s93, 0
  v_mfma_f32_32x32x16_bf16 v[128:143], v[108:111], a[60:63], v[128:143]
  buffer_load_dwordx4 v2, s[36:39], s92 offen offset:1024 sc1 lds
  ds_read_b128 v[104:107], v208 offset:40960
  s_waitcnt lgkmcnt(2)
  v_mfma_f32_32x32x16_bf16 v[112:127], v[96:99], a[64:67], v[112:127]
  ds_read_b128 v[108:111], v209 offset:40960
  s_waitcnt lgkmcnt(2)
  s_add_u32 m0, s93, 0
  v_mfma_f32_32x32x16_bf16 v[128:143], v[100:103], a[64:67], v[128:143]
  buffer_load_dwordx4 v2, s[36:39], s92 offen offset:2048 sc1 lds
  ds_read_b128 v[96:99], v208 offset:45056
  s_add_u32 s92, s92, 12288
  s_waitcnt lgkmcnt(2)
  v_mfma_f32_32x32x16_bf16 v[112:127], v[104:107], a[68:71], v[112:127]
  ds_read_b128 v[100:103], v209 offset:45056
  s_waitcnt lgkmcnt(2)
  s_add_u32 m0, s93, 12288
  v_mfma_f32_32x32x16_bf16 v[128:143], v[108:111], a[68:71], v[128:143]
  buffer_load_dwordx4 v2, s[36:39], s92 offen offset:0 sc1 lds
  ds_read_b128 v[104:107], v208 offset:49152
  s_waitcnt lgkmcnt(2)
  v_mfma_f32_32x32x16_bf16 v[112:127], v[96:99], a[72:75], v[112:127]
  ds_read_b128 v[108:111], v209 offset:49152
  s_waitcnt lgkmcnt(2)
  s_add_u32 m0, s93, 12288
  v_mfma_f32_32x32x16_bf16 v[128:143], v[100:103], a[72:75], v[128:143]
  buffer_load_dwordx4 v2, s[36:39], s92 offen offset:1024 sc1 lds
  ds_read_b128 v[96:99], v208 offset:53248
  s_waitcnt lgkmcnt(2)
  v_mfma_f32_32x32x16_bf16 v[112:127], v[104:107], a[76:79], v[112:127]
  ds_read_b128 v[100:103], v209 offset:53248
  s_waitcnt lgkmcnt(2)
  s_add_u32 m0, s93, 12288
  v_mfma_f32_32x32x16_bf16 v[128:143], v[108:111], a[76:79], v[128:143]
  buffer_load_dwordx4 v2, s[36:39], s92 offen offset:2048 sc1 lds
  ds_read_b128 v[104:107], v208 offset:57344
  s_add_u32 s92, s92, 12288
  s_waitcnt lgkmcnt(2)
  v_mfma_f32_32x32x16_bf16 v[112:127], v[96:99], a[80:83], v[112:127]
  ds_read_b128 v[108:111], v209 offset:57344
  s_waitcnt lgkmcnt(2)
  s_add_u32 m0, s93, 24576
  v_mfma_f32_32x32x16_bf16 v[128:143], v[100:103], a[80:83], v[128:143]
  buffer_load_dwordx4 v2, s[36:39], s92 offen offset:0 sc1 lds
  ds_read_b128 v[96:99], v210 offset:0
  s_waitcnt vmcnt(23)
  s_waitcnt lgkmcnt(2)
  v_mfma_f32_32x32x16_bf16 v[112:127], v[104:107], a[84:87], v[112:127]
  ds_read_b128 v[100:103], v211 offset:0
  s_waitcnt lgkmcnt(2)
  s_add_u32 m0, s93, 24576
  v_mfma_f32_32x32x16_bf16 v[128:143], v[108:111], a[84:87], v[128:143]
  buffer_load_dwordx4 v2, s[36:39], s92 offen offset:1024 sc1 lds
  ds_read_b128 v[104:107], v210 offset:4096
  s_waitcnt vmcnt(22)
  s_waitcnt lgkmcnt(2)
  v_mfma_f32_32x32x16_bf16 v[112:127], v[96:99], a[88:91], v[112:127]
  ds_read_b128 v[108:111], v211 offset:4096
  s_waitcnt lgkmcnt(2)
  s_add_u32 m0, s93, 24576
  v_mfma_f32_32x32x16_bf16 v[128:143], v[100:103], a[88:91], v[128:143]
  buffer_load_dwordx4 v2, s[36:39], s92 offen offset:2048 sc1 lds
  ds_read_b128 v[96:99], v210 offset:8192
  s_add_u32 s92, s92, 12288
  s_waitcnt vmcnt(21)
  s_waitcnt lgkmcnt(2)
  v_mfma_f32_32x32x16_bf16 v[112:127], v[104:107], a[92:95], v[112:127]
  ds_read_b128 v[100:103], v211 offset:8192
  s_waitcnt lgkmcnt(2)
  v_mfma_f32_32x32x16_bf16 v[128:143], v[108:111], a[92:95], v[128:143]
  ds_read_b128 v[104:107], v210 offset:12288
  s_waitcnt vmcnt(19)
  s_waitcnt lgkmcnt(2)
  v_mfma_f32_32x32x16_bf16 v[112:127], v[96:99], a[96:99], v[112:127]
  ds_read_b128 v[108:111], v211 offset:12288
  s_waitcnt lgkmcnt(2)
  v_mfma_f32_32x32x16_bf16 v[128:143], v[100:103], a[96:99], v[128:143]
  ds_read_b128 v[96:99], v210 offset:16384
  s_waitcnt vmcnt(17)
  s_waitcnt lgkmcnt(2)
  v_mfma_f32_32x32x16_bf16 v[112:127], v[104:107], a[100:103], v[112:127]
  ds_read_b128 v[100:103], v211 offset:16384
  s_waitcnt lgkmcnt(2)
  v_mfma_f32_32x32x16_bf16 v[128:143], v[108:111], a[100:103], v[128:143]
  ds_read_b128 v[104:107], v210 offset:20480
  s_waitcnt vmcnt(15)
  s_waitcnt lgkmcnt(2)
  v_mfma_f32_32x32x16_bf16 v[112:127], v[96:99], a[104:107], v[112:127]
  ds_read_b128 v[108:111], v211 offset:20480
  s_waitcnt lgkmcnt(2)
  v_mfma_f32_32x32x16_bf16 v[128:143], v[100:103], a[104:107], v[128:143]
  ds_read_b128 v[96:99], v210 offset:24576
  s_waitcnt vmcnt(13)
  s_waitcnt lgkmcnt(2)
  v_mfma_f32_32x32x16_bf16 v[112:127], v[104:107], a[108:111], v[112:127]
  ds_read_b128 v[100:103], v211 offset:24576
  s_waitcnt lgkmcnt(2)
  v_mfma_f32_32x32x16_bf16 v[128:143], v[108:111], a[108:111], v[128:143]
  s_waitcnt vmcnt(11)
  s_waitcnt lgkmcnt(1)
  v_mfma_f32_32x32x16_bf16 v[112:127], v[96:99], a[112:115], v[112:127]
  s_waitcnt lgkmcnt(0)
  v_mfma_f32_32x32x16_bf16 v[128:143], v[100:103], a[112:115], v[128:143]
  s_nop 11
  ds_write_b128 v214, v[128:131] offset:0
  ds_write_b128 v214, v[132:135] offset:1024
  ds_write_b128 v214, v[136:139] offset:2048
  ds_write_b128 v214, v[140:143] offset:3072
  s_waitcnt lgkmcnt(0)
  s_barrier
  ds_read_b128 v[128:131], v215 offset:0
  ds_read_b128 v[132:135], v215 offset:1024
  ds_read_b128 v[136:139], v215 offset:2048
  ds_read_b128 v[140:143], v215 offset:3072
  s_add_u32 m0, s93, 36864
  s_nop 0
  buffer_load_dwordx4 v2, s[36:39], s92 offen offset:0 sc1 lds
  s_add_u32 m0, s93, 36864
  s_nop 0
  buffer_load_dwordx4 v2, s[36:39], s92 offen offset:1024 sc1 lds
  s_waitcnt lgkmcnt(3)
  v_pk_add_f32 v[112:113], v[112:113], v[128:129]
  v_pk_add_f32 v[114:115], v[114:115], v[130:131]
  v_cvt_pk_bf16_f32 v248, v112, v113
  v_cvt_pk_bf16_f32 v249, v114, v115
  v_pk_add_f32 v[90:91], v[112:113], v[114:115]
  v_pk_mul_f32 v[92:93], v[112:113], v[112:113]
  v_pk_fma_f32 v[92:93], v[114:115], v[114:115], v[92:93]
  s_waitcnt lgkmcnt(2)
  v_pk_add_f32 v[116:117], v[116:117], v[132:133]
  v_pk_add_f32 v[118:119], v[118:119], v[134:135]
  v_cvt_pk_bf16_f32 v250, v116, v117
  v_cvt_pk_bf16_f32 v251, v118, v119
  buffer_store_dwordx4 v[248:251], v2, s[36:39], s44 offen offset:0 sc1
  v_pk_add_f32 v[90:91], v[90:91], v[116:117]
  v_pk_fma_f32 v[92:93], v[116:117], v[116:117], v[92:93]
  v_pk_add_f32 v[90:91], v[90:91], v[118:119]
  v_pk_fma_f32 v[92:93], v[118:119], v[118:119], v[92:93]
  s_waitcnt lgkmcnt(1)
  v_pk_add_f32 v[120:121], v[120:121], v[136:137]
  v_pk_add_f32 v[122:123], v[122:123], v[138:139]
  v_cvt_pk_bf16_f32 v252, v120, v121
  v_cvt_pk_bf16_f32 v253, v122, v123
  v_pk_add_f32 v[90:91], v[90:91], v[120:121]
  v_pk_fma_f32 v[92:93], v[120:121], v[120:121], v[92:93]
  v_pk_add_f32 v[90:91], v[90:91], v[122:123]
  v_pk_fma_f32 v[92:93], v[122:123], v[122:123], v[92:93]
  s_waitcnt lgkmcnt(0)
  v_pk_add_f32 v[124:125], v[124:125], v[140:141]
  v_pk_add_f32 v[126:127], v[126:127], v[142:143]
  v_cvt_pk_bf16_f32 v254, v124, v125
  v_cvt_pk_bf16_f32 v255, v126, v127
  buffer_store_dwordx4 v[252:255], v2, s[36:39], s44 offen offset:1024 sc1
  v_pk_add_f32 v[90:91], v[90:91], v[124:125]
  v_pk_fma_f32 v[92:93], v[124:125], v[124:125], v[92:93]
  v_pk_add_f32 v[90:91], v[90:91], v[126:127]
  v_pk_fma_f32 v[92:93], v[126:127], v[126:127], v[92:93]
  v_add_f32 v90, v90, v91
  v_add_f32 v91, v92, v93
  v_mov_b32 v92, v90
  v_mov_b32 v93, v91
  s_nop 0
  v_permlane32_swap_b32 v90, v92
  v_permlane32_swap_b32 v91, v93
  s_mov_b32 exec_hi, 0
  v_pk_add_f32 v[90:91], v[90:91], v[92:93]
  buffer_store_dwordx2 v[90:91], v2, s[36:39], s45 offen sc1
  s_mov_b32 exec_hi, -1
  s_add_u32 m0, s93, 36864
  s_nop 0
  buffer_load_dwordx4 v2, s[36:39], s92 offen offset:2048 sc1 lds
  s_add_u32 s92, s92, 12288
  s_add_u32 m0, s93, 49152
  s_nop 0
  buffer_load_dwordx4 v2, s[36:39], s92 offen offset:0 sc1 lds
  s_add_u32 m0, s93, 49152
  s_nop 0
  buffer_load_dwordx4 v2, s[36:39], s92 offen offset:1024 sc1 lds
  s_add_u32 m0, s93, 49152
  s_nop 0
  buffer_load_dwordx4 v2, s[36:39], s92 offen offset:2048 sc1 lds
  s_waitcnt vmcnt(4)
  s_mov_b64 exec, 1
  buffer_store_dword v229, off, s[36:39], s12 sc0 sc1
  s_mov_b64 exec, -1
  s_add_u32 s68, s68, 0x8000
  s_add_u32 s69, s69, 1
  s_add_u32 s96, s57, 0x2000
  s_add_u32 s48, s48, 0x8000
  s_add_u32 s49, s49, 0x8000
  s_add_u32 s50, s50, 0x8000
  s_add_u32 s55, s55, 0x8000
  s_add_u32 s57, s57, 0x8000
  s_branch G_layer
G_dnf:
  ds_read_b128 v[96:99], v210 offset:16384
  ds_read_b128 v[100:103], v211 offset:16384
  ds_read_b128 v[104:107], v210 offset:20480
  s_waitcnt lgkmcnt(2)
  s_add_u32 s87, s47, 26624
  v_mfma_f32_32x32x16_bf16 v[112:127], v[96:99], a[128:131], v[112:127]
  buffer_load_dwordx4 a[32:35], v2, s[36:39], s87 offen offset:0 sc1
  ds_read_b128 v[108:111], v211 offset:20480
  s_waitcnt lgkmcnt(2)
  v_mfma_f32_32x32x16_bf16 v[128:143], v[100:103], a[128:131], 0
  ds_read_b128 v[96:99], v210 offset:24576
  s_waitcnt lgkmcnt(2)
  v_mfma_f32_32x32x16_bf16 v[112:127], v[104:107], a[132:135], v[112:127]
  buffer_load_dwordx4 a[36:39], v2, s[36:39], s87 offen offset:1024 sc1
  ds_read_b128 v[100:103], v211 offset:24576
  s_waitcnt lgkmcnt(2)
  v_mfma_f32_32x32x16_bf16 v[128:143], v[108:111], a[132:135], v[128:143]
  ds_read_b128 v[104:107], v210 offset:28672
  s_waitcnt lgkmcnt(2)
  s_add_u32 s87, s47, 32768
  v_mfma_f32_32x32x16_bf16 v[112:127], v[96:99], a[136:139], v[112:127]
  buffer_load_dwordx4 a[40:43], v2, s[36:39], s87 offen offset:0 sc1
  ds_read_b128 v[108:111], v211 offset:28672
  s_waitcnt lgkmcnt(2)
  v_mfma_f32_32x32x16_bf16 v[128:143], v[100:103], a[136:139], v[128:143]
  ds_read_b128 v[96:99], v210 offset:32768
  s_waitcnt lgkmcnt(2)
  v_mfma_f32_32x32x16_bf16 v[112:127], v[104:107], a[140:143], v[112:127]
  buffer_load_dwordx4 a[44:47], v2, s[36:39], s87 offen offset:1024 sc1
  ds_read_b128 v[100:103], v211 offset:32768
  s_waitcnt lgkmcnt(2)
  v_mfma_f32_32x32x16_bf16 v[128:143], v[108:111], a[140:143], v[128:143]
  ds_read_b128 v[104:107], v210 offset:36864
  s_waitcnt lgkmcnt(2)
  s_add_u32 s87, s47, 38912
  v_mfma_f32_32x32x16_bf16 v[112:127], v[96:99], a[144:147], v[112:127]
  buffer_load_dwordx4 a[48:51], v2, s[36:39], s87 offen offset:0 sc1
  ds_read_b128 v[108:111], v211 offset:36864
  s_waitcnt lgkmcnt(2)
  v_mfma_f32_32x32x16_bf16 v[128:143], v[100:103], a[144:147], v[128:143]
  ds_read_b128 v[96:99], v210 offset:40960
  s_waitcnt lgkmcnt(2)
  v_mfma_f32_32x32x16_bf16 v[112:127], v[104:107], a[148:151], v[112:127]
  buffer_load_dwordx4 a[52:55], v2, s[36:39], s87 offen offset:1024 sc1
  ds_read_b128 v[100:103], v211 offset:40960
  s_waitcnt lgkmcnt(2)
  v_mfma_f32_32x32x16_bf16 v[128:143], v[108:111], a[148:151], v[128:143]
  ds_read_b128 v[104:107], v210 offset:45056
  s_waitcnt lgkmcnt(2)
  v_mfma_f32_32x32x16_bf16 v[112:127], v[96:99], a[152:155], v[112:127]
  ds_read_b128 v[108:111], v211 offset:45056
  s_waitcnt lgkmcnt(2)
  s_add_u32 m0, s89, 45056
  s_add_u32 s88, s90, 0x1808000
  v_mfma_f32_32x32x16_bf16 v[128:143], v[100:103], a[152:155], v[128:143]
  buffer_load_dwordx4 v2, s[36:39], s88 offen sc1 lds
  ds_read_b128 v[96:99], v210 offset:49152
  buffer_load_dword v224, v227, s[36:39], s14 offen sc0 sc1
  s_waitcnt lgkmcnt(2)
  v_mfma_f32_32x32x16_bf16 v[112:127], v[104:107], a[156:159], v[112:127]
  ds_read_b128 v[100:103], v211 offset:49152
  s_waitcnt lgkmcnt(2)
  s_add_u32 m0, s89, 49152
  s_add_u32 s88, s90, 0x1808800
  v_mfma_f32_32x32x16_bf16 v[128:143], v[108:111], a[156:159], v[128:143]
  buffer_load_dwordx4 v2, s[36:39], s88 offen sc1 lds
  ds_read_b128 v[104:107], v210 offset:53248
  s_waitcnt lgkmcnt(2)
  v_mfma_f32_32x32x16_bf16 v[112:127], v[96:99], a[160:163], v[112:127]
  ds_read_b128 v[108:111], v211 offset:53248
  s_waitcnt lgkmcnt(2)
  s_add_u32 m0, s89, 53248
  s_add_u32 s88, s90, 0x180b000
  v_mfma_f32_32x32x16_bf16 v[128:143], v[100:103], a[160:163], v[128:143]
  buffer_load_dwordx4 v2, s[36:39], s88 offen sc1 lds
  ds_read_b128 v[96:99], v212 offset:12288
  s_waitcnt lgkmcnt(2)
  v_mfma_f32_32x32x16_bf16 v[112:127], v[104:107], a[164:167], v[112:127]
  ds_read_b128 v[100:103], v213 offset:12288
  s_waitcnt lgkmcnt(2)
  s_add_u32 m0, s89, 57344
  s_add_u32 s88, s90, 0x180b800
  v_mfma_f32_32x32x16_bf16 v[128:143], v[108:111], a[164:167], v[128:143]
  buffer_load_dwordx4 v2, s[36:39], s88 offen sc1 lds
  ds_read_b128 v[104:107], v212 offset:16384
  s_mov_b32 s8, 0
  s_waitcnt vmcnt(3)
  s_branch pchk_134
pl_132:
  buffer_load_dword v224, v227, s[36:39], s14 offen sc0 sc1
  s_add_u32 s8, s8, 1
  s_cmp_gt_u32 s8, 0x80000
  s_cbranch_scc1 L_abort
  s_waitcnt vmcnt(0)
pchk_134:
  v_cmp_ne_u32 vcc, 1, v224
  s_nop 3
  s_cbranch_vccnz pl_132
  s_waitcnt lgkmcnt(2)
  s_add_u32 s87, s47, 4096
  v_mfma_f32_32x32x16_bf16 v[112:127], v[96:99], a[168:171], v[112:127]
  buffer_load_dwordx4 a[56:59], v2, s[36:39], s87 offen offset:0 sc1
  ds_read_b128 v[108:111], v213 offset:16384
  s_waitcnt lgkmcnt(2)
  s_add_u32 m0, s89, 61440
  s_add_u32 s88, s90, 0x180e000
  v_mfma_f32_32x32x16_bf16 v[128:143], v[100:103], a[168:171], v[128:143]
  buffer_load_dwordx4 v2, s[36:39], s88 offen sc1 lds
  ds_read_b128 v[96:99], v212 offset:20480
  s_waitcnt lgkmcnt(2)
  v_mfma_f32_32x32x16_bf16 v[112:127], v[104:107], a[172:175], v[112:127]
  buffer_load_dwordx4 a[60:63], v2, s[36:39], s87 offen offset:1024 sc1
  ds_read_b128 v[100:103], v213 offset:20480
  s_waitcnt lgkmcnt(2)
  s_add_u32 m0, s89, 65536
  s_add_u32 s88, s90, 0x180e800
  v_mfma_f32_32x32x16_bf16 v[128:143], v[108:111], a[172:175], v[128:143]
  buffer_load_dwordx4 v2, s[36:39], s88 offen sc1 lds
  ds_read_b128 v[104:107], v212 offset:24576
  s_barrier
  s_waitcnt lgkmcnt(2)
  s_add_u32 s87, s47, 10240
  v_mfma_f32_32x32x16_bf16 v[112:127], v[96:99], a[176:179], v[112:127]
  buffer_load_dwordx4 a[64:67], v2, s[36:39], s87 offen offset:0 sc1
  ds_read_b128 v[108:111], v213 offset:24576
  s_waitcnt lgkmcnt(2)
  s_add_u32 m0, s89, 69632
  s_add_u32 s88, s90, 0x1811000
  v_mfma_f32_32x32x16_bf16 v[128:143], v[100:103], a[176:179], v[128:143]
  buffer_load_dwordx4 v2, s[36:39], s88 offen sc1 lds
  ds_read_b128 v[96:99], v212 offset:28672
  s_waitcnt lgkmcnt(2)
  v_mfma_f32_32x32x16_bf16 v[112:127], v[104:107], a[180:183], v[112:127]
  buffer_load_dwordx4 a[68:71], v2, s[36:39], s87 offen offset:1024 sc1
  ds_read_b128 v[100:103], v213 offset:28672
  s_waitcnt lgkmcnt(2)
  s_add_u32 m0, s89, 73728
  s_add_u32 s88, s90, 0x1811800
  v_mfma_f32_32x32x16_bf16 v[128:143], v[108:111], a[180:183], v[128:143]
  buffer_load_dwordx4 v2, s[36:39], s88 offen sc1 lds
  ds_read_b128 v[104:107], v212 offset:32768
  s_waitcnt lgkmcnt(2)
  s_add_u32 s87, s47, 16384
  v_mfma_f32_32x32x16_bf16 v[112:127], v[96:99], a[0:3], v[112:127]
  buffer_load_dwordx4 a[72:75], v2, s[36:39], s87 offen offset:0 sc1
  ds_read_b128 v[108:111], v213 offset:32768
  s_waitcnt lgkmcnt(2)
  s_add_u32 m0, s89, 77824
  s_add_u32 s88, s90, 0x1814000
  v_mfma_f32_32x32x16_bf16 v[128:143], v[100:103], a[0:3], v[128:143]
  buffer_load_dwordx4 v2, s[36:39], s88 offen sc1 lds
  ds_read_b128 v[96:99], v212 offset:36864
  s_waitcnt lgkmcnt(2)
  v_mfma_f32_32x32x16_bf16 v[112:127], v[104:107], a[4:7], v[112:127]
  buffer_load_dwordx4 a[76:79], v2, s[36:39], s87 offen offset:1024 sc1
  ds_read_b128 v[100:103], v213 offset:36864
  s_waitcnt lgkmcnt(2)
  s_add_u32 m0, s89, 81920
  s_add_u32 s88, s90, 0x1814800
  v_mfma_f32_32x32x16_bf16 v[128:143], v[108:111], a[4:7], v[128:143]
  buffer_load_dwordx4 v2, s[36:39], s88 offen sc1 lds
  ds_read_b128 v[104:107], v208 offset:0
  s_waitcnt lgkmcnt(2)
  s_add_u32 s87, s47, 22528
  v_mfma_f32_32x32x16_bf16 v[112:127], v[96:99], a[8:11], v[112:127]
  buffer_load_dwordx4 a[80:83], v2, s[36:39], s87 offen offset:0 sc1
  ds_read_b128 v[108:111], v209 offset:0
  s_waitcnt lgkmcnt(2)
  s_lshr_b32 s88, s3, 1
  s_mul_i32 s88, s88, 83968
  s_sub_u32 s90, s90, s88
  s_add_u32 m0, s89, 86016
  s_add_u32 s88, s90, 0x182a000
  v_mfma_f32_32x32x16_bf16 v[128:143], v[100:103], a[8:11], v[128:143]
  buffer_load_dwordx4 v2, s[36:39], s88 offen sc1 lds
  ds_read_b128 v[96:99], v208 offset:4096
  s_waitcnt lgkmcnt(2)
  v_mfma_f32_32x32x16_bf16 v[112:127], v[104:107], a[12:15], v[112:127]
  buffer_load_dwordx4 a[84:87], v2, s[36:39], s87 offen offset:1024 sc1
  ds_read_b128 v[100:103], v209 offset:4096
  s_waitcnt lgkmcnt(2)
  v_mfma_f32_32x32x16_bf16 v[128:143], v[108:111], a[12:15], v[128:143]
  ds_read_b128 v[104:107], v208 offset:8192
  s_waitcnt lgkmcnt(2)
  s_add_u32 s87, s47, 28672
  v_mfma_f32_32x32x16_bf16 v[112:127], v[96:99], a[16:19], v[112:127]
  buffer_load_dwordx4 a[88:91], v2, s[36:39], s87 offen offset:0 sc1
  ds_read_b128 v[108:111], v209 offset:8192
  s_waitcnt lgkmcnt(2)
  v_mfma_f32_32x32x16_bf16 v[128:143], v[100:103], a[16:19], v[128:143]
  ds_read_b128 v[96:99], v208 offset:12288
  s_waitcnt lgkmcnt(2)
  v_mfma_f32_32x32x16_bf16 v[112:127], v[104:107], a[20:23], v[112:127]
  buffer_load_dwordx4 a[92:95], v2, s[36:39], s87 offen offset:1024 sc1
  ds_read_b128 v[100:103], v209 offset:12288
  s_waitcnt lgkmcnt(2)
  v_mfma_f32_32x32x16_bf16 v[128:143], v[108:111], a[20:23], v[128:143]
  ds_read_b128 v[104:107], v208 offset:16384
  s_waitcnt lgkmcnt(2)
  s_add_u32 s87, s47, 34816
  v_mfma_f32_32x32x16_bf16 v[112:127], v[96:99], a[24:27], v[112:127]
  buffer_load_dwordx4 a[96:99], v2, s[36:39], s87 offen offset:0 sc1
  ds_read_b128 v[108:111], v209 offset:16384
  s_waitcnt lgkmcnt(2)
  v_mfma_f32_32x32x16_bf16 v[128:143], v[100:103], a[24:27], v[128:143]
  ds_read_b128 v[96:99], v208 offset:20480
  s_waitcnt lgkmcnt(2)
  v_mfma_f32_32x32x16_bf16 v[112:127], v[104:107], a[28:31], v[112:127]
  buffer_load_dwordx4 a[100:103], v2, s[36:39], s87 offen offset:1024 sc1
  ds_read_b128 v[100:103], v209 offset:20480
  s_waitcnt lgkmcnt(2)
  v_mfma_f32_32x32x16_bf16 v[128:143], v[108:111], a[28:31], v[128:143]
  ds_read_b128 v[104:107], v208 offset:32768
  s_waitcnt lgkmcnt(2)
  s_add_u32 s87, s47, 40960
  v_mfma_f32_32x32x16_bf16 v[112:127], v[96:99], a[32:35], v[112:127]
  buffer_load_dwordx4 a[104:107], v2, s[36:39], s87 offen offset:0 sc1
  ds_read_b128 v[108:111], v209 offset:32768
  s_waitcnt lgkmcnt(2)
  v_mfma_f32_32x32x16_bf16 v[128:143], v[100:103], a[32:35], v[128:143]
  ds_read_b128 v[96:99], v208 offset:24576
  s_waitcnt lgkmcnt(2)
  v_mfma_f32_32x32x16_bf16 v[112:127], v[104:107], a[36:39], v[112:127]
  buffer_load_dwordx4 a[108:111], v2, s[36:39], s87 offen offset:1024 sc1
  ds_read_b128 v[100:103], v209 offset:24576
  s_waitcnt lgkmcnt(2)
  v_mfma_f32_32x32x16_bf16 v[128:143], v[108:111], a[36:39], v[128:143]
  ds_read_b128 v[104:107], v208 offset:28672
  s_waitcnt lgkmcnt(2)
  s_lshr_b32 s87, s3, 1
  s_mul_i32 s87, s87, 41984
  s_sub_u32 s87, s47, s87
  s_add_u32 s87, s87, 86016
  v_mfma_f32_32x32x16_bf16 v[112:127], v[96:99], a[40:43], v[112:127]
  buffer_load_dwordx4 a[112:115], v2, s[36:39], s87 offen offset:0 sc1
  ds_read_b128 v[108:111], v209 offset:28672
  s_waitcnt lgkmcnt(2)
  v_mfma_f32_32x32x16_bf16 v[128:143], v[100:103], a[40:43], v[128:143]
  ds_read_b128 v[96:99], v210 offset:57344
  s_waitcnt lgkmcnt(2)
  v_mfma_f32_32x32x16_bf16 v[112:127], v[104:107], a[44:47], v[112:127]
  ds_read_b128 v[100:103], v211 offset:57344
  s_waitcnt lgkmcnt(2)
  v_mfma_f32_32x32x16_bf16 v[128:143], v[108:111], a[44:47], v[128:143]
  ds_read_b128 v[104:107], v212 offset:0
  s_waitcnt lgkmcnt(2)
  v_mfma_f32_32x32x16_bf16 v[112:127], v[96:99], a[48:51], v[112:127]
  ds_read_b128 v[108:111], v213 offset:0
  s_waitcnt lgkmcnt(2)
  v_mfma_f32_32x32x16_bf16 v[128:143], v[100:103], a[48:51], v[128:143]
  ds_read_b128 v[96:99], v212 offset:4096
  s_waitcnt lgkmcnt(2)
  v_mfma_f32_32x32x16_bf16 v[112:127], v[104:107], a[52:55], v[112:127]
  ds_read_b128 v[100:103], v213 offset:4096
  s_waitcnt lgkmcnt(2)
  v_mfma_f32_32x32x16_bf16 v[128:143], v[108:111], a[52:55], v[128:143]
  ds_read_b128 v[104:107], v212 offset:8192
  s_waitcnt vmcnt(8)
  s_barrier
  s_waitcnt lgkmcnt(2)
  v_mfma_f32_32x32x16_bf16 v[112:127], v[96:99], a[56:59], v[112:127]
  ds_read_b128 v[108:111], v213 offset:8192
  s_waitcnt lgkmcnt(2)
  v_mfma_f32_32x32x16_bf16 v[128:143], v[100:103], a[56:59], v[128:143]
  ds_read_b128 v[96:99], v208 offset:36864
  s_waitcnt lgkmcnt(2)
  v_mfma_f32_32x32x16_bf16 v[112:127], v[104:107], a[60:63], v[112:127]
  ds_read_b128 v[100:103], v209 offset:36864
  s_waitcnt lgkmcnt(2)
  v_mfma_f32_32x32x16_bf16 v[128:143], v[108:111], a[60:63], v[128:143]
  ds_read_b128 v[104:107], v208 offset:40960
  s_waitcnt lgkmcnt(2)
  v_mfma_f32_32x32x16_bf16 v[112:127], v[96:99], a[64:67], v[112:127]
  ds_read_b128 v[108:111], v209 offset:40960
  s_waitcnt lgkmcnt(2)
  v_mfma_f32_32x32x16_bf16 v[128:143], v[100:103], a[64:67], v[128:143]
  ds_read_b128 v[96:99], v208 offset:45056
  s_waitcnt lgkmcnt(2)
  v_mfma_f32_32x32x16_bf16 v[112:127], v[104:107], a[68:71], v[112:127]
  ds_read_b128 v[100:103], v209 offset:45056
  s_waitcnt lgkmcnt(2)
  v_mfma_f32_32x32x16_bf16 v[128:143], v[108:111], a[68:71], v[128:143]
  ds_read_b128 v[104:107], v208 offset:49152
  s_waitcnt lgkmcnt(2)
  v_mfma_f32_32x32x16_bf16 v[112:127], v[96:99], a[72:75], v[112:127]
  ds_read_b128 v[108:111], v209 offset:49152
  s_waitcnt lgkmcnt(2)
  v_mfma_f32_32x32x16_bf16 v[128:143], v[100:103], a[72:75], v[128:143]
  ds_read_b128 v[96:99], v208 offset:53248
  s_waitcnt lgkmcnt(2)
  v_mfma_f32_32x32x16_bf16 v[112:127], v[104:107], a[76:79], v[112:127]
  ds_read_b128 v[100:103], v209 offset:53248
  s_waitcnt lgkmcnt(2)
  v_mfma_f32_32x32x16_bf16 v[128:143], v[108:111], a[76:79], v[128:143]
  ds_read_b128 v[104:107], v208 offset:57344
  s_waitcnt lgkmcnt(2)
  v_mfma_f32_32x32x16_bf16 v[112:127], v[96:99], a[80:83], v[112:127]
  ds_read_b128 v[108:111], v209 offset:57344
  s_waitcnt lgkmcnt(2)
  v_mfma_f32_32x32x16_bf16 v[128:143], v[100:103], a[80:83], v[128:143]
  ds_read_b128 v[96:99], v210 offset:0
  s_waitcnt vmcnt(7)
  s_waitcnt lgkmcnt(2)
  v_mfma_f32_32x32x16_bf16 v[112:127], v[104:107], a[84:87], v[112:127]
  ds_read_b128 v[100:103], v211 offset:0
  s_waitcnt lgkmcnt(2)
  v_mfma_f32_32x32x16_bf16 v[128:143], v[108:111], a[84:87], v[128:143]
  ds_read_b128 v[104:107], v210 offset:4096
  s_waitcnt vmcnt(6)
  s_waitcnt lgkmcnt(2)
  v_mfma_f32_32x32x16_bf16 v[112:127], v[96:99], a[88:91], v[112:127]
  ds_read_b128 v[108:111], v211 offset:4096
  s_waitcnt lgkmcnt(2)
  v_mfma_f32_32x32x16_bf16 v[128:143], v[100:103], a[88:91], v[128:143]
  ds_read_b128 v[96:99], v210 offset:8192
  s_waitcnt vmcnt(5)
  s_waitcnt lgkmcnt(2)
  v_mfma_f32_32x32x16_bf16 v[112:127], v[104:107], a[92:95], v[112:127]
  ds_read_b128 v[100:103], v211 offset:8192
  s_waitcnt lgkmcnt(2)
  v_mfma_f32_32x32x16_bf16 v[128:143], v[108:111], a[92:95], v[128:143]
  ds_read_b128 v[104:107], v210 offset:12288
  s_waitcnt vmcnt(4)
  s_waitcnt lgkmcnt(2)
  v_mfma_f32_32x32x16_bf16 v[112:127], v[96:99], a[96:99], v[112:127]
  ds_read_b128 v[108:111], v211 offset:12288
  s_waitcnt lgkmcnt(2)
  v_mfma_f32_32x32x16_bf16 v[128:143], v[100:103], a[96:99], v[128:143]
  ds_read_b128 v[96:99], v210 offset:16384
  s_waitcnt vmcnt(3)
  s_waitcnt lgkmcnt(2)
  v_mfma_f32_32x32x16_bf16 v[112:127], v[104:107], a[100:103], v[112:127]
  ds_read_b128 v[100:103], v211 offset:16384
  s_waitcnt lgkmcnt(2)
  v_mfma_f32_32x32x16_bf16 v[128:143], v[108:111], a[100:103], v[128:143]
  ds_read_b128 v[104:107], v210 offset:20480
  s_waitcnt vmcnt(2)
  s_waitcnt lgkmcnt(2)
  v_mfma_f32_32x32x16_bf16 v[112:127], v[96:99], a[104:107], v[112:127]
  ds_read_b128 v[108:111], v211 offset:20480
  s_waitcnt lgkmcnt(2)
  v_mfma_f32_32x32x16_bf16 v[128:143], v[100:103], a[104:107], v[128:143]
  ds_read_b128 v[96:99], v210 offset:24576
  s_waitcnt vmcnt(1)
  s_waitcnt lgkmcnt(2)
  v_mfma_f32_32x32x16_bf16 v[112:127], v[104:107], a[108:111], v[112:127]
  ds_read_b128 v[100:103], v211 offset:24576
  s_waitcnt lgkmcnt(2)
  v_mfma_f32_32x32x16_bf16 v[128:143], v[108:111], a[108:111], v[128:143]
  s_waitcnt vmcnt(0)
  s_waitcnt lgkmcnt(1)
  v_mfma_f32_32x32x16_bf16 v[112:127], v[96:99], a[112:115], v[112:127]
  s_waitcnt lgkmcnt(0)
  v_mfma_f32_32x32x16_bf16 v[128:143], v[100:103], a[112:115], v[128:143]
  s_nop 11
  ds_write_b128 v214, v[128:131] offset:0
  ds_write_b128 v214, v[132:135] offset:1024
  ds_write_b128 v214, v[136:139] offset:2048
  ds_write_b128 v214, v[140:143] offset:3072
  s_waitcnt lgkmcnt(0)
  s_barrier
  ds_read_b128 v[128:131], v215 offset:0
  ds_read_b128 v[132:135], v215 offset:1024
  ds_read_b128 v[136:139], v215 offset:2048
  ds_read_b128 v[140:143], v215 offset:3072
  s_waitcnt lgkmcnt(3)
  v_pk_add_f32 v[112:113], v[112:113], v[128:129]
  v_pk_add_f32 v[114:115], v[114:115], v[130:131]
  v_cvt_pk_bf16_f32 v248, v112, v113
  v_cvt_pk_bf16_f32 v249, v114, v115
  s_waitcnt lgkmcnt(2)
  v_pk_add_f32 v[116:117], v[116:117], v[132:133]
  v_pk_add_f32 v[118:119], v[118:119], v[134:135]
  v_cvt_pk_bf16_f32 v250, v116, v117
  v_cvt_pk_bf16_f32 v251, v118, v119
G_final:
  s_waitcnt lgkmcnt(1)
  v_pk_add_f32 v[120:121], v[120:121], v[136:137]
  v_pk_add_f32 v[122:123], v[122:123], v[138:139]
  v_cvt_pk_bf16_f32 v252, v120, v121
  v_cvt_pk_bf16_f32 v253, v122, v123
  s_waitcnt lgkmcnt(0)
  v_pk_add_f32 v[124:125], v[124:125], v[140:141]
  v_pk_add_f32 v[126:127], v[126:127], v[142:143]
  v_cvt_pk_bf16_f32 v254, v124, v125
  v_cvt_pk_bf16_f32 v255, v126, v127
  s_sub_u32 s86, s44, 0x800000
  s_and_b32 s87, s86, 0xffff8000
  s_bfe_u32 s86, s86, 0x4000b
  s_lshl_b32 s86, s86, 6
  s_add_u32 s87, s87, s86
  v_permlane32_swap_b32 v248, v250
  v_permlane32_swap_b32 v249, v251
  ds_write_b128 v90, v[248:251] offset:0
  v_permlane32_swap_b32 v252, v254
  v_permlane32_swap_b32 v253, v255
  ds_write_b128 v90, v[252:255] offset:32
  ds_read_b128 v[128:131], v91 offset:0
  ds_read_b128 v[132:135], v91 offset:1280
  s_add_u32 s86, s87, 16384
  s_waitcnt lgkmcnt(1)
  buffer_store_dwordx4 v[128:131], v92, s[64:67], s87 offen
  s_waitcnt lgkmcnt(0)
  buffer_store_dwordx4 v[132:135], v92, s[64:67], s86 offen
  s_endpgm
G_aslow:
  v_mov_b32 v136, 0xff800000
  v_mov_b32 v137, 0xff800000
  s_mov_b32 s78, 0
  s_mov_b32 s74, 0
G_aslow_mx:
  buffer_load_dwordx4 v[12:15], v2, s[12:15], s74 offen sc1
  s_add_u32 s74, s74, 2048
  s_waitcnt vmcnt(0)
  v_mfma_f32_32x32x16_bf16 v[40:55], v[12:15], v[4:7], 0
  v_mfma_f32_32x32x16_bf16 v[56:71], v[12:15], v[8:11], 0
  s_nop 15
  v_max3_f32 v136, v40, v41, v136
  v_max3_f32 v136, v42, v43, v136
  v_max3_f32 v136, v44, v45, v136
  v_max3_f32 v136, v46, v47, v136
  v_max3_f32 v136, v48, v49, v136
  v_max3_f32 v136, v50, v51, v136
  v_max3_f32 v136, v52, v53, v136
  v_max3_f32 v136, v54, v55, v136
  v_max3_f32 v137, v56, v57, v137
  v_max3_f32 v137, v58, v59, v137
  v_max3_f32 v137, v60, v61, v137
  v_max3_f32 v137, v62, v63, v137
  v_max3_f32 v137, v64, v65, v137
  v_max3_f32 v137, v66, v67, v137
  v_max3_f32 v137, v68, v69, v137
  v_max3_f32 v137, v70, v71, v137
  s_add_u32 s78, s78, 1
  s_cmp_lt_u32 s78, 64
  s_cbranch_scc1 G_aslow_mx
  v_mov_b32 v138, v136
  s_nop 1
  v_permlane32_swap_b32 v136, v138
  s_nop 0
  v_max_f32 v136, v136, v138
  v_sub_f32 v104, 0, v136
  v_sub_f32 v105, 0, v136
  v_sub_f32 v106, 0, v136
  v_sub_f32 v107, 0, v136
  v_sub_f32 v108, 0, v136
  v_sub_f32 v109, 0, v136
  v_sub_f32 v110, 0, v136
  v_sub_f32 v111, 0, v136
  v_sub_f32 v112, 0, v136
  v_sub_f32 v113, 0, v136
  v_sub_f32 v114, 0, v136
  v_sub_f32 v115, 0, v136
  v_sub_f32 v116, 0, v136
  v_sub_f32 v117, 0, v136
  v_sub_f32 v118, 0, v136
  v_sub_f32 v119, 0, v136
  v_mov_b32 v138, v137
  s_nop 1
  v_permlane32_swap_b32 v137, v138
  s_nop 0
  v_max_f32 v137, v137, v138
  v_sub_f32 v120, 0, v137
  v_sub_f32 v121, 0, v137
  v_sub_f32 v122, 0, v137
  v_sub_f32 v123, 0, v137
  v_sub_f32 v124, 0, v137
  v_sub_f32 v125, 0, v137
  v_sub_f32 v126, 0, v137
  v_sub_f32 v127, 0, v137
  v_sub_f32 v128, 0, v137
  v_sub_f32 v129, 0, v137
  v_sub_f32 v130, 0, v137
  v_sub_f32 v131, 0, v137
  v_sub_f32 v132, 0, v137
  v_sub_f32 v133, 0, v137
  v_sub_f32 v134, 0, v137
  v_sub_f32 v135, 0, v137
  v_mov_b32 v72, 0
  v_mov_b32 v73, 0
  v_mov_b32 v74, 0
  v_mov_b32 v75, 0
  v_mov_b32 v76, 0
  v_mov_b32 v77, 0
  v_mov_b32 v78, 0
  v_mov_b32 v79, 0
  v_mov_b32 v80, 0
  v_mov_b32 v81, 0
  v_mov_b32 v82, 0
  v_mov_b32 v83, 0
  v_mov_b32 v84, 0
  v_mov_b32 v85, 0
  v_mov_b32 v86, 0
  v_mov_b32 v87, 0
  v_mov_b32 v88, 0
  v_mov_b32 v89, 0
  v_mov_b32 v90, 0
  v_mov_b32 v91, 0
  v_mov_b32 v92, 0
  v_mov_b32 v93, 0
  v_mov_b32 v94, 0
  v_mov_b32 v95, 0
  v_mov_b32 v96, 0
  v_mov_b32 v97, 0
  v_mov_b32 v98, 0
  v_mov_b32 v99, 0
  v_mov_b32 v100, 0
  v_mov_b32 v101, 0
  v_mov_b32 v102, 0
  v_mov_b32 v103, 0
  v_mov_b32 v20, 0x3f803f80
  v_mov_b32 v21, 0x3f803f80
  v_mov_b32 v22, 0x3f803f80
  v_mov_b32 v23, 0x3f803f80
  v_mov_b32 v24, 0x3f803f80
  v_mov_b32 v25, 0x3f803f80
  v_mov_b32 v26, 0x3f803f80
  v_mov_b32 v27, 0x3f803f80
  v_and_b32 v138, 0xffff, v239
  s_mov_b32 s78, 0
  s_mov_b32 s74, 0
G_aslow_pv:
  buffer_load_dwordx4 v[12:15], v2, s[12:15], s74 offen sc1
  s_mov_b32 exec_lo, 0xffff
  s_mov_b32 exec_hi, 0xffff
  buffer_load_dwordx4 v[20:23], v138, s[12:15], s74 offen sc1
  buffer_load_dwordx4 v[24:27], v138, s[12:15], s74 offen offset:512 sc1
  s_mov_b64 exec, -1
  s_add_u32 s74, s74, 2048
  s_waitcnt vmcnt(0)
  v_mfma_f32_32x32x16_bf16 v[40:55], v[12:15], v[4:7], v[104:119]
  v_mfma_f32_32x32x16_bf16 v[56:71], v[12:15], v[8:11], v[120:135]
  s_nop 15
  v_exp_f32 v40, v40
  v_exp_f32 v41, v41
  v_exp_f32 v42, v42
  v_exp_f32 v43, v43
  v_exp_f32 v44, v44
  v_exp_f32 v45, v45
  v_exp_f32 v46, v46
  v_exp_f32 v47, v47
  v_exp_f32 v48, v48
  v_exp_f32 v49, v49
  v_exp_f32 v50, v50
  v_exp_f32 v51, v51
  v_exp_f32 v52, v52
  v_exp_f32 v53, v53
  v_exp_f32 v54, v54
  v_exp_f32 v55, v55
  v_exp_f32 v56, v56
  v_exp_f32 v57, v57
  v_exp_f32 v58, v58
  v_exp_f32 v59, v59
  v_exp_f32 v60, v60
  v_exp_f32 v61, v61
  v_exp_f32 v62, v62
  v_exp_f32 v63, v63
  v_exp_f32 v64, v64
  v_exp_f32 v65, v65
  v_exp_f32 v66, v66
  v_exp_f32 v67, v67
  v_exp_f32 v68, v68
  v_exp_f32 v69, v69
  v_exp_f32 v70, v70
  v_exp_f32 v71, v71
  s_nop 1
  v_smfmac_f32_32x32x32_bf16 v[72:87], v[20:23], v[40:47], v36
  v_smfmac_f32_32x32x32_bf16 v[72:87], v[24:27], v[48:55], v36
  v_smfmac_f32_32x32x32_bf16 v[88:103], v[20:23], v[56:63], v36
  v_smfmac_f32_32x32x32_bf16 v[88:103], v[24:27], v[64:71], v36
  s_nop 7
  s_add_u32 s78, s78, 1
  s_cmp_lt_u32 s78, 64
  s_cbranch_scc1 G_aslow_pv
  s_nop 15
  v_rcp_f32 v136, v80
  v_rcp_f32 v137, v96
  s_nop 0
  s_branch G_afin
.section .rodata,"a"
.p2align 6
.amdhsa_kernel interleave_layers__mha_block__glu_gated_bilinear__prompt_kernel
  .amdhsa_next_free_vgpr 512
  .amdhsa_next_free_sgpr 102
  .amdhsa_accum_offset 256
  .amdhsa_group_segment_fixed_size 0
  .amdhsa_kernarg_size 80
  .amdhsa_user_sgpr_count 2
  .amdhsa_user_sgpr_kernarg_segment_ptr 1
  .amdhsa_system_sgpr_workgroup_id_x 1
.end_amdhsa_kernel
```
